```python
import torch

def _softmax(x, axis=-1):
    return torch.softmax(x, dim=axis)

def _gelu(x):
    return torch.nn.functional.gelu(x, approximate='tanh')

def _silu(x):
    return torch.nn.functional.silu(x)

def _sigmoid(x):
    return torch.sigmoid(x)

def _layernorm(x, axis=-1, eps=1e-05):
    m = x.mean(dim=axis, keepdim=True)
    v = x.var(dim=axis, keepdim=True, unbiased=False)
    return (x - m) / torch.sqrt(v + eps)

def _scatter_add(tgt, idx, src, axis=0):
    return tgt.clone().index_add_(axis, idx, src)

def _segment_sum(src, seg, n):
    out = torch.zeros((n,) + src.shape[1:], dtype=src.dtype)
    return out.index_add_(0, seg, src)

def _pad(x, pw):
    flat = tuple((v for pair in reversed(pw) for v in pair))
    return torch.nn.functional.pad(x, flat)
kernel_name = 'sequential_preLN__memory_aug_recurrent_mem_tr__dense_activation_relu__prompt'

def setup_inputs():

    _w = lambda a: (lambda t: t.to(torch.bfloat16) if t.is_floating_point() else t)(torch.as_tensor(a))

    def _A_setup():
        B, S, Dm = (1, 2048, 448)
        H, Dh = (16, 256)
        M, seg = (8, 32)
        seg = min(seg, S)
        S = S // seg * seg
        return {'x': _w((lambda *s: torch.randn(*s, dtype=torch.bfloat16) * 0.05)(B, S, Dm)), 'mem0': _w((lambda *s: torch.randn(*s, dtype=torch.bfloat16) * 0.2)(B, M, Dm)), 'Wq': _w((lambda *s: torch.randn(*s, dtype=torch.bfloat16) * 1.6)(Dm, H, Dh) * Dm ** (-0.5)), 'Wk': _w((lambda *s: torch.randn(*s, dtype=torch.bfloat16) * 1.6)(Dm, H, Dh) * Dm ** (-0.5)), 'Wv': _w((lambda *s: torch.randn(*s, dtype=torch.bfloat16) * 0.2)(Dm, H, Dh) * Dm ** (-0.5)), 'Wo': _w((lambda *s: torch.randn(*s, dtype=torch.bfloat16) * 0.2)(H, Dh, Dm) * (H * Dh) ** (-0.5)), 'seg_len': seg}
    _A_in = _A_setup()

    def _B_setup():
        B, S, D, Dff = (1, 2048, 448, 1792)
        return {'x': _w((lambda *s: torch.randn(*s, dtype=torch.bfloat16) * 0.05)(B, S, D)), 'w1': _w((lambda *s: torch.randn(*s, dtype=torch.bfloat16) * 0.05)(D, Dff)), 'w2': _w((lambda *s: torch.randn(*s, dtype=torch.bfloat16) * 0.05)(Dff, D))}
    _B_in = _B_setup()
    return {'A_x': _A_in['x'], 'A_mem0': _A_in['mem0'], 'A_Wq': _A_in['Wq'], 'A_Wk': _A_in['Wk'], 'A_Wv': _A_in['Wv'], 'A_Wo': _A_in['Wo'], 'A_seg_len': _A_in['seg_len'], 'B_x': _B_in['x'], 'B_w1': _B_in['w1'], 'B_w2': _B_in['w2']}

def reference(A_x, A_mem0, A_Wq, A_Wk, A_Wv, A_Wo, A_seg_len, B_x, B_w1, B_w2):

    def _A_ref(x, mem0, Wq, Wk, Wv, Wo, seg_len):
        B, S, Dm = x.shape
        H, Dh = (Wq.shape[1], Wq.shape[2])
        M = mem0.shape[1]
        scale = Dh ** (-0.5)
        n_seg = S // seg_len
        L = M + seg_len
        idx = torch.arange(L)
        mask = (idx[:, None] < M) | (idx[:, None] >= idx[None, :])
        mem = mem0
        outs = []
        for s in range(n_seg):
            xs = x[:, s * seg_len:(s + 1) * seg_len, :].clone()
            h = torch.concatenate([mem, xs], axis=1)
            q = torch.einsum('btd,dhe->bhte', h, Wq)
            k = torch.einsum('btd,dhe->bhte', h, Wk)
            v = torch.einsum('btd,dhe->bhte', h, Wv)
            scores = torch.einsum('bhqe,bhke->bhqk', q, k) * scale
            scores = torch.where(mask[None, None], scores, -1000000000.0)
            p = _softmax(scores, axis=-1)
            o = torch.einsum('bhqk,bhke->bhqe', p, v)
            o = torch.einsum('bhte,hed->btd', o, Wo)
            mem = o[:, :M, :].clone()
            outs.append(o[:, M:, :])
        return torch.concatenate(outs, axis=1)

    def _B_ref(x, w1, w2):
        h = torch.einsum('bsd,df->bsf', x, w1)
        zero = torch.zeros_like(h)
        h = torch.maximum(h, zero)
        return torch.einsum('bsf,fd->bsd', h, w2)
    x = A_x
    h = x + _A_ref(_layernorm(x, axis=-1), A_mem0, A_Wq, A_Wk, A_Wv, A_Wo, A_seg_len)
    h2 = h + _B_ref(_layernorm(h, axis=-1), B_w1, B_w2)
    return h2
```

```asm
; @launch kernel=sequential_preLN__memory_aug_recurrent_mem_tr__dense_activation_relu__prompt_kernel grid=(256,1,1) block=(256,1,1) lds=126976
.amdgcn_target "amdgcn-amd-amdhsa--gfx950"
.text
.globl sequential_preLN__memory_aug_recurrent_mem_tr__dense_activation_relu__prompt_kernel
.p2align 8
.type sequential_preLN__memory_aug_recurrent_mem_tr__dense_activation_relu__prompt_kernel,@function
sequential_preLN__memory_aug_recurrent_mem_tr__dense_activation_relu__prompt_kernel:
    s_cmp_ge_u32 s2, 256
    s_cbranch_scc1 M_exit2
    s_load_dwordx2 s[4:5], s[0:1], 96
    s_load_dwordx2 s[64:65], s[0:1], 0
    s_load_dwordx2 s[66:67], s[0:1], 64
    s_load_dwordx2 s[68:69], s[0:1], 72
    s_load_dwordx2 s[70:71], s[0:1], 80
    s_mov_b32 s6, 0x10000000
    s_mov_b32 s7, 0x00020000
    v_lshrrev_b32 v1, 6, v0
    v_and_b32 v0, 63, v0
    v_readfirstlane_b32 s10, v1
    s_load_dwordx4 s[12:15], s[0:1], 0
    s_load_dwordx8 s[16:23], s[0:1], 16
    s_load_dwordx2 s[84:85], s[0:1], 88
    s_getpc_b64 s[24:25]
M_pc:
    s_mov_b32 s26, M_end - M_pc
    s_mov_b32 s27, 0x00020000
    s_lshr_b32 s28, s2, 3
    s_lshl_b32 s28, s28, 2
    s_add_u32 s28, s28, s10
    s_lshl_b32 s28, s28, 10
    v_lshlrev_b32 v2, 7, v0
    s_mov_b64 exec, 0xff
    buffer_load_dword v255, v2, s[24:27], s28 offen
    s_mov_b64 exec, -1
    s_waitcnt lgkmcnt(0)
    s_mov_b32 s86, 0x100
    s_mov_b32 s87, 0x00020000
    v_mov_b32 v7, 0
    s_or_b32 s24, s2, s10
    s_cmp_lg_u32 s24, 0
    s_cbranch_scc1 P_nononce
    s_memrealtime s[24:25]
    s_waitcnt lgkmcnt(0)
    s_lshl_b32 s25, s25, 4
    s_or_b32 s25, s25, 0x80000000
    v_mov_b32 v2, s24
    v_mov_b32 v3, s25
    s_mov_b64 exec, 1
    buffer_store_dwordx2 v[2:3], v7, s[84:87], 0 offen sc1
    s_mov_b64 exec, -1
P_nononce:
    s_cmp_lg_u32 s10, 3
    s_cbranch_scc1 P_nox
    s_setprio 3
    s_mov_b32 s56, s12
    s_mov_b32 s57, s13
    s_mov_b32 s58, 0x1c0000
    s_mov_b32 s59, 0x00020000
    v_lshrrev_b32 v8, 3, v0
    v_and_b32 v9, 7, v0
    v_mul_u32_u24 v10, 896, v8
    v_lshrrev_b32 v11, 2, v9
    v_and_b32 v12, 3, v9
    v_lshl_add_u32 v10, v11, 6, v10
    v_lshl_add_u32 v10, v12, 3, v10
    s_mul_i32 s24, s2, 7168
    buffer_load_dwordx2 v[152:153], v10, s[56:59], s24 offen offset:0
    buffer_load_dwordx2 v[154:155], v10, s[56:59], s24 offen offset:32
    buffer_load_dwordx2 v[156:157], v10, s[56:59], s24 offen offset:128
    buffer_load_dwordx2 v[158:159], v10, s[56:59], s24 offen offset:160
    buffer_load_dwordx2 v[160:161], v10, s[56:59], s24 offen offset:256
    buffer_load_dwordx2 v[162:163], v10, s[56:59], s24 offen offset:288
    buffer_load_dwordx2 v[164:165], v10, s[56:59], s24 offen offset:384
    buffer_load_dwordx2 v[166:167], v10, s[56:59], s24 offen offset:416
    buffer_load_dwordx2 v[168:169], v10, s[56:59], s24 offen offset:512
    buffer_load_dwordx2 v[170:171], v10, s[56:59], s24 offen offset:544
    buffer_load_dwordx2 v[172:173], v10, s[56:59], s24 offen offset:640
    buffer_load_dwordx2 v[174:175], v10, s[56:59], s24 offen offset:672
    buffer_load_dwordx2 v[176:177], v10, s[56:59], s24 offen offset:768
    buffer_load_dwordx2 v[178:179], v10, s[56:59], s24 offen offset:800
P_nox:
    s_and_b32 s24, s2, 7
    s_lshr_b32 s25, s2, 3
    s_lshl_b32 s24, s24, 2
    s_lshr_b32 s26, s25, 3
    s_add_u32 s24, s24, s26
    s_lshl_b32 s50, s24, 3
    s_and_b32 s26, s25, 7
    s_add_u32 s50, s50, s26
    s_lshr_b32 s27, s24, 4
    s_and_b32 s28, s24, 15
    s_bfe_u32 s29, s25, 0x10002
    s_and_b32 s30, s25, 3
    s_mul_i32 s31, s29, 7
    s_lshl_b32 s26, s10, 1
    s_add_u32 s31, s31, s26
    s_mul_i32 s32, s30, 7
    v_lshrrev_b32 v1, 3, v0
    v_lshrrev_b32 v2, 4, v0
    v_and_b32 v15, 7, v0
    v_xor_b32 v15, v15, v2
    v_lshlrev_b32 v3, 13, v1
    v_lshl_add_u32 v3, v15, 4, v3
    v_xor_b32 v4, 64, v3
    v_add_u32 v4, 0x10000, v4
    v_bfe_u32 v1, v0, 1, 3
    v_xor_b32 v1, v1, v2
    v_lshlrev_b32 v13, 4, v1
    v_and_b32 v1, 15, v0
    v_lshl_add_u32 v13, v1, 7, v13
    v_xor_b32 v14, 64, v13
    v_lshlrev_b32 v5, 4, v0
    s_cmp_eq_u32 s27, 1
    s_cselect_b32 s36, s20, s16
    s_cselect_b32 s37, s21, s17
    s_cselect_b32 s40, s22, s18
    s_cselect_b32 s41, s23, s19
    s_mov_b32 s38, 3670016
    s_mov_b32 s39, 0x00020000
    s_mov_b32 s42, 3670016
    s_mov_b32 s43, 0x00020000
    s_lshl_b32 s34, s28, 9
    s_lshl_b32 s35, s31, 18
    s_add_u32 s52, s35, s34
    s_lshl_b32 s53, s10, 14
    s_add_u32 s53, s53, 57344
    v_add_u32 v1, s53, v13
    v_add_u32 v2, s53, v14
    s_add_u32 m0, s53, 0
    s_add_u32 s45, s52, 0
    buffer_load_dwordx4 v3, s[36:39], s45 offen nt lds
    s_add_u32 m0, s53, 1024
    s_add_u32 s45, s52, 0
    buffer_load_dwordx4 v4, s[36:39], s45 offen nt lds
    s_add_u32 m0, s53, 2048
    s_add_u32 s45, s52, 128
    buffer_load_dwordx4 v3, s[36:39], s45 offen nt lds
    s_add_u32 m0, s53, 3072
    s_add_u32 s45, s52, 128
    buffer_load_dwordx4 v4, s[36:39], s45 offen nt lds
    s_add_u32 m0, s53, 4096
    s_add_u32 s45, s52, 256
    buffer_load_dwordx4 v3, s[36:39], s45 offen nt lds
    s_add_u32 m0, s53, 5120
    s_add_u32 s45, s52, 256
    buffer_load_dwordx4 v4, s[36:39], s45 offen nt lds
    s_add_u32 m0, s53, 6144
    s_add_u32 s45, s52, 384
    buffer_load_dwordx4 v3, s[36:39], s45 offen nt lds
    s_add_u32 m0, s53, 7168
    s_add_u32 s45, s52, 384
    buffer_load_dwordx4 v4, s[36:39], s45 offen nt lds
    s_add_u32 m0, s53, 8192
    s_add_u32 s45, s52, 131072
    buffer_load_dwordx4 v3, s[36:39], s45 offen nt lds
    s_add_u32 m0, s53, 9216
    s_add_u32 s45, s52, 131072
    buffer_load_dwordx4 v4, s[36:39], s45 offen nt lds
    s_add_u32 m0, s53, 10240
    s_add_u32 s45, s52, 131200
    buffer_load_dwordx4 v3, s[36:39], s45 offen nt lds
    s_add_u32 m0, s53, 11264
    s_add_u32 s45, s52, 131200
    buffer_load_dwordx4 v4, s[36:39], s45 offen nt lds
    s_add_u32 m0, s53, 12288
    s_add_u32 s45, s52, 131328
    buffer_load_dwordx4 v3, s[36:39], s45 offen nt lds
    s_add_u32 m0, s53, 13312
    s_add_u32 s45, s52, 131328
    buffer_load_dwordx4 v4, s[36:39], s45 offen nt lds
    s_add_u32 m0, s53, 14336
    s_add_u32 s45, s52, 131456
    buffer_load_dwordx4 v3, s[36:39], s45 offen nt lds
    s_add_u32 m0, s53, 15360
    s_add_u32 s45, s52, 131456
    buffer_load_dwordx4 v4, s[36:39], s45 offen nt lds
    s_cmp_eq_u32 s27, 1
    s_cbranch_scc1 P_matB
    s_lshl_b32 s44, s10, 11
    s_lshl_b32 s35, s32, 17
    s_add_u32 s35, s35, s34
    s_lshl_b32 s45, s10, 7
    s_add_u32 s35, s35, s45
    s_add_u32 m0, s44, 0
    s_add_u32 s45, s35, 0
    buffer_load_dwordx4 v3, s[40:43], s45 offen nt lds
    s_add_u32 m0, s44, 1024
    s_add_u32 s45, s35, 0
    buffer_load_dwordx4 v4, s[40:43], s45 offen nt lds
    s_add_u32 m0, s44, 8192
    s_add_u32 s45, s35, 131072
    buffer_load_dwordx4 v3, s[40:43], s45 offen nt lds
    s_add_u32 m0, s44, 9216
    s_add_u32 s45, s35, 131072
    buffer_load_dwordx4 v4, s[40:43], s45 offen nt lds
    s_add_u32 m0, s44, 16384
    s_add_u32 s45, s35, 262144
    buffer_load_dwordx4 v3, s[40:43], s45 offen nt lds
    s_add_u32 m0, s44, 17408
    s_add_u32 s45, s35, 262144
    buffer_load_dwordx4 v4, s[40:43], s45 offen nt lds
    s_add_u32 m0, s44, 24576
    s_add_u32 s45, s35, 393216
    buffer_load_dwordx4 v3, s[40:43], s45 offen nt lds
    s_add_u32 m0, s44, 25600
    s_add_u32 s45, s35, 393216
    buffer_load_dwordx4 v4, s[40:43], s45 offen nt lds
    s_add_u32 m0, s44, 32768
    s_add_u32 s45, s35, 524288
    buffer_load_dwordx4 v3, s[40:43], s45 offen nt lds
    s_add_u32 m0, s44, 33792
    s_add_u32 s45, s35, 524288
    buffer_load_dwordx4 v4, s[40:43], s45 offen nt lds
    s_add_u32 m0, s44, 40960
    s_add_u32 s45, s35, 655360
    buffer_load_dwordx4 v3, s[40:43], s45 offen nt lds
    s_add_u32 m0, s44, 41984
    s_add_u32 s45, s35, 655360
    buffer_load_dwordx4 v4, s[40:43], s45 offen nt lds
    s_add_u32 m0, s44, 49152
    s_add_u32 s45, s35, 786432
    buffer_load_dwordx4 v3, s[40:43], s45 offen nt lds
    s_add_u32 m0, s44, 50176
    s_add_u32 s45, s35, 786432
    buffer_load_dwordx4 v4, s[40:43], s45 offen nt lds
    s_mov_b32 s46, 0x3db8aa3b
    s_mul_i32 s47, s28, 401408
    s_mul_i32 s48, s32, 14336
    s_add_u32 s47, s47, s48
    s_add_u32 s47, s47, 0x200000
    s_mov_b32 s48, 14336
    s_branch P_comp
P_matB:
    v_add_u32 v15, 0, v0
    v_mul_u32_u24 v9, 4682, v15
    v_lshrrev_b32 v9, 16, v9
    v_mul_u32_u24 v240, 14, v9
    v_sub_u32 v15, v15, v240
    v_bfe_u32 v240, v9, 2, 2
    v_lshlrev_b32 v240, 3, v240
    v_lshrrev_b32 v6, 4, v9
    v_lshl_add_u32 v240, v6, 2, v240
    v_and_b32 v9, 3, v9
    v_add_u32 v240, v240, v9
    v_mul_u32_u24 v240, 896, v240
    v_lshl_add_u32 v240, v15, 4, v240
    v_add_u32 v15, 64, v0
    v_mul_u32_u24 v9, 4682, v15
    v_lshrrev_b32 v9, 16, v9
    v_mul_u32_u24 v241, 14, v9
    v_sub_u32 v15, v15, v241
    v_bfe_u32 v241, v9, 2, 2
    v_lshlrev_b32 v241, 3, v241
    v_lshrrev_b32 v6, 4, v9
    v_lshl_add_u32 v241, v6, 2, v241
    v_and_b32 v9, 3, v9
    v_add_u32 v241, v241, v9
    v_mul_u32_u24 v241, 896, v241
    v_lshl_add_u32 v241, v15, 4, v241
    v_add_u32 v15, 128, v0
    v_mul_u32_u24 v9, 4682, v15
    v_lshrrev_b32 v9, 16, v9
    v_mul_u32_u24 v242, 14, v9
    v_sub_u32 v15, v15, v242
    v_bfe_u32 v242, v9, 2, 2
    v_lshlrev_b32 v242, 3, v242
    v_lshrrev_b32 v6, 4, v9
    v_lshl_add_u32 v242, v6, 2, v242
    v_and_b32 v9, 3, v9
    v_add_u32 v242, v242, v9
    v_mul_u32_u24 v242, 896, v242
    v_lshl_add_u32 v242, v15, 4, v242
    v_add_u32 v15, 192, v0
    v_mul_u32_u24 v9, 4682, v15
    v_lshrrev_b32 v9, 16, v9
    v_mul_u32_u24 v243, 14, v9
    v_sub_u32 v15, v15, v243
    v_bfe_u32 v243, v9, 2, 2
    v_lshlrev_b32 v243, 3, v243
    v_lshrrev_b32 v6, 4, v9
    v_lshl_add_u32 v243, v6, 2, v243
    v_and_b32 v9, 3, v9
    v_add_u32 v243, v243, v9
    v_mul_u32_u24 v243, 896, v243
    v_lshl_add_u32 v243, v15, 4, v243
    v_add_u32 v15, 256, v0
    v_mul_u32_u24 v9, 4682, v15
    v_lshrrev_b32 v9, 16, v9
    v_mul_u32_u24 v244, 14, v9
    v_sub_u32 v15, v15, v244
    v_bfe_u32 v244, v9, 2, 2
    v_lshlrev_b32 v244, 3, v244
    v_lshrrev_b32 v6, 4, v9
    v_lshl_add_u32 v244, v6, 2, v244
    v_and_b32 v9, 3, v9
    v_add_u32 v244, v244, v9
    v_mul_u32_u24 v244, 896, v244
    v_lshl_add_u32 v244, v15, 4, v244
    v_add_u32 v15, 320, v0
    v_mul_u32_u24 v9, 4682, v15
    v_lshrrev_b32 v9, 16, v9
    v_mul_u32_u24 v245, 14, v9
    v_sub_u32 v15, v15, v245
    v_bfe_u32 v245, v9, 2, 2
    v_lshlrev_b32 v245, 3, v245
    v_lshrrev_b32 v6, 4, v9
    v_lshl_add_u32 v245, v6, 2, v245
    v_and_b32 v9, 3, v9
    v_add_u32 v245, v245, v9
    v_mul_u32_u24 v245, 896, v245
    v_lshl_add_u32 v245, v15, 4, v245
    v_add_u32 v15, 384, v0
    v_mul_u32_u24 v9, 4682, v15
    v_lshrrev_b32 v9, 16, v9
    v_mul_u32_u24 v246, 14, v9
    v_sub_u32 v15, v15, v246
    v_bfe_u32 v246, v9, 2, 2
    v_lshlrev_b32 v246, 3, v246
    v_lshrrev_b32 v6, 4, v9
    v_lshl_add_u32 v246, v6, 2, v246
    v_and_b32 v9, 3, v9
    v_add_u32 v246, v246, v9
    v_mul_u32_u24 v246, 896, v246
    v_lshl_add_u32 v246, v15, 4, v246
    s_mul_i32 s35, s28, 229376
    s_lshl_b32 s45, s32, 5
    s_add_u32 s35, s35, s45
    s_mul_i32 s45, s10, 57344
    s_add_u32 s35, s35, s45
    s_add_u32 s45, s35, 28672
    s_mul_i32 s44, s10, 14336
    s_add_u32 m0, s44, 0
    s_nop 0
    buffer_load_dwordx4 v240, s[40:43], s35 offen nt lds
    s_add_u32 m0, s44, 1024
    s_nop 0
    buffer_load_dwordx4 v241, s[40:43], s35 offen nt lds
    s_add_u32 m0, s44, 2048
    s_nop 0
    buffer_load_dwordx4 v242, s[40:43], s35 offen nt lds
    s_add_u32 m0, s44, 3072
    s_nop 0
    buffer_load_dwordx4 v243, s[40:43], s35 offen nt lds
    s_add_u32 m0, s44, 4096
    s_nop 0
    buffer_load_dwordx4 v244, s[40:43], s35 offen nt lds
    s_add_u32 m0, s44, 5120
    s_nop 0
    buffer_load_dwordx4 v245, s[40:43], s35 offen nt lds
    s_add_u32 m0, s44, 6144
    s_nop 0
    buffer_load_dwordx4 v246, s[40:43], s35 offen nt lds
    s_add_u32 m0, s44, 7168
    s_nop 0
    buffer_load_dwordx4 v240, s[40:43], s45 offen nt lds
    s_add_u32 m0, s44, 8192
    s_nop 0
    buffer_load_dwordx4 v241, s[40:43], s45 offen nt lds
    s_add_u32 m0, s44, 9216
    s_nop 0
    buffer_load_dwordx4 v242, s[40:43], s45 offen nt lds
    s_add_u32 m0, s44, 10240
    s_nop 0
    buffer_load_dwordx4 v243, s[40:43], s45 offen nt lds
    s_add_u32 m0, s44, 11264
    s_nop 0
    buffer_load_dwordx4 v244, s[40:43], s45 offen nt lds
    s_add_u32 m0, s44, 12288
    s_nop 0
    buffer_load_dwordx4 v245, s[40:43], s45 offen nt lds
    s_add_u32 m0, s44, 13312
    s_nop 0
    buffer_load_dwordx4 v246, s[40:43], s45 offen nt lds
    v_lshrrev_b32 v15, 2, v0
    v_mul_u32_u24 v6, 224, v15
    v_and_b32 v15, 3, v0
    v_lshl_add_u32 v6, v15, 3, v6
    s_mov_b32 s46, 1.0
    s_mul_i32 s47, s32, 229376
    s_mul_i32 s48, s28, 14336
    s_add_u32 s47, s47, s48
    s_add_u32 s47, s47, 0x900000
    s_mov_b32 s48, 229376
P_comp:
    s_lshl_b32 s49, s31, 10
    s_add_u32 s47, s47, s49
    s_cmp_eq_u32 s10, 3
    s_cbranch_scc1 P_w3
    s_waitcnt vmcnt(14)
    ds_read_b128 a[0:3], v1 offset:0
    ds_read_b128 a[4:7], v1 offset:8192
    ds_read_b128 a[8:11], v2 offset:0
    ds_read_b128 a[12:15], v2 offset:8192
    ds_read_b128 a[16:19], v1 offset:2048
    ds_read_b128 a[20:23], v1 offset:10240
    ds_read_b128 a[24:27], v2 offset:2048
    ds_read_b128 a[28:31], v2 offset:10240
    s_waitcnt lgkmcnt(4)
    ds_read_b128 a[32:35], v1 offset:4096
    ds_read_b128 a[36:39], v1 offset:12288
    ds_read_b128 a[40:43], v2 offset:4096
    ds_read_b128 a[44:47], v2 offset:12288
    ds_read_b128 a[48:51], v1 offset:6144
    ds_read_b128 a[52:55], v1 offset:14336
    ds_read_b128 a[56:59], v2 offset:6144
    ds_read_b128 a[60:63], v2 offset:14336
    s_waitcnt lgkmcnt(0)
    s_add_u32 m0, s53, 0
    s_add_u32 s45, s52, 262144
    buffer_load_dwordx4 v3, s[36:39], s45 offen nt lds
    s_add_u32 m0, s53, 1024
    s_add_u32 s45, s52, 262144
    buffer_load_dwordx4 v4, s[36:39], s45 offen nt lds
    s_add_u32 m0, s53, 2048
    s_add_u32 s45, s52, 262272
    buffer_load_dwordx4 v3, s[36:39], s45 offen nt lds
    s_add_u32 m0, s53, 3072
    s_add_u32 s45, s52, 262272
    buffer_load_dwordx4 v4, s[36:39], s45 offen nt lds
    s_add_u32 m0, s53, 4096
    s_add_u32 s45, s52, 262400
    buffer_load_dwordx4 v3, s[36:39], s45 offen nt lds
    s_add_u32 m0, s53, 5120
    s_add_u32 s45, s52, 262400
    buffer_load_dwordx4 v4, s[36:39], s45 offen nt lds
    s_add_u32 m0, s53, 6144
    s_add_u32 s45, s52, 262528
    buffer_load_dwordx4 v3, s[36:39], s45 offen nt lds
    s_add_u32 m0, s53, 7168
    s_add_u32 s45, s52, 262528
    buffer_load_dwordx4 v4, s[36:39], s45 offen nt lds
    s_add_u32 m0, s53, 8192
    s_add_u32 s45, s52, 393216
    buffer_load_dwordx4 v3, s[36:39], s45 offen nt lds
    s_add_u32 m0, s53, 9216
    s_add_u32 s45, s52, 393216
    buffer_load_dwordx4 v4, s[36:39], s45 offen nt lds
    s_add_u32 m0, s53, 10240
    s_add_u32 s45, s52, 393344
    buffer_load_dwordx4 v3, s[36:39], s45 offen nt lds
    s_add_u32 m0, s53, 11264
    s_add_u32 s45, s52, 393344
    buffer_load_dwordx4 v4, s[36:39], s45 offen nt lds
    s_add_u32 m0, s53, 12288
    s_add_u32 s45, s52, 393472
    buffer_load_dwordx4 v3, s[36:39], s45 offen nt lds
    s_add_u32 m0, s53, 13312
    s_add_u32 s45, s52, 393472
    buffer_load_dwordx4 v4, s[36:39], s45 offen nt lds
    s_add_u32 m0, s53, 14336
    s_add_u32 s45, s52, 393600
    buffer_load_dwordx4 v3, s[36:39], s45 offen nt lds
    s_add_u32 m0, s53, 15360
    s_add_u32 s45, s52, 393600
    buffer_load_dwordx4 v4, s[36:39], s45 offen nt lds
    s_waitcnt vmcnt(16)
    s_barrier
    s_cmp_eq_u32 s27, 1
    s_cbranch_scc1 P_compBa
    ds_read_b128 v[128:131], v13 offset:0
    ds_read_b128 v[132:135], v14 offset:0
    ds_read_b128 v[136:139], v13 offset:2048
    ds_read_b128 v[140:143], v14 offset:2048
    ds_read_b128 v[144:147], v13 offset:4096
    ds_read_b128 v[148:151], v14 offset:4096
    s_waitcnt lgkmcnt(5)
    v_mfma_f32_16x16x32_bf16 v[16:19], a[0:3], v[128:131], 0
    v_mfma_f32_16x16x32_bf16 v[20:23], a[4:7], v[128:131], 0
    ds_read_b128 v[128:131], v13 offset:6144
    s_waitcnt lgkmcnt(5)
    v_mfma_f32_16x16x32_bf16 v[16:19], a[8:11], v[132:135], v[16:19]
    v_mfma_f32_16x16x32_bf16 v[20:23], a[12:15], v[132:135], v[20:23]
    ds_read_b128 v[132:135], v14 offset:6144
    s_waitcnt lgkmcnt(5)
    v_mfma_f32_16x16x32_bf16 v[16:19], a[16:19], v[136:139], v[16:19]
    v_mfma_f32_16x16x32_bf16 v[20:23], a[20:23], v[136:139], v[20:23]
    ds_read_b128 v[136:139], v13 offset:8192
    s_waitcnt lgkmcnt(5)
    v_mfma_f32_16x16x32_bf16 v[16:19], a[24:27], v[140:143], v[16:19]
    v_mfma_f32_16x16x32_bf16 v[20:23], a[28:31], v[140:143], v[20:23]
    ds_read_b128 v[140:143], v14 offset:8192
    s_waitcnt lgkmcnt(5)
    v_mfma_f32_16x16x32_bf16 v[16:19], a[32:35], v[144:147], v[16:19]
    v_mfma_f32_16x16x32_bf16 v[20:23], a[36:39], v[144:147], v[20:23]
    ds_read_b128 v[144:147], v13 offset:10240
    s_waitcnt lgkmcnt(5)
    v_mfma_f32_16x16x32_bf16 v[16:19], a[40:43], v[148:151], v[16:19]
    v_mfma_f32_16x16x32_bf16 v[20:23], a[44:47], v[148:151], v[20:23]
    ds_read_b128 v[148:151], v14 offset:10240
    s_waitcnt lgkmcnt(5)
    v_mfma_f32_16x16x32_bf16 v[16:19], a[48:51], v[128:131], v[16:19]
    v_mfma_f32_16x16x32_bf16 v[20:23], a[52:55], v[128:131], v[20:23]
    ds_read_b128 v[128:131], v13 offset:12288
    s_waitcnt lgkmcnt(5)
    v_mfma_f32_16x16x32_bf16 v[16:19], a[56:59], v[132:135], v[16:19]
    v_mfma_f32_16x16x32_bf16 v[20:23], a[60:63], v[132:135], v[20:23]
    ds_read_b128 v[132:135], v14 offset:12288
    s_waitcnt lgkmcnt(5)
    v_mfma_f32_16x16x32_bf16 v[24:27], a[0:3], v[136:139], 0
    v_mfma_f32_16x16x32_bf16 v[28:31], a[4:7], v[136:139], 0
    ds_read_b128 v[136:139], v13 offset:14336
    s_waitcnt lgkmcnt(5)
    v_mfma_f32_16x16x32_bf16 v[24:27], a[8:11], v[140:143], v[24:27]
    v_mfma_f32_16x16x32_bf16 v[28:31], a[12:15], v[140:143], v[28:31]
    ds_read_b128 v[140:143], v14 offset:14336
    s_waitcnt lgkmcnt(5)
    v_mfma_f32_16x16x32_bf16 v[24:27], a[16:19], v[144:147], v[24:27]
    s_mov_b32 s49, s47
    v_mul_f32 v16, s46, v16
    v_mul_f32 v17, s46, v17
    v_mul_f32 v18, s46, v18
    v_mfma_f32_16x16x32_bf16 v[28:31], a[20:23], v[144:147], v[28:31]
    ds_read_b128 v[144:147], v13 offset:16384
    s_waitcnt lgkmcnt(5)
    v_mfma_f32_16x16x32_bf16 v[24:27], a[24:27], v[148:151], v[24:27]
    v_mul_f32 v19, s46, v19
    v_mul_f32 v20, s46, v20
    v_mul_f32 v21, s46, v21
    v_mfma_f32_16x16x32_bf16 v[28:31], a[28:31], v[148:151], v[28:31]
    ds_read_b128 v[148:151], v14 offset:16384
    s_waitcnt lgkmcnt(5)
    v_mfma_f32_16x16x32_bf16 v[24:27], a[32:35], v[128:131], v[24:27]
    v_mul_f32 v22, s46, v22
    v_mul_f32 v23, s46, v23
    v_cvt_pk_bf16_f32 v16, v16, v20
    v_mfma_f32_16x16x32_bf16 v[28:31], a[36:39], v[128:131], v[28:31]
    ds_read_b128 v[128:131], v13 offset:18432
    s_waitcnt lgkmcnt(5)
    v_mfma_f32_16x16x32_bf16 v[24:27], a[40:43], v[132:135], v[24:27]
    v_cvt_pk_bf16_f32 v17, v17, v21
    v_cvt_pk_bf16_f32 v18, v18, v22
    v_cvt_pk_bf16_f32 v19, v19, v23
    v_mfma_f32_16x16x32_bf16 v[28:31], a[44:47], v[132:135], v[28:31]
    buffer_store_dwordx4 v[16:19], v5, s[4:7], s49 offen offset:0 sc1
    s_add_u32 s49, s49, s48
    ds_read_b128 v[132:135], v14 offset:18432
    s_waitcnt lgkmcnt(5)
    v_mfma_f32_16x16x32_bf16 v[24:27], a[48:51], v[136:139], v[24:27]
    v_mfma_f32_16x16x32_bf16 v[28:31], a[52:55], v[136:139], v[28:31]
    ds_read_b128 v[136:139], v13 offset:20480
    s_waitcnt lgkmcnt(5)
    v_mfma_f32_16x16x32_bf16 v[24:27], a[56:59], v[140:143], v[24:27]
    v_mfma_f32_16x16x32_bf16 v[28:31], a[60:63], v[140:143], v[28:31]
    ds_read_b128 v[140:143], v14 offset:20480
    s_waitcnt lgkmcnt(5)
    v_mfma_f32_16x16x32_bf16 v[32:35], a[0:3], v[144:147], 0
    v_mfma_f32_16x16x32_bf16 v[36:39], a[4:7], v[144:147], 0
    ds_read_b128 v[144:147], v13 offset:22528
    s_waitcnt lgkmcnt(5)
    v_mfma_f32_16x16x32_bf16 v[32:35], a[8:11], v[148:151], v[32:35]
    v_mfma_f32_16x16x32_bf16 v[36:39], a[12:15], v[148:151], v[36:39]
    ds_read_b128 v[148:151], v14 offset:22528
    s_waitcnt lgkmcnt(5)
    v_mfma_f32_16x16x32_bf16 v[32:35], a[16:19], v[128:131], v[32:35]
    v_mul_f32 v24, s46, v24
    v_mul_f32 v25, s46, v25
    v_mul_f32 v26, s46, v26
    v_mfma_f32_16x16x32_bf16 v[36:39], a[20:23], v[128:131], v[36:39]
    ds_read_b128 v[128:131], v13 offset:24576
    s_waitcnt lgkmcnt(5)
    v_mfma_f32_16x16x32_bf16 v[32:35], a[24:27], v[132:135], v[32:35]
    v_mul_f32 v27, s46, v27
    v_mul_f32 v28, s46, v28
    v_mul_f32 v29, s46, v29
    v_mfma_f32_16x16x32_bf16 v[36:39], a[28:31], v[132:135], v[36:39]
    ds_read_b128 v[132:135], v14 offset:24576
    s_waitcnt lgkmcnt(5)
    v_mfma_f32_16x16x32_bf16 v[32:35], a[32:35], v[136:139], v[32:35]
    v_mul_f32 v30, s46, v30
    v_mul_f32 v31, s46, v31
    v_cvt_pk_bf16_f32 v24, v24, v28
    v_mfma_f32_16x16x32_bf16 v[36:39], a[36:39], v[136:139], v[36:39]
    ds_read_b128 v[136:139], v13 offset:26624
    s_waitcnt lgkmcnt(5)
    v_mfma_f32_16x16x32_bf16 v[32:35], a[40:43], v[140:143], v[32:35]
    v_cvt_pk_bf16_f32 v25, v25, v29
    v_cvt_pk_bf16_f32 v26, v26, v30
    v_cvt_pk_bf16_f32 v27, v27, v31
    v_mfma_f32_16x16x32_bf16 v[36:39], a[44:47], v[140:143], v[36:39]
    buffer_store_dwordx4 v[24:27], v5, s[4:7], s49 offen offset:0 sc1
    s_add_u32 s49, s49, s48
    ds_read_b128 v[140:143], v14 offset:26624
    s_waitcnt lgkmcnt(5)
    v_mfma_f32_16x16x32_bf16 v[32:35], a[48:51], v[144:147], v[32:35]
    v_mfma_f32_16x16x32_bf16 v[36:39], a[52:55], v[144:147], v[36:39]
    ds_read_b128 v[144:147], v13 offset:28672
    s_waitcnt lgkmcnt(5)
    v_mfma_f32_16x16x32_bf16 v[32:35], a[56:59], v[148:151], v[32:35]
    v_mfma_f32_16x16x32_bf16 v[36:39], a[60:63], v[148:151], v[36:39]
    ds_read_b128 v[148:151], v14 offset:28672
    s_waitcnt lgkmcnt(5)
    v_mfma_f32_16x16x32_bf16 v[40:43], a[0:3], v[128:131], 0
    v_mfma_f32_16x16x32_bf16 v[44:47], a[4:7], v[128:131], 0
    ds_read_b128 v[128:131], v13 offset:30720
    s_waitcnt lgkmcnt(5)
    v_mfma_f32_16x16x32_bf16 v[40:43], a[8:11], v[132:135], v[40:43]
    v_mfma_f32_16x16x32_bf16 v[44:47], a[12:15], v[132:135], v[44:47]
    ds_read_b128 v[132:135], v14 offset:30720
    s_waitcnt lgkmcnt(5)
    v_mfma_f32_16x16x32_bf16 v[40:43], a[16:19], v[136:139], v[40:43]
    v_mul_f32 v32, s46, v32
    v_mul_f32 v33, s46, v33
    v_mul_f32 v34, s46, v34
    v_mfma_f32_16x16x32_bf16 v[44:47], a[20:23], v[136:139], v[44:47]
    ds_read_b128 v[136:139], v13 offset:32768
    s_waitcnt lgkmcnt(5)
    v_mfma_f32_16x16x32_bf16 v[40:43], a[24:27], v[140:143], v[40:43]
    v_mul_f32 v35, s46, v35
    v_mul_f32 v36, s46, v36
    v_mul_f32 v37, s46, v37
    v_mfma_f32_16x16x32_bf16 v[44:47], a[28:31], v[140:143], v[44:47]
    ds_read_b128 v[140:143], v14 offset:32768
    s_waitcnt lgkmcnt(5)
    v_mfma_f32_16x16x32_bf16 v[40:43], a[32:35], v[144:147], v[40:43]
    v_mul_f32 v38, s46, v38
    v_mul_f32 v39, s46, v39
    v_cvt_pk_bf16_f32 v32, v32, v36
    v_mfma_f32_16x16x32_bf16 v[44:47], a[36:39], v[144:147], v[44:47]
    ds_read_b128 v[144:147], v13 offset:34816
    s_waitcnt lgkmcnt(5)
    v_mfma_f32_16x16x32_bf16 v[40:43], a[40:43], v[148:151], v[40:43]
    v_cvt_pk_bf16_f32 v33, v33, v37
    v_cvt_pk_bf16_f32 v34, v34, v38
    v_cvt_pk_bf16_f32 v35, v35, v39
    v_mfma_f32_16x16x32_bf16 v[44:47], a[44:47], v[148:151], v[44:47]
    buffer_store_dwordx4 v[32:35], v5, s[4:7], s49 offen offset:0 sc1
    s_add_u32 s49, s49, s48
    ds_read_b128 v[148:151], v14 offset:34816
    s_waitcnt lgkmcnt(5)
    v_mfma_f32_16x16x32_bf16 v[40:43], a[48:51], v[128:131], v[40:43]
    v_mfma_f32_16x16x32_bf16 v[44:47], a[52:55], v[128:131], v[44:47]
    ds_read_b128 v[128:131], v13 offset:36864
    s_waitcnt lgkmcnt(5)
    v_mfma_f32_16x16x32_bf16 v[40:43], a[56:59], v[132:135], v[40:43]
    v_mfma_f32_16x16x32_bf16 v[44:47], a[60:63], v[132:135], v[44:47]
    ds_read_b128 v[132:135], v14 offset:36864
    s_waitcnt lgkmcnt(5)
    v_mfma_f32_16x16x32_bf16 v[48:51], a[0:3], v[136:139], 0
    v_mfma_f32_16x16x32_bf16 v[52:55], a[4:7], v[136:139], 0
    ds_read_b128 v[136:139], v13 offset:38912
    s_waitcnt lgkmcnt(5)
    v_mfma_f32_16x16x32_bf16 v[48:51], a[8:11], v[140:143], v[48:51]
    v_mfma_f32_16x16x32_bf16 v[52:55], a[12:15], v[140:143], v[52:55]
    ds_read_b128 v[140:143], v14 offset:38912
    s_waitcnt lgkmcnt(5)
    v_mfma_f32_16x16x32_bf16 v[48:51], a[16:19], v[144:147], v[48:51]
    v_mul_f32 v40, s46, v40
    v_mul_f32 v41, s46, v41
    v_mul_f32 v42, s46, v42
    v_mfma_f32_16x16x32_bf16 v[52:55], a[20:23], v[144:147], v[52:55]
    ds_read_b128 v[144:147], v13 offset:40960
    s_waitcnt lgkmcnt(5)
    v_mfma_f32_16x16x32_bf16 v[48:51], a[24:27], v[148:151], v[48:51]
    v_mul_f32 v43, s46, v43
    v_mul_f32 v44, s46, v44
    v_mul_f32 v45, s46, v45
    v_mfma_f32_16x16x32_bf16 v[52:55], a[28:31], v[148:151], v[52:55]
    ds_read_b128 v[148:151], v14 offset:40960
    s_waitcnt lgkmcnt(5)
    v_mfma_f32_16x16x32_bf16 v[48:51], a[32:35], v[128:131], v[48:51]
    v_mul_f32 v46, s46, v46
    v_mul_f32 v47, s46, v47
    v_cvt_pk_bf16_f32 v40, v40, v44
    v_mfma_f32_16x16x32_bf16 v[52:55], a[36:39], v[128:131], v[52:55]
    ds_read_b128 v[128:131], v13 offset:43008
    s_waitcnt lgkmcnt(5)
    v_mfma_f32_16x16x32_bf16 v[48:51], a[40:43], v[132:135], v[48:51]
    v_cvt_pk_bf16_f32 v41, v41, v45
    v_cvt_pk_bf16_f32 v42, v42, v46
    v_cvt_pk_bf16_f32 v43, v43, v47
    v_mfma_f32_16x16x32_bf16 v[52:55], a[44:47], v[132:135], v[52:55]
    buffer_store_dwordx4 v[40:43], v5, s[4:7], s49 offen offset:0 sc1
    s_add_u32 s49, s49, s48
    ds_read_b128 v[132:135], v14 offset:43008
    s_waitcnt lgkmcnt(5)
    v_mfma_f32_16x16x32_bf16 v[48:51], a[48:51], v[136:139], v[48:51]
    v_mfma_f32_16x16x32_bf16 v[52:55], a[52:55], v[136:139], v[52:55]
    ds_read_b128 v[136:139], v13 offset:45056
    s_waitcnt lgkmcnt(5)
    v_mfma_f32_16x16x32_bf16 v[48:51], a[56:59], v[140:143], v[48:51]
    v_mfma_f32_16x16x32_bf16 v[52:55], a[60:63], v[140:143], v[52:55]
    ds_read_b128 v[140:143], v14 offset:45056
    s_waitcnt lgkmcnt(5)
    v_mfma_f32_16x16x32_bf16 v[56:59], a[0:3], v[144:147], 0
    v_mfma_f32_16x16x32_bf16 v[60:63], a[4:7], v[144:147], 0
    ds_read_b128 v[144:147], v13 offset:47104
    s_waitcnt lgkmcnt(5)
    v_mfma_f32_16x16x32_bf16 v[56:59], a[8:11], v[148:151], v[56:59]
    v_mfma_f32_16x16x32_bf16 v[60:63], a[12:15], v[148:151], v[60:63]
    ds_read_b128 v[148:151], v14 offset:47104
    s_waitcnt lgkmcnt(5)
    v_mfma_f32_16x16x32_bf16 v[56:59], a[16:19], v[128:131], v[56:59]
    v_mul_f32 v48, s46, v48
    v_mul_f32 v49, s46, v49
    v_mul_f32 v50, s46, v50
    v_mfma_f32_16x16x32_bf16 v[60:63], a[20:23], v[128:131], v[60:63]
    ds_read_b128 v[128:131], v13 offset:49152
    s_waitcnt lgkmcnt(5)
    v_mfma_f32_16x16x32_bf16 v[56:59], a[24:27], v[132:135], v[56:59]
    v_mul_f32 v51, s46, v51
    v_mul_f32 v52, s46, v52
    v_mul_f32 v53, s46, v53
    v_mfma_f32_16x16x32_bf16 v[60:63], a[28:31], v[132:135], v[60:63]
    ds_read_b128 v[132:135], v14 offset:49152
    s_waitcnt lgkmcnt(5)
    v_mfma_f32_16x16x32_bf16 v[56:59], a[32:35], v[136:139], v[56:59]
    v_mul_f32 v54, s46, v54
    v_mul_f32 v55, s46, v55
    v_cvt_pk_bf16_f32 v48, v48, v52
    v_mfma_f32_16x16x32_bf16 v[60:63], a[36:39], v[136:139], v[60:63]
    ds_read_b128 v[136:139], v13 offset:51200
    s_waitcnt lgkmcnt(5)
    v_mfma_f32_16x16x32_bf16 v[56:59], a[40:43], v[140:143], v[56:59]
    v_cvt_pk_bf16_f32 v49, v49, v53
    v_cvt_pk_bf16_f32 v50, v50, v54
    v_cvt_pk_bf16_f32 v51, v51, v55
    v_mfma_f32_16x16x32_bf16 v[60:63], a[44:47], v[140:143], v[60:63]
    buffer_store_dwordx4 v[48:51], v5, s[4:7], s49 offen offset:0 sc1
    s_add_u32 s49, s49, s48
    ds_read_b128 v[140:143], v14 offset:51200
    s_waitcnt lgkmcnt(5)
    v_mfma_f32_16x16x32_bf16 v[56:59], a[48:51], v[144:147], v[56:59]
    v_mfma_f32_16x16x32_bf16 v[60:63], a[52:55], v[144:147], v[60:63]
    ds_read_b128 v[144:147], v13 offset:53248
    s_waitcnt lgkmcnt(5)
    v_mfma_f32_16x16x32_bf16 v[56:59], a[56:59], v[148:151], v[56:59]
    v_mfma_f32_16x16x32_bf16 v[60:63], a[60:63], v[148:151], v[60:63]
    ds_read_b128 v[148:151], v14 offset:53248
    s_waitcnt lgkmcnt(5)
    v_mfma_f32_16x16x32_bf16 v[64:67], a[0:3], v[128:131], 0
    v_mfma_f32_16x16x32_bf16 v[68:71], a[4:7], v[128:131], 0
    ds_read_b128 v[128:131], v13 offset:55296
    s_waitcnt lgkmcnt(5)
    v_mfma_f32_16x16x32_bf16 v[64:67], a[8:11], v[132:135], v[64:67]
    v_mfma_f32_16x16x32_bf16 v[68:71], a[12:15], v[132:135], v[68:71]
    ds_read_b128 v[132:135], v14 offset:55296
    s_waitcnt lgkmcnt(5)
    v_mfma_f32_16x16x32_bf16 v[64:67], a[16:19], v[136:139], v[64:67]
    v_mul_f32 v56, s46, v56
    v_mul_f32 v57, s46, v57
    v_mul_f32 v58, s46, v58
    v_mfma_f32_16x16x32_bf16 v[68:71], a[20:23], v[136:139], v[68:71]
    s_waitcnt lgkmcnt(4)
    v_mfma_f32_16x16x32_bf16 v[64:67], a[24:27], v[140:143], v[64:67]
    v_mul_f32 v59, s46, v59
    v_mul_f32 v60, s46, v60
    v_mul_f32 v61, s46, v61
    v_mfma_f32_16x16x32_bf16 v[68:71], a[28:31], v[140:143], v[68:71]
    s_waitcnt lgkmcnt(3)
    v_mfma_f32_16x16x32_bf16 v[64:67], a[32:35], v[144:147], v[64:67]
    v_mul_f32 v62, s46, v62
    v_mul_f32 v63, s46, v63
    v_cvt_pk_bf16_f32 v56, v56, v60
    v_mfma_f32_16x16x32_bf16 v[68:71], a[36:39], v[144:147], v[68:71]
    s_waitcnt lgkmcnt(2)
    v_mfma_f32_16x16x32_bf16 v[64:67], a[40:43], v[148:151], v[64:67]
    v_cvt_pk_bf16_f32 v57, v57, v61
    v_cvt_pk_bf16_f32 v58, v58, v62
    v_cvt_pk_bf16_f32 v59, v59, v63
    v_mfma_f32_16x16x32_bf16 v[68:71], a[44:47], v[148:151], v[68:71]
    buffer_store_dwordx4 v[56:59], v5, s[4:7], s49 offen offset:0 sc1
    s_add_u32 s49, s49, s48
    s_waitcnt lgkmcnt(1)
    v_mfma_f32_16x16x32_bf16 v[64:67], a[48:51], v[128:131], v[64:67]
    v_mfma_f32_16x16x32_bf16 v[68:71], a[52:55], v[128:131], v[68:71]
    s_waitcnt lgkmcnt(0)
    v_mfma_f32_16x16x32_bf16 v[64:67], a[56:59], v[132:135], v[64:67]
    v_mfma_f32_16x16x32_bf16 v[68:71], a[60:63], v[132:135], v[68:71]
    s_waitcnt vmcnt(6)
    ds_read_b128 a[64:67], v1 offset:0
    ds_read_b128 a[68:71], v1 offset:8192
    ds_read_b128 a[72:75], v2 offset:0
    ds_read_b128 a[76:79], v2 offset:8192
    ds_read_b128 a[80:83], v1 offset:2048
    ds_read_b128 a[84:87], v1 offset:10240
    ds_read_b128 a[88:91], v2 offset:2048
    ds_read_b128 a[92:95], v2 offset:10240
    s_waitcnt lgkmcnt(4)
    ds_read_b128 a[96:99], v1 offset:4096
    ds_read_b128 a[100:103], v1 offset:12288
    ds_read_b128 a[104:107], v2 offset:4096
    ds_read_b128 a[108:111], v2 offset:12288
    ds_read_b128 a[112:115], v1 offset:6144
    ds_read_b128 a[116:119], v1 offset:14336
    ds_read_b128 a[120:123], v2 offset:6144
    ds_read_b128 a[124:127], v2 offset:14336
    s_waitcnt lgkmcnt(0)
    ds_read_b128 v[128:131], v13 offset:0
    ds_read_b128 v[132:135], v14 offset:0
    ds_read_b128 v[136:139], v13 offset:2048
    ds_read_b128 v[140:143], v14 offset:2048
    ds_read_b128 v[144:147], v13 offset:4096
    ds_read_b128 v[148:151], v14 offset:4096
    s_waitcnt lgkmcnt(5)
    v_mfma_f32_16x16x32_bf16 v[72:75], a[64:67], v[128:131], 0
    v_mfma_f32_16x16x32_bf16 v[76:79], a[68:71], v[128:131], 0
    ds_read_b128 v[128:131], v13 offset:6144
    s_waitcnt lgkmcnt(5)
    v_mfma_f32_16x16x32_bf16 v[72:75], a[72:75], v[132:135], v[72:75]
    v_mfma_f32_16x16x32_bf16 v[76:79], a[76:79], v[132:135], v[76:79]
    ds_read_b128 v[132:135], v14 offset:6144
    s_waitcnt lgkmcnt(5)
    v_mfma_f32_16x16x32_bf16 v[72:75], a[80:83], v[136:139], v[72:75]
    v_mul_f32 v64, s46, v64
    v_mul_f32 v65, s46, v65
    v_mul_f32 v66, s46, v66
    v_mfma_f32_16x16x32_bf16 v[76:79], a[84:87], v[136:139], v[76:79]
    ds_read_b128 v[136:139], v13 offset:8192
    s_waitcnt lgkmcnt(5)
    v_mfma_f32_16x16x32_bf16 v[72:75], a[88:91], v[140:143], v[72:75]
    v_mul_f32 v67, s46, v67
    v_mul_f32 v68, s46, v68
    v_mul_f32 v69, s46, v69
    v_mfma_f32_16x16x32_bf16 v[76:79], a[92:95], v[140:143], v[76:79]
    ds_read_b128 v[140:143], v14 offset:8192
    s_waitcnt lgkmcnt(5)
    v_mfma_f32_16x16x32_bf16 v[72:75], a[96:99], v[144:147], v[72:75]
    v_mul_f32 v70, s46, v70
    v_mul_f32 v71, s46, v71
    v_cvt_pk_bf16_f32 v64, v64, v68
    v_mfma_f32_16x16x32_bf16 v[76:79], a[100:103], v[144:147], v[76:79]
    ds_read_b128 v[144:147], v13 offset:10240
    s_waitcnt lgkmcnt(5)
    v_mfma_f32_16x16x32_bf16 v[72:75], a[104:107], v[148:151], v[72:75]
    v_cvt_pk_bf16_f32 v65, v65, v69
    v_cvt_pk_bf16_f32 v66, v66, v70
    v_cvt_pk_bf16_f32 v67, v67, v71
    v_mfma_f32_16x16x32_bf16 v[76:79], a[108:111], v[148:151], v[76:79]
    buffer_store_dwordx4 v[64:67], v5, s[4:7], s49 offen offset:0 sc1
    s_add_u32 s49, s49, s48
    ds_read_b128 v[148:151], v14 offset:10240
    s_waitcnt lgkmcnt(5)
    v_mfma_f32_16x16x32_bf16 v[72:75], a[112:115], v[128:131], v[72:75]
    v_mfma_f32_16x16x32_bf16 v[76:79], a[116:119], v[128:131], v[76:79]
    ds_read_b128 v[128:131], v13 offset:12288
    s_waitcnt lgkmcnt(5)
    v_mfma_f32_16x16x32_bf16 v[72:75], a[120:123], v[132:135], v[72:75]
    v_mfma_f32_16x16x32_bf16 v[76:79], a[124:127], v[132:135], v[76:79]
    ds_read_b128 v[132:135], v14 offset:12288
    s_waitcnt lgkmcnt(5)
    v_mfma_f32_16x16x32_bf16 v[80:83], a[64:67], v[136:139], 0
    v_mfma_f32_16x16x32_bf16 v[84:87], a[68:71], v[136:139], 0
    ds_read_b128 v[136:139], v13 offset:14336
    s_waitcnt lgkmcnt(5)
    v_mfma_f32_16x16x32_bf16 v[80:83], a[72:75], v[140:143], v[80:83]
    v_mfma_f32_16x16x32_bf16 v[84:87], a[76:79], v[140:143], v[84:87]
    ds_read_b128 v[140:143], v14 offset:14336
    s_waitcnt lgkmcnt(5)
    v_mfma_f32_16x16x32_bf16 v[80:83], a[80:83], v[144:147], v[80:83]
    s_mov_b32 s49, s47
    v_mul_f32 v72, s46, v72
    v_mul_f32 v73, s46, v73
    v_mul_f32 v74, s46, v74
    v_mfma_f32_16x16x32_bf16 v[84:87], a[84:87], v[144:147], v[84:87]
    ds_read_b128 v[144:147], v13 offset:16384
    s_waitcnt lgkmcnt(5)
    v_mfma_f32_16x16x32_bf16 v[80:83], a[88:91], v[148:151], v[80:83]
    v_mul_f32 v75, s46, v75
    v_mul_f32 v76, s46, v76
    v_mul_f32 v77, s46, v77
    v_mfma_f32_16x16x32_bf16 v[84:87], a[92:95], v[148:151], v[84:87]
    ds_read_b128 v[148:151], v14 offset:16384
    s_waitcnt lgkmcnt(5)
    v_mfma_f32_16x16x32_bf16 v[80:83], a[96:99], v[128:131], v[80:83]
    v_mul_f32 v78, s46, v78
    v_mul_f32 v79, s46, v79
    v_cvt_pk_bf16_f32 v72, v72, v76
    v_mfma_f32_16x16x32_bf16 v[84:87], a[100:103], v[128:131], v[84:87]
    ds_read_b128 v[128:131], v13 offset:18432
    s_waitcnt lgkmcnt(5)
    v_mfma_f32_16x16x32_bf16 v[80:83], a[104:107], v[132:135], v[80:83]
    v_cvt_pk_bf16_f32 v73, v73, v77
    v_cvt_pk_bf16_f32 v74, v74, v78
    v_cvt_pk_bf16_f32 v75, v75, v79
    v_mfma_f32_16x16x32_bf16 v[84:87], a[108:111], v[132:135], v[84:87]
    buffer_store_dwordx4 v[72:75], v5, s[4:7], s49 offen offset:1024 sc1
    s_add_u32 s49, s49, s48
    ds_read_b128 v[132:135], v14 offset:18432
    s_waitcnt lgkmcnt(5)
    v_mfma_f32_16x16x32_bf16 v[80:83], a[112:115], v[136:139], v[80:83]
    v_mfma_f32_16x16x32_bf16 v[84:87], a[116:119], v[136:139], v[84:87]
    ds_read_b128 v[136:139], v13 offset:20480
    s_waitcnt lgkmcnt(5)
    v_mfma_f32_16x16x32_bf16 v[80:83], a[120:123], v[140:143], v[80:83]
    v_mfma_f32_16x16x32_bf16 v[84:87], a[124:127], v[140:143], v[84:87]
    ds_read_b128 v[140:143], v14 offset:20480
    s_waitcnt lgkmcnt(5)
    v_mfma_f32_16x16x32_bf16 v[88:91], a[64:67], v[144:147], 0
    v_mfma_f32_16x16x32_bf16 v[92:95], a[68:71], v[144:147], 0
    ds_read_b128 v[144:147], v13 offset:22528
    s_waitcnt lgkmcnt(5)
    v_mfma_f32_16x16x32_bf16 v[88:91], a[72:75], v[148:151], v[88:91]
    v_mfma_f32_16x16x32_bf16 v[92:95], a[76:79], v[148:151], v[92:95]
    ds_read_b128 v[148:151], v14 offset:22528
    s_waitcnt lgkmcnt(5)
    v_mfma_f32_16x16x32_bf16 v[88:91], a[80:83], v[128:131], v[88:91]
    v_mul_f32 v80, s46, v80
    v_mul_f32 v81, s46, v81
    v_mul_f32 v82, s46, v82
    v_mfma_f32_16x16x32_bf16 v[92:95], a[84:87], v[128:131], v[92:95]
    ds_read_b128 v[128:131], v13 offset:24576
    s_waitcnt lgkmcnt(5)
    v_mfma_f32_16x16x32_bf16 v[88:91], a[88:91], v[132:135], v[88:91]
    v_mul_f32 v83, s46, v83
    v_mul_f32 v84, s46, v84
    v_mul_f32 v85, s46, v85
    v_mfma_f32_16x16x32_bf16 v[92:95], a[92:95], v[132:135], v[92:95]
    ds_read_b128 v[132:135], v14 offset:24576
    s_waitcnt lgkmcnt(5)
    v_mfma_f32_16x16x32_bf16 v[88:91], a[96:99], v[136:139], v[88:91]
    v_mul_f32 v86, s46, v86
    v_mul_f32 v87, s46, v87
    v_cvt_pk_bf16_f32 v80, v80, v84
    v_mfma_f32_16x16x32_bf16 v[92:95], a[100:103], v[136:139], v[92:95]
    ds_read_b128 v[136:139], v13 offset:26624
    s_waitcnt lgkmcnt(5)
    v_mfma_f32_16x16x32_bf16 v[88:91], a[104:107], v[140:143], v[88:91]
    v_cvt_pk_bf16_f32 v81, v81, v85
    v_cvt_pk_bf16_f32 v82, v82, v86
    v_cvt_pk_bf16_f32 v83, v83, v87
    v_mfma_f32_16x16x32_bf16 v[92:95], a[108:111], v[140:143], v[92:95]
    buffer_store_dwordx4 v[80:83], v5, s[4:7], s49 offen offset:1024 sc1
    s_add_u32 s49, s49, s48
    ds_read_b128 v[140:143], v14 offset:26624
    s_waitcnt lgkmcnt(5)
    v_mfma_f32_16x16x32_bf16 v[88:91], a[112:115], v[144:147], v[88:91]
    v_mfma_f32_16x16x32_bf16 v[92:95], a[116:119], v[144:147], v[92:95]
    ds_read_b128 v[144:147], v13 offset:28672
    s_waitcnt lgkmcnt(5)
    v_mfma_f32_16x16x32_bf16 v[88:91], a[120:123], v[148:151], v[88:91]
    v_mfma_f32_16x16x32_bf16 v[92:95], a[124:127], v[148:151], v[92:95]
    ds_read_b128 v[148:151], v14 offset:28672
    s_waitcnt lgkmcnt(5)
    v_mfma_f32_16x16x32_bf16 v[96:99], a[64:67], v[128:131], 0
    v_mfma_f32_16x16x32_bf16 v[100:103], a[68:71], v[128:131], 0
    ds_read_b128 v[128:131], v13 offset:30720
    s_waitcnt lgkmcnt(5)
    v_mfma_f32_16x16x32_bf16 v[96:99], a[72:75], v[132:135], v[96:99]
    v_mfma_f32_16x16x32_bf16 v[100:103], a[76:79], v[132:135], v[100:103]
    ds_read_b128 v[132:135], v14 offset:30720
    s_waitcnt lgkmcnt(5)
    v_mfma_f32_16x16x32_bf16 v[96:99], a[80:83], v[136:139], v[96:99]
    v_mul_f32 v88, s46, v88
    v_mul_f32 v89, s46, v89
    v_mul_f32 v90, s46, v90
    v_mfma_f32_16x16x32_bf16 v[100:103], a[84:87], v[136:139], v[100:103]
    ds_read_b128 v[136:139], v13 offset:32768
    s_waitcnt lgkmcnt(5)
    v_mfma_f32_16x16x32_bf16 v[96:99], a[88:91], v[140:143], v[96:99]
    v_mul_f32 v91, s46, v91
    v_mul_f32 v92, s46, v92
    v_mul_f32 v93, s46, v93
    v_mfma_f32_16x16x32_bf16 v[100:103], a[92:95], v[140:143], v[100:103]
    ds_read_b128 v[140:143], v14 offset:32768
    s_waitcnt lgkmcnt(5)
    v_mfma_f32_16x16x32_bf16 v[96:99], a[96:99], v[144:147], v[96:99]
    v_mul_f32 v94, s46, v94
    v_mul_f32 v95, s46, v95
    v_cvt_pk_bf16_f32 v88, v88, v92
    v_mfma_f32_16x16x32_bf16 v[100:103], a[100:103], v[144:147], v[100:103]
    ds_read_b128 v[144:147], v13 offset:34816
    s_waitcnt lgkmcnt(5)
    v_mfma_f32_16x16x32_bf16 v[96:99], a[104:107], v[148:151], v[96:99]
    v_cvt_pk_bf16_f32 v89, v89, v93
    v_cvt_pk_bf16_f32 v90, v90, v94
    v_cvt_pk_bf16_f32 v91, v91, v95
    v_mfma_f32_16x16x32_bf16 v[100:103], a[108:111], v[148:151], v[100:103]
    buffer_store_dwordx4 v[88:91], v5, s[4:7], s49 offen offset:1024 sc1
    s_add_u32 s49, s49, s48
    ds_read_b128 v[148:151], v14 offset:34816
    s_waitcnt lgkmcnt(5)
    v_mfma_f32_16x16x32_bf16 v[96:99], a[112:115], v[128:131], v[96:99]
    v_mfma_f32_16x16x32_bf16 v[100:103], a[116:119], v[128:131], v[100:103]
    ds_read_b128 v[128:131], v13 offset:36864
    s_waitcnt lgkmcnt(5)
    v_mfma_f32_16x16x32_bf16 v[96:99], a[120:123], v[132:135], v[96:99]
    v_mfma_f32_16x16x32_bf16 v[100:103], a[124:127], v[132:135], v[100:103]
    ds_read_b128 v[132:135], v14 offset:36864
    s_waitcnt lgkmcnt(5)
    v_mfma_f32_16x16x32_bf16 v[104:107], a[64:67], v[136:139], 0
    v_mfma_f32_16x16x32_bf16 v[108:111], a[68:71], v[136:139], 0
    ds_read_b128 v[136:139], v13 offset:38912
    s_waitcnt lgkmcnt(5)
    v_mfma_f32_16x16x32_bf16 v[104:107], a[72:75], v[140:143], v[104:107]
    v_mfma_f32_16x16x32_bf16 v[108:111], a[76:79], v[140:143], v[108:111]
    ds_read_b128 v[140:143], v14 offset:38912
    s_waitcnt lgkmcnt(5)
    v_mfma_f32_16x16x32_bf16 v[104:107], a[80:83], v[144:147], v[104:107]
    v_mul_f32 v96, s46, v96
    v_mul_f32 v97, s46, v97
    v_mul_f32 v98, s46, v98
    v_mfma_f32_16x16x32_bf16 v[108:111], a[84:87], v[144:147], v[108:111]
    ds_read_b128 v[144:147], v13 offset:40960
    s_waitcnt lgkmcnt(5)
    v_mfma_f32_16x16x32_bf16 v[104:107], a[88:91], v[148:151], v[104:107]
    v_mul_f32 v99, s46, v99
    v_mul_f32 v100, s46, v100
    v_mul_f32 v101, s46, v101
    v_mfma_f32_16x16x32_bf16 v[108:111], a[92:95], v[148:151], v[108:111]
    ds_read_b128 v[148:151], v14 offset:40960
    s_waitcnt lgkmcnt(5)
    v_mfma_f32_16x16x32_bf16 v[104:107], a[96:99], v[128:131], v[104:107]
    v_mul_f32 v102, s46, v102
    v_mul_f32 v103, s46, v103
    v_cvt_pk_bf16_f32 v96, v96, v100
    v_mfma_f32_16x16x32_bf16 v[108:111], a[100:103], v[128:131], v[108:111]
    ds_read_b128 v[128:131], v13 offset:43008
    s_waitcnt lgkmcnt(5)
    v_mfma_f32_16x16x32_bf16 v[104:107], a[104:107], v[132:135], v[104:107]
    v_cvt_pk_bf16_f32 v97, v97, v101
    v_cvt_pk_bf16_f32 v98, v98, v102
    v_cvt_pk_bf16_f32 v99, v99, v103
    v_mfma_f32_16x16x32_bf16 v[108:111], a[108:111], v[132:135], v[108:111]
    buffer_store_dwordx4 v[96:99], v5, s[4:7], s49 offen offset:1024 sc1
    s_add_u32 s49, s49, s48
    ds_read_b128 v[132:135], v14 offset:43008
    s_waitcnt lgkmcnt(5)
    v_mfma_f32_16x16x32_bf16 v[104:107], a[112:115], v[136:139], v[104:107]
    v_mfma_f32_16x16x32_bf16 v[108:111], a[116:119], v[136:139], v[108:111]
    ds_read_b128 v[136:139], v13 offset:45056
    s_waitcnt lgkmcnt(5)
    v_mfma_f32_16x16x32_bf16 v[104:107], a[120:123], v[140:143], v[104:107]
    v_mfma_f32_16x16x32_bf16 v[108:111], a[124:127], v[140:143], v[108:111]
    ds_read_b128 v[140:143], v14 offset:45056
    s_waitcnt lgkmcnt(5)
    v_mfma_f32_16x16x32_bf16 v[112:115], a[64:67], v[144:147], 0
    v_mfma_f32_16x16x32_bf16 v[116:119], a[68:71], v[144:147], 0
    ds_read_b128 v[144:147], v13 offset:47104
    s_waitcnt lgkmcnt(5)
    v_mfma_f32_16x16x32_bf16 v[112:115], a[72:75], v[148:151], v[112:115]
    v_mfma_f32_16x16x32_bf16 v[116:119], a[76:79], v[148:151], v[116:119]
    ds_read_b128 v[148:151], v14 offset:47104
    s_waitcnt lgkmcnt(5)
    v_mfma_f32_16x16x32_bf16 v[112:115], a[80:83], v[128:131], v[112:115]
    v_mul_f32 v104, s46, v104
    v_mul_f32 v105, s46, v105
    v_mul_f32 v106, s46, v106
    v_mfma_f32_16x16x32_bf16 v[116:119], a[84:87], v[128:131], v[116:119]
    ds_read_b128 v[128:131], v13 offset:49152
    s_waitcnt lgkmcnt(5)
    v_mfma_f32_16x16x32_bf16 v[112:115], a[88:91], v[132:135], v[112:115]
    v_mul_f32 v107, s46, v107
    v_mul_f32 v108, s46, v108
    v_mul_f32 v109, s46, v109
    v_mfma_f32_16x16x32_bf16 v[116:119], a[92:95], v[132:135], v[116:119]
    ds_read_b128 v[132:135], v14 offset:49152
    s_waitcnt lgkmcnt(5)
    v_mfma_f32_16x16x32_bf16 v[112:115], a[96:99], v[136:139], v[112:115]
    v_mul_f32 v110, s46, v110
    v_mul_f32 v111, s46, v111
    v_cvt_pk_bf16_f32 v104, v104, v108
    v_mfma_f32_16x16x32_bf16 v[116:119], a[100:103], v[136:139], v[116:119]
    ds_read_b128 v[136:139], v13 offset:51200
    s_waitcnt lgkmcnt(5)
    v_mfma_f32_16x16x32_bf16 v[112:115], a[104:107], v[140:143], v[112:115]
    v_cvt_pk_bf16_f32 v105, v105, v109
    v_cvt_pk_bf16_f32 v106, v106, v110
    v_cvt_pk_bf16_f32 v107, v107, v111
    v_mfma_f32_16x16x32_bf16 v[116:119], a[108:111], v[140:143], v[116:119]
    buffer_store_dwordx4 v[104:107], v5, s[4:7], s49 offen offset:1024 sc1
    s_add_u32 s49, s49, s48
    ds_read_b128 v[140:143], v14 offset:51200
    s_waitcnt lgkmcnt(5)
    v_mfma_f32_16x16x32_bf16 v[112:115], a[112:115], v[144:147], v[112:115]
    v_mfma_f32_16x16x32_bf16 v[116:119], a[116:119], v[144:147], v[116:119]
    ds_read_b128 v[144:147], v13 offset:53248
    s_waitcnt lgkmcnt(5)
    v_mfma_f32_16x16x32_bf16 v[112:115], a[120:123], v[148:151], v[112:115]
    v_mfma_f32_16x16x32_bf16 v[116:119], a[124:127], v[148:151], v[116:119]
    ds_read_b128 v[148:151], v14 offset:53248
    s_waitcnt lgkmcnt(5)
    v_mfma_f32_16x16x32_bf16 v[120:123], a[64:67], v[128:131], 0
    v_mfma_f32_16x16x32_bf16 v[124:127], a[68:71], v[128:131], 0
    ds_read_b128 v[128:131], v13 offset:55296
    s_waitcnt lgkmcnt(5)
    v_mfma_f32_16x16x32_bf16 v[120:123], a[72:75], v[132:135], v[120:123]
    v_mfma_f32_16x16x32_bf16 v[124:127], a[76:79], v[132:135], v[124:127]
    ds_read_b128 v[132:135], v14 offset:55296
    s_waitcnt lgkmcnt(5)
    v_mfma_f32_16x16x32_bf16 v[120:123], a[80:83], v[136:139], v[120:123]
    v_mul_f32 v112, s46, v112
    v_mul_f32 v113, s46, v113
    v_mul_f32 v114, s46, v114
    v_mfma_f32_16x16x32_bf16 v[124:127], a[84:87], v[136:139], v[124:127]
    s_waitcnt lgkmcnt(4)
    v_mfma_f32_16x16x32_bf16 v[120:123], a[88:91], v[140:143], v[120:123]
    v_mul_f32 v115, s46, v115
    v_mul_f32 v116, s46, v116
    v_mul_f32 v117, s46, v117
    v_mfma_f32_16x16x32_bf16 v[124:127], a[92:95], v[140:143], v[124:127]
    s_waitcnt lgkmcnt(3)
    v_mfma_f32_16x16x32_bf16 v[120:123], a[96:99], v[144:147], v[120:123]
    v_mul_f32 v118, s46, v118
    v_mul_f32 v119, s46, v119
    v_cvt_pk_bf16_f32 v112, v112, v116
    v_mfma_f32_16x16x32_bf16 v[124:127], a[100:103], v[144:147], v[124:127]
    s_waitcnt lgkmcnt(2)
    v_mfma_f32_16x16x32_bf16 v[120:123], a[104:107], v[148:151], v[120:123]
    v_cvt_pk_bf16_f32 v113, v113, v117
    v_cvt_pk_bf16_f32 v114, v114, v118
    v_cvt_pk_bf16_f32 v115, v115, v119
    v_mfma_f32_16x16x32_bf16 v[124:127], a[108:111], v[148:151], v[124:127]
    buffer_store_dwordx4 v[112:115], v5, s[4:7], s49 offen offset:1024 sc1
    s_add_u32 s49, s49, s48
    s_waitcnt lgkmcnt(1)
    v_mfma_f32_16x16x32_bf16 v[120:123], a[112:115], v[128:131], v[120:123]
    v_mfma_f32_16x16x32_bf16 v[124:127], a[116:119], v[128:131], v[124:127]
    s_waitcnt lgkmcnt(0)
    v_mfma_f32_16x16x32_bf16 v[120:123], a[120:123], v[132:135], v[120:123]
    v_mfma_f32_16x16x32_bf16 v[124:127], a[124:127], v[132:135], v[124:127]
    s_nop 7
    v_mul_f32 v120, s46, v120
    v_mul_f32 v121, s46, v121
    v_mul_f32 v122, s46, v122
    v_mul_f32 v123, s46, v123
    v_mul_f32 v124, s46, v124
    v_mul_f32 v125, s46, v125
    v_mul_f32 v126, s46, v126
    v_mul_f32 v127, s46, v127
    v_cvt_pk_bf16_f32 v120, v120, v124
    v_cvt_pk_bf16_f32 v121, v121, v125
    v_cvt_pk_bf16_f32 v122, v122, v126
    v_cvt_pk_bf16_f32 v123, v123, v127
    buffer_store_dwordx4 v[120:123], v5, s[4:7], s49 offen offset:1024 sc1
    s_add_u32 s49, s49, s48
    s_branch P_cenda
P_compBa:
    ds_read_b64_tr_b16 v[128:129], v6 offset:0
    ds_read_b64_tr_b16 v[130:131], v6 offset:3584
    ds_read_b64_tr_b16 v[132:133], v6 offset:7168
    ds_read_b64_tr_b16 v[134:135], v6 offset:10752
    ds_read_b64_tr_b16 v[136:137], v6 offset:14336
    ds_read_b64_tr_b16 v[138:139], v6 offset:17920
    ds_read_b64_tr_b16 v[140:141], v6 offset:21504
    ds_read_b64_tr_b16 v[142:143], v6 offset:25088
    ds_read_b64_tr_b16 v[144:145], v6 offset:28672
    ds_read_b64_tr_b16 v[146:147], v6 offset:32256
    ds_read_b64_tr_b16 v[148:149], v6 offset:35840
    ds_read_b64_tr_b16 v[150:151], v6 offset:39424
    s_waitcnt lgkmcnt(10)
    v_mfma_f32_16x16x32_bf16 v[16:19], a[0:3], v[128:131], 0
    v_mfma_f32_16x16x32_bf16 v[20:23], a[4:7], v[128:131], 0
    ds_read_b64_tr_b16 v[128:129], v6 offset:43008
    ds_read_b64_tr_b16 v[130:131], v6 offset:46592
    s_waitcnt lgkmcnt(10)
    v_mfma_f32_16x16x32_bf16 v[16:19], a[8:11], v[132:135], v[16:19]
    v_mfma_f32_16x16x32_bf16 v[20:23], a[12:15], v[132:135], v[20:23]
    ds_read_b64_tr_b16 v[132:133], v6 offset:50176
    ds_read_b64_tr_b16 v[134:135], v6 offset:53760
    s_waitcnt lgkmcnt(10)
    v_mfma_f32_16x16x32_bf16 v[16:19], a[16:19], v[136:139], v[16:19]
    v_mfma_f32_16x16x32_bf16 v[20:23], a[20:23], v[136:139], v[20:23]
    ds_read_b64_tr_b16 v[136:137], v6 offset:32
    ds_read_b64_tr_b16 v[138:139], v6 offset:3616
    s_waitcnt lgkmcnt(10)
    v_mfma_f32_16x16x32_bf16 v[16:19], a[24:27], v[140:143], v[16:19]
    v_mfma_f32_16x16x32_bf16 v[20:23], a[28:31], v[140:143], v[20:23]
    ds_read_b64_tr_b16 v[140:141], v6 offset:7200
    ds_read_b64_tr_b16 v[142:143], v6 offset:10784
    s_waitcnt lgkmcnt(10)
    v_mfma_f32_16x16x32_bf16 v[16:19], a[32:35], v[144:147], v[16:19]
    v_mfma_f32_16x16x32_bf16 v[20:23], a[36:39], v[144:147], v[20:23]
    ds_read_b64_tr_b16 v[144:145], v6 offset:14368
    ds_read_b64_tr_b16 v[146:147], v6 offset:17952
    s_waitcnt lgkmcnt(10)
    v_mfma_f32_16x16x32_bf16 v[16:19], a[40:43], v[148:151], v[16:19]
    v_mfma_f32_16x16x32_bf16 v[20:23], a[44:47], v[148:151], v[20:23]
    ds_read_b64_tr_b16 v[148:149], v6 offset:21536
    ds_read_b64_tr_b16 v[150:151], v6 offset:25120
    s_waitcnt lgkmcnt(10)
    v_mfma_f32_16x16x32_bf16 v[16:19], a[48:51], v[128:131], v[16:19]
    v_mfma_f32_16x16x32_bf16 v[20:23], a[52:55], v[128:131], v[20:23]
    ds_read_b64_tr_b16 v[128:129], v6 offset:28704
    ds_read_b64_tr_b16 v[130:131], v6 offset:32288
    s_waitcnt lgkmcnt(10)
    v_mfma_f32_16x16x32_bf16 v[16:19], a[56:59], v[132:135], v[16:19]
    v_mfma_f32_16x16x32_bf16 v[20:23], a[60:63], v[132:135], v[20:23]
    ds_read_b64_tr_b16 v[132:133], v6 offset:35872
    ds_read_b64_tr_b16 v[134:135], v6 offset:39456
    s_waitcnt lgkmcnt(10)
    v_mfma_f32_16x16x32_bf16 v[24:27], a[0:3], v[136:139], 0
    v_mfma_f32_16x16x32_bf16 v[28:31], a[4:7], v[136:139], 0
    ds_read_b64_tr_b16 v[136:137], v6 offset:43040
    ds_read_b64_tr_b16 v[138:139], v6 offset:46624
    s_waitcnt lgkmcnt(10)
    v_mfma_f32_16x16x32_bf16 v[24:27], a[8:11], v[140:143], v[24:27]
    v_mfma_f32_16x16x32_bf16 v[28:31], a[12:15], v[140:143], v[28:31]
    ds_read_b64_tr_b16 v[140:141], v6 offset:50208
    ds_read_b64_tr_b16 v[142:143], v6 offset:53792
    s_waitcnt lgkmcnt(10)
    v_mfma_f32_16x16x32_bf16 v[24:27], a[16:19], v[144:147], v[24:27]
    s_mov_b32 s49, s47
    v_cvt_pk_bf16_f32 v16, v16, v20
    v_cvt_pk_bf16_f32 v17, v17, v21
    v_cvt_pk_bf16_f32 v18, v18, v22
    v_mfma_f32_16x16x32_bf16 v[28:31], a[20:23], v[144:147], v[28:31]
    ds_read_b64_tr_b16 v[144:145], v6 offset:64
    ds_read_b64_tr_b16 v[146:147], v6 offset:3648
    s_waitcnt lgkmcnt(10)
    v_mfma_f32_16x16x32_bf16 v[24:27], a[24:27], v[148:151], v[24:27]
    v_cvt_pk_bf16_f32 v19, v19, v23
    v_mfma_f32_16x16x32_bf16 v[28:31], a[28:31], v[148:151], v[28:31]
    buffer_store_dwordx4 v[16:19], v5, s[4:7], s49 offen offset:0 sc1
    s_add_u32 s49, s49, s48
    ds_read_b64_tr_b16 v[148:149], v6 offset:7232
    ds_read_b64_tr_b16 v[150:151], v6 offset:10816
    s_waitcnt lgkmcnt(10)
    v_mfma_f32_16x16x32_bf16 v[24:27], a[32:35], v[128:131], v[24:27]
    v_mfma_f32_16x16x32_bf16 v[28:31], a[36:39], v[128:131], v[28:31]
    ds_read_b64_tr_b16 v[128:129], v6 offset:14400
    ds_read_b64_tr_b16 v[130:131], v6 offset:17984
    s_waitcnt lgkmcnt(10)
    v_mfma_f32_16x16x32_bf16 v[24:27], a[40:43], v[132:135], v[24:27]
    v_mfma_f32_16x16x32_bf16 v[28:31], a[44:47], v[132:135], v[28:31]
    ds_read_b64_tr_b16 v[132:133], v6 offset:21568
    ds_read_b64_tr_b16 v[134:135], v6 offset:25152
    s_waitcnt lgkmcnt(10)
    v_mfma_f32_16x16x32_bf16 v[24:27], a[48:51], v[136:139], v[24:27]
    v_mfma_f32_16x16x32_bf16 v[28:31], a[52:55], v[136:139], v[28:31]
    ds_read_b64_tr_b16 v[136:137], v6 offset:28736
    ds_read_b64_tr_b16 v[138:139], v6 offset:32320
    s_waitcnt lgkmcnt(10)
    v_mfma_f32_16x16x32_bf16 v[24:27], a[56:59], v[140:143], v[24:27]
    v_mfma_f32_16x16x32_bf16 v[28:31], a[60:63], v[140:143], v[28:31]
    ds_read_b64_tr_b16 v[140:141], v6 offset:35904
    ds_read_b64_tr_b16 v[142:143], v6 offset:39488
    s_waitcnt lgkmcnt(10)
    v_mfma_f32_16x16x32_bf16 v[32:35], a[0:3], v[144:147], 0
    v_mfma_f32_16x16x32_bf16 v[36:39], a[4:7], v[144:147], 0
    ds_read_b64_tr_b16 v[144:145], v6 offset:43072
    ds_read_b64_tr_b16 v[146:147], v6 offset:46656
    s_waitcnt lgkmcnt(10)
    v_mfma_f32_16x16x32_bf16 v[32:35], a[8:11], v[148:151], v[32:35]
    v_mfma_f32_16x16x32_bf16 v[36:39], a[12:15], v[148:151], v[36:39]
    ds_read_b64_tr_b16 v[148:149], v6 offset:50240
    ds_read_b64_tr_b16 v[150:151], v6 offset:53824
    s_waitcnt lgkmcnt(10)
    v_mfma_f32_16x16x32_bf16 v[32:35], a[16:19], v[128:131], v[32:35]
    v_cvt_pk_bf16_f32 v24, v24, v28
    v_cvt_pk_bf16_f32 v25, v25, v29
    v_cvt_pk_bf16_f32 v26, v26, v30
    v_mfma_f32_16x16x32_bf16 v[36:39], a[20:23], v[128:131], v[36:39]
    ds_read_b64_tr_b16 v[128:129], v6 offset:96
    ds_read_b64_tr_b16 v[130:131], v6 offset:3680
    s_waitcnt lgkmcnt(10)
    v_mfma_f32_16x16x32_bf16 v[32:35], a[24:27], v[132:135], v[32:35]
    v_cvt_pk_bf16_f32 v27, v27, v31
    v_mfma_f32_16x16x32_bf16 v[36:39], a[28:31], v[132:135], v[36:39]
    buffer_store_dwordx4 v[24:27], v5, s[4:7], s49 offen offset:0 sc1
    s_add_u32 s49, s49, s48
    ds_read_b64_tr_b16 v[132:133], v6 offset:7264
    ds_read_b64_tr_b16 v[134:135], v6 offset:10848
    s_waitcnt lgkmcnt(10)
    v_mfma_f32_16x16x32_bf16 v[32:35], a[32:35], v[136:139], v[32:35]
    v_mfma_f32_16x16x32_bf16 v[36:39], a[36:39], v[136:139], v[36:39]
    ds_read_b64_tr_b16 v[136:137], v6 offset:14432
    ds_read_b64_tr_b16 v[138:139], v6 offset:18016
    s_waitcnt lgkmcnt(10)
    v_mfma_f32_16x16x32_bf16 v[32:35], a[40:43], v[140:143], v[32:35]
    v_mfma_f32_16x16x32_bf16 v[36:39], a[44:47], v[140:143], v[36:39]
    ds_read_b64_tr_b16 v[140:141], v6 offset:21600
    ds_read_b64_tr_b16 v[142:143], v6 offset:25184
    s_waitcnt lgkmcnt(10)
    v_mfma_f32_16x16x32_bf16 v[32:35], a[48:51], v[144:147], v[32:35]
    v_mfma_f32_16x16x32_bf16 v[36:39], a[52:55], v[144:147], v[36:39]
    ds_read_b64_tr_b16 v[144:145], v6 offset:28768
    ds_read_b64_tr_b16 v[146:147], v6 offset:32352
    s_waitcnt lgkmcnt(10)
    v_mfma_f32_16x16x32_bf16 v[32:35], a[56:59], v[148:151], v[32:35]
    v_mfma_f32_16x16x32_bf16 v[36:39], a[60:63], v[148:151], v[36:39]
    ds_read_b64_tr_b16 v[148:149], v6 offset:35936
    ds_read_b64_tr_b16 v[150:151], v6 offset:39520
    s_waitcnt lgkmcnt(10)
    v_mfma_f32_16x16x32_bf16 v[40:43], a[0:3], v[128:131], 0
    v_mfma_f32_16x16x32_bf16 v[44:47], a[4:7], v[128:131], 0
    ds_read_b64_tr_b16 v[128:129], v6 offset:43104
    ds_read_b64_tr_b16 v[130:131], v6 offset:46688
    s_waitcnt lgkmcnt(10)
    v_mfma_f32_16x16x32_bf16 v[40:43], a[8:11], v[132:135], v[40:43]
    v_mfma_f32_16x16x32_bf16 v[44:47], a[12:15], v[132:135], v[44:47]
    ds_read_b64_tr_b16 v[132:133], v6 offset:50272
    ds_read_b64_tr_b16 v[134:135], v6 offset:53856
    s_waitcnt lgkmcnt(10)
    v_mfma_f32_16x16x32_bf16 v[40:43], a[16:19], v[136:139], v[40:43]
    v_cvt_pk_bf16_f32 v32, v32, v36
    v_cvt_pk_bf16_f32 v33, v33, v37
    v_cvt_pk_bf16_f32 v34, v34, v38
    v_mfma_f32_16x16x32_bf16 v[44:47], a[20:23], v[136:139], v[44:47]
    ds_read_b64_tr_b16 v[136:137], v6 offset:128
    ds_read_b64_tr_b16 v[138:139], v6 offset:3712
    s_waitcnt lgkmcnt(10)
    v_mfma_f32_16x16x32_bf16 v[40:43], a[24:27], v[140:143], v[40:43]
    v_cvt_pk_bf16_f32 v35, v35, v39
    v_mfma_f32_16x16x32_bf16 v[44:47], a[28:31], v[140:143], v[44:47]
    buffer_store_dwordx4 v[32:35], v5, s[4:7], s49 offen offset:0 sc1
    s_add_u32 s49, s49, s48
    ds_read_b64_tr_b16 v[140:141], v6 offset:7296
    ds_read_b64_tr_b16 v[142:143], v6 offset:10880
    s_waitcnt lgkmcnt(10)
    v_mfma_f32_16x16x32_bf16 v[40:43], a[32:35], v[144:147], v[40:43]
    v_mfma_f32_16x16x32_bf16 v[44:47], a[36:39], v[144:147], v[44:47]
    ds_read_b64_tr_b16 v[144:145], v6 offset:14464
    ds_read_b64_tr_b16 v[146:147], v6 offset:18048
    s_waitcnt lgkmcnt(10)
    v_mfma_f32_16x16x32_bf16 v[40:43], a[40:43], v[148:151], v[40:43]
    v_mfma_f32_16x16x32_bf16 v[44:47], a[44:47], v[148:151], v[44:47]
    ds_read_b64_tr_b16 v[148:149], v6 offset:21632
    ds_read_b64_tr_b16 v[150:151], v6 offset:25216
    s_waitcnt lgkmcnt(10)
    v_mfma_f32_16x16x32_bf16 v[40:43], a[48:51], v[128:131], v[40:43]
    v_mfma_f32_16x16x32_bf16 v[44:47], a[52:55], v[128:131], v[44:47]
    ds_read_b64_tr_b16 v[128:129], v6 offset:28800
    ds_read_b64_tr_b16 v[130:131], v6 offset:32384
    s_waitcnt lgkmcnt(10)
    v_mfma_f32_16x16x32_bf16 v[40:43], a[56:59], v[132:135], v[40:43]
    v_mfma_f32_16x16x32_bf16 v[44:47], a[60:63], v[132:135], v[44:47]
    ds_read_b64_tr_b16 v[132:133], v6 offset:35968
    ds_read_b64_tr_b16 v[134:135], v6 offset:39552
    s_waitcnt lgkmcnt(10)
    v_mfma_f32_16x16x32_bf16 v[48:51], a[0:3], v[136:139], 0
    v_mfma_f32_16x16x32_bf16 v[52:55], a[4:7], v[136:139], 0
    ds_read_b64_tr_b16 v[136:137], v6 offset:43136
    ds_read_b64_tr_b16 v[138:139], v6 offset:46720
    s_waitcnt lgkmcnt(10)
    v_mfma_f32_16x16x32_bf16 v[48:51], a[8:11], v[140:143], v[48:51]
    v_mfma_f32_16x16x32_bf16 v[52:55], a[12:15], v[140:143], v[52:55]
    ds_read_b64_tr_b16 v[140:141], v6 offset:50304
    ds_read_b64_tr_b16 v[142:143], v6 offset:53888
    s_waitcnt lgkmcnt(10)
    v_mfma_f32_16x16x32_bf16 v[48:51], a[16:19], v[144:147], v[48:51]
    v_cvt_pk_bf16_f32 v40, v40, v44
    v_cvt_pk_bf16_f32 v41, v41, v45
    v_cvt_pk_bf16_f32 v42, v42, v46
    v_mfma_f32_16x16x32_bf16 v[52:55], a[20:23], v[144:147], v[52:55]
    ds_read_b64_tr_b16 v[144:145], v6 offset:160
    ds_read_b64_tr_b16 v[146:147], v6 offset:3744
    s_waitcnt lgkmcnt(10)
    v_mfma_f32_16x16x32_bf16 v[48:51], a[24:27], v[148:151], v[48:51]
    v_cvt_pk_bf16_f32 v43, v43, v47
    v_mfma_f32_16x16x32_bf16 v[52:55], a[28:31], v[148:151], v[52:55]
    buffer_store_dwordx4 v[40:43], v5, s[4:7], s49 offen offset:0 sc1
    s_add_u32 s49, s49, s48
    ds_read_b64_tr_b16 v[148:149], v6 offset:7328
    ds_read_b64_tr_b16 v[150:151], v6 offset:10912
    s_waitcnt lgkmcnt(10)
    v_mfma_f32_16x16x32_bf16 v[48:51], a[32:35], v[128:131], v[48:51]
    v_mfma_f32_16x16x32_bf16 v[52:55], a[36:39], v[128:131], v[52:55]
    ds_read_b64_tr_b16 v[128:129], v6 offset:14496
    ds_read_b64_tr_b16 v[130:131], v6 offset:18080
    s_waitcnt lgkmcnt(10)
    v_mfma_f32_16x16x32_bf16 v[48:51], a[40:43], v[132:135], v[48:51]
    v_mfma_f32_16x16x32_bf16 v[52:55], a[44:47], v[132:135], v[52:55]
    ds_read_b64_tr_b16 v[132:133], v6 offset:21664
    ds_read_b64_tr_b16 v[134:135], v6 offset:25248
    s_waitcnt lgkmcnt(10)
    v_mfma_f32_16x16x32_bf16 v[48:51], a[48:51], v[136:139], v[48:51]
    v_mfma_f32_16x16x32_bf16 v[52:55], a[52:55], v[136:139], v[52:55]
    ds_read_b64_tr_b16 v[136:137], v6 offset:28832
    ds_read_b64_tr_b16 v[138:139], v6 offset:32416
    s_waitcnt lgkmcnt(10)
    v_mfma_f32_16x16x32_bf16 v[48:51], a[56:59], v[140:143], v[48:51]
    v_mfma_f32_16x16x32_bf16 v[52:55], a[60:63], v[140:143], v[52:55]
    ds_read_b64_tr_b16 v[140:141], v6 offset:36000
    ds_read_b64_tr_b16 v[142:143], v6 offset:39584
    s_waitcnt lgkmcnt(10)
    v_mfma_f32_16x16x32_bf16 v[56:59], a[0:3], v[144:147], 0
    v_mfma_f32_16x16x32_bf16 v[60:63], a[4:7], v[144:147], 0
    ds_read_b64_tr_b16 v[144:145], v6 offset:43168
    ds_read_b64_tr_b16 v[146:147], v6 offset:46752
    s_waitcnt lgkmcnt(10)
    v_mfma_f32_16x16x32_bf16 v[56:59], a[8:11], v[148:151], v[56:59]
    v_mfma_f32_16x16x32_bf16 v[60:63], a[12:15], v[148:151], v[60:63]
    ds_read_b64_tr_b16 v[148:149], v6 offset:50336
    ds_read_b64_tr_b16 v[150:151], v6 offset:53920
    s_waitcnt lgkmcnt(10)
    v_mfma_f32_16x16x32_bf16 v[56:59], a[16:19], v[128:131], v[56:59]
    v_cvt_pk_bf16_f32 v48, v48, v52
    v_cvt_pk_bf16_f32 v49, v49, v53
    v_cvt_pk_bf16_f32 v50, v50, v54
    v_mfma_f32_16x16x32_bf16 v[60:63], a[20:23], v[128:131], v[60:63]
    ds_read_b64_tr_b16 v[128:129], v6 offset:192
    ds_read_b64_tr_b16 v[130:131], v6 offset:3776
    s_waitcnt lgkmcnt(10)
    v_mfma_f32_16x16x32_bf16 v[56:59], a[24:27], v[132:135], v[56:59]
    v_cvt_pk_bf16_f32 v51, v51, v55
    v_mfma_f32_16x16x32_bf16 v[60:63], a[28:31], v[132:135], v[60:63]
    buffer_store_dwordx4 v[48:51], v5, s[4:7], s49 offen offset:0 sc1
    s_add_u32 s49, s49, s48
    ds_read_b64_tr_b16 v[132:133], v6 offset:7360
    ds_read_b64_tr_b16 v[134:135], v6 offset:10944
    s_waitcnt lgkmcnt(10)
    v_mfma_f32_16x16x32_bf16 v[56:59], a[32:35], v[136:139], v[56:59]
    v_mfma_f32_16x16x32_bf16 v[60:63], a[36:39], v[136:139], v[60:63]
    ds_read_b64_tr_b16 v[136:137], v6 offset:14528
    ds_read_b64_tr_b16 v[138:139], v6 offset:18112
    s_waitcnt lgkmcnt(10)
    v_mfma_f32_16x16x32_bf16 v[56:59], a[40:43], v[140:143], v[56:59]
    v_mfma_f32_16x16x32_bf16 v[60:63], a[44:47], v[140:143], v[60:63]
    ds_read_b64_tr_b16 v[140:141], v6 offset:21696
    ds_read_b64_tr_b16 v[142:143], v6 offset:25280
    s_waitcnt lgkmcnt(10)
    v_mfma_f32_16x16x32_bf16 v[56:59], a[48:51], v[144:147], v[56:59]
    v_mfma_f32_16x16x32_bf16 v[60:63], a[52:55], v[144:147], v[60:63]
    ds_read_b64_tr_b16 v[144:145], v6 offset:28864
    ds_read_b64_tr_b16 v[146:147], v6 offset:32448
    s_waitcnt lgkmcnt(10)
    v_mfma_f32_16x16x32_bf16 v[56:59], a[56:59], v[148:151], v[56:59]
    v_mfma_f32_16x16x32_bf16 v[60:63], a[60:63], v[148:151], v[60:63]
    ds_read_b64_tr_b16 v[148:149], v6 offset:36032
    ds_read_b64_tr_b16 v[150:151], v6 offset:39616
    s_waitcnt lgkmcnt(10)
    v_mfma_f32_16x16x32_bf16 v[64:67], a[0:3], v[128:131], 0
    v_mfma_f32_16x16x32_bf16 v[68:71], a[4:7], v[128:131], 0
    ds_read_b64_tr_b16 v[128:129], v6 offset:43200
    ds_read_b64_tr_b16 v[130:131], v6 offset:46784
    s_waitcnt lgkmcnt(10)
    v_mfma_f32_16x16x32_bf16 v[64:67], a[8:11], v[132:135], v[64:67]
    v_mfma_f32_16x16x32_bf16 v[68:71], a[12:15], v[132:135], v[68:71]
    ds_read_b64_tr_b16 v[132:133], v6 offset:50368
    ds_read_b64_tr_b16 v[134:135], v6 offset:53952
    s_waitcnt lgkmcnt(10)
    v_mfma_f32_16x16x32_bf16 v[64:67], a[16:19], v[136:139], v[64:67]
    v_cvt_pk_bf16_f32 v56, v56, v60
    v_cvt_pk_bf16_f32 v57, v57, v61
    v_cvt_pk_bf16_f32 v58, v58, v62
    v_mfma_f32_16x16x32_bf16 v[68:71], a[20:23], v[136:139], v[68:71]
    s_waitcnt lgkmcnt(8)
    v_mfma_f32_16x16x32_bf16 v[64:67], a[24:27], v[140:143], v[64:67]
    v_cvt_pk_bf16_f32 v59, v59, v63
    v_mfma_f32_16x16x32_bf16 v[68:71], a[28:31], v[140:143], v[68:71]
    buffer_store_dwordx4 v[56:59], v5, s[4:7], s49 offen offset:0 sc1
    s_add_u32 s49, s49, s48
    s_waitcnt lgkmcnt(6)
    v_mfma_f32_16x16x32_bf16 v[64:67], a[32:35], v[144:147], v[64:67]
    v_mfma_f32_16x16x32_bf16 v[68:71], a[36:39], v[144:147], v[68:71]
    s_waitcnt lgkmcnt(4)
    v_mfma_f32_16x16x32_bf16 v[64:67], a[40:43], v[148:151], v[64:67]
    v_mfma_f32_16x16x32_bf16 v[68:71], a[44:47], v[148:151], v[68:71]
    s_waitcnt lgkmcnt(2)
    v_mfma_f32_16x16x32_bf16 v[64:67], a[48:51], v[128:131], v[64:67]
    v_mfma_f32_16x16x32_bf16 v[68:71], a[52:55], v[128:131], v[68:71]
    s_waitcnt lgkmcnt(0)
    v_mfma_f32_16x16x32_bf16 v[64:67], a[56:59], v[132:135], v[64:67]
    v_mfma_f32_16x16x32_bf16 v[68:71], a[60:63], v[132:135], v[68:71]
    s_waitcnt vmcnt(6)
    ds_read_b128 a[64:67], v1 offset:0
    ds_read_b128 a[68:71], v1 offset:8192
    ds_read_b128 a[72:75], v2 offset:0
    ds_read_b128 a[76:79], v2 offset:8192
    ds_read_b128 a[80:83], v1 offset:2048
    ds_read_b128 a[84:87], v1 offset:10240
    ds_read_b128 a[88:91], v2 offset:2048
    ds_read_b128 a[92:95], v2 offset:10240
    s_waitcnt lgkmcnt(4)
    ds_read_b128 a[96:99], v1 offset:4096
    ds_read_b128 a[100:103], v1 offset:12288
    ds_read_b128 a[104:107], v2 offset:4096
    ds_read_b128 a[108:111], v2 offset:12288
    ds_read_b128 a[112:115], v1 offset:6144
    ds_read_b128 a[116:119], v1 offset:14336
    ds_read_b128 a[120:123], v2 offset:6144
    ds_read_b128 a[124:127], v2 offset:14336
    s_waitcnt lgkmcnt(0)
    ds_read_b64_tr_b16 v[128:129], v6 offset:0
    ds_read_b64_tr_b16 v[130:131], v6 offset:3584
    ds_read_b64_tr_b16 v[132:133], v6 offset:7168
    ds_read_b64_tr_b16 v[134:135], v6 offset:10752
    ds_read_b64_tr_b16 v[136:137], v6 offset:14336
    ds_read_b64_tr_b16 v[138:139], v6 offset:17920
    ds_read_b64_tr_b16 v[140:141], v6 offset:21504
    ds_read_b64_tr_b16 v[142:143], v6 offset:25088
    ds_read_b64_tr_b16 v[144:145], v6 offset:28672
    ds_read_b64_tr_b16 v[146:147], v6 offset:32256
    ds_read_b64_tr_b16 v[148:149], v6 offset:35840
    ds_read_b64_tr_b16 v[150:151], v6 offset:39424
    s_waitcnt lgkmcnt(10)
    v_mfma_f32_16x16x32_bf16 v[72:75], a[64:67], v[128:131], 0
    v_mfma_f32_16x16x32_bf16 v[76:79], a[68:71], v[128:131], 0
    ds_read_b64_tr_b16 v[128:129], v6 offset:43008
    ds_read_b64_tr_b16 v[130:131], v6 offset:46592
    s_waitcnt lgkmcnt(10)
    v_mfma_f32_16x16x32_bf16 v[72:75], a[72:75], v[132:135], v[72:75]
    v_mfma_f32_16x16x32_bf16 v[76:79], a[76:79], v[132:135], v[76:79]
    ds_read_b64_tr_b16 v[132:133], v6 offset:50176
    ds_read_b64_tr_b16 v[134:135], v6 offset:53760
    s_waitcnt lgkmcnt(10)
    v_mfma_f32_16x16x32_bf16 v[72:75], a[80:83], v[136:139], v[72:75]
    v_cvt_pk_bf16_f32 v64, v64, v68
    v_cvt_pk_bf16_f32 v65, v65, v69
    v_cvt_pk_bf16_f32 v66, v66, v70
    v_mfma_f32_16x16x32_bf16 v[76:79], a[84:87], v[136:139], v[76:79]
    ds_read_b64_tr_b16 v[136:137], v6 offset:32
    ds_read_b64_tr_b16 v[138:139], v6 offset:3616
    s_waitcnt lgkmcnt(10)
    v_mfma_f32_16x16x32_bf16 v[72:75], a[88:91], v[140:143], v[72:75]
    v_cvt_pk_bf16_f32 v67, v67, v71
    v_mfma_f32_16x16x32_bf16 v[76:79], a[92:95], v[140:143], v[76:79]
    buffer_store_dwordx4 v[64:67], v5, s[4:7], s49 offen offset:0 sc1
    s_add_u32 s49, s49, s48
    ds_read_b64_tr_b16 v[140:141], v6 offset:7200
    ds_read_b64_tr_b16 v[142:143], v6 offset:10784
    s_waitcnt lgkmcnt(10)
    v_mfma_f32_16x16x32_bf16 v[72:75], a[96:99], v[144:147], v[72:75]
    v_mfma_f32_16x16x32_bf16 v[76:79], a[100:103], v[144:147], v[76:79]
    ds_read_b64_tr_b16 v[144:145], v6 offset:14368
    ds_read_b64_tr_b16 v[146:147], v6 offset:17952
    s_waitcnt lgkmcnt(10)
    v_mfma_f32_16x16x32_bf16 v[72:75], a[104:107], v[148:151], v[72:75]
    v_mfma_f32_16x16x32_bf16 v[76:79], a[108:111], v[148:151], v[76:79]
    ds_read_b64_tr_b16 v[148:149], v6 offset:21536
    ds_read_b64_tr_b16 v[150:151], v6 offset:25120
    s_waitcnt lgkmcnt(10)
    v_mfma_f32_16x16x32_bf16 v[72:75], a[112:115], v[128:131], v[72:75]
    v_mfma_f32_16x16x32_bf16 v[76:79], a[116:119], v[128:131], v[76:79]
    ds_read_b64_tr_b16 v[128:129], v6 offset:28704
    ds_read_b64_tr_b16 v[130:131], v6 offset:32288
    s_waitcnt lgkmcnt(10)
    v_mfma_f32_16x16x32_bf16 v[72:75], a[120:123], v[132:135], v[72:75]
    v_mfma_f32_16x16x32_bf16 v[76:79], a[124:127], v[132:135], v[76:79]
    ds_read_b64_tr_b16 v[132:133], v6 offset:35872
    ds_read_b64_tr_b16 v[134:135], v6 offset:39456
    s_waitcnt lgkmcnt(10)
    v_mfma_f32_16x16x32_bf16 v[80:83], a[64:67], v[136:139], 0
    v_mfma_f32_16x16x32_bf16 v[84:87], a[68:71], v[136:139], 0
    ds_read_b64_tr_b16 v[136:137], v6 offset:43040
    ds_read_b64_tr_b16 v[138:139], v6 offset:46624
    s_waitcnt lgkmcnt(10)
    v_mfma_f32_16x16x32_bf16 v[80:83], a[72:75], v[140:143], v[80:83]
    v_mfma_f32_16x16x32_bf16 v[84:87], a[76:79], v[140:143], v[84:87]
    ds_read_b64_tr_b16 v[140:141], v6 offset:50208
    ds_read_b64_tr_b16 v[142:143], v6 offset:53792
    s_waitcnt lgkmcnt(10)
    v_mfma_f32_16x16x32_bf16 v[80:83], a[80:83], v[144:147], v[80:83]
    s_mov_b32 s49, s47
    v_cvt_pk_bf16_f32 v72, v72, v76
    v_cvt_pk_bf16_f32 v73, v73, v77
    v_cvt_pk_bf16_f32 v74, v74, v78
    v_mfma_f32_16x16x32_bf16 v[84:87], a[84:87], v[144:147], v[84:87]
    ds_read_b64_tr_b16 v[144:145], v6 offset:64
    ds_read_b64_tr_b16 v[146:147], v6 offset:3648
    s_waitcnt lgkmcnt(10)
    v_mfma_f32_16x16x32_bf16 v[80:83], a[88:91], v[148:151], v[80:83]
    v_cvt_pk_bf16_f32 v75, v75, v79
    v_mfma_f32_16x16x32_bf16 v[84:87], a[92:95], v[148:151], v[84:87]
    buffer_store_dwordx4 v[72:75], v5, s[4:7], s49 offen offset:1024 sc1
    s_add_u32 s49, s49, s48
    ds_read_b64_tr_b16 v[148:149], v6 offset:7232
    ds_read_b64_tr_b16 v[150:151], v6 offset:10816
    s_waitcnt lgkmcnt(10)
    v_mfma_f32_16x16x32_bf16 v[80:83], a[96:99], v[128:131], v[80:83]
    v_mfma_f32_16x16x32_bf16 v[84:87], a[100:103], v[128:131], v[84:87]
    ds_read_b64_tr_b16 v[128:129], v6 offset:14400
    ds_read_b64_tr_b16 v[130:131], v6 offset:17984
    s_waitcnt lgkmcnt(10)
    v_mfma_f32_16x16x32_bf16 v[80:83], a[104:107], v[132:135], v[80:83]
    v_mfma_f32_16x16x32_bf16 v[84:87], a[108:111], v[132:135], v[84:87]
    ds_read_b64_tr_b16 v[132:133], v6 offset:21568
    ds_read_b64_tr_b16 v[134:135], v6 offset:25152
    s_waitcnt lgkmcnt(10)
    v_mfma_f32_16x16x32_bf16 v[80:83], a[112:115], v[136:139], v[80:83]
    v_mfma_f32_16x16x32_bf16 v[84:87], a[116:119], v[136:139], v[84:87]
    ds_read_b64_tr_b16 v[136:137], v6 offset:28736
    ds_read_b64_tr_b16 v[138:139], v6 offset:32320
    s_waitcnt lgkmcnt(10)
    v_mfma_f32_16x16x32_bf16 v[80:83], a[120:123], v[140:143], v[80:83]
    v_mfma_f32_16x16x32_bf16 v[84:87], a[124:127], v[140:143], v[84:87]
    ds_read_b64_tr_b16 v[140:141], v6 offset:35904
    ds_read_b64_tr_b16 v[142:143], v6 offset:39488
    s_waitcnt lgkmcnt(10)
    v_mfma_f32_16x16x32_bf16 v[88:91], a[64:67], v[144:147], 0
    v_mfma_f32_16x16x32_bf16 v[92:95], a[68:71], v[144:147], 0
    ds_read_b64_tr_b16 v[144:145], v6 offset:43072
    ds_read_b64_tr_b16 v[146:147], v6 offset:46656
    s_waitcnt lgkmcnt(10)
    v_mfma_f32_16x16x32_bf16 v[88:91], a[72:75], v[148:151], v[88:91]
    v_mfma_f32_16x16x32_bf16 v[92:95], a[76:79], v[148:151], v[92:95]
    ds_read_b64_tr_b16 v[148:149], v6 offset:50240
    ds_read_b64_tr_b16 v[150:151], v6 offset:53824
    s_waitcnt lgkmcnt(10)
    v_mfma_f32_16x16x32_bf16 v[88:91], a[80:83], v[128:131], v[88:91]
    v_cvt_pk_bf16_f32 v80, v80, v84
    v_cvt_pk_bf16_f32 v81, v81, v85
    v_cvt_pk_bf16_f32 v82, v82, v86
    v_mfma_f32_16x16x32_bf16 v[92:95], a[84:87], v[128:131], v[92:95]
    ds_read_b64_tr_b16 v[128:129], v6 offset:96
    ds_read_b64_tr_b16 v[130:131], v6 offset:3680
    s_waitcnt lgkmcnt(10)
    v_mfma_f32_16x16x32_bf16 v[88:91], a[88:91], v[132:135], v[88:91]
    v_cvt_pk_bf16_f32 v83, v83, v87
    v_mfma_f32_16x16x32_bf16 v[92:95], a[92:95], v[132:135], v[92:95]
    buffer_store_dwordx4 v[80:83], v5, s[4:7], s49 offen offset:1024 sc1
    s_add_u32 s49, s49, s48
    ds_read_b64_tr_b16 v[132:133], v6 offset:7264
    ds_read_b64_tr_b16 v[134:135], v6 offset:10848
    s_waitcnt lgkmcnt(10)
    v_mfma_f32_16x16x32_bf16 v[88:91], a[96:99], v[136:139], v[88:91]
    v_mfma_f32_16x16x32_bf16 v[92:95], a[100:103], v[136:139], v[92:95]
    ds_read_b64_tr_b16 v[136:137], v6 offset:14432
    ds_read_b64_tr_b16 v[138:139], v6 offset:18016
    s_waitcnt lgkmcnt(10)
    v_mfma_f32_16x16x32_bf16 v[88:91], a[104:107], v[140:143], v[88:91]
    v_mfma_f32_16x16x32_bf16 v[92:95], a[108:111], v[140:143], v[92:95]
    ds_read_b64_tr_b16 v[140:141], v6 offset:21600
    ds_read_b64_tr_b16 v[142:143], v6 offset:25184
    s_waitcnt lgkmcnt(10)
    v_mfma_f32_16x16x32_bf16 v[88:91], a[112:115], v[144:147], v[88:91]
    v_mfma_f32_16x16x32_bf16 v[92:95], a[116:119], v[144:147], v[92:95]
    ds_read_b64_tr_b16 v[144:145], v6 offset:28768
    ds_read_b64_tr_b16 v[146:147], v6 offset:32352
    s_waitcnt lgkmcnt(10)
    v_mfma_f32_16x16x32_bf16 v[88:91], a[120:123], v[148:151], v[88:91]
    v_mfma_f32_16x16x32_bf16 v[92:95], a[124:127], v[148:151], v[92:95]
    ds_read_b64_tr_b16 v[148:149], v6 offset:35936
    ds_read_b64_tr_b16 v[150:151], v6 offset:39520
    s_waitcnt lgkmcnt(10)
    v_mfma_f32_16x16x32_bf16 v[96:99], a[64:67], v[128:131], 0
    v_mfma_f32_16x16x32_bf16 v[100:103], a[68:71], v[128:131], 0
    ds_read_b64_tr_b16 v[128:129], v6 offset:43104
    ds_read_b64_tr_b16 v[130:131], v6 offset:46688
    s_waitcnt lgkmcnt(10)
    v_mfma_f32_16x16x32_bf16 v[96:99], a[72:75], v[132:135], v[96:99]
    v_mfma_f32_16x16x32_bf16 v[100:103], a[76:79], v[132:135], v[100:103]
    ds_read_b64_tr_b16 v[132:133], v6 offset:50272
    ds_read_b64_tr_b16 v[134:135], v6 offset:53856
    s_waitcnt lgkmcnt(10)
    v_mfma_f32_16x16x32_bf16 v[96:99], a[80:83], v[136:139], v[96:99]
    v_cvt_pk_bf16_f32 v88, v88, v92
    v_cvt_pk_bf16_f32 v89, v89, v93
    v_cvt_pk_bf16_f32 v90, v90, v94
    v_mfma_f32_16x16x32_bf16 v[100:103], a[84:87], v[136:139], v[100:103]
    ds_read_b64_tr_b16 v[136:137], v6 offset:128
    ds_read_b64_tr_b16 v[138:139], v6 offset:3712
    s_waitcnt lgkmcnt(10)
    v_mfma_f32_16x16x32_bf16 v[96:99], a[88:91], v[140:143], v[96:99]
    v_cvt_pk_bf16_f32 v91, v91, v95
    v_mfma_f32_16x16x32_bf16 v[100:103], a[92:95], v[140:143], v[100:103]
    buffer_store_dwordx4 v[88:91], v5, s[4:7], s49 offen offset:1024 sc1
    s_add_u32 s49, s49, s48
    ds_read_b64_tr_b16 v[140:141], v6 offset:7296
    ds_read_b64_tr_b16 v[142:143], v6 offset:10880
    s_waitcnt lgkmcnt(10)
    v_mfma_f32_16x16x32_bf16 v[96:99], a[96:99], v[144:147], v[96:99]
    v_mfma_f32_16x16x32_bf16 v[100:103], a[100:103], v[144:147], v[100:103]
    ds_read_b64_tr_b16 v[144:145], v6 offset:14464
    ds_read_b64_tr_b16 v[146:147], v6 offset:18048
    s_waitcnt lgkmcnt(10)
    v_mfma_f32_16x16x32_bf16 v[96:99], a[104:107], v[148:151], v[96:99]
    v_mfma_f32_16x16x32_bf16 v[100:103], a[108:111], v[148:151], v[100:103]
    ds_read_b64_tr_b16 v[148:149], v6 offset:21632
    ds_read_b64_tr_b16 v[150:151], v6 offset:25216
    s_waitcnt lgkmcnt(10)
    v_mfma_f32_16x16x32_bf16 v[96:99], a[112:115], v[128:131], v[96:99]
    v_mfma_f32_16x16x32_bf16 v[100:103], a[116:119], v[128:131], v[100:103]
    ds_read_b64_tr_b16 v[128:129], v6 offset:28800
    ds_read_b64_tr_b16 v[130:131], v6 offset:32384
    s_waitcnt lgkmcnt(10)
    v_mfma_f32_16x16x32_bf16 v[96:99], a[120:123], v[132:135], v[96:99]
    v_mfma_f32_16x16x32_bf16 v[100:103], a[124:127], v[132:135], v[100:103]
    ds_read_b64_tr_b16 v[132:133], v6 offset:35968
    ds_read_b64_tr_b16 v[134:135], v6 offset:39552
    s_waitcnt lgkmcnt(10)
    v_mfma_f32_16x16x32_bf16 v[104:107], a[64:67], v[136:139], 0
    v_mfma_f32_16x16x32_bf16 v[108:111], a[68:71], v[136:139], 0
    ds_read_b64_tr_b16 v[136:137], v6 offset:43136
    ds_read_b64_tr_b16 v[138:139], v6 offset:46720
    s_waitcnt lgkmcnt(10)
    v_mfma_f32_16x16x32_bf16 v[104:107], a[72:75], v[140:143], v[104:107]
    v_mfma_f32_16x16x32_bf16 v[108:111], a[76:79], v[140:143], v[108:111]
    ds_read_b64_tr_b16 v[140:141], v6 offset:50304
    ds_read_b64_tr_b16 v[142:143], v6 offset:53888
    s_waitcnt lgkmcnt(10)
    v_mfma_f32_16x16x32_bf16 v[104:107], a[80:83], v[144:147], v[104:107]
    v_cvt_pk_bf16_f32 v96, v96, v100
    v_cvt_pk_bf16_f32 v97, v97, v101
    v_cvt_pk_bf16_f32 v98, v98, v102
    v_mfma_f32_16x16x32_bf16 v[108:111], a[84:87], v[144:147], v[108:111]
    ds_read_b64_tr_b16 v[144:145], v6 offset:160
    ds_read_b64_tr_b16 v[146:147], v6 offset:3744
    s_waitcnt lgkmcnt(10)
    v_mfma_f32_16x16x32_bf16 v[104:107], a[88:91], v[148:151], v[104:107]
    v_cvt_pk_bf16_f32 v99, v99, v103
    v_mfma_f32_16x16x32_bf16 v[108:111], a[92:95], v[148:151], v[108:111]
    buffer_store_dwordx4 v[96:99], v5, s[4:7], s49 offen offset:1024 sc1
    s_add_u32 s49, s49, s48
    ds_read_b64_tr_b16 v[148:149], v6 offset:7328
    ds_read_b64_tr_b16 v[150:151], v6 offset:10912
    s_waitcnt lgkmcnt(10)
    v_mfma_f32_16x16x32_bf16 v[104:107], a[96:99], v[128:131], v[104:107]
    v_mfma_f32_16x16x32_bf16 v[108:111], a[100:103], v[128:131], v[108:111]
    ds_read_b64_tr_b16 v[128:129], v6 offset:14496
    ds_read_b64_tr_b16 v[130:131], v6 offset:18080
    s_waitcnt lgkmcnt(10)
    v_mfma_f32_16x16x32_bf16 v[104:107], a[104:107], v[132:135], v[104:107]
    v_mfma_f32_16x16x32_bf16 v[108:111], a[108:111], v[132:135], v[108:111]
    ds_read_b64_tr_b16 v[132:133], v6 offset:21664
    ds_read_b64_tr_b16 v[134:135], v6 offset:25248
    s_waitcnt lgkmcnt(10)
    v_mfma_f32_16x16x32_bf16 v[104:107], a[112:115], v[136:139], v[104:107]
    v_mfma_f32_16x16x32_bf16 v[108:111], a[116:119], v[136:139], v[108:111]
    ds_read_b64_tr_b16 v[136:137], v6 offset:28832
    ds_read_b64_tr_b16 v[138:139], v6 offset:32416
    s_waitcnt lgkmcnt(10)
    v_mfma_f32_16x16x32_bf16 v[104:107], a[120:123], v[140:143], v[104:107]
    v_mfma_f32_16x16x32_bf16 v[108:111], a[124:127], v[140:143], v[108:111]
    ds_read_b64_tr_b16 v[140:141], v6 offset:36000
    ds_read_b64_tr_b16 v[142:143], v6 offset:39584
    s_waitcnt lgkmcnt(10)
    v_mfma_f32_16x16x32_bf16 v[112:115], a[64:67], v[144:147], 0
    v_mfma_f32_16x16x32_bf16 v[116:119], a[68:71], v[144:147], 0
    ds_read_b64_tr_b16 v[144:145], v6 offset:43168
    ds_read_b64_tr_b16 v[146:147], v6 offset:46752
    s_waitcnt lgkmcnt(10)
    v_mfma_f32_16x16x32_bf16 v[112:115], a[72:75], v[148:151], v[112:115]
    v_mfma_f32_16x16x32_bf16 v[116:119], a[76:79], v[148:151], v[116:119]
    ds_read_b64_tr_b16 v[148:149], v6 offset:50336
    ds_read_b64_tr_b16 v[150:151], v6 offset:53920
    s_waitcnt lgkmcnt(10)
    v_mfma_f32_16x16x32_bf16 v[112:115], a[80:83], v[128:131], v[112:115]
    v_cvt_pk_bf16_f32 v104, v104, v108
    v_cvt_pk_bf16_f32 v105, v105, v109
    v_cvt_pk_bf16_f32 v106, v106, v110
    v_mfma_f32_16x16x32_bf16 v[116:119], a[84:87], v[128:131], v[116:119]
    ds_read_b64_tr_b16 v[128:129], v6 offset:192
    ds_read_b64_tr_b16 v[130:131], v6 offset:3776
    s_waitcnt lgkmcnt(10)
    v_mfma_f32_16x16x32_bf16 v[112:115], a[88:91], v[132:135], v[112:115]
    v_cvt_pk_bf16_f32 v107, v107, v111
    v_mfma_f32_16x16x32_bf16 v[116:119], a[92:95], v[132:135], v[116:119]
    buffer_store_dwordx4 v[104:107], v5, s[4:7], s49 offen offset:1024 sc1
    s_add_u32 s49, s49, s48
    ds_read_b64_tr_b16 v[132:133], v6 offset:7360
    ds_read_b64_tr_b16 v[134:135], v6 offset:10944
    s_waitcnt lgkmcnt(10)
    v_mfma_f32_16x16x32_bf16 v[112:115], a[96:99], v[136:139], v[112:115]
    v_mfma_f32_16x16x32_bf16 v[116:119], a[100:103], v[136:139], v[116:119]
    ds_read_b64_tr_b16 v[136:137], v6 offset:14528
    ds_read_b64_tr_b16 v[138:139], v6 offset:18112
    s_waitcnt lgkmcnt(10)
    v_mfma_f32_16x16x32_bf16 v[112:115], a[104:107], v[140:143], v[112:115]
    v_mfma_f32_16x16x32_bf16 v[116:119], a[108:111], v[140:143], v[116:119]
    ds_read_b64_tr_b16 v[140:141], v6 offset:21696
    ds_read_b64_tr_b16 v[142:143], v6 offset:25280
    s_waitcnt lgkmcnt(10)
    v_mfma_f32_16x16x32_bf16 v[112:115], a[112:115], v[144:147], v[112:115]
    v_mfma_f32_16x16x32_bf16 v[116:119], a[116:119], v[144:147], v[116:119]
    ds_read_b64_tr_b16 v[144:145], v6 offset:28864
    ds_read_b64_tr_b16 v[146:147], v6 offset:32448
    s_waitcnt lgkmcnt(10)
    v_mfma_f32_16x16x32_bf16 v[112:115], a[120:123], v[148:151], v[112:115]
    v_mfma_f32_16x16x32_bf16 v[116:119], a[124:127], v[148:151], v[116:119]
    ds_read_b64_tr_b16 v[148:149], v6 offset:36032
    ds_read_b64_tr_b16 v[150:151], v6 offset:39616
    s_waitcnt lgkmcnt(10)
    v_mfma_f32_16x16x32_bf16 v[120:123], a[64:67], v[128:131], 0
    v_mfma_f32_16x16x32_bf16 v[124:127], a[68:71], v[128:131], 0
    ds_read_b64_tr_b16 v[128:129], v6 offset:43200
    ds_read_b64_tr_b16 v[130:131], v6 offset:46784
    s_waitcnt lgkmcnt(10)
    v_mfma_f32_16x16x32_bf16 v[120:123], a[72:75], v[132:135], v[120:123]
    v_mfma_f32_16x16x32_bf16 v[124:127], a[76:79], v[132:135], v[124:127]
    ds_read_b64_tr_b16 v[132:133], v6 offset:50368
    ds_read_b64_tr_b16 v[134:135], v6 offset:53952
    s_waitcnt lgkmcnt(10)
    v_mfma_f32_16x16x32_bf16 v[120:123], a[80:83], v[136:139], v[120:123]
    v_cvt_pk_bf16_f32 v112, v112, v116
    v_cvt_pk_bf16_f32 v113, v113, v117
    v_cvt_pk_bf16_f32 v114, v114, v118
    v_mfma_f32_16x16x32_bf16 v[124:127], a[84:87], v[136:139], v[124:127]
    s_waitcnt lgkmcnt(8)
    v_mfma_f32_16x16x32_bf16 v[120:123], a[88:91], v[140:143], v[120:123]
    v_cvt_pk_bf16_f32 v115, v115, v119
    v_mfma_f32_16x16x32_bf16 v[124:127], a[92:95], v[140:143], v[124:127]
    buffer_store_dwordx4 v[112:115], v5, s[4:7], s49 offen offset:1024 sc1
    s_add_u32 s49, s49, s48
    s_waitcnt lgkmcnt(6)
    v_mfma_f32_16x16x32_bf16 v[120:123], a[96:99], v[144:147], v[120:123]
    v_mfma_f32_16x16x32_bf16 v[124:127], a[100:103], v[144:147], v[124:127]
    s_waitcnt lgkmcnt(4)
    v_mfma_f32_16x16x32_bf16 v[120:123], a[104:107], v[148:151], v[120:123]
    v_mfma_f32_16x16x32_bf16 v[124:127], a[108:111], v[148:151], v[124:127]
    s_waitcnt lgkmcnt(2)
    v_mfma_f32_16x16x32_bf16 v[120:123], a[112:115], v[128:131], v[120:123]
    v_mfma_f32_16x16x32_bf16 v[124:127], a[116:119], v[128:131], v[124:127]
    s_waitcnt lgkmcnt(0)
    v_mfma_f32_16x16x32_bf16 v[120:123], a[120:123], v[132:135], v[120:123]
    v_mfma_f32_16x16x32_bf16 v[124:127], a[124:127], v[132:135], v[124:127]
    s_nop 7
    v_cvt_pk_bf16_f32 v120, v120, v124
    v_cvt_pk_bf16_f32 v121, v121, v125
    v_cvt_pk_bf16_f32 v122, v122, v126
    v_cvt_pk_bf16_f32 v123, v123, v127
    buffer_store_dwordx4 v[120:123], v5, s[4:7], s49 offen offset:1024 sc1
    s_add_u32 s49, s49, s48
P_cenda:
    s_branch P_done
P_w3:
    s_waitcnt vmcnt(30)
    v_lshlrev_b32 v180, 16, v152
    v_and_b32 v181, 0xffff0000, v152
    v_lshlrev_b32 v182, 16, v153
    v_and_b32 v183, 0xffff0000, v153
    v_lshlrev_b32 v184, 16, v154
    v_and_b32 v185, 0xffff0000, v154
    v_lshlrev_b32 v186, 16, v155
    v_and_b32 v187, 0xffff0000, v155
    v_lshlrev_b32 v188, 16, v156
    v_and_b32 v189, 0xffff0000, v156
    v_lshlrev_b32 v190, 16, v157
    v_and_b32 v191, 0xffff0000, v157
    v_lshlrev_b32 v192, 16, v158
    v_and_b32 v193, 0xffff0000, v158
    v_lshlrev_b32 v194, 16, v159
    v_and_b32 v195, 0xffff0000, v159
    v_lshlrev_b32 v196, 16, v160
    v_and_b32 v197, 0xffff0000, v160
    v_lshlrev_b32 v198, 16, v161
    v_and_b32 v199, 0xffff0000, v161
    v_lshlrev_b32 v200, 16, v162
    v_and_b32 v201, 0xffff0000, v162
    v_lshlrev_b32 v202, 16, v163
    v_and_b32 v203, 0xffff0000, v163
    v_lshlrev_b32 v204, 16, v164
    v_and_b32 v205, 0xffff0000, v164
    v_lshlrev_b32 v206, 16, v165
    v_and_b32 v207, 0xffff0000, v165
    v_lshlrev_b32 v208, 16, v166
    v_and_b32 v209, 0xffff0000, v166
    v_lshlrev_b32 v210, 16, v167
    v_and_b32 v211, 0xffff0000, v167
    v_lshlrev_b32 v212, 16, v168
    v_and_b32 v213, 0xffff0000, v168
    v_lshlrev_b32 v214, 16, v169
    v_and_b32 v215, 0xffff0000, v169
    v_lshlrev_b32 v216, 16, v170
    v_and_b32 v217, 0xffff0000, v170
    v_lshlrev_b32 v218, 16, v171
    v_and_b32 v219, 0xffff0000, v171
    v_lshlrev_b32 v220, 16, v172
    v_and_b32 v221, 0xffff0000, v172
    v_lshlrev_b32 v222, 16, v173
    v_and_b32 v223, 0xffff0000, v173
    v_lshlrev_b32 v224, 16, v174
    v_and_b32 v225, 0xffff0000, v174
    v_lshlrev_b32 v226, 16, v175
    v_and_b32 v227, 0xffff0000, v175
    v_lshlrev_b32 v228, 16, v176
    v_and_b32 v229, 0xffff0000, v176
    v_lshlrev_b32 v230, 16, v177
    v_and_b32 v231, 0xffff0000, v177
    v_lshlrev_b32 v232, 16, v178
    v_and_b32 v233, 0xffff0000, v178
    v_lshlrev_b32 v234, 16, v179
    v_and_b32 v235, 0xffff0000, v179
    v_pk_add_f32 v[248:249], v[180:181], v[182:183]
    v_pk_add_f32 v[250:251], v[184:185], v[186:187]
    v_pk_add_f32 v[248:249], v[248:249], v[188:189]
    v_pk_add_f32 v[250:251], v[250:251], v[190:191]
    v_pk_add_f32 v[248:249], v[248:249], v[192:193]
    v_pk_add_f32 v[250:251], v[250:251], v[194:195]
    v_pk_add_f32 v[248:249], v[248:249], v[196:197]
    v_pk_add_f32 v[250:251], v[250:251], v[198:199]
    v_pk_add_f32 v[248:249], v[248:249], v[200:201]
    v_pk_add_f32 v[250:251], v[250:251], v[202:203]
    v_pk_add_f32 v[248:249], v[248:249], v[204:205]
    v_pk_add_f32 v[250:251], v[250:251], v[206:207]
    v_pk_add_f32 v[248:249], v[248:249], v[208:209]
    v_pk_add_f32 v[250:251], v[250:251], v[210:211]
    v_pk_add_f32 v[248:249], v[248:249], v[212:213]
    v_pk_add_f32 v[250:251], v[250:251], v[214:215]
    v_pk_add_f32 v[248:249], v[248:249], v[216:217]
    v_pk_add_f32 v[250:251], v[250:251], v[218:219]
    v_pk_add_f32 v[248:249], v[248:249], v[220:221]
    v_pk_add_f32 v[250:251], v[250:251], v[222:223]
    v_pk_add_f32 v[248:249], v[248:249], v[224:225]
    v_pk_add_f32 v[250:251], v[250:251], v[226:227]
    v_pk_add_f32 v[248:249], v[248:249], v[228:229]
    v_pk_add_f32 v[250:251], v[250:251], v[230:231]
    v_pk_add_f32 v[248:249], v[248:249], v[232:233]
    v_pk_add_f32 v[250:251], v[250:251], v[234:235]
    v_pk_add_f32 v[248:249], v[248:249], v[250:251]
    v_add_f32 v248, v248, v249
    s_nop 1
    v_add_f32_dpp v248, v248, v248 quad_perm:[1,0,3,2] row_mask:0xf bank_mask:0xf
    s_nop 1
    v_add_f32_dpp v248, v248, v248 quad_perm:[2,3,0,1] row_mask:0xf bank_mask:0xf
    s_nop 1
    v_add_f32_dpp v248, v248, v248 row_half_mirror row_mask:0xf bank_mask:0xf
    v_mul_f32 v248, 0x3b124925, v248
    v_mov_b32 v252, v248
    v_cvt_pk_bf16_f32 v252, v252, v252
    v_and_b32 v252, 0xffff0000, v252
    v_pk_add_f32 v[180:181], v[180:181], v[252:253] op_sel_hi:[1,0] neg_lo:[0,1] neg_hi:[0,1]
    v_pk_add_f32 v[182:183], v[182:183], v[252:253] op_sel_hi:[1,0] neg_lo:[0,1] neg_hi:[0,1]
    v_pk_add_f32 v[184:185], v[184:185], v[252:253] op_sel_hi:[1,0] neg_lo:[0,1] neg_hi:[0,1]
    v_pk_add_f32 v[186:187], v[186:187], v[252:253] op_sel_hi:[1,0] neg_lo:[0,1] neg_hi:[0,1]
    v_pk_add_f32 v[188:189], v[188:189], v[252:253] op_sel_hi:[1,0] neg_lo:[0,1] neg_hi:[0,1]
    v_pk_add_f32 v[190:191], v[190:191], v[252:253] op_sel_hi:[1,0] neg_lo:[0,1] neg_hi:[0,1]
    v_pk_add_f32 v[192:193], v[192:193], v[252:253] op_sel_hi:[1,0] neg_lo:[0,1] neg_hi:[0,1]
    v_pk_add_f32 v[194:195], v[194:195], v[252:253] op_sel_hi:[1,0] neg_lo:[0,1] neg_hi:[0,1]
    v_pk_add_f32 v[196:197], v[196:197], v[252:253] op_sel_hi:[1,0] neg_lo:[0,1] neg_hi:[0,1]
    v_pk_add_f32 v[198:199], v[198:199], v[252:253] op_sel_hi:[1,0] neg_lo:[0,1] neg_hi:[0,1]
    v_pk_add_f32 v[200:201], v[200:201], v[252:253] op_sel_hi:[1,0] neg_lo:[0,1] neg_hi:[0,1]
    v_pk_add_f32 v[202:203], v[202:203], v[252:253] op_sel_hi:[1,0] neg_lo:[0,1] neg_hi:[0,1]
    v_pk_add_f32 v[204:205], v[204:205], v[252:253] op_sel_hi:[1,0] neg_lo:[0,1] neg_hi:[0,1]
    v_pk_add_f32 v[206:207], v[206:207], v[252:253] op_sel_hi:[1,0] neg_lo:[0,1] neg_hi:[0,1]
    v_pk_add_f32 v[208:209], v[208:209], v[252:253] op_sel_hi:[1,0] neg_lo:[0,1] neg_hi:[0,1]
    v_pk_add_f32 v[210:211], v[210:211], v[252:253] op_sel_hi:[1,0] neg_lo:[0,1] neg_hi:[0,1]
    v_pk_add_f32 v[212:213], v[212:213], v[252:253] op_sel_hi:[1,0] neg_lo:[0,1] neg_hi:[0,1]
    v_pk_add_f32 v[214:215], v[214:215], v[252:253] op_sel_hi:[1,0] neg_lo:[0,1] neg_hi:[0,1]
    v_pk_add_f32 v[216:217], v[216:217], v[252:253] op_sel_hi:[1,0] neg_lo:[0,1] neg_hi:[0,1]
    v_pk_add_f32 v[218:219], v[218:219], v[252:253] op_sel_hi:[1,0] neg_lo:[0,1] neg_hi:[0,1]
    v_pk_add_f32 v[220:221], v[220:221], v[252:253] op_sel_hi:[1,0] neg_lo:[0,1] neg_hi:[0,1]
    v_pk_add_f32 v[222:223], v[222:223], v[252:253] op_sel_hi:[1,0] neg_lo:[0,1] neg_hi:[0,1]
    v_pk_add_f32 v[224:225], v[224:225], v[252:253] op_sel_hi:[1,0] neg_lo:[0,1] neg_hi:[0,1]
    v_pk_add_f32 v[226:227], v[226:227], v[252:253] op_sel_hi:[1,0] neg_lo:[0,1] neg_hi:[0,1]
    v_pk_add_f32 v[228:229], v[228:229], v[252:253] op_sel_hi:[1,0] neg_lo:[0,1] neg_hi:[0,1]
    v_pk_add_f32 v[230:231], v[230:231], v[252:253] op_sel_hi:[1,0] neg_lo:[0,1] neg_hi:[0,1]
    v_pk_add_f32 v[232:233], v[232:233], v[252:253] op_sel_hi:[1,0] neg_lo:[0,1] neg_hi:[0,1]
    v_pk_add_f32 v[234:235], v[234:235], v[252:253] op_sel_hi:[1,0] neg_lo:[0,1] neg_hi:[0,1]
    v_pk_mul_f32 v[250:251], v[180:181], v[180:181]
    v_pk_fma_f32 v[250:251], v[182:183], v[182:183], v[250:251]
    v_pk_fma_f32 v[250:251], v[184:185], v[184:185], v[250:251]
    v_pk_fma_f32 v[250:251], v[186:187], v[186:187], v[250:251]
    v_pk_fma_f32 v[250:251], v[188:189], v[188:189], v[250:251]
    v_pk_fma_f32 v[250:251], v[190:191], v[190:191], v[250:251]
    v_pk_fma_f32 v[250:251], v[192:193], v[192:193], v[250:251]
    v_pk_fma_f32 v[250:251], v[194:195], v[194:195], v[250:251]
    v_pk_fma_f32 v[250:251], v[196:197], v[196:197], v[250:251]
    v_pk_fma_f32 v[250:251], v[198:199], v[198:199], v[250:251]
    v_pk_fma_f32 v[250:251], v[200:201], v[200:201], v[250:251]
    v_pk_fma_f32 v[250:251], v[202:203], v[202:203], v[250:251]
    v_pk_fma_f32 v[250:251], v[204:205], v[204:205], v[250:251]
    v_pk_fma_f32 v[250:251], v[206:207], v[206:207], v[250:251]
    v_pk_fma_f32 v[250:251], v[208:209], v[208:209], v[250:251]
    v_pk_fma_f32 v[250:251], v[210:211], v[210:211], v[250:251]
    v_pk_fma_f32 v[250:251], v[212:213], v[212:213], v[250:251]
    v_pk_fma_f32 v[250:251], v[214:215], v[214:215], v[250:251]
    v_pk_fma_f32 v[250:251], v[216:217], v[216:217], v[250:251]
    v_pk_fma_f32 v[250:251], v[218:219], v[218:219], v[250:251]
    v_pk_fma_f32 v[250:251], v[220:221], v[220:221], v[250:251]
    v_pk_fma_f32 v[250:251], v[222:223], v[222:223], v[250:251]
    v_pk_fma_f32 v[250:251], v[224:225], v[224:225], v[250:251]
    v_pk_fma_f32 v[250:251], v[226:227], v[226:227], v[250:251]
    v_pk_fma_f32 v[250:251], v[228:229], v[228:229], v[250:251]
    v_pk_fma_f32 v[250:251], v[230:231], v[230:231], v[250:251]
    v_pk_fma_f32 v[250:251], v[232:233], v[232:233], v[250:251]
    v_pk_fma_f32 v[250:251], v[234:235], v[234:235], v[250:251]
    v_add_f32 v250, v250, v251
    v_sub_f32 v248, v248, v252
    s_nop 1
    v_add_f32_dpp v250, v250, v250 quad_perm:[1,0,3,2] row_mask:0xf bank_mask:0xf
    s_nop 1
    v_add_f32_dpp v250, v250, v250 quad_perm:[2,3,0,1] row_mask:0xf bank_mask:0xf
    s_nop 1
    v_add_f32_dpp v250, v250, v250 row_half_mirror row_mask:0xf bank_mask:0xf
    v_mul_f32 v250, 0x3b124925, v250
    v_fma_f32 v250, -v248, v248, v250
    v_max_f32 v250, 0, v250
    v_cvt_pk_bf16_f32 v250, v250, v250
    v_and_b32 v250, 0xffff0000, v250
    v_add_f32 v250, 0x3727c5ac, v250
    v_cvt_pk_bf16_f32 v250, v250, v250
    v_and_b32 v250, 0xffff0000, v250
    v_sqrt_f32 v250, v250
    s_nop 0
    v_cvt_pk_bf16_f32 v250, v250, v250
    v_and_b32 v250, 0xffff0000, v250
    v_rcp_f32 v250, v250
    v_cvt_pk_bf16_f32 v181, v180, v181
    v_cvt_pk_bf16_f32 v183, v182, v183
    v_cvt_pk_bf16_f32 v185, v184, v185
    v_cvt_pk_bf16_f32 v187, v186, v187
    v_cvt_pk_bf16_f32 v189, v188, v189
    v_cvt_pk_bf16_f32 v191, v190, v191
    v_cvt_pk_bf16_f32 v193, v192, v193
    v_cvt_pk_bf16_f32 v195, v194, v195
    v_cvt_pk_bf16_f32 v197, v196, v197
    v_cvt_pk_bf16_f32 v199, v198, v199
    v_cvt_pk_bf16_f32 v201, v200, v201
    v_cvt_pk_bf16_f32 v203, v202, v203
    v_cvt_pk_bf16_f32 v205, v204, v205
    v_cvt_pk_bf16_f32 v207, v206, v207
    v_cvt_pk_bf16_f32 v209, v208, v209
    v_cvt_pk_bf16_f32 v211, v210, v211
    v_cvt_pk_bf16_f32 v213, v212, v213
    v_cvt_pk_bf16_f32 v215, v214, v215
    v_cvt_pk_bf16_f32 v217, v216, v217
    v_cvt_pk_bf16_f32 v219, v218, v219
    v_cvt_pk_bf16_f32 v221, v220, v221
    v_cvt_pk_bf16_f32 v223, v222, v223
    v_cvt_pk_bf16_f32 v225, v224, v225
    v_cvt_pk_bf16_f32 v227, v226, v227
    v_cvt_pk_bf16_f32 v229, v228, v229
    v_cvt_pk_bf16_f32 v231, v230, v231
    v_cvt_pk_bf16_f32 v233, v232, v233
    v_cvt_pk_bf16_f32 v235, v234, v235
    v_lshlrev_b32 v180, 16, v181
    v_and_b32 v181, 0xffff0000, v181
    v_lshlrev_b32 v182, 16, v183
    v_and_b32 v183, 0xffff0000, v183
    v_lshlrev_b32 v184, 16, v185
    v_and_b32 v185, 0xffff0000, v185
    v_lshlrev_b32 v186, 16, v187
    v_and_b32 v187, 0xffff0000, v187
    v_lshlrev_b32 v188, 16, v189
    v_and_b32 v189, 0xffff0000, v189
    v_lshlrev_b32 v190, 16, v191
    v_and_b32 v191, 0xffff0000, v191
    v_lshlrev_b32 v192, 16, v193
    v_and_b32 v193, 0xffff0000, v193
    v_lshlrev_b32 v194, 16, v195
    v_and_b32 v195, 0xffff0000, v195
    v_lshlrev_b32 v196, 16, v197
    v_and_b32 v197, 0xffff0000, v197
    v_lshlrev_b32 v198, 16, v199
    v_and_b32 v199, 0xffff0000, v199
    v_lshlrev_b32 v200, 16, v201
    v_and_b32 v201, 0xffff0000, v201
    v_lshlrev_b32 v202, 16, v203
    v_and_b32 v203, 0xffff0000, v203
    v_lshlrev_b32 v204, 16, v205
    v_and_b32 v205, 0xffff0000, v205
    v_lshlrev_b32 v206, 16, v207
    v_and_b32 v207, 0xffff0000, v207
    v_lshlrev_b32 v208, 16, v209
    v_and_b32 v209, 0xffff0000, v209
    v_lshlrev_b32 v210, 16, v211
    v_and_b32 v211, 0xffff0000, v211
    v_lshlrev_b32 v212, 16, v213
    v_and_b32 v213, 0xffff0000, v213
    v_lshlrev_b32 v214, 16, v215
    v_and_b32 v215, 0xffff0000, v215
    v_lshlrev_b32 v216, 16, v217
    v_and_b32 v217, 0xffff0000, v217
    v_lshlrev_b32 v218, 16, v219
    v_and_b32 v219, 0xffff0000, v219
    v_lshlrev_b32 v220, 16, v221
    v_and_b32 v221, 0xffff0000, v221
    v_lshlrev_b32 v222, 16, v223
    v_and_b32 v223, 0xffff0000, v223
    v_lshlrev_b32 v224, 16, v225
    v_and_b32 v225, 0xffff0000, v225
    v_lshlrev_b32 v226, 16, v227
    v_and_b32 v227, 0xffff0000, v227
    v_lshlrev_b32 v228, 16, v229
    v_and_b32 v229, 0xffff0000, v229
    v_lshlrev_b32 v230, 16, v231
    v_and_b32 v231, 0xffff0000, v231
    v_lshlrev_b32 v232, 16, v233
    v_and_b32 v233, 0xffff0000, v233
    v_lshlrev_b32 v234, 16, v235
    v_and_b32 v235, 0xffff0000, v235
    v_pk_mul_f32 v[180:181], v[180:181], v[250:251] op_sel_hi:[1,0]
    v_pk_mul_f32 v[182:183], v[182:183], v[250:251] op_sel_hi:[1,0]
    v_pk_mul_f32 v[184:185], v[184:185], v[250:251] op_sel_hi:[1,0]
    v_pk_mul_f32 v[186:187], v[186:187], v[250:251] op_sel_hi:[1,0]
    v_pk_mul_f32 v[188:189], v[188:189], v[250:251] op_sel_hi:[1,0]
    v_pk_mul_f32 v[190:191], v[190:191], v[250:251] op_sel_hi:[1,0]
    v_pk_mul_f32 v[192:193], v[192:193], v[250:251] op_sel_hi:[1,0]
    v_pk_mul_f32 v[194:195], v[194:195], v[250:251] op_sel_hi:[1,0]
    v_pk_mul_f32 v[196:197], v[196:197], v[250:251] op_sel_hi:[1,0]
    v_pk_mul_f32 v[198:199], v[198:199], v[250:251] op_sel_hi:[1,0]
    v_pk_mul_f32 v[200:201], v[200:201], v[250:251] op_sel_hi:[1,0]
    v_pk_mul_f32 v[202:203], v[202:203], v[250:251] op_sel_hi:[1,0]
    v_pk_mul_f32 v[204:205], v[204:205], v[250:251] op_sel_hi:[1,0]
    v_pk_mul_f32 v[206:207], v[206:207], v[250:251] op_sel_hi:[1,0]
    v_pk_mul_f32 v[208:209], v[208:209], v[250:251] op_sel_hi:[1,0]
    v_pk_mul_f32 v[210:211], v[210:211], v[250:251] op_sel_hi:[1,0]
    v_pk_mul_f32 v[212:213], v[212:213], v[250:251] op_sel_hi:[1,0]
    v_pk_mul_f32 v[214:215], v[214:215], v[250:251] op_sel_hi:[1,0]
    v_pk_mul_f32 v[216:217], v[216:217], v[250:251] op_sel_hi:[1,0]
    v_pk_mul_f32 v[218:219], v[218:219], v[250:251] op_sel_hi:[1,0]
    v_pk_mul_f32 v[220:221], v[220:221], v[250:251] op_sel_hi:[1,0]
    v_pk_mul_f32 v[222:223], v[222:223], v[250:251] op_sel_hi:[1,0]
    v_pk_mul_f32 v[224:225], v[224:225], v[250:251] op_sel_hi:[1,0]
    v_pk_mul_f32 v[226:227], v[226:227], v[250:251] op_sel_hi:[1,0]
    v_pk_mul_f32 v[228:229], v[228:229], v[250:251] op_sel_hi:[1,0]
    v_pk_mul_f32 v[230:231], v[230:231], v[250:251] op_sel_hi:[1,0]
    v_pk_mul_f32 v[232:233], v[232:233], v[250:251] op_sel_hi:[1,0]
    v_pk_mul_f32 v[234:235], v[234:235], v[250:251] op_sel_hi:[1,0]
    v_cvt_pk_bf16_f32 v152, v180, v184
    v_cvt_pk_bf16_f32 v153, v181, v185
    v_cvt_pk_bf16_f32 v154, v182, v186
    v_cvt_pk_bf16_f32 v155, v183, v187
    v_cvt_pk_bf16_f32 v156, v188, v192
    v_cvt_pk_bf16_f32 v157, v189, v193
    v_cvt_pk_bf16_f32 v158, v190, v194
    v_cvt_pk_bf16_f32 v159, v191, v195
    v_cvt_pk_bf16_f32 v160, v196, v200
    v_cvt_pk_bf16_f32 v161, v197, v201
    v_cvt_pk_bf16_f32 v162, v198, v202
    v_cvt_pk_bf16_f32 v163, v199, v203
    v_cvt_pk_bf16_f32 v164, v204, v208
    v_cvt_pk_bf16_f32 v165, v205, v209
    v_cvt_pk_bf16_f32 v166, v206, v210
    v_cvt_pk_bf16_f32 v167, v207, v211
    v_cvt_pk_bf16_f32 v168, v212, v216
    v_cvt_pk_bf16_f32 v169, v213, v217
    v_cvt_pk_bf16_f32 v170, v214, v218
    v_cvt_pk_bf16_f32 v171, v215, v219
    v_cvt_pk_bf16_f32 v172, v220, v224
    v_cvt_pk_bf16_f32 v173, v221, v225
    v_cvt_pk_bf16_f32 v174, v222, v226
    v_cvt_pk_bf16_f32 v175, v223, v227
    v_cvt_pk_bf16_f32 v176, v228, v232
    v_cvt_pk_bf16_f32 v177, v229, v233
    v_cvt_pk_bf16_f32 v178, v230, v234
    v_cvt_pk_bf16_f32 v179, v231, v235
    s_lshr_b32 s24, s2, 1
    s_mul_i32 s24, s24, 14336
    s_and_b32 s25, s2, 1
    s_lshl_b32 s25, s25, 7
    s_add_u32 s24, s24, s25
    v_lshlrev_b32 v10, 4, v8
    v_lshl_add_u32 v10, v11, 10, v10
    v_lshl_add_u32 v10, v12, 8, v10
    buffer_store_dwordx4 v[152:155], v10, s[4:7], s24 offen offset:0 sc1
    buffer_store_dwordx4 v[156:159], v10, s[4:7], s24 offen offset:2048 sc1
    s_add_u32 s24, s24, 4096
    buffer_store_dwordx4 v[160:163], v10, s[4:7], s24 offen offset:0 sc1
    buffer_store_dwordx4 v[164:167], v10, s[4:7], s24 offen offset:2048 sc1
    s_add_u32 s24, s24, 4096
    buffer_store_dwordx4 v[168:171], v10, s[4:7], s24 offen offset:0 sc1
    buffer_store_dwordx4 v[172:175], v10, s[4:7], s24 offen offset:2048 sc1
    s_add_u32 s24, s24, 4096
    buffer_store_dwordx4 v[176:179], v10, s[4:7], s24 offen offset:0 sc1
    s_waitcnt vmcnt(21)
    ds_read_b128 a[0:3], v1 offset:0
    ds_read_b128 a[4:7], v1 offset:8192
    ds_read_b128 a[8:11], v2 offset:0
    ds_read_b128 a[12:15], v2 offset:8192
    ds_read_b128 a[16:19], v1 offset:2048
    ds_read_b128 a[20:23], v1 offset:10240
    ds_read_b128 a[24:27], v2 offset:2048
    ds_read_b128 a[28:31], v2 offset:10240
    s_waitcnt lgkmcnt(4)
    ds_read_b128 a[32:35], v1 offset:4096
    ds_read_b128 a[36:39], v1 offset:12288
    ds_read_b128 a[40:43], v2 offset:4096
    ds_read_b128 a[44:47], v2 offset:12288
    ds_read_b128 a[48:51], v1 offset:6144
    ds_read_b128 a[52:55], v1 offset:14336
    ds_read_b128 a[56:59], v2 offset:6144
    ds_read_b128 a[60:63], v2 offset:14336
    s_waitcnt lgkmcnt(0)
    s_waitcnt vmcnt(7)
    s_barrier
    s_cmp_eq_u32 s27, 1
    s_cbranch_scc1 P_compBb
    ds_read_b128 v[128:131], v13 offset:0
    ds_read_b128 v[132:135], v14 offset:0
    ds_read_b128 v[136:139], v13 offset:2048
    ds_read_b128 v[140:143], v14 offset:2048
    ds_read_b128 v[144:147], v13 offset:4096
    ds_read_b128 v[148:151], v14 offset:4096
    s_waitcnt lgkmcnt(5)
    v_mfma_f32_16x16x32_bf16 v[16:19], a[0:3], v[128:131], 0
    v_mfma_f32_16x16x32_bf16 v[20:23], a[4:7], v[128:131], 0
    ds_read_b128 v[128:131], v13 offset:6144
    s_waitcnt lgkmcnt(5)
    v_mfma_f32_16x16x32_bf16 v[16:19], a[8:11], v[132:135], v[16:19]
    v_mfma_f32_16x16x32_bf16 v[20:23], a[12:15], v[132:135], v[20:23]
    ds_read_b128 v[132:135], v14 offset:6144
    s_waitcnt lgkmcnt(5)
    v_mfma_f32_16x16x32_bf16 v[16:19], a[16:19], v[136:139], v[16:19]
    v_mfma_f32_16x16x32_bf16 v[20:23], a[20:23], v[136:139], v[20:23]
    ds_read_b128 v[136:139], v13 offset:8192
    s_waitcnt lgkmcnt(5)
    v_mfma_f32_16x16x32_bf16 v[16:19], a[24:27], v[140:143], v[16:19]
    v_mfma_f32_16x16x32_bf16 v[20:23], a[28:31], v[140:143], v[20:23]
    ds_read_b128 v[140:143], v14 offset:8192
    s_waitcnt lgkmcnt(5)
    v_mfma_f32_16x16x32_bf16 v[16:19], a[32:35], v[144:147], v[16:19]
    v_mfma_f32_16x16x32_bf16 v[20:23], a[36:39], v[144:147], v[20:23]
    ds_read_b128 v[144:147], v13 offset:10240
    s_waitcnt lgkmcnt(5)
    v_mfma_f32_16x16x32_bf16 v[16:19], a[40:43], v[148:151], v[16:19]
    v_mfma_f32_16x16x32_bf16 v[20:23], a[44:47], v[148:151], v[20:23]
    ds_read_b128 v[148:151], v14 offset:10240
    s_waitcnt lgkmcnt(5)
    v_mfma_f32_16x16x32_bf16 v[16:19], a[48:51], v[128:131], v[16:19]
    v_mfma_f32_16x16x32_bf16 v[20:23], a[52:55], v[128:131], v[20:23]
    ds_read_b128 v[128:131], v13 offset:12288
    s_waitcnt lgkmcnt(5)
    v_mfma_f32_16x16x32_bf16 v[16:19], a[56:59], v[132:135], v[16:19]
    v_mfma_f32_16x16x32_bf16 v[20:23], a[60:63], v[132:135], v[20:23]
    ds_read_b128 v[132:135], v14 offset:12288
    s_waitcnt lgkmcnt(5)
    v_mfma_f32_16x16x32_bf16 v[24:27], a[0:3], v[136:139], 0
    v_mfma_f32_16x16x32_bf16 v[28:31], a[4:7], v[136:139], 0
    ds_read_b128 v[136:139], v13 offset:14336
    s_waitcnt lgkmcnt(5)
    v_mfma_f32_16x16x32_bf16 v[24:27], a[8:11], v[140:143], v[24:27]
    v_mfma_f32_16x16x32_bf16 v[28:31], a[12:15], v[140:143], v[28:31]
    ds_read_b128 v[140:143], v14 offset:14336
    s_waitcnt lgkmcnt(5)
    v_mfma_f32_16x16x32_bf16 v[24:27], a[16:19], v[144:147], v[24:27]
    s_mov_b32 s49, s47
    v_mul_f32 v16, s46, v16
    v_mul_f32 v17, s46, v17
    v_mul_f32 v18, s46, v18
    v_mfma_f32_16x16x32_bf16 v[28:31], a[20:23], v[144:147], v[28:31]
    ds_read_b128 v[144:147], v13 offset:16384
    s_waitcnt lgkmcnt(5)
    v_mfma_f32_16x16x32_bf16 v[24:27], a[24:27], v[148:151], v[24:27]
    v_mul_f32 v19, s46, v19
    v_mul_f32 v20, s46, v20
    v_mul_f32 v21, s46, v21
    v_mfma_f32_16x16x32_bf16 v[28:31], a[28:31], v[148:151], v[28:31]
    ds_read_b128 v[148:151], v14 offset:16384
    s_waitcnt lgkmcnt(5)
    v_mfma_f32_16x16x32_bf16 v[24:27], a[32:35], v[128:131], v[24:27]
    v_mul_f32 v22, s46, v22
    v_mul_f32 v23, s46, v23
    v_cvt_pk_bf16_f32 v16, v16, v20
    v_mfma_f32_16x16x32_bf16 v[28:31], a[36:39], v[128:131], v[28:31]
    ds_read_b128 v[128:131], v13 offset:18432
    s_waitcnt lgkmcnt(5)
    v_mfma_f32_16x16x32_bf16 v[24:27], a[40:43], v[132:135], v[24:27]
    v_cvt_pk_bf16_f32 v17, v17, v21
    v_cvt_pk_bf16_f32 v18, v18, v22
    v_cvt_pk_bf16_f32 v19, v19, v23
    v_mfma_f32_16x16x32_bf16 v[28:31], a[44:47], v[132:135], v[28:31]
    buffer_store_dwordx4 v[16:19], v5, s[4:7], s49 offen offset:0 sc1
    s_add_u32 s49, s49, s48
    ds_read_b128 v[132:135], v14 offset:18432
    s_waitcnt lgkmcnt(5)
    v_mfma_f32_16x16x32_bf16 v[24:27], a[48:51], v[136:139], v[24:27]
    v_mfma_f32_16x16x32_bf16 v[28:31], a[52:55], v[136:139], v[28:31]
    ds_read_b128 v[136:139], v13 offset:20480
    s_waitcnt lgkmcnt(5)
    v_mfma_f32_16x16x32_bf16 v[24:27], a[56:59], v[140:143], v[24:27]
    v_mfma_f32_16x16x32_bf16 v[28:31], a[60:63], v[140:143], v[28:31]
    ds_read_b128 v[140:143], v14 offset:20480
    s_waitcnt lgkmcnt(5)
    v_mfma_f32_16x16x32_bf16 v[32:35], a[0:3], v[144:147], 0
    v_mfma_f32_16x16x32_bf16 v[36:39], a[4:7], v[144:147], 0
    ds_read_b128 v[144:147], v13 offset:22528
    s_waitcnt lgkmcnt(5)
    v_mfma_f32_16x16x32_bf16 v[32:35], a[8:11], v[148:151], v[32:35]
    v_mfma_f32_16x16x32_bf16 v[36:39], a[12:15], v[148:151], v[36:39]
    ds_read_b128 v[148:151], v14 offset:22528
    s_waitcnt lgkmcnt(5)
    v_mfma_f32_16x16x32_bf16 v[32:35], a[16:19], v[128:131], v[32:35]
    v_mul_f32 v24, s46, v24
    v_mul_f32 v25, s46, v25
    v_mul_f32 v26, s46, v26
    v_mfma_f32_16x16x32_bf16 v[36:39], a[20:23], v[128:131], v[36:39]
    ds_read_b128 v[128:131], v13 offset:24576
    s_waitcnt lgkmcnt(5)
    v_mfma_f32_16x16x32_bf16 v[32:35], a[24:27], v[132:135], v[32:35]
    v_mul_f32 v27, s46, v27
    v_mul_f32 v28, s46, v28
    v_mul_f32 v29, s46, v29
    v_mfma_f32_16x16x32_bf16 v[36:39], a[28:31], v[132:135], v[36:39]
    ds_read_b128 v[132:135], v14 offset:24576
    s_waitcnt lgkmcnt(5)
    v_mfma_f32_16x16x32_bf16 v[32:35], a[32:35], v[136:139], v[32:35]
    v_mul_f32 v30, s46, v30
    v_mul_f32 v31, s46, v31
    v_cvt_pk_bf16_f32 v24, v24, v28
    v_mfma_f32_16x16x32_bf16 v[36:39], a[36:39], v[136:139], v[36:39]
    ds_read_b128 v[136:139], v13 offset:26624
    s_waitcnt lgkmcnt(5)
    v_mfma_f32_16x16x32_bf16 v[32:35], a[40:43], v[140:143], v[32:35]
    v_cvt_pk_bf16_f32 v25, v25, v29
    v_cvt_pk_bf16_f32 v26, v26, v30
    v_cvt_pk_bf16_f32 v27, v27, v31
    v_mfma_f32_16x16x32_bf16 v[36:39], a[44:47], v[140:143], v[36:39]
    buffer_store_dwordx4 v[24:27], v5, s[4:7], s49 offen offset:0 sc1
    s_add_u32 s49, s49, s48
    ds_read_b128 v[140:143], v14 offset:26624
    s_waitcnt lgkmcnt(5)
    v_mfma_f32_16x16x32_bf16 v[32:35], a[48:51], v[144:147], v[32:35]
    v_mfma_f32_16x16x32_bf16 v[36:39], a[52:55], v[144:147], v[36:39]
    ds_read_b128 v[144:147], v13 offset:28672
    s_waitcnt lgkmcnt(5)
    v_mfma_f32_16x16x32_bf16 v[32:35], a[56:59], v[148:151], v[32:35]
    v_mfma_f32_16x16x32_bf16 v[36:39], a[60:63], v[148:151], v[36:39]
    ds_read_b128 v[148:151], v14 offset:28672
    s_waitcnt lgkmcnt(5)
    v_mfma_f32_16x16x32_bf16 v[40:43], a[0:3], v[128:131], 0
    v_mfma_f32_16x16x32_bf16 v[44:47], a[4:7], v[128:131], 0
    ds_read_b128 v[128:131], v13 offset:30720
    s_waitcnt lgkmcnt(5)
    v_mfma_f32_16x16x32_bf16 v[40:43], a[8:11], v[132:135], v[40:43]
    v_mfma_f32_16x16x32_bf16 v[44:47], a[12:15], v[132:135], v[44:47]
    ds_read_b128 v[132:135], v14 offset:30720
    s_waitcnt lgkmcnt(5)
    v_mfma_f32_16x16x32_bf16 v[40:43], a[16:19], v[136:139], v[40:43]
    v_mul_f32 v32, s46, v32
    v_mul_f32 v33, s46, v33
    v_mul_f32 v34, s46, v34
    v_mfma_f32_16x16x32_bf16 v[44:47], a[20:23], v[136:139], v[44:47]
    ds_read_b128 v[136:139], v13 offset:32768
    s_waitcnt lgkmcnt(5)
    v_mfma_f32_16x16x32_bf16 v[40:43], a[24:27], v[140:143], v[40:43]
    v_mul_f32 v35, s46, v35
    v_mul_f32 v36, s46, v36
    v_mul_f32 v37, s46, v37
    v_mfma_f32_16x16x32_bf16 v[44:47], a[28:31], v[140:143], v[44:47]
    ds_read_b128 v[140:143], v14 offset:32768
    s_waitcnt lgkmcnt(5)
    v_mfma_f32_16x16x32_bf16 v[40:43], a[32:35], v[144:147], v[40:43]
    v_mul_f32 v38, s46, v38
    v_mul_f32 v39, s46, v39
    v_cvt_pk_bf16_f32 v32, v32, v36
    v_mfma_f32_16x16x32_bf16 v[44:47], a[36:39], v[144:147], v[44:47]
    ds_read_b128 v[144:147], v13 offset:34816
    s_waitcnt lgkmcnt(5)
    v_mfma_f32_16x16x32_bf16 v[40:43], a[40:43], v[148:151], v[40:43]
    v_cvt_pk_bf16_f32 v33, v33, v37
    v_cvt_pk_bf16_f32 v34, v34, v38
    v_cvt_pk_bf16_f32 v35, v35, v39
    v_mfma_f32_16x16x32_bf16 v[44:47], a[44:47], v[148:151], v[44:47]
    buffer_store_dwordx4 v[32:35], v5, s[4:7], s49 offen offset:0 sc1
    s_add_u32 s49, s49, s48
    ds_read_b128 v[148:151], v14 offset:34816
    s_waitcnt lgkmcnt(5)
    v_mfma_f32_16x16x32_bf16 v[40:43], a[48:51], v[128:131], v[40:43]
    v_mfma_f32_16x16x32_bf16 v[44:47], a[52:55], v[128:131], v[44:47]
    ds_read_b128 v[128:131], v13 offset:36864
    s_waitcnt lgkmcnt(5)
    v_mfma_f32_16x16x32_bf16 v[40:43], a[56:59], v[132:135], v[40:43]
    v_mfma_f32_16x16x32_bf16 v[44:47], a[60:63], v[132:135], v[44:47]
    ds_read_b128 v[132:135], v14 offset:36864
    s_waitcnt lgkmcnt(5)
    v_mfma_f32_16x16x32_bf16 v[48:51], a[0:3], v[136:139], 0
    v_mfma_f32_16x16x32_bf16 v[52:55], a[4:7], v[136:139], 0
    ds_read_b128 v[136:139], v13 offset:38912
    s_waitcnt lgkmcnt(5)
    v_mfma_f32_16x16x32_bf16 v[48:51], a[8:11], v[140:143], v[48:51]
    v_mfma_f32_16x16x32_bf16 v[52:55], a[12:15], v[140:143], v[52:55]
    ds_read_b128 v[140:143], v14 offset:38912
    s_waitcnt lgkmcnt(5)
    v_mfma_f32_16x16x32_bf16 v[48:51], a[16:19], v[144:147], v[48:51]
    v_mul_f32 v40, s46, v40
    v_mul_f32 v41, s46, v41
    v_mul_f32 v42, s46, v42
    v_mfma_f32_16x16x32_bf16 v[52:55], a[20:23], v[144:147], v[52:55]
    ds_read_b128 v[144:147], v13 offset:40960
    s_waitcnt lgkmcnt(5)
    v_mfma_f32_16x16x32_bf16 v[48:51], a[24:27], v[148:151], v[48:51]
    v_mul_f32 v43, s46, v43
    v_mul_f32 v44, s46, v44
    v_mul_f32 v45, s46, v45
    v_mfma_f32_16x16x32_bf16 v[52:55], a[28:31], v[148:151], v[52:55]
    ds_read_b128 v[148:151], v14 offset:40960
    s_waitcnt lgkmcnt(5)
    v_mfma_f32_16x16x32_bf16 v[48:51], a[32:35], v[128:131], v[48:51]
    v_mul_f32 v46, s46, v46
    v_mul_f32 v47, s46, v47
    v_cvt_pk_bf16_f32 v40, v40, v44
    v_mfma_f32_16x16x32_bf16 v[52:55], a[36:39], v[128:131], v[52:55]
    ds_read_b128 v[128:131], v13 offset:43008
    s_waitcnt lgkmcnt(5)
    v_mfma_f32_16x16x32_bf16 v[48:51], a[40:43], v[132:135], v[48:51]
    v_cvt_pk_bf16_f32 v41, v41, v45
    v_cvt_pk_bf16_f32 v42, v42, v46
    v_cvt_pk_bf16_f32 v43, v43, v47
    v_mfma_f32_16x16x32_bf16 v[52:55], a[44:47], v[132:135], v[52:55]
    buffer_store_dwordx4 v[40:43], v5, s[4:7], s49 offen offset:0 sc1
    s_add_u32 s49, s49, s48
    ds_read_b128 v[132:135], v14 offset:43008
    s_waitcnt lgkmcnt(5)
    v_mfma_f32_16x16x32_bf16 v[48:51], a[48:51], v[136:139], v[48:51]
    v_mfma_f32_16x16x32_bf16 v[52:55], a[52:55], v[136:139], v[52:55]
    ds_read_b128 v[136:139], v13 offset:45056
    s_waitcnt lgkmcnt(5)
    v_mfma_f32_16x16x32_bf16 v[48:51], a[56:59], v[140:143], v[48:51]
    v_mfma_f32_16x16x32_bf16 v[52:55], a[60:63], v[140:143], v[52:55]
    ds_read_b128 v[140:143], v14 offset:45056
    s_waitcnt lgkmcnt(5)
    v_mfma_f32_16x16x32_bf16 v[56:59], a[0:3], v[144:147], 0
    v_mfma_f32_16x16x32_bf16 v[60:63], a[4:7], v[144:147], 0
    ds_read_b128 v[144:147], v13 offset:47104
    s_waitcnt lgkmcnt(5)
    v_mfma_f32_16x16x32_bf16 v[56:59], a[8:11], v[148:151], v[56:59]
    v_mfma_f32_16x16x32_bf16 v[60:63], a[12:15], v[148:151], v[60:63]
    ds_read_b128 v[148:151], v14 offset:47104
    s_waitcnt lgkmcnt(5)
    v_mfma_f32_16x16x32_bf16 v[56:59], a[16:19], v[128:131], v[56:59]
    v_mul_f32 v48, s46, v48
    v_mul_f32 v49, s46, v49
    v_mul_f32 v50, s46, v50
    v_mfma_f32_16x16x32_bf16 v[60:63], a[20:23], v[128:131], v[60:63]
    ds_read_b128 v[128:131], v13 offset:49152
    s_waitcnt lgkmcnt(5)
    v_mfma_f32_16x16x32_bf16 v[56:59], a[24:27], v[132:135], v[56:59]
    v_mul_f32 v51, s46, v51
    v_mul_f32 v52, s46, v52
    v_mul_f32 v53, s46, v53
    v_mfma_f32_16x16x32_bf16 v[60:63], a[28:31], v[132:135], v[60:63]
    ds_read_b128 v[132:135], v14 offset:49152
    s_waitcnt lgkmcnt(5)
    v_mfma_f32_16x16x32_bf16 v[56:59], a[32:35], v[136:139], v[56:59]
    v_mul_f32 v54, s46, v54
    v_mul_f32 v55, s46, v55
    v_cvt_pk_bf16_f32 v48, v48, v52
    v_mfma_f32_16x16x32_bf16 v[60:63], a[36:39], v[136:139], v[60:63]
    ds_read_b128 v[136:139], v13 offset:51200
    s_waitcnt lgkmcnt(5)
    v_mfma_f32_16x16x32_bf16 v[56:59], a[40:43], v[140:143], v[56:59]
    v_cvt_pk_bf16_f32 v49, v49, v53
    v_cvt_pk_bf16_f32 v50, v50, v54
    v_cvt_pk_bf16_f32 v51, v51, v55
    v_mfma_f32_16x16x32_bf16 v[60:63], a[44:47], v[140:143], v[60:63]
    buffer_store_dwordx4 v[48:51], v5, s[4:7], s49 offen offset:0 sc1
    s_add_u32 s49, s49, s48
    ds_read_b128 v[140:143], v14 offset:51200
    s_waitcnt lgkmcnt(5)
    v_mfma_f32_16x16x32_bf16 v[56:59], a[48:51], v[144:147], v[56:59]
    v_mfma_f32_16x16x32_bf16 v[60:63], a[52:55], v[144:147], v[60:63]
    ds_read_b128 v[144:147], v13 offset:53248
    s_waitcnt lgkmcnt(5)
    v_mfma_f32_16x16x32_bf16 v[56:59], a[56:59], v[148:151], v[56:59]
    v_mfma_f32_16x16x32_bf16 v[60:63], a[60:63], v[148:151], v[60:63]
    ds_read_b128 v[148:151], v14 offset:53248
    s_waitcnt lgkmcnt(5)
    v_mfma_f32_16x16x32_bf16 v[64:67], a[0:3], v[128:131], 0
    v_mfma_f32_16x16x32_bf16 v[68:71], a[4:7], v[128:131], 0
    ds_read_b128 v[128:131], v13 offset:55296
    s_waitcnt lgkmcnt(5)
    v_mfma_f32_16x16x32_bf16 v[64:67], a[8:11], v[132:135], v[64:67]
    v_mfma_f32_16x16x32_bf16 v[68:71], a[12:15], v[132:135], v[68:71]
    ds_read_b128 v[132:135], v14 offset:55296
    s_waitcnt lgkmcnt(5)
    v_mfma_f32_16x16x32_bf16 v[64:67], a[16:19], v[136:139], v[64:67]
    v_mul_f32 v56, s46, v56
    v_mul_f32 v57, s46, v57
    v_mul_f32 v58, s46, v58
    v_mfma_f32_16x16x32_bf16 v[68:71], a[20:23], v[136:139], v[68:71]
    s_waitcnt lgkmcnt(4)
    v_mfma_f32_16x16x32_bf16 v[64:67], a[24:27], v[140:143], v[64:67]
    v_mul_f32 v59, s46, v59
    v_mul_f32 v60, s46, v60
    v_mul_f32 v61, s46, v61
    v_mfma_f32_16x16x32_bf16 v[68:71], a[28:31], v[140:143], v[68:71]
    s_waitcnt lgkmcnt(3)
    v_mfma_f32_16x16x32_bf16 v[64:67], a[32:35], v[144:147], v[64:67]
    v_mul_f32 v62, s46, v62
    v_mul_f32 v63, s46, v63
    v_cvt_pk_bf16_f32 v56, v56, v60
    v_mfma_f32_16x16x32_bf16 v[68:71], a[36:39], v[144:147], v[68:71]
    s_waitcnt lgkmcnt(2)
    v_mfma_f32_16x16x32_bf16 v[64:67], a[40:43], v[148:151], v[64:67]
    v_cvt_pk_bf16_f32 v57, v57, v61
    v_cvt_pk_bf16_f32 v58, v58, v62
    v_cvt_pk_bf16_f32 v59, v59, v63
    v_mfma_f32_16x16x32_bf16 v[68:71], a[44:47], v[148:151], v[68:71]
    buffer_store_dwordx4 v[56:59], v5, s[4:7], s49 offen offset:0 sc1
    s_add_u32 s49, s49, s48
    s_waitcnt lgkmcnt(1)
    v_mfma_f32_16x16x32_bf16 v[64:67], a[48:51], v[128:131], v[64:67]
    v_mfma_f32_16x16x32_bf16 v[68:71], a[52:55], v[128:131], v[68:71]
    s_waitcnt lgkmcnt(0)
    v_mfma_f32_16x16x32_bf16 v[64:67], a[56:59], v[132:135], v[64:67]
    v_mfma_f32_16x16x32_bf16 v[68:71], a[60:63], v[132:135], v[68:71]
    s_nop 7
    v_mul_f32 v64, s46, v64
    v_mul_f32 v65, s46, v65
    v_mul_f32 v66, s46, v66
    v_mul_f32 v67, s46, v67
    v_mul_f32 v68, s46, v68
    v_mul_f32 v69, s46, v69
    v_mul_f32 v70, s46, v70
    v_mul_f32 v71, s46, v71
    v_cvt_pk_bf16_f32 v64, v64, v68
    v_cvt_pk_bf16_f32 v65, v65, v69
    v_cvt_pk_bf16_f32 v66, v66, v70
    v_cvt_pk_bf16_f32 v67, v67, v71
    buffer_store_dwordx4 v[64:67], v5, s[4:7], s49 offen offset:0 sc1
    s_add_u32 s49, s49, s48
    s_branch P_cendb
P_compBb:
    ds_read_b64_tr_b16 v[128:129], v6 offset:0
    ds_read_b64_tr_b16 v[130:131], v6 offset:3584
    ds_read_b64_tr_b16 v[132:133], v6 offset:7168
    ds_read_b64_tr_b16 v[134:135], v6 offset:10752
    ds_read_b64_tr_b16 v[136:137], v6 offset:14336
    ds_read_b64_tr_b16 v[138:139], v6 offset:17920
    ds_read_b64_tr_b16 v[140:141], v6 offset:21504
    ds_read_b64_tr_b16 v[142:143], v6 offset:25088
    ds_read_b64_tr_b16 v[144:145], v6 offset:28672
    ds_read_b64_tr_b16 v[146:147], v6 offset:32256
    ds_read_b64_tr_b16 v[148:149], v6 offset:35840
    ds_read_b64_tr_b16 v[150:151], v6 offset:39424
    s_waitcnt lgkmcnt(10)
    v_mfma_f32_16x16x32_bf16 v[16:19], a[0:3], v[128:131], 0
    v_mfma_f32_16x16x32_bf16 v[20:23], a[4:7], v[128:131], 0
    ds_read_b64_tr_b16 v[128:129], v6 offset:43008
    ds_read_b64_tr_b16 v[130:131], v6 offset:46592
    s_waitcnt lgkmcnt(10)
    v_mfma_f32_16x16x32_bf16 v[16:19], a[8:11], v[132:135], v[16:19]
    v_mfma_f32_16x16x32_bf16 v[20:23], a[12:15], v[132:135], v[20:23]
    ds_read_b64_tr_b16 v[132:133], v6 offset:50176
    ds_read_b64_tr_b16 v[134:135], v6 offset:53760
    s_waitcnt lgkmcnt(10)
    v_mfma_f32_16x16x32_bf16 v[16:19], a[16:19], v[136:139], v[16:19]
    v_mfma_f32_16x16x32_bf16 v[20:23], a[20:23], v[136:139], v[20:23]
    ds_read_b64_tr_b16 v[136:137], v6 offset:32
    ds_read_b64_tr_b16 v[138:139], v6 offset:3616
    s_waitcnt lgkmcnt(10)
    v_mfma_f32_16x16x32_bf16 v[16:19], a[24:27], v[140:143], v[16:19]
    v_mfma_f32_16x16x32_bf16 v[20:23], a[28:31], v[140:143], v[20:23]
    ds_read_b64_tr_b16 v[140:141], v6 offset:7200
    ds_read_b64_tr_b16 v[142:143], v6 offset:10784
    s_waitcnt lgkmcnt(10)
    v_mfma_f32_16x16x32_bf16 v[16:19], a[32:35], v[144:147], v[16:19]
    v_mfma_f32_16x16x32_bf16 v[20:23], a[36:39], v[144:147], v[20:23]
    ds_read_b64_tr_b16 v[144:145], v6 offset:14368
    ds_read_b64_tr_b16 v[146:147], v6 offset:17952
    s_waitcnt lgkmcnt(10)
    v_mfma_f32_16x16x32_bf16 v[16:19], a[40:43], v[148:151], v[16:19]
    v_mfma_f32_16x16x32_bf16 v[20:23], a[44:47], v[148:151], v[20:23]
    ds_read_b64_tr_b16 v[148:149], v6 offset:21536
    ds_read_b64_tr_b16 v[150:151], v6 offset:25120
    s_waitcnt lgkmcnt(10)
    v_mfma_f32_16x16x32_bf16 v[16:19], a[48:51], v[128:131], v[16:19]
    v_mfma_f32_16x16x32_bf16 v[20:23], a[52:55], v[128:131], v[20:23]
    ds_read_b64_tr_b16 v[128:129], v6 offset:28704
    ds_read_b64_tr_b16 v[130:131], v6 offset:32288
    s_waitcnt lgkmcnt(10)
    v_mfma_f32_16x16x32_bf16 v[16:19], a[56:59], v[132:135], v[16:19]
    v_mfma_f32_16x16x32_bf16 v[20:23], a[60:63], v[132:135], v[20:23]
    ds_read_b64_tr_b16 v[132:133], v6 offset:35872
    ds_read_b64_tr_b16 v[134:135], v6 offset:39456
    s_waitcnt lgkmcnt(10)
    v_mfma_f32_16x16x32_bf16 v[24:27], a[0:3], v[136:139], 0
    v_mfma_f32_16x16x32_bf16 v[28:31], a[4:7], v[136:139], 0
    ds_read_b64_tr_b16 v[136:137], v6 offset:43040
    ds_read_b64_tr_b16 v[138:139], v6 offset:46624
    s_waitcnt lgkmcnt(10)
    v_mfma_f32_16x16x32_bf16 v[24:27], a[8:11], v[140:143], v[24:27]
    v_mfma_f32_16x16x32_bf16 v[28:31], a[12:15], v[140:143], v[28:31]
    ds_read_b64_tr_b16 v[140:141], v6 offset:50208
    ds_read_b64_tr_b16 v[142:143], v6 offset:53792
    s_waitcnt lgkmcnt(10)
    v_mfma_f32_16x16x32_bf16 v[24:27], a[16:19], v[144:147], v[24:27]
    s_mov_b32 s49, s47
    v_cvt_pk_bf16_f32 v16, v16, v20
    v_cvt_pk_bf16_f32 v17, v17, v21
    v_cvt_pk_bf16_f32 v18, v18, v22
    v_mfma_f32_16x16x32_bf16 v[28:31], a[20:23], v[144:147], v[28:31]
    ds_read_b64_tr_b16 v[144:145], v6 offset:64
    ds_read_b64_tr_b16 v[146:147], v6 offset:3648
    s_waitcnt lgkmcnt(10)
    v_mfma_f32_16x16x32_bf16 v[24:27], a[24:27], v[148:151], v[24:27]
    v_cvt_pk_bf16_f32 v19, v19, v23
    v_mfma_f32_16x16x32_bf16 v[28:31], a[28:31], v[148:151], v[28:31]
    buffer_store_dwordx4 v[16:19], v5, s[4:7], s49 offen offset:0 sc1
    s_add_u32 s49, s49, s48
    ds_read_b64_tr_b16 v[148:149], v6 offset:7232
    ds_read_b64_tr_b16 v[150:151], v6 offset:10816
    s_waitcnt lgkmcnt(10)
    v_mfma_f32_16x16x32_bf16 v[24:27], a[32:35], v[128:131], v[24:27]
    v_mfma_f32_16x16x32_bf16 v[28:31], a[36:39], v[128:131], v[28:31]
    ds_read_b64_tr_b16 v[128:129], v6 offset:14400
    ds_read_b64_tr_b16 v[130:131], v6 offset:17984
    s_waitcnt lgkmcnt(10)
    v_mfma_f32_16x16x32_bf16 v[24:27], a[40:43], v[132:135], v[24:27]
    v_mfma_f32_16x16x32_bf16 v[28:31], a[44:47], v[132:135], v[28:31]
    ds_read_b64_tr_b16 v[132:133], v6 offset:21568
    ds_read_b64_tr_b16 v[134:135], v6 offset:25152
    s_waitcnt lgkmcnt(10)
    v_mfma_f32_16x16x32_bf16 v[24:27], a[48:51], v[136:139], v[24:27]
    v_mfma_f32_16x16x32_bf16 v[28:31], a[52:55], v[136:139], v[28:31]
    ds_read_b64_tr_b16 v[136:137], v6 offset:28736
    ds_read_b64_tr_b16 v[138:139], v6 offset:32320
    s_waitcnt lgkmcnt(10)
    v_mfma_f32_16x16x32_bf16 v[24:27], a[56:59], v[140:143], v[24:27]
    v_mfma_f32_16x16x32_bf16 v[28:31], a[60:63], v[140:143], v[28:31]
    ds_read_b64_tr_b16 v[140:141], v6 offset:35904
    ds_read_b64_tr_b16 v[142:143], v6 offset:39488
    s_waitcnt lgkmcnt(10)
    v_mfma_f32_16x16x32_bf16 v[32:35], a[0:3], v[144:147], 0
    v_mfma_f32_16x16x32_bf16 v[36:39], a[4:7], v[144:147], 0
    ds_read_b64_tr_b16 v[144:145], v6 offset:43072
    ds_read_b64_tr_b16 v[146:147], v6 offset:46656
    s_waitcnt lgkmcnt(10)
    v_mfma_f32_16x16x32_bf16 v[32:35], a[8:11], v[148:151], v[32:35]
    v_mfma_f32_16x16x32_bf16 v[36:39], a[12:15], v[148:151], v[36:39]
    ds_read_b64_tr_b16 v[148:149], v6 offset:50240
    ds_read_b64_tr_b16 v[150:151], v6 offset:53824
    s_waitcnt lgkmcnt(10)
    v_mfma_f32_16x16x32_bf16 v[32:35], a[16:19], v[128:131], v[32:35]
    v_cvt_pk_bf16_f32 v24, v24, v28
    v_cvt_pk_bf16_f32 v25, v25, v29
    v_cvt_pk_bf16_f32 v26, v26, v30
    v_mfma_f32_16x16x32_bf16 v[36:39], a[20:23], v[128:131], v[36:39]
    ds_read_b64_tr_b16 v[128:129], v6 offset:96
    ds_read_b64_tr_b16 v[130:131], v6 offset:3680
    s_waitcnt lgkmcnt(10)
    v_mfma_f32_16x16x32_bf16 v[32:35], a[24:27], v[132:135], v[32:35]
    v_cvt_pk_bf16_f32 v27, v27, v31
    v_mfma_f32_16x16x32_bf16 v[36:39], a[28:31], v[132:135], v[36:39]
    buffer_store_dwordx4 v[24:27], v5, s[4:7], s49 offen offset:0 sc1
    s_add_u32 s49, s49, s48
    ds_read_b64_tr_b16 v[132:133], v6 offset:7264
    ds_read_b64_tr_b16 v[134:135], v6 offset:10848
    s_waitcnt lgkmcnt(10)
    v_mfma_f32_16x16x32_bf16 v[32:35], a[32:35], v[136:139], v[32:35]
    v_mfma_f32_16x16x32_bf16 v[36:39], a[36:39], v[136:139], v[36:39]
    ds_read_b64_tr_b16 v[136:137], v6 offset:14432
    ds_read_b64_tr_b16 v[138:139], v6 offset:18016
    s_waitcnt lgkmcnt(10)
    v_mfma_f32_16x16x32_bf16 v[32:35], a[40:43], v[140:143], v[32:35]
    v_mfma_f32_16x16x32_bf16 v[36:39], a[44:47], v[140:143], v[36:39]
    ds_read_b64_tr_b16 v[140:141], v6 offset:21600
    ds_read_b64_tr_b16 v[142:143], v6 offset:25184
    s_waitcnt lgkmcnt(10)
    v_mfma_f32_16x16x32_bf16 v[32:35], a[48:51], v[144:147], v[32:35]
    v_mfma_f32_16x16x32_bf16 v[36:39], a[52:55], v[144:147], v[36:39]
    ds_read_b64_tr_b16 v[144:145], v6 offset:28768
    ds_read_b64_tr_b16 v[146:147], v6 offset:32352
    s_waitcnt lgkmcnt(10)
    v_mfma_f32_16x16x32_bf16 v[32:35], a[56:59], v[148:151], v[32:35]
    v_mfma_f32_16x16x32_bf16 v[36:39], a[60:63], v[148:151], v[36:39]
    ds_read_b64_tr_b16 v[148:149], v6 offset:35936
    ds_read_b64_tr_b16 v[150:151], v6 offset:39520
    s_waitcnt lgkmcnt(10)
    v_mfma_f32_16x16x32_bf16 v[40:43], a[0:3], v[128:131], 0
    v_mfma_f32_16x16x32_bf16 v[44:47], a[4:7], v[128:131], 0
    ds_read_b64_tr_b16 v[128:129], v6 offset:43104
    ds_read_b64_tr_b16 v[130:131], v6 offset:46688
    s_waitcnt lgkmcnt(10)
    v_mfma_f32_16x16x32_bf16 v[40:43], a[8:11], v[132:135], v[40:43]
    v_mfma_f32_16x16x32_bf16 v[44:47], a[12:15], v[132:135], v[44:47]
    ds_read_b64_tr_b16 v[132:133], v6 offset:50272
    ds_read_b64_tr_b16 v[134:135], v6 offset:53856
    s_waitcnt lgkmcnt(10)
    v_mfma_f32_16x16x32_bf16 v[40:43], a[16:19], v[136:139], v[40:43]
    v_cvt_pk_bf16_f32 v32, v32, v36
    v_cvt_pk_bf16_f32 v33, v33, v37
    v_cvt_pk_bf16_f32 v34, v34, v38
    v_mfma_f32_16x16x32_bf16 v[44:47], a[20:23], v[136:139], v[44:47]
    ds_read_b64_tr_b16 v[136:137], v6 offset:128
    ds_read_b64_tr_b16 v[138:139], v6 offset:3712
    s_waitcnt lgkmcnt(10)
    v_mfma_f32_16x16x32_bf16 v[40:43], a[24:27], v[140:143], v[40:43]
    v_cvt_pk_bf16_f32 v35, v35, v39
    v_mfma_f32_16x16x32_bf16 v[44:47], a[28:31], v[140:143], v[44:47]
    buffer_store_dwordx4 v[32:35], v5, s[4:7], s49 offen offset:0 sc1
    s_add_u32 s49, s49, s48
    ds_read_b64_tr_b16 v[140:141], v6 offset:7296
    ds_read_b64_tr_b16 v[142:143], v6 offset:10880
    s_waitcnt lgkmcnt(10)
    v_mfma_f32_16x16x32_bf16 v[40:43], a[32:35], v[144:147], v[40:43]
    v_mfma_f32_16x16x32_bf16 v[44:47], a[36:39], v[144:147], v[44:47]
    ds_read_b64_tr_b16 v[144:145], v6 offset:14464
    ds_read_b64_tr_b16 v[146:147], v6 offset:18048
    s_waitcnt lgkmcnt(10)
    v_mfma_f32_16x16x32_bf16 v[40:43], a[40:43], v[148:151], v[40:43]
    v_mfma_f32_16x16x32_bf16 v[44:47], a[44:47], v[148:151], v[44:47]
    ds_read_b64_tr_b16 v[148:149], v6 offset:21632
    ds_read_b64_tr_b16 v[150:151], v6 offset:25216
    s_waitcnt lgkmcnt(10)
    v_mfma_f32_16x16x32_bf16 v[40:43], a[48:51], v[128:131], v[40:43]
    v_mfma_f32_16x16x32_bf16 v[44:47], a[52:55], v[128:131], v[44:47]
    ds_read_b64_tr_b16 v[128:129], v6 offset:28800
    ds_read_b64_tr_b16 v[130:131], v6 offset:32384
    s_waitcnt lgkmcnt(10)
    v_mfma_f32_16x16x32_bf16 v[40:43], a[56:59], v[132:135], v[40:43]
    v_mfma_f32_16x16x32_bf16 v[44:47], a[60:63], v[132:135], v[44:47]
    ds_read_b64_tr_b16 v[132:133], v6 offset:35968
    ds_read_b64_tr_b16 v[134:135], v6 offset:39552
    s_waitcnt lgkmcnt(10)
    v_mfma_f32_16x16x32_bf16 v[48:51], a[0:3], v[136:139], 0
    v_mfma_f32_16x16x32_bf16 v[52:55], a[4:7], v[136:139], 0
    ds_read_b64_tr_b16 v[136:137], v6 offset:43136
    ds_read_b64_tr_b16 v[138:139], v6 offset:46720
    s_waitcnt lgkmcnt(10)
    v_mfma_f32_16x16x32_bf16 v[48:51], a[8:11], v[140:143], v[48:51]
    v_mfma_f32_16x16x32_bf16 v[52:55], a[12:15], v[140:143], v[52:55]
    ds_read_b64_tr_b16 v[140:141], v6 offset:50304
    ds_read_b64_tr_b16 v[142:143], v6 offset:53888
    s_waitcnt lgkmcnt(10)
    v_mfma_f32_16x16x32_bf16 v[48:51], a[16:19], v[144:147], v[48:51]
    v_cvt_pk_bf16_f32 v40, v40, v44
    v_cvt_pk_bf16_f32 v41, v41, v45
    v_cvt_pk_bf16_f32 v42, v42, v46
    v_mfma_f32_16x16x32_bf16 v[52:55], a[20:23], v[144:147], v[52:55]
    ds_read_b64_tr_b16 v[144:145], v6 offset:160
    ds_read_b64_tr_b16 v[146:147], v6 offset:3744
    s_waitcnt lgkmcnt(10)
    v_mfma_f32_16x16x32_bf16 v[48:51], a[24:27], v[148:151], v[48:51]
    v_cvt_pk_bf16_f32 v43, v43, v47
    v_mfma_f32_16x16x32_bf16 v[52:55], a[28:31], v[148:151], v[52:55]
    buffer_store_dwordx4 v[40:43], v5, s[4:7], s49 offen offset:0 sc1
    s_add_u32 s49, s49, s48
    ds_read_b64_tr_b16 v[148:149], v6 offset:7328
    ds_read_b64_tr_b16 v[150:151], v6 offset:10912
    s_waitcnt lgkmcnt(10)
    v_mfma_f32_16x16x32_bf16 v[48:51], a[32:35], v[128:131], v[48:51]
    v_mfma_f32_16x16x32_bf16 v[52:55], a[36:39], v[128:131], v[52:55]
    ds_read_b64_tr_b16 v[128:129], v6 offset:14496
    ds_read_b64_tr_b16 v[130:131], v6 offset:18080
    s_waitcnt lgkmcnt(10)
    v_mfma_f32_16x16x32_bf16 v[48:51], a[40:43], v[132:135], v[48:51]
    v_mfma_f32_16x16x32_bf16 v[52:55], a[44:47], v[132:135], v[52:55]
    ds_read_b64_tr_b16 v[132:133], v6 offset:21664
    ds_read_b64_tr_b16 v[134:135], v6 offset:25248
    s_waitcnt lgkmcnt(10)
    v_mfma_f32_16x16x32_bf16 v[48:51], a[48:51], v[136:139], v[48:51]
    v_mfma_f32_16x16x32_bf16 v[52:55], a[52:55], v[136:139], v[52:55]
    ds_read_b64_tr_b16 v[136:137], v6 offset:28832
    ds_read_b64_tr_b16 v[138:139], v6 offset:32416
    s_waitcnt lgkmcnt(10)
    v_mfma_f32_16x16x32_bf16 v[48:51], a[56:59], v[140:143], v[48:51]
    v_mfma_f32_16x16x32_bf16 v[52:55], a[60:63], v[140:143], v[52:55]
    ds_read_b64_tr_b16 v[140:141], v6 offset:36000
    ds_read_b64_tr_b16 v[142:143], v6 offset:39584
    s_waitcnt lgkmcnt(10)
    v_mfma_f32_16x16x32_bf16 v[56:59], a[0:3], v[144:147], 0
    v_mfma_f32_16x16x32_bf16 v[60:63], a[4:7], v[144:147], 0
    ds_read_b64_tr_b16 v[144:145], v6 offset:43168
    ds_read_b64_tr_b16 v[146:147], v6 offset:46752
    s_waitcnt lgkmcnt(10)
    v_mfma_f32_16x16x32_bf16 v[56:59], a[8:11], v[148:151], v[56:59]
    v_mfma_f32_16x16x32_bf16 v[60:63], a[12:15], v[148:151], v[60:63]
    ds_read_b64_tr_b16 v[148:149], v6 offset:50336
    ds_read_b64_tr_b16 v[150:151], v6 offset:53920
    s_waitcnt lgkmcnt(10)
    v_mfma_f32_16x16x32_bf16 v[56:59], a[16:19], v[128:131], v[56:59]
    v_cvt_pk_bf16_f32 v48, v48, v52
    v_cvt_pk_bf16_f32 v49, v49, v53
    v_cvt_pk_bf16_f32 v50, v50, v54
    v_mfma_f32_16x16x32_bf16 v[60:63], a[20:23], v[128:131], v[60:63]
    ds_read_b64_tr_b16 v[128:129], v6 offset:192
    ds_read_b64_tr_b16 v[130:131], v6 offset:3776
    s_waitcnt lgkmcnt(10)
    v_mfma_f32_16x16x32_bf16 v[56:59], a[24:27], v[132:135], v[56:59]
    v_cvt_pk_bf16_f32 v51, v51, v55
    v_mfma_f32_16x16x32_bf16 v[60:63], a[28:31], v[132:135], v[60:63]
    buffer_store_dwordx4 v[48:51], v5, s[4:7], s49 offen offset:0 sc1
    s_add_u32 s49, s49, s48
    ds_read_b64_tr_b16 v[132:133], v6 offset:7360
    ds_read_b64_tr_b16 v[134:135], v6 offset:10944
    s_waitcnt lgkmcnt(10)
    v_mfma_f32_16x16x32_bf16 v[56:59], a[32:35], v[136:139], v[56:59]
    v_mfma_f32_16x16x32_bf16 v[60:63], a[36:39], v[136:139], v[60:63]
    ds_read_b64_tr_b16 v[136:137], v6 offset:14528
    ds_read_b64_tr_b16 v[138:139], v6 offset:18112
    s_waitcnt lgkmcnt(10)
    v_mfma_f32_16x16x32_bf16 v[56:59], a[40:43], v[140:143], v[56:59]
    v_mfma_f32_16x16x32_bf16 v[60:63], a[44:47], v[140:143], v[60:63]
    ds_read_b64_tr_b16 v[140:141], v6 offset:21696
    ds_read_b64_tr_b16 v[142:143], v6 offset:25280
    s_waitcnt lgkmcnt(10)
    v_mfma_f32_16x16x32_bf16 v[56:59], a[48:51], v[144:147], v[56:59]
    v_mfma_f32_16x16x32_bf16 v[60:63], a[52:55], v[144:147], v[60:63]
    ds_read_b64_tr_b16 v[144:145], v6 offset:28864
    ds_read_b64_tr_b16 v[146:147], v6 offset:32448
    s_waitcnt lgkmcnt(10)
    v_mfma_f32_16x16x32_bf16 v[56:59], a[56:59], v[148:151], v[56:59]
    v_mfma_f32_16x16x32_bf16 v[60:63], a[60:63], v[148:151], v[60:63]
    ds_read_b64_tr_b16 v[148:149], v6 offset:36032
    ds_read_b64_tr_b16 v[150:151], v6 offset:39616
    s_waitcnt lgkmcnt(10)
    v_mfma_f32_16x16x32_bf16 v[64:67], a[0:3], v[128:131], 0
    v_mfma_f32_16x16x32_bf16 v[68:71], a[4:7], v[128:131], 0
    ds_read_b64_tr_b16 v[128:129], v6 offset:43200
    ds_read_b64_tr_b16 v[130:131], v6 offset:46784
    s_waitcnt lgkmcnt(10)
    v_mfma_f32_16x16x32_bf16 v[64:67], a[8:11], v[132:135], v[64:67]
    v_mfma_f32_16x16x32_bf16 v[68:71], a[12:15], v[132:135], v[68:71]
    ds_read_b64_tr_b16 v[132:133], v6 offset:50368
    ds_read_b64_tr_b16 v[134:135], v6 offset:53952
    s_waitcnt lgkmcnt(10)
    v_mfma_f32_16x16x32_bf16 v[64:67], a[16:19], v[136:139], v[64:67]
    v_cvt_pk_bf16_f32 v56, v56, v60
    v_cvt_pk_bf16_f32 v57, v57, v61
    v_cvt_pk_bf16_f32 v58, v58, v62
    v_mfma_f32_16x16x32_bf16 v[68:71], a[20:23], v[136:139], v[68:71]
    s_waitcnt lgkmcnt(8)
    v_mfma_f32_16x16x32_bf16 v[64:67], a[24:27], v[140:143], v[64:67]
    v_cvt_pk_bf16_f32 v59, v59, v63
    v_mfma_f32_16x16x32_bf16 v[68:71], a[28:31], v[140:143], v[68:71]
    buffer_store_dwordx4 v[56:59], v5, s[4:7], s49 offen offset:0 sc1
    s_add_u32 s49, s49, s48
    s_waitcnt lgkmcnt(6)
    v_mfma_f32_16x16x32_bf16 v[64:67], a[32:35], v[144:147], v[64:67]
    v_mfma_f32_16x16x32_bf16 v[68:71], a[36:39], v[144:147], v[68:71]
    s_waitcnt lgkmcnt(4)
    v_mfma_f32_16x16x32_bf16 v[64:67], a[40:43], v[148:151], v[64:67]
    v_mfma_f32_16x16x32_bf16 v[68:71], a[44:47], v[148:151], v[68:71]
    s_waitcnt lgkmcnt(2)
    v_mfma_f32_16x16x32_bf16 v[64:67], a[48:51], v[128:131], v[64:67]
    v_mfma_f32_16x16x32_bf16 v[68:71], a[52:55], v[128:131], v[68:71]
    s_waitcnt lgkmcnt(0)
    v_mfma_f32_16x16x32_bf16 v[64:67], a[56:59], v[132:135], v[64:67]
    v_mfma_f32_16x16x32_bf16 v[68:71], a[60:63], v[132:135], v[68:71]
    s_nop 7
    v_cvt_pk_bf16_f32 v64, v64, v68
    v_cvt_pk_bf16_f32 v65, v65, v69
    v_cvt_pk_bf16_f32 v66, v66, v70
    v_cvt_pk_bf16_f32 v67, v67, v71
    buffer_store_dwordx4 v[64:67], v5, s[4:7], s49 offen offset:0 sc1
    s_add_u32 s49, s49, s48
P_cendb:
    s_and_b32 s24, s2, 7
    s_lshr_b32 s33, s2, 3
    s_cmp_lg_u32 s24, 2
    s_cbranch_scc1 P_urg3
    s_cmp_ge_u32 s33, 10
    s_cbranch_scc1 P_nourg
    s_add_u32 s33, s33, 0xffffffc0
    s_branch P_unit
P_urg3:
    s_cmp_lg_u32 s24, 3
    s_cbranch_scc1 P_nourg
    s_cmp_ge_u32 s33, 16
    s_cbranch_scc1 P_mem0
P_unit:
    s_cmp_eq_u32 s33, 15
    s_cselect_b32 s24, 0, -1
    v_mov_b32 v240, s24
    v_mov_b32 v241, s24
    v_mov_b32 v242, s24
    v_mov_b32 v243, s24
    s_lshl_b32 s25, s33, 13
    s_add_u32 s25, s25, 0x3102000
    s_cmp_eq_u32 s33, 15
    s_cselect_b32 s25, 0x3b00000, s25
    s_add_u32 s26, s25, 4096
    buffer_store_dwordx4 v[240:243], v5, s[4:7], s25 offen offset:0 sc1
    buffer_store_dwordx4 v[240:243], v5, s[4:7], s25 offen offset:1024 sc1
    buffer_store_dwordx4 v[240:243], v5, s[4:7], s25 offen offset:2048 sc1
    buffer_store_dwordx4 v[240:243], v5, s[4:7], s25 offen offset:3072 sc1
    buffer_store_dwordx4 v[240:243], v5, s[4:7], s26 offen offset:0 sc1
    buffer_store_dwordx4 v[240:243], v5, s[4:7], s26 offen offset:1024 sc1
    buffer_store_dwordx4 v[240:243], v5, s[4:7], s26 offen offset:2048 sc1
    buffer_store_dwordx4 v[240:243], v5, s[4:7], s26 offen offset:3072 sc1
    s_branch P_nourg
P_mem0:
    s_sub_u32 s24, s33, 16
    s_cmp_ge_u32 s24, 14
    s_cbranch_scc1 P_nourg
    s_mov_b32 s56, s14
    s_mov_b32 s57, s15
    s_mov_b32 s58, 0x1c00
    s_mov_b32 s59, 0x00020000
    v_and_b32 v1, 15, v0
    v_lshrrev_b32 v2, 4, v0
    v_mul_u32_u24 v10, 1792, v2
    v_lshl_add_u32 v10, v1, 1, v10
    s_lshl_b32 s25, s24, 6
    buffer_load_ushort v240, v10, s[56:59], s25 offen offset:0
    buffer_load_ushort v241, v10, s[56:59], s25 offen offset:32
    buffer_load_ushort v242, v10, s[56:59], s25 offen offset:896
    buffer_load_ushort v243, v10, s[56:59], s25 offen offset:928
    v_bfe_u32 v4, v0, 3, 1
    v_lshlrev_b32 v11, 8, v4
    v_lshl_add_u32 v11, v2, 6, v11
    v_and_b32 v4, 1, v0
    v_lshl_add_u32 v11, v4, 5, v11
    v_bfe_u32 v4, v0, 1, 2
    v_lshl_add_u32 v11, v4, 2, v11
    s_lshl_b32 s24, s24, 9
    s_add_u32 s25, s24, 0x3080000
    s_add_u32 s26, s24, 0x3100000
    s_waitcnt vmcnt(0)
    v_lshl_or_b32 v240, v241, 16, v240
    v_min_u32 v240, -2, v240
    buffer_store_dword v240, v11, s[4:7], s25 offen offset:0 sc1
    buffer_store_dword v240, v11, s[4:7], s26 offen offset:0 sc1
    v_lshl_or_b32 v242, v243, 16, v242
    v_min_u32 v242, -2, v242
    buffer_store_dword v242, v11, s[4:7], s25 offen offset:16 sc1
    buffer_store_dword v242, v11, s[4:7], s26 offen offset:16 sc1
P_nourg:
    s_setprio 0
P_done:
    s_mov_b32 s24, 0
P_nonce:
    s_add_u32 s24, s24, 1
    s_cmp_gt_u32 s24, 65536
    s_cbranch_scc1 M_exit
    buffer_load_dwordx2 v[2:3], v7, s[84:87], 0 offen sc1
    s_waitcnt vmcnt(0)
    v_readfirstlane_b32 s80, v2
    v_readfirstlane_b32 s81, v3
    s_cmp_eq_u32 s81, 0
    s_cbranch_scc1 P_nonce
    s_barrier
    s_cmp_lg_u32 s10, 3
    s_cbranch_scc1 P_end
    s_getreg_b32 s24, hwreg(HW_REG_XCC_ID, 0, 4)
    s_or_b32 s24, s24, s81
    v_mov_b32 v3, s24
    s_lshl_b32 s51, s50, 3
    s_add_u32 s51, s51, 0x3b02000
    s_mov_b64 exec, 1
    buffer_store_dwordx2 v[2:3], v7, s[4:7], s51 offen sc1
    s_mov_b64 exec, -1
P_end:
    s_and_b32 s11, s2, 7
    s_lshr_b32 s9, s2, 3
    s_lshl_b32 s11, s11, 2
    s_lshr_b32 s11, 0x64532170, s11
    s_and_b32 s11, s11, 15
    s_sub_u32 s34, s11, 5
    s_lshl_b32 s34, s34, 5
    s_add_u32 s34, s34, s9
    s_cmp_ge_u32 s11, 5
    s_cbranch_scc1 M_H
    s_cmp_ge_u32 s11, 3
    s_cbranch_scc1 M_SX
    s_cmp_ge_u32 s11, 1
    s_cbranch_scc1 M_Y
    s_cmp_ge_u32 s9, 32
    s_cbranch_scc1 M_exit
    s_cmp_ge_u32 s9, 30
    s_cbranch_scc1 role_pf_2
    s_cmp_ge_u32 s9, 16
    s_cbranch_scc1 role_v_1
    s_cmp_eq_u32 s10, 1
    s_cbranch_scc1 s_w1_4
    s_cmp_eq_u32 s10, 2
    s_cbranch_scc1 s_w2_5
    s_cmp_eq_u32 s10, 3
    s_cbranch_scc1 s_w3_6
    v_and_b32 v0, 63, v0
    v_lshlrev_b32 v1, 4, v0
    v_and_b32 v72, 2, v0
    v_cmp_eq_u32 s[20:21], 0, v72
    v_mov_b32 v2, 0xeeee
    v_mov_b32 v72, 0x4444
    v_cndmask_b32 v2, v2, v72, s[20:21]
    v_bfe_u32 v72, v0, 3, 1
    v_lshlrev_b32 v3, 8, v72
    v_lshrrev_b32 v72, 4, v0
    v_lshl_add_u32 v3, v72, 6, v3
    v_and_b32 v72, 1, v0
    v_lshl_add_u32 v3, v72, 5, v3
    v_bfe_u32 v72, v0, 1, 2
    v_lshl_add_u32 v3, v72, 2, v3
    v_mov_b32 v80, 0
    v_mov_b32 v81, 0xff800000
    v_mov_b32 v82, -1
    v_cndmask_b32 v98, 0, 1.0, s[20:21]
    v_cndmask_b32 v99, 1.0, 0, s[20:21]
    s_lshl_b32 s11, s9, 9
    v_mov_b32 v85, v1
    v_and_b32 v72, 3, v0
    v_lshlrev_b32 v86, 6, v72
    v_bfe_u32 v72, v0, 5, 1
    v_lshl_add_u32 v86, v72, 9, v86
    v_bfe_u32 v72, v0, 2, 1
    v_lshl_add_u32 v86, v72, 8, v86
    v_bfe_u32 v72, v0, 4, 1
    v_lshl_add_u32 v86, v72, 5, v86
    v_bfe_u32 v72, v0, 3, 1
    v_lshl_add_u32 v86, v72, 3, v86
    v_bfe_u32 v72, v0, 2, 1
    v_lshlrev_b32 v78, 5, v72
    v_bfe_u32 v72, v0, 3, 1
    v_lshl_add_u32 v78, v72, 8, v78
    v_lshrrev_b32 v72, 5, v0
    v_lshl_add_u32 v78, v72, 6, v78
    v_bfe_u32 v72, v0, 4, 1
    v_lshl_add_u32 v78, v72, 4, v78
    v_and_b32 v72, 3, v0
    v_lshl_add_u32 v78, v72, 2, v78
    v_add_u32 v78, s11, v78
    s_lshr_b32 s11, s9, 1
    s_lshl_b32 s11, s11, 9
    s_and_b32 s12, s9, 1
    s_lshl_b32 s12, s12, 2
    s_add_u32 s11, s11, s12
    s_add_u32 s11, s11, 8192
    v_mov_b32 v79, s11
    v_bfe_u32 v72, v0, 3, 1
    v_lshl_add_u32 v79, v72, 8, v79
    v_bfe_u32 v72, v0, 1, 1
    v_lshl_add_u32 v79, v72, 7, v79
    v_bfe_u32 v72, v0, 5, 1
    v_lshl_add_u32 v79, v72, 6, v79
    v_bfe_u32 v72, v0, 0, 1
    v_lshl_add_u32 v79, v72, 5, v79
    v_bfe_u32 v72, v0, 4, 1
    v_lshl_add_u32 v79, v72, 4, v79
    v_bfe_u32 v72, v0, 2, 1
    v_lshl_add_u32 v79, v72, 3, v79
    s_lshl_b32 s11, s9, 6
    s_add_u32 s11, s11, 0x3b02000
    v_min_u32 v4, 3, v0
    v_lshlrev_b32 v4, 4, v4
    s_mov_b32 s22, 0
wt_7:
    buffer_load_dwordx4 v[32:35], v4, s[4:7], s11 offen offset:0 sc1
    s_waitcnt vmcnt(0)
    v_xor_b32 v32, s80, v32
    v_xor_b32 v33, s81, v33
    v_and_b32 v33, -16, v33
    v_xor_b32 v34, s80, v34
    v_xor_b32 v35, s81, v35
    v_and_b32 v35, -16, v35
    v_or3_b32 v32, v32, v33, v34
    v_or_b32 v32, v32, v35
    v_cmp_ne_u32 vcc, 0, v32
    s_cbranch_vccz wtok_8
    s_add_u32 s22, s22, 1
    s_cmp_gt_u32 s22, 65536
    s_cbranch_scc1 M_exit
    s_sleep 16
    s_branch wt_7
wtok_8:
    s_mul_i32 s11, s9, 401408
    s_add_u32 s12, s11, 0x22a000
    s_add_u32 s14, s12, 0
    buffer_load_dwordx4 a[0:3], v1, s[4:7], s14 offen offset:0 sc1
    buffer_load_dwordx4 a[4:7], v1, s[4:7], s14 offen offset:1024 sc1
    buffer_load_dwordx4 a[8:11], v1, s[4:7], s14 offen offset:2048 sc1
    buffer_load_dwordx4 a[12:15], v1, s[4:7], s14 offen offset:3072 sc1
    s_add_u32 s14, s12, 4096
    buffer_load_dwordx4 a[16:19], v1, s[4:7], s14 offen offset:0 sc1
    buffer_load_dwordx4 a[20:23], v1, s[4:7], s14 offen offset:1024 sc1
    buffer_load_dwordx4 a[24:27], v1, s[4:7], s14 offen offset:2048 sc1
    buffer_load_dwordx4 a[28:31], v1, s[4:7], s14 offen offset:3072 sc1
    s_add_u32 s14, s12, 8192
    buffer_load_dwordx4 a[32:35], v1, s[4:7], s14 offen offset:0 sc1
    buffer_load_dwordx4 a[36:39], v1, s[4:7], s14 offen offset:1024 sc1
    buffer_load_dwordx4 a[40:43], v1, s[4:7], s14 offen offset:2048 sc1
    buffer_load_dwordx4 a[44:47], v1, s[4:7], s14 offen offset:3072 sc1
    s_add_u32 s14, s12, 12288
    buffer_load_dwordx4 a[48:51], v1, s[4:7], s14 offen offset:0 sc1
    buffer_load_dwordx4 a[52:55], v1, s[4:7], s14 offen offset:1024 sc1
    s_add_u32 s12, s11, 0x22d800
    s_add_u32 s14, s12, 0
    buffer_load_dwordx4 a[56:59], v1, s[4:7], s14 offen offset:0 sc1
    buffer_load_dwordx4 a[60:63], v1, s[4:7], s14 offen offset:1024 sc1
    buffer_load_dwordx4 a[64:67], v1, s[4:7], s14 offen offset:2048 sc1
    buffer_load_dwordx4 a[68:71], v1, s[4:7], s14 offen offset:3072 sc1
    s_add_u32 s14, s12, 4096
    buffer_load_dwordx4 a[72:75], v1, s[4:7], s14 offen offset:0 sc1
    buffer_load_dwordx4 a[76:79], v1, s[4:7], s14 offen offset:1024 sc1
    buffer_load_dwordx4 a[80:83], v1, s[4:7], s14 offen offset:2048 sc1
    buffer_load_dwordx4 a[84:87], v1, s[4:7], s14 offen offset:3072 sc1
    s_add_u32 s14, s12, 8192
    buffer_load_dwordx4 a[88:91], v1, s[4:7], s14 offen offset:0 sc1
    buffer_load_dwordx4 a[92:95], v1, s[4:7], s14 offen offset:1024 sc1
    buffer_load_dwordx4 a[96:99], v1, s[4:7], s14 offen offset:2048 sc1
    buffer_load_dwordx4 a[100:103], v1, s[4:7], s14 offen offset:3072 sc1
    s_add_u32 s14, s12, 12288
    buffer_load_dwordx4 a[104:107], v1, s[4:7], s14 offen offset:0 sc1
    buffer_load_dwordx4 a[108:111], v1, s[4:7], s14 offen offset:1024 sc1
    s_add_u32 s12, s11, 0x231000
    s_add_u32 s14, s12, 0
    buffer_load_dwordx4 a[112:115], v1, s[4:7], s14 offen offset:0 sc1
    buffer_load_dwordx4 a[116:119], v1, s[4:7], s14 offen offset:1024 sc1
    buffer_load_dwordx4 a[120:123], v1, s[4:7], s14 offen offset:2048 sc1
    buffer_load_dwordx4 a[124:127], v1, s[4:7], s14 offen offset:3072 sc1
    s_add_u32 s14, s12, 4096
    buffer_load_dwordx4 a[128:131], v1, s[4:7], s14 offen offset:0 sc1
    buffer_load_dwordx4 a[132:135], v1, s[4:7], s14 offen offset:1024 sc1
    buffer_load_dwordx4 a[136:139], v1, s[4:7], s14 offen offset:2048 sc1
    buffer_load_dwordx4 a[140:143], v1, s[4:7], s14 offen offset:3072 sc1
    s_add_u32 s14, s12, 8192
    buffer_load_dwordx4 a[144:147], v1, s[4:7], s14 offen offset:0 sc1
    buffer_load_dwordx4 a[148:151], v1, s[4:7], s14 offen offset:1024 sc1
    buffer_load_dwordx4 a[152:155], v1, s[4:7], s14 offen offset:2048 sc1
    buffer_load_dwordx4 a[156:159], v1, s[4:7], s14 offen offset:3072 sc1
    s_add_u32 s14, s12, 12288
    buffer_load_dwordx4 a[160:163], v1, s[4:7], s14 offen offset:0 sc1
    buffer_load_dwordx4 a[164:167], v1, s[4:7], s14 offen offset:1024 sc1
    s_add_u32 s12, s11, 0x234800
    s_add_u32 s14, s12, 0
    buffer_load_dwordx4 a[168:171], v1, s[4:7], s14 offen offset:0 sc1
    buffer_load_dwordx4 a[172:175], v1, s[4:7], s14 offen offset:1024 sc1
    buffer_load_dwordx4 a[176:179], v1, s[4:7], s14 offen offset:2048 sc1
    buffer_load_dwordx4 a[180:183], v1, s[4:7], s14 offen offset:3072 sc1
    s_add_u32 s14, s12, 4096
    buffer_load_dwordx4 a[184:187], v1, s[4:7], s14 offen offset:0 sc1
    buffer_load_dwordx4 a[188:191], v1, s[4:7], s14 offen offset:1024 sc1
    buffer_load_dwordx4 a[192:195], v1, s[4:7], s14 offen offset:2048 sc1
    buffer_load_dwordx4 a[196:199], v1, s[4:7], s14 offen offset:3072 sc1
    s_add_u32 s14, s12, 8192
    buffer_load_dwordx4 a[200:203], v1, s[4:7], s14 offen offset:0 sc1
    buffer_load_dwordx4 a[204:207], v1, s[4:7], s14 offen offset:1024 sc1
    buffer_load_dwordx4 a[208:211], v1, s[4:7], s14 offen offset:2048 sc1
    buffer_load_dwordx4 a[212:215], v1, s[4:7], s14 offen offset:3072 sc1
    s_add_u32 s14, s12, 12288
    buffer_load_dwordx4 a[216:219], v1, s[4:7], s14 offen offset:0 sc1
    buffer_load_dwordx4 a[220:223], v1, s[4:7], s14 offen offset:1024 sc1
    s_waitcnt vmcnt(28)
    s_mov_b32 s11, 0x3b02000
    v_min_u32 v4, 63, v0
    v_lshlrev_b32 v4, 4, v4
    s_mov_b32 s22, 0
wt_9:
    buffer_load_dwordx4 v[32:35], v4, s[4:7], s11 offen offset:0 sc1
    buffer_load_dwordx4 v[36:39], v4, s[4:7], s11 offen offset:1024 sc1
    s_waitcnt vmcnt(0)
    v_xor_b32 v32, s80, v32
    v_xor_b32 v33, s81, v33
    v_and_b32 v33, -16, v33
    v_xor_b32 v34, s80, v34
    v_xor_b32 v35, s81, v35
    v_and_b32 v35, -16, v35
    v_xor_b32 v36, s80, v36
    v_xor_b32 v37, s81, v37
    v_and_b32 v37, -16, v37
    v_xor_b32 v38, s80, v38
    v_xor_b32 v39, s81, v39
    v_and_b32 v39, -16, v39
    v_or3_b32 v32, v32, v33, v34
    v_or_b32 v32, v32, v35
    v_or3_b32 v32, v32, v36, v37
    v_or3_b32 v32, v32, v38, v39
    v_cmp_ne_u32 vcc, 0, v32
    s_cbranch_vccz wtok_10
    s_add_u32 s22, s22, 1
    s_cmp_gt_u32 s22, 65536
    s_cbranch_scc1 M_exit
    s_sleep 16
    s_branch wt_9
wtok_10:
    s_mov_b32 s8, 0
    s_mul_i32 s11, s8, 28672
    s_add_u32 s14, s11, 0
    buffer_load_dwordx4 v[128:131], v85, s[4:7], s14 offen offset:0 sc1
    buffer_load_dwordx4 v[132:135], v85, s[4:7], s14 offen offset:1024 sc1
    buffer_load_dwordx4 v[136:139], v85, s[4:7], s14 offen offset:2048 sc1
    buffer_load_dwordx4 v[140:143], v85, s[4:7], s14 offen offset:3072 sc1
    s_add_u32 s14, s11, 4096
    buffer_load_dwordx4 v[144:147], v85, s[4:7], s14 offen offset:0 sc1
    buffer_load_dwordx4 v[148:151], v85, s[4:7], s14 offen offset:1024 sc1
    buffer_load_dwordx4 v[152:155], v85, s[4:7], s14 offen offset:2048 sc1
    buffer_load_dwordx4 v[156:159], v85, s[4:7], s14 offen offset:3072 sc1
    s_add_u32 s14, s11, 8192
    buffer_load_dwordx4 v[160:163], v85, s[4:7], s14 offen offset:0 sc1
    buffer_load_dwordx4 v[164:167], v85, s[4:7], s14 offen offset:1024 sc1
    buffer_load_dwordx4 v[168:171], v85, s[4:7], s14 offen offset:2048 sc1
    buffer_load_dwordx4 v[172:175], v85, s[4:7], s14 offen offset:3072 sc1
    s_add_u32 s14, s11, 12288
    buffer_load_dwordx4 v[176:179], v85, s[4:7], s14 offen offset:0 sc1
    buffer_load_dwordx4 v[180:183], v85, s[4:7], s14 offen offset:1024 sc1
    buffer_load_dwordx4 v[184:187], v85, s[4:7], s14 offen offset:2048 sc1
    buffer_load_dwordx4 v[188:191], v85, s[4:7], s14 offen offset:3072 sc1
    s_add_u32 s14, s11, 16384
    buffer_load_dwordx4 v[192:195], v85, s[4:7], s14 offen offset:0 sc1
    buffer_load_dwordx4 v[196:199], v85, s[4:7], s14 offen offset:1024 sc1
    buffer_load_dwordx4 v[200:203], v85, s[4:7], s14 offen offset:2048 sc1
    buffer_load_dwordx4 v[204:207], v85, s[4:7], s14 offen offset:3072 sc1
    s_add_u32 s14, s11, 20480
    buffer_load_dwordx4 v[208:211], v85, s[4:7], s14 offen offset:0 sc1
    buffer_load_dwordx4 v[212:215], v85, s[4:7], s14 offen offset:1024 sc1
    buffer_load_dwordx4 v[216:219], v85, s[4:7], s14 offen offset:2048 sc1
    buffer_load_dwordx4 v[220:223], v85, s[4:7], s14 offen offset:3072 sc1
    s_add_u32 s14, s11, 24576
    buffer_load_dwordx4 v[224:227], v85, s[4:7], s14 offen offset:0 sc1
    buffer_load_dwordx4 v[228:231], v85, s[4:7], s14 offen offset:1024 sc1
    buffer_load_dwordx4 v[232:235], v85, s[4:7], s14 offen offset:2048 sc1
    buffer_load_dwordx4 v[236:239], v85, s[4:7], s14 offen offset:3072 sc1
    v_mov_b32 v32, 0
    v_mov_b32 v33, 0
    v_mov_b32 v34, 0
    v_mov_b32 v35, 0
    v_mov_b32 v36, 0
    v_mov_b32 v37, 0
    v_mov_b32 v38, 0
    v_mov_b32 v39, 0
    v_mov_b32 v40, 0
    v_mov_b32 v41, 0
    v_mov_b32 v42, 0
    v_mov_b32 v43, 0
    v_mov_b32 v44, 0
    v_mov_b32 v45, 0
    v_mov_b32 v46, 0
    v_mov_b32 v47, 0
    v_mov_b32 v60, 0
    v_mov_b32 v61, 0
    v_mov_b32 v62, 0
    v_mov_b32 v63, 0
    v_mov_b32 v64, 0
    v_mov_b32 v65, 0
    v_mov_b32 v66, 0
    v_mov_b32 v67, 0
    v_mov_b32 v68, 0
    v_mov_b32 v69, 0
    v_mov_b32 v70, 0
    v_mov_b32 v71, 0
    s_getreg_b32 s27, hwreg(HW_REG_XCC_ID, 0, 4)
    v_min_u32 v73, 31, v0
    v_lshlrev_b32 v73, 3, v73
    s_mov_b32 s11, 0x3b02000
    buffer_load_dword v72, v73, s[4:7], s11 offen offset:4 sc1
    s_waitcnt vmcnt(0)
    v_and_b32 v72, 15, v72
    v_cmp_ne_u32 vcc, s27, v72
    s_cbranch_vccnz s0_mode_11
.p2align 8
s0_loop_12:
    s_and_b32 s23, s8, 7
    s_lshl_b32 s23, s23, 13
    s_add_u32 s23, s23, 0x3100000
    s_add_u32 s26, s23, 4096
    s_and_b32 s11, s8, 3
    s_lshl_b32 s11, s11, 14
    s_add_u32 s24, s11, 0x3110000
    s_add_u32 s52, s8, 1
    s_mul_i32 s52, s52, 28672
    s_waitcnt vmcnt(0)
    s_mov_b32 s22, 0
    buffer_load_dwordx4 v[4:7], v1, s[4:7], s23 offen offset:0 sc1
    s_sleep 2
    buffer_load_dwordx4 v[4:7], v1, s[4:7], s23 offen offset:0 sc1
q_14:
    s_waitcnt vmcnt(1)
    v_max3_u32 v76, v4, v5, v6
    v_max_u32 v76, v76, v7
    v_cmp_eq_u32 vcc, -1, v76
    ds_write_b128 v1, v[4:7] offset:0
    buffer_load_dwordx4 v[4:7], v1, s[4:7], s23 offen offset:0 sc1
    s_add_u32 s22, s22, 1
    s_cmp_gt_u32 s22, 196608
    s_cbranch_scc1 M_exit
    s_cbranch_vccnz q_14
qdone_13:
    v_smfmac_f32_16x16x64_bf16 v[32:35], v[4:7], a[0:7], v2
    v_smfmac_f32_16x16x64_bf16 v[36:39], v[4:7], a[56:63], v2
    v_smfmac_f32_16x16x64_bf16 v[40:43], v[4:7], a[112:119], v2
    v_smfmac_f32_16x16x64_bf16 v[44:47], v[4:7], a[168:175], v2
    s_waitcnt lgkmcnt(0)
    s_barrier
    ds_read_b128 v[8:11], v1 offset:1024
    ds_read_b128 v[12:15], v1 offset:2048
    ds_read_b128 v[16:19], v1 offset:3072
    ds_read_b128 v[20:23], v1 offset:4096
    ds_read_b128 v[24:27], v1 offset:5120
    ds_read_b128 v[28:31], v1 offset:6144
    s_waitcnt lgkmcnt(5)
    v_smfmac_f32_16x16x64_bf16 v[32:35], v[8:11], a[8:15], v2
    v_smfmac_f32_16x16x64_bf16 v[36:39], v[8:11], a[64:71], v2
    v_smfmac_f32_16x16x64_bf16 v[40:43], v[8:11], a[120:127], v2
    v_smfmac_f32_16x16x64_bf16 v[44:47], v[8:11], a[176:183], v2
    s_waitcnt lgkmcnt(4)
    v_smfmac_f32_16x16x64_bf16 v[32:35], v[12:15], a[16:23], v2
    v_smfmac_f32_16x16x64_bf16 v[36:39], v[12:15], a[72:79], v2
    v_smfmac_f32_16x16x64_bf16 v[40:43], v[12:15], a[128:135], v2
    v_smfmac_f32_16x16x64_bf16 v[44:47], v[12:15], a[184:191], v2
    s_waitcnt lgkmcnt(3)
    v_smfmac_f32_16x16x64_bf16 v[32:35], v[16:19], a[24:31], v2
    v_smfmac_f32_16x16x64_bf16 v[36:39], v[16:19], a[80:87], v2
    v_smfmac_f32_16x16x64_bf16 v[40:43], v[16:19], a[136:143], v2
    v_smfmac_f32_16x16x64_bf16 v[44:47], v[16:19], a[192:199], v2
    s_waitcnt lgkmcnt(2)
    v_smfmac_f32_16x16x64_bf16 v[32:35], v[20:23], a[32:39], v2
    v_smfmac_f32_16x16x64_bf16 v[36:39], v[20:23], a[88:95], v2
    s_waitcnt lgkmcnt(1)
    v_smfmac_f32_16x16x64_bf16 v[32:35], v[24:27], a[40:47], v2
    v_smfmac_f32_16x16x64_bf16 v[36:39], v[24:27], a[96:103], v2
    s_waitcnt lgkmcnt(0)
    v_smfmac_f32_16x16x64_bf16 v[32:35], v[28:31], a[48:55], v2
    v_smfmac_f32_16x16x64_bf16 v[36:39], v[28:31], a[104:111], v2
    v_smfmac_f32_16x16x64_bf16 v[40:43], v[20:23], a[144:151], v2
    v_smfmac_f32_16x16x64_bf16 v[44:47], v[20:23], a[200:207], v2
    v_smfmac_f32_16x16x64_bf16 v[40:43], v[24:27], a[152:159], v2
    v_add_f32 v32, v32, v34
    v_smfmac_f32_16x16x64_bf16 v[44:47], v[24:27], a[208:215], v2
    v_add_f32 v36, v36, v38
    v_smfmac_f32_16x16x64_bf16 v[40:43], v[28:31], a[160:167], v2
    v_add_f32 v33, v33, v35
    v_smfmac_f32_16x16x64_bf16 v[44:47], v[28:31], a[216:223], v2
    v_add_f32 v37, v37, v39
    v_cvt_pk_bf16_f32 v32, v32, v36
    v_cvt_pk_bf16_f32 v33, v33, v37
    s_nop 2
    ds_write_b32 v3, v32 offset:11264
    ds_write_b32 v3, v33 offset:11280
    v_add_f32 v40, v40, v42
    v_add_f32 v44, v44, v46
    v_add_f32 v41, v41, v43
    v_add_f32 v45, v45, v47
    v_cvt_pk_bf16_f32 v40, v40, v44
    v_cvt_pk_bf16_f32 v41, v41, v45
    ds_write_b32 v3, v40 offset:11776
    ds_write_b32 v3, v41 offset:11792
    ds_read_b128 v[100:103], v1 offset:11264
    s_waitcnt lgkmcnt(0)
    v_mfma_f32_16x16x32_bf16 v[68:71], v[100:103], v[16:19], v[68:71]
    v_smfmac_f32_16x16x64_bf16 v[60:63], v[100:103], v[152:159], v2
    v_smfmac_f32_16x16x64_bf16 v[64:67], v[100:103], v[208:215], v2
    s_barrier
    ds_read_b128 v[48:51], v1 offset:8192
    ds_read_b128 v[52:55], v1 offset:9216
    ds_read_b128 v[56:59], v1 offset:10240
    s_add_u32 s53, s52, 6144
    buffer_load_dwordx4 v[152:155], v85, s[4:7], s53 offen sc1
    buffer_load_dwordx4 v[156:159], v85, s[4:7], s53 offen offset:1024 sc1
    s_add_u32 s53, s52, 20480
    buffer_load_dwordx4 v[208:211], v85, s[4:7], s53 offen sc1
    s_waitcnt lgkmcnt(2)
    v_mfma_f32_16x16x32_bf16 v[68:71], v[48:51], v[4:7], v[68:71]
    buffer_load_dwordx4 v[212:215], v85, s[4:7], s53 offen offset:1024 sc1
    v_smfmac_f32_16x16x64_bf16 v[60:63], v[48:51], v[128:135], v2
    v_smfmac_f32_16x16x64_bf16 v[64:67], v[48:51], v[184:191], v2
    s_waitcnt lgkmcnt(1)
    v_mfma_f32_16x16x32_bf16 v[68:71], v[52:55], v[8:11], v[68:71]
    s_add_u32 s53, s52, 0
    buffer_load_dwordx4 v[128:131], v85, s[4:7], s53 offen sc1
    v_smfmac_f32_16x16x64_bf16 v[60:63], v[52:55], v[136:143], v2
    buffer_load_dwordx4 v[132:135], v85, s[4:7], s53 offen offset:1024 sc1
    v_smfmac_f32_16x16x64_bf16 v[64:67], v[52:55], v[192:199], v2
    s_add_u32 s53, s52, 14336
    buffer_load_dwordx4 v[184:187], v85, s[4:7], s53 offen sc1
    s_waitcnt lgkmcnt(0)
    v_mfma_f32_16x16x32_bf16 v[68:71], v[56:59], v[12:15], v[68:71]
    buffer_load_dwordx4 v[188:191], v85, s[4:7], s53 offen offset:1024 sc1
    v_smfmac_f32_16x16x64_bf16 v[60:63], v[56:59], v[144:151], v2
    s_add_u32 s53, s52, 2048
    buffer_load_dwordx4 v[136:139], v85, s[4:7], s53 offen sc1
    v_smfmac_f32_16x16x64_bf16 v[64:67], v[56:59], v[200:207], v2
    buffer_load_dwordx4 v[140:143], v85, s[4:7], s53 offen offset:1024 sc1
    s_add_u32 s53, s52, 16384
    buffer_load_dwordx4 v[192:195], v85, s[4:7], s53 offen sc1
    buffer_load_dwordx4 v[196:199], v85, s[4:7], s53 offen offset:1024 sc1
    s_add_u32 s53, s52, 4096
    buffer_load_dwordx4 v[144:147], v85, s[4:7], s53 offen sc1
    buffer_load_dwordx4 v[148:151], v85, s[4:7], s53 offen offset:1024 sc1
    s_barrier
    ds_read_b128 v[48:51], v1 offset:12288
    ds_read_b128 v[52:55], v1 offset:13312
    s_waitcnt lgkmcnt(1)
    v_mfma_f32_16x16x32_bf16 v[68:71], v[48:51], v[20:23], v[68:71]
    v_smfmac_f32_16x16x64_bf16 v[60:63], v[48:51], v[160:167], v2
    v_smfmac_f32_16x16x64_bf16 v[64:67], v[48:51], v[216:223], v2
    s_waitcnt lgkmcnt(0)
    s_barrier
    ds_read_b64_tr_b16 v[56:57], v86 offset:14336
    ds_read_b64_tr_b16 v[58:59], v86 offset:14352
    v_mfma_f32_16x16x32_bf16 v[68:71], v[52:55], v[24:27], v[68:71]
    v_smfmac_f32_16x16x64_bf16 v[60:63], v[52:55], v[168:175], v2
    v_smfmac_f32_16x16x64_bf16 v[64:67], v[52:55], v[224:231], v2
    s_waitcnt lgkmcnt(0)
    v_mfma_f32_16x16x32_bf16 v[68:71], v[56:59], v[28:31], v[68:71]
    v_smfmac_f32_16x16x64_bf16 v[60:63], v[56:59], v[176:183], v2
    v_smfmac_f32_16x16x64_bf16 v[64:67], v[56:59], v[232:239], v2
    v_add_f32_dpp v68, v70, v68 quad_perm:[2,3,0,1] row_mask:0xf bank_mask:0xf
    v_add_f32_dpp v71, v69, v71 quad_perm:[2,3,0,1] row_mask:0xf bank_mask:0xf
    v_cndmask_b32 v68, v71, v68, s[20:21]
    v_exp_f32 v96, v68
    v_pk_add_f32 v[60:61], v[60:61], v[62:63]
    v_exp_f32 v92, v60
    v_exp_f32 v93, v61
    v_pk_add_f32 v[64:65], v[64:65], v[66:67]
    v_exp_f32 v94, v64
    v_exp_f32 v95, v65
    v_pk_fma_f32 v[90:91], v[96:97], v[98:99], v[92:93] op_sel_hi:[0,1,1]
    v_pk_add_f32 v[90:91], v[90:91], v[94:95]
    v_max3_f32 v88, |v60|, |v64|, |v68|
    v_max3_f32 v88, |v61|, |v65|, v88
    v_add_f32_dpp v90, v90, v90 row_ror:8 row_mask:0xf bank_mask:0xf
    v_add_f32_dpp v91, v91, v91 row_ror:8 row_mask:0xf bank_mask:0xf
    v_cmp_lt_f32 vcc, 0x42700000, v88
    v_add_f32_dpp v90, v90, v90 row_ror:4 row_mask:0xf bank_mask:0xf
    v_add_f32_dpp v91, v91, v91 row_ror:4 row_mask:0xf bank_mask:0xf
    s_nop 0
    v_add_f32_dpp v90, v90, v90 row_ror:2 row_mask:0xf bank_mask:0xf
    v_add_f32_dpp v91, v91, v91 row_ror:2 row_mask:0xf bank_mask:0xf
    s_nop 0
    v_add_f32_dpp v90, v90, v90 row_ror:1 row_mask:0xf bank_mask:0xf
    v_add_f32_dpp v91, v91, v91 row_ror:1 row_mask:0xf bank_mask:0xf
    v_rcp_f32 v90, v90
    v_rcp_f32 v91, v91
    s_cbranch_vccnz s0_slow_16
s0_back_17:
    v_pk_mul_f32 v[92:93], v[92:93], v[90:91]
    v_pk_mul_f32 v[94:95], v[94:95], v[90:91]
    v_cvt_pk_bf16_f32 v72, |v92|, |v94|
    v_cndmask_b32 v90, v91, v90, s[20:21]
    v_mul_f32 v96, v96, v90
    v_cvt_pk_bf16_f32 v74, v96, v80
    v_cvt_pk_bf16_f32 v73, |v93|, |v95|
    buffer_store_dword v72, v78, s[4:7], s24 offen
    buffer_store_dword v74, v79, s[4:7], s24 offen
    buffer_store_dword v73, v78, s[4:7], s24 offen offset:128
    v_mov_b32 v32, 0
    v_mov_b32 v33, 0
    v_mov_b32 v34, 0
    v_mov_b32 v35, 0
    v_mov_b32 v36, 0
    v_mov_b32 v37, 0
    v_mov_b32 v38, 0
    v_mov_b32 v39, 0
    v_mov_b32 v40, 0
    v_mov_b32 v41, 0
    v_mov_b32 v42, 0
    v_mov_b32 v43, 0
    v_mov_b32 v44, 0
    v_mov_b32 v45, 0
    v_mov_b32 v46, 0
    v_mov_b32 v47, 0
    v_mov_b32 v60, 0
    v_mov_b32 v61, 0
    v_mov_b32 v62, 0
    v_mov_b32 v63, 0
    v_mov_b32 v64, 0
    v_mov_b32 v65, 0
    v_mov_b32 v66, 0
    v_mov_b32 v67, 0
    v_mov_b32 v68, 0
    v_mov_b32 v69, 0
    v_mov_b32 v70, 0
    v_mov_b32 v71, 0
    s_sleep 5
    s_add_u32 s8, s8, 1
    s_add_u32 s53, s52, 18432
    buffer_load_dwordx4 v[200:203], v85, s[4:7], s53 offen sc1
    buffer_load_dwordx4 v[204:207], v85, s[4:7], s53 offen offset:1024 sc1
    s_add_u32 s53, s52, 8192
    buffer_load_dwordx4 v[160:163], v85, s[4:7], s53 offen sc1
    buffer_load_dwordx4 v[164:167], v85, s[4:7], s53 offen offset:1024 sc1
    s_add_u32 s53, s52, 22528
    buffer_load_dwordx4 v[216:219], v85, s[4:7], s53 offen sc1
    buffer_load_dwordx4 v[220:223], v85, s[4:7], s53 offen offset:1024 sc1
    s_add_u32 s53, s52, 10240
    buffer_load_dwordx4 v[168:171], v85, s[4:7], s53 offen sc1
    buffer_load_dwordx4 v[172:175], v85, s[4:7], s53 offen offset:1024 sc1
    s_add_u32 s53, s52, 24576
    buffer_load_dwordx4 v[224:227], v85, s[4:7], s53 offen sc1
    buffer_load_dwordx4 v[228:231], v85, s[4:7], s53 offen offset:1024 sc1
    s_add_u32 s53, s52, 12288
    buffer_load_dwordx4 v[176:179], v85, s[4:7], s53 offen sc1
    buffer_load_dwordx4 v[180:183], v85, s[4:7], s53 offen offset:1024 sc1
    s_add_u32 s53, s52, 26624
    buffer_load_dwordx4 v[232:235], v85, s[4:7], s53 offen sc1
    buffer_load_dwordx4 v[236:239], v85, s[4:7], s53 offen offset:1024 sc1
    s_xor_b32 s24, s24, 0x8000
    buffer_store_dword v82, v78, s[4:7], s24 offen offset:0
    buffer_store_dword v82, v78, s[4:7], s24 offen offset:128
    buffer_store_dword v82, v79, s[4:7], s24 offen offset:0
    s_cmp_lt_u32 s8, 63
    s_cbranch_scc1 s0_loop_12
    s_branch M_exit
s0_slow_16:
    v_cndmask_b32 v69, v81, v68, s[20:21]
    v_cndmask_b32 v70, v68, v81, s[20:21]
    v_max3_f32 v88, v60, v64, v69
    v_max3_f32 v89, v61, v65, v70
    s_nop 1
    v_max_f32_dpp v88, v88, v88 row_ror:8 row_mask:0xf bank_mask:0xf
    v_max_f32_dpp v89, v89, v89 row_ror:8 row_mask:0xf bank_mask:0xf
    s_nop 1
    v_max_f32_dpp v88, v88, v88 row_ror:4 row_mask:0xf bank_mask:0xf
    v_max_f32_dpp v89, v89, v89 row_ror:4 row_mask:0xf bank_mask:0xf
    s_nop 1
    v_max_f32_dpp v88, v88, v88 row_ror:2 row_mask:0xf bank_mask:0xf
    v_max_f32_dpp v89, v89, v89 row_ror:2 row_mask:0xf bank_mask:0xf
    s_nop 1
    v_max_f32_dpp v88, v88, v88 row_ror:1 row_mask:0xf bank_mask:0xf
    v_max_f32_dpp v89, v89, v89 row_ror:1 row_mask:0xf bank_mask:0xf
    v_sub_f32 v60, v60, v88
    v_sub_f32 v61, v61, v89
    v_sub_f32 v64, v64, v88
    v_sub_f32 v65, v65, v89
    v_cndmask_b32 v88, v89, v88, s[20:21]
    v_sub_f32 v68, v68, v88
    v_exp_f32 v92, v60
    v_exp_f32 v93, v61
    v_exp_f32 v94, v64
    v_exp_f32 v95, v65
    v_exp_f32 v96, v68
    s_nop 1
    v_pk_fma_f32 v[90:91], v[96:97], v[98:99], v[92:93] op_sel_hi:[0,1,1]
    v_pk_add_f32 v[90:91], v[90:91], v[94:95]
    s_nop 1
    s_nop 1
    v_add_f32_dpp v90, v90, v90 row_ror:8 row_mask:0xf bank_mask:0xf
    v_add_f32_dpp v91, v91, v91 row_ror:8 row_mask:0xf bank_mask:0xf
    s_nop 1
    v_add_f32_dpp v90, v90, v90 row_ror:4 row_mask:0xf bank_mask:0xf
    v_add_f32_dpp v91, v91, v91 row_ror:4 row_mask:0xf bank_mask:0xf
    s_nop 1
    v_add_f32_dpp v90, v90, v90 row_ror:2 row_mask:0xf bank_mask:0xf
    v_add_f32_dpp v91, v91, v91 row_ror:2 row_mask:0xf bank_mask:0xf
    s_nop 0
    v_add_f32_dpp v90, v90, v90 row_ror:1 row_mask:0xf bank_mask:0xf
    v_add_f32_dpp v91, v91, v91 row_ror:1 row_mask:0xf bank_mask:0xf
    v_rcp_f32 v90, v90
    v_rcp_f32 v91, v91
    s_branch s0_back_17
s0_mode_11:
.p2align 8
s0_loop_18:
    s_and_b32 s23, s8, 7
    s_lshl_b32 s23, s23, 13
    s_add_u32 s23, s23, 0x3100000
    s_add_u32 s26, s23, 4096
    s_and_b32 s11, s8, 3
    s_lshl_b32 s11, s11, 14
    s_add_u32 s24, s11, 0x3110000
    s_add_u32 s52, s8, 1
    s_mul_i32 s52, s52, 28672
    s_waitcnt vmcnt(0)
    s_mov_b32 s22, 0
    buffer_load_dwordx4 v[4:7], v1, s[4:7], s23 offen offset:0 sc1
    s_sleep 2
    buffer_load_dwordx4 v[4:7], v1, s[4:7], s23 offen offset:0 sc1
q_20:
    s_waitcnt vmcnt(1)
    v_max3_u32 v76, v4, v5, v6
    v_max_u32 v76, v76, v7
    v_cmp_eq_u32 vcc, -1, v76
    ds_write_b128 v1, v[4:7] offset:0
    buffer_load_dwordx4 v[4:7], v1, s[4:7], s23 offen offset:0 sc1
    s_add_u32 s22, s22, 1
    s_cmp_gt_u32 s22, 196608
    s_cbranch_scc1 M_exit
    s_cbranch_vccnz q_20
qdone_19:
    v_smfmac_f32_16x16x64_bf16 v[32:35], v[4:7], a[0:7], v2
    v_smfmac_f32_16x16x64_bf16 v[36:39], v[4:7], a[56:63], v2
    v_smfmac_f32_16x16x64_bf16 v[40:43], v[4:7], a[112:119], v2
    v_smfmac_f32_16x16x64_bf16 v[44:47], v[4:7], a[168:175], v2
    s_waitcnt lgkmcnt(0)
    s_barrier
    ds_read_b128 v[8:11], v1 offset:1024
    ds_read_b128 v[12:15], v1 offset:2048
    ds_read_b128 v[16:19], v1 offset:3072
    ds_read_b128 v[20:23], v1 offset:4096
    ds_read_b128 v[24:27], v1 offset:5120
    ds_read_b128 v[28:31], v1 offset:6144
    s_waitcnt lgkmcnt(5)
    v_smfmac_f32_16x16x64_bf16 v[32:35], v[8:11], a[8:15], v2
    v_smfmac_f32_16x16x64_bf16 v[36:39], v[8:11], a[64:71], v2
    v_smfmac_f32_16x16x64_bf16 v[40:43], v[8:11], a[120:127], v2
    v_smfmac_f32_16x16x64_bf16 v[44:47], v[8:11], a[176:183], v2
    s_waitcnt lgkmcnt(4)
    v_smfmac_f32_16x16x64_bf16 v[32:35], v[12:15], a[16:23], v2
    v_smfmac_f32_16x16x64_bf16 v[36:39], v[12:15], a[72:79], v2
    v_smfmac_f32_16x16x64_bf16 v[40:43], v[12:15], a[128:135], v2
    v_smfmac_f32_16x16x64_bf16 v[44:47], v[12:15], a[184:191], v2
    s_waitcnt lgkmcnt(3)
    v_smfmac_f32_16x16x64_bf16 v[32:35], v[16:19], a[24:31], v2
    v_smfmac_f32_16x16x64_bf16 v[36:39], v[16:19], a[80:87], v2
    v_smfmac_f32_16x16x64_bf16 v[40:43], v[16:19], a[136:143], v2
    v_smfmac_f32_16x16x64_bf16 v[44:47], v[16:19], a[192:199], v2
    s_waitcnt lgkmcnt(2)
    v_smfmac_f32_16x16x64_bf16 v[32:35], v[20:23], a[32:39], v2
    v_smfmac_f32_16x16x64_bf16 v[36:39], v[20:23], a[88:95], v2
    s_waitcnt lgkmcnt(1)
    v_smfmac_f32_16x16x64_bf16 v[32:35], v[24:27], a[40:47], v2
    v_smfmac_f32_16x16x64_bf16 v[36:39], v[24:27], a[96:103], v2
    s_waitcnt lgkmcnt(0)
    v_smfmac_f32_16x16x64_bf16 v[32:35], v[28:31], a[48:55], v2
    v_smfmac_f32_16x16x64_bf16 v[36:39], v[28:31], a[104:111], v2
    v_smfmac_f32_16x16x64_bf16 v[40:43], v[20:23], a[144:151], v2
    v_smfmac_f32_16x16x64_bf16 v[44:47], v[20:23], a[200:207], v2
    v_smfmac_f32_16x16x64_bf16 v[40:43], v[24:27], a[152:159], v2
    v_add_f32 v32, v32, v34
    v_smfmac_f32_16x16x64_bf16 v[44:47], v[24:27], a[208:215], v2
    v_add_f32 v36, v36, v38
    v_smfmac_f32_16x16x64_bf16 v[40:43], v[28:31], a[160:167], v2
    v_add_f32 v33, v33, v35
    v_smfmac_f32_16x16x64_bf16 v[44:47], v[28:31], a[216:223], v2
    v_add_f32 v37, v37, v39
    v_cvt_pk_bf16_f32 v32, v32, v36
    v_cvt_pk_bf16_f32 v33, v33, v37
    s_nop 2
    ds_write_b32 v3, v32 offset:11264
    ds_write_b32 v3, v33 offset:11280
    v_add_f32 v40, v40, v42
    v_add_f32 v44, v44, v46
    v_add_f32 v41, v41, v43
    v_add_f32 v45, v45, v47
    v_cvt_pk_bf16_f32 v40, v40, v44
    v_cvt_pk_bf16_f32 v41, v41, v45
    ds_write_b32 v3, v40 offset:11776
    ds_write_b32 v3, v41 offset:11792
    ds_read_b128 v[100:103], v1 offset:11264
    s_waitcnt lgkmcnt(0)
    v_mfma_f32_16x16x32_bf16 v[68:71], v[100:103], v[16:19], v[68:71]
    v_smfmac_f32_16x16x64_bf16 v[60:63], v[100:103], v[152:159], v2
    v_smfmac_f32_16x16x64_bf16 v[64:67], v[100:103], v[208:215], v2
    s_barrier
    ds_read_b128 v[48:51], v1 offset:8192
    ds_read_b128 v[52:55], v1 offset:9216
    ds_read_b128 v[56:59], v1 offset:10240
    s_add_u32 s53, s52, 6144
    buffer_load_dwordx4 v[152:155], v85, s[4:7], s53 offen sc1
    buffer_load_dwordx4 v[156:159], v85, s[4:7], s53 offen offset:1024 sc1
    s_add_u32 s53, s52, 20480
    buffer_load_dwordx4 v[208:211], v85, s[4:7], s53 offen sc1
    s_waitcnt lgkmcnt(2)
    v_mfma_f32_16x16x32_bf16 v[68:71], v[48:51], v[4:7], v[68:71]
    buffer_load_dwordx4 v[212:215], v85, s[4:7], s53 offen offset:1024 sc1
    v_smfmac_f32_16x16x64_bf16 v[60:63], v[48:51], v[128:135], v2
    v_smfmac_f32_16x16x64_bf16 v[64:67], v[48:51], v[184:191], v2
    s_waitcnt lgkmcnt(1)
    v_mfma_f32_16x16x32_bf16 v[68:71], v[52:55], v[8:11], v[68:71]
    s_add_u32 s53, s52, 0
    buffer_load_dwordx4 v[128:131], v85, s[4:7], s53 offen sc1
    v_smfmac_f32_16x16x64_bf16 v[60:63], v[52:55], v[136:143], v2
    buffer_load_dwordx4 v[132:135], v85, s[4:7], s53 offen offset:1024 sc1
    v_smfmac_f32_16x16x64_bf16 v[64:67], v[52:55], v[192:199], v2
    s_add_u32 s53, s52, 14336
    buffer_load_dwordx4 v[184:187], v85, s[4:7], s53 offen sc1
    s_waitcnt lgkmcnt(0)
    v_mfma_f32_16x16x32_bf16 v[68:71], v[56:59], v[12:15], v[68:71]
    buffer_load_dwordx4 v[188:191], v85, s[4:7], s53 offen offset:1024 sc1
    v_smfmac_f32_16x16x64_bf16 v[60:63], v[56:59], v[144:151], v2
    s_add_u32 s53, s52, 2048
    buffer_load_dwordx4 v[136:139], v85, s[4:7], s53 offen sc1
    v_smfmac_f32_16x16x64_bf16 v[64:67], v[56:59], v[200:207], v2
    buffer_load_dwordx4 v[140:143], v85, s[4:7], s53 offen offset:1024 sc1
    s_add_u32 s53, s52, 16384
    buffer_load_dwordx4 v[192:195], v85, s[4:7], s53 offen sc1
    buffer_load_dwordx4 v[196:199], v85, s[4:7], s53 offen offset:1024 sc1
    s_add_u32 s53, s52, 4096
    buffer_load_dwordx4 v[144:147], v85, s[4:7], s53 offen sc1
    buffer_load_dwordx4 v[148:151], v85, s[4:7], s53 offen offset:1024 sc1
    s_barrier
    ds_read_b128 v[48:51], v1 offset:12288
    ds_read_b128 v[52:55], v1 offset:13312
    s_waitcnt lgkmcnt(1)
    v_mfma_f32_16x16x32_bf16 v[68:71], v[48:51], v[20:23], v[68:71]
    v_smfmac_f32_16x16x64_bf16 v[60:63], v[48:51], v[160:167], v2
    v_smfmac_f32_16x16x64_bf16 v[64:67], v[48:51], v[216:223], v2
    s_waitcnt lgkmcnt(0)
    s_barrier
    ds_read_b64_tr_b16 v[56:57], v86 offset:14336
    ds_read_b64_tr_b16 v[58:59], v86 offset:14352
    v_mfma_f32_16x16x32_bf16 v[68:71], v[52:55], v[24:27], v[68:71]
    v_smfmac_f32_16x16x64_bf16 v[60:63], v[52:55], v[168:175], v2
    v_smfmac_f32_16x16x64_bf16 v[64:67], v[52:55], v[224:231], v2
    s_waitcnt lgkmcnt(0)
    v_mfma_f32_16x16x32_bf16 v[68:71], v[56:59], v[28:31], v[68:71]
    v_smfmac_f32_16x16x64_bf16 v[60:63], v[56:59], v[176:183], v2
    v_smfmac_f32_16x16x64_bf16 v[64:67], v[56:59], v[232:239], v2
    v_add_f32_dpp v68, v70, v68 quad_perm:[2,3,0,1] row_mask:0xf bank_mask:0xf
    v_add_f32_dpp v71, v69, v71 quad_perm:[2,3,0,1] row_mask:0xf bank_mask:0xf
    v_cndmask_b32 v68, v71, v68, s[20:21]
    v_exp_f32 v96, v68
    v_pk_add_f32 v[60:61], v[60:61], v[62:63]
    v_exp_f32 v92, v60
    v_exp_f32 v93, v61
    v_pk_add_f32 v[64:65], v[64:65], v[66:67]
    v_exp_f32 v94, v64
    v_exp_f32 v95, v65
    v_pk_fma_f32 v[90:91], v[96:97], v[98:99], v[92:93] op_sel_hi:[0,1,1]
    v_pk_add_f32 v[90:91], v[90:91], v[94:95]
    v_max3_f32 v88, |v60|, |v64|, |v68|
    v_max3_f32 v88, |v61|, |v65|, v88
    v_add_f32_dpp v90, v90, v90 row_ror:8 row_mask:0xf bank_mask:0xf
    v_add_f32_dpp v91, v91, v91 row_ror:8 row_mask:0xf bank_mask:0xf
    v_cmp_lt_f32 vcc, 0x42700000, v88
    v_add_f32_dpp v90, v90, v90 row_ror:4 row_mask:0xf bank_mask:0xf
    v_add_f32_dpp v91, v91, v91 row_ror:4 row_mask:0xf bank_mask:0xf
    s_nop 0
    v_add_f32_dpp v90, v90, v90 row_ror:2 row_mask:0xf bank_mask:0xf
    v_add_f32_dpp v91, v91, v91 row_ror:2 row_mask:0xf bank_mask:0xf
    s_nop 0
    v_add_f32_dpp v90, v90, v90 row_ror:1 row_mask:0xf bank_mask:0xf
    v_add_f32_dpp v91, v91, v91 row_ror:1 row_mask:0xf bank_mask:0xf
    v_rcp_f32 v90, v90
    v_rcp_f32 v91, v91
    s_cbranch_vccnz s0_slow_22
s0_back_23:
    v_pk_mul_f32 v[92:93], v[92:93], v[90:91]
    v_pk_mul_f32 v[94:95], v[94:95], v[90:91]
    v_cvt_pk_bf16_f32 v72, |v92|, |v94|
    v_cndmask_b32 v90, v91, v90, s[20:21]
    v_mul_f32 v96, v96, v90
    v_cvt_pk_bf16_f32 v74, v96, v80
    v_cvt_pk_bf16_f32 v73, |v93|, |v95|
    buffer_store_dword v72, v78, s[4:7], s24 offen sc1
    buffer_store_dword v74, v79, s[4:7], s24 offen sc1
    buffer_store_dword v73, v78, s[4:7], s24 offen offset:128 sc1
    v_mov_b32 v32, 0
    v_mov_b32 v33, 0
    v_mov_b32 v34, 0
    v_mov_b32 v35, 0
    v_mov_b32 v36, 0
    v_mov_b32 v37, 0
    v_mov_b32 v38, 0
    v_mov_b32 v39, 0
    v_mov_b32 v40, 0
    v_mov_b32 v41, 0
    v_mov_b32 v42, 0
    v_mov_b32 v43, 0
    v_mov_b32 v44, 0
    v_mov_b32 v45, 0
    v_mov_b32 v46, 0
    v_mov_b32 v47, 0
    v_mov_b32 v60, 0
    v_mov_b32 v61, 0
    v_mov_b32 v62, 0
    v_mov_b32 v63, 0
    v_mov_b32 v64, 0
    v_mov_b32 v65, 0
    v_mov_b32 v66, 0
    v_mov_b32 v67, 0
    v_mov_b32 v68, 0
    v_mov_b32 v69, 0
    v_mov_b32 v70, 0
    v_mov_b32 v71, 0
    s_sleep 5
    s_add_u32 s8, s8, 1
    s_add_u32 s53, s52, 18432
    buffer_load_dwordx4 v[200:203], v85, s[4:7], s53 offen sc1
    buffer_load_dwordx4 v[204:207], v85, s[4:7], s53 offen offset:1024 sc1
    s_add_u32 s53, s52, 8192
    buffer_load_dwordx4 v[160:163], v85, s[4:7], s53 offen sc1
    buffer_load_dwordx4 v[164:167], v85, s[4:7], s53 offen offset:1024 sc1
    s_add_u32 s53, s52, 22528
    buffer_load_dwordx4 v[216:219], v85, s[4:7], s53 offen sc1
    buffer_load_dwordx4 v[220:223], v85, s[4:7], s53 offen offset:1024 sc1
    s_add_u32 s53, s52, 10240
    buffer_load_dwordx4 v[168:171], v85, s[4:7], s53 offen sc1
    buffer_load_dwordx4 v[172:175], v85, s[4:7], s53 offen offset:1024 sc1
    s_add_u32 s53, s52, 24576
    buffer_load_dwordx4 v[224:227], v85, s[4:7], s53 offen sc1
    buffer_load_dwordx4 v[228:231], v85, s[4:7], s53 offen offset:1024 sc1
    s_add_u32 s53, s52, 12288
    buffer_load_dwordx4 v[176:179], v85, s[4:7], s53 offen sc1
    buffer_load_dwordx4 v[180:183], v85, s[4:7], s53 offen offset:1024 sc1
    s_add_u32 s53, s52, 26624
    buffer_load_dwordx4 v[232:235], v85, s[4:7], s53 offen sc1
    buffer_load_dwordx4 v[236:239], v85, s[4:7], s53 offen offset:1024 sc1
    s_xor_b32 s24, s24, 0x8000
    buffer_store_dword v82, v78, s[4:7], s24 offen offset:0 sc1
    buffer_store_dword v82, v78, s[4:7], s24 offen offset:128 sc1
    buffer_store_dword v82, v79, s[4:7], s24 offen offset:0 sc1
    s_cmp_lt_u32 s8, 63
    s_cbranch_scc1 s0_loop_18
    s_branch M_exit
s0_slow_22:
    v_cndmask_b32 v69, v81, v68, s[20:21]
    v_cndmask_b32 v70, v68, v81, s[20:21]
    v_max3_f32 v88, v60, v64, v69
    v_max3_f32 v89, v61, v65, v70
    s_nop 1
    v_max_f32_dpp v88, v88, v88 row_ror:8 row_mask:0xf bank_mask:0xf
    v_max_f32_dpp v89, v89, v89 row_ror:8 row_mask:0xf bank_mask:0xf
    s_nop 1
    v_max_f32_dpp v88, v88, v88 row_ror:4 row_mask:0xf bank_mask:0xf
    v_max_f32_dpp v89, v89, v89 row_ror:4 row_mask:0xf bank_mask:0xf
    s_nop 1
    v_max_f32_dpp v88, v88, v88 row_ror:2 row_mask:0xf bank_mask:0xf
    v_max_f32_dpp v89, v89, v89 row_ror:2 row_mask:0xf bank_mask:0xf
    s_nop 1
    v_max_f32_dpp v88, v88, v88 row_ror:1 row_mask:0xf bank_mask:0xf
    v_max_f32_dpp v89, v89, v89 row_ror:1 row_mask:0xf bank_mask:0xf
    v_sub_f32 v60, v60, v88
    v_sub_f32 v61, v61, v89
    v_sub_f32 v64, v64, v88
    v_sub_f32 v65, v65, v89
    v_cndmask_b32 v88, v89, v88, s[20:21]
    v_sub_f32 v68, v68, v88
    v_exp_f32 v92, v60
    v_exp_f32 v93, v61
    v_exp_f32 v94, v64
    v_exp_f32 v95, v65
    v_exp_f32 v96, v68
    s_nop 1
    v_pk_fma_f32 v[90:91], v[96:97], v[98:99], v[92:93] op_sel_hi:[0,1,1]
    v_pk_add_f32 v[90:91], v[90:91], v[94:95]
    s_nop 1
    s_nop 1
    v_add_f32_dpp v90, v90, v90 row_ror:8 row_mask:0xf bank_mask:0xf
    v_add_f32_dpp v91, v91, v91 row_ror:8 row_mask:0xf bank_mask:0xf
    s_nop 1
    v_add_f32_dpp v90, v90, v90 row_ror:4 row_mask:0xf bank_mask:0xf
    v_add_f32_dpp v91, v91, v91 row_ror:4 row_mask:0xf bank_mask:0xf
    s_nop 1
    v_add_f32_dpp v90, v90, v90 row_ror:2 row_mask:0xf bank_mask:0xf
    v_add_f32_dpp v91, v91, v91 row_ror:2 row_mask:0xf bank_mask:0xf
    s_nop 0
    v_add_f32_dpp v90, v90, v90 row_ror:1 row_mask:0xf bank_mask:0xf
    v_add_f32_dpp v91, v91, v91 row_ror:1 row_mask:0xf bank_mask:0xf
    v_rcp_f32 v90, v90
    v_rcp_f32 v91, v91
    s_branch s0_back_23
s_w1_4:
    v_and_b32 v0, 63, v0
    v_lshlrev_b32 v1, 4, v0
    v_and_b32 v4, 2, v0
    v_cmp_eq_u32 s[20:21], 0, v4
    v_mov_b32 v2, 0xeeee
    v_mov_b32 v4, 0x4444
    v_cndmask_b32 v2, v2, v4, s[20:21]
    v_bfe_u32 v4, v0, 3, 1
    v_lshlrev_b32 v3, 8, v4
    v_lshrrev_b32 v4, 4, v0
    v_lshl_add_u32 v3, v4, 6, v3
    v_and_b32 v4, 1, v0
    v_lshl_add_u32 v3, v4, 5, v3
    v_bfe_u32 v4, v0, 1, 2
    v_lshl_add_u32 v3, v4, 2, v3
    s_lshl_b32 s11, s9, 6
    s_add_u32 s11, s11, 0x3b02000
    v_min_u32 v4, 3, v0
    v_lshlrev_b32 v4, 4, v4
    s_mov_b32 s22, 0
wt_24:
    buffer_load_dwordx4 v[32:35], v4, s[4:7], s11 offen offset:0 sc1
    s_waitcnt vmcnt(0)
    v_xor_b32 v32, s80, v32
    v_xor_b32 v33, s81, v33
    v_and_b32 v33, -16, v33
    v_xor_b32 v34, s80, v34
    v_xor_b32 v35, s81, v35
    v_and_b32 v35, -16, v35
    v_or3_b32 v32, v32, v33, v34
    v_or_b32 v32, v32, v35
    v_cmp_ne_u32 vcc, 0, v32
    s_cbranch_vccz wtok_25
    s_add_u32 s22, s22, 1
    s_cmp_gt_u32 s22, 65536
    s_cbranch_scc1 M_exit
    s_sleep 16
    s_branch wt_24
wtok_25:
    s_mul_i32 s11, s9, 401408
    s_add_u32 s12, s11, 0x200000
    s_add_u32 s14, s12, 0
    buffer_load_dwordx4 a[0:3], v1, s[4:7], s14 offen offset:0 sc1
    buffer_load_dwordx4 a[4:7], v1, s[4:7], s14 offen offset:1024 sc1
    buffer_load_dwordx4 a[8:11], v1, s[4:7], s14 offen offset:2048 sc1
    buffer_load_dwordx4 a[12:15], v1, s[4:7], s14 offen offset:3072 sc1
    s_add_u32 s14, s12, 4096
    buffer_load_dwordx4 a[16:19], v1, s[4:7], s14 offen offset:0 sc1
    buffer_load_dwordx4 a[20:23], v1, s[4:7], s14 offen offset:1024 sc1
    buffer_load_dwordx4 a[24:27], v1, s[4:7], s14 offen offset:2048 sc1
    buffer_load_dwordx4 a[28:31], v1, s[4:7], s14 offen offset:3072 sc1
    s_add_u32 s14, s12, 8192
    buffer_load_dwordx4 a[32:35], v1, s[4:7], s14 offen offset:0 sc1
    buffer_load_dwordx4 a[36:39], v1, s[4:7], s14 offen offset:1024 sc1
    buffer_load_dwordx4 a[40:43], v1, s[4:7], s14 offen offset:2048 sc1
    buffer_load_dwordx4 a[44:47], v1, s[4:7], s14 offen offset:3072 sc1
    s_add_u32 s14, s12, 12288
    buffer_load_dwordx4 a[48:51], v1, s[4:7], s14 offen offset:0 sc1
    buffer_load_dwordx4 a[52:55], v1, s[4:7], s14 offen offset:1024 sc1
    s_add_u32 s12, s11, 0x203800
    s_add_u32 s14, s12, 0
    buffer_load_dwordx4 a[56:59], v1, s[4:7], s14 offen offset:0 sc1
    buffer_load_dwordx4 a[60:63], v1, s[4:7], s14 offen offset:1024 sc1
    buffer_load_dwordx4 a[64:67], v1, s[4:7], s14 offen offset:2048 sc1
    buffer_load_dwordx4 a[68:71], v1, s[4:7], s14 offen offset:3072 sc1
    s_add_u32 s14, s12, 4096
    buffer_load_dwordx4 a[72:75], v1, s[4:7], s14 offen offset:0 sc1
    buffer_load_dwordx4 a[76:79], v1, s[4:7], s14 offen offset:1024 sc1
    buffer_load_dwordx4 a[80:83], v1, s[4:7], s14 offen offset:2048 sc1
    buffer_load_dwordx4 a[84:87], v1, s[4:7], s14 offen offset:3072 sc1
    s_add_u32 s14, s12, 8192
    buffer_load_dwordx4 a[88:91], v1, s[4:7], s14 offen offset:0 sc1
    buffer_load_dwordx4 a[92:95], v1, s[4:7], s14 offen offset:1024 sc1
    buffer_load_dwordx4 a[96:99], v1, s[4:7], s14 offen offset:2048 sc1
    buffer_load_dwordx4 a[100:103], v1, s[4:7], s14 offen offset:3072 sc1
    s_add_u32 s14, s12, 12288
    buffer_load_dwordx4 a[104:107], v1, s[4:7], s14 offen offset:0 sc1
    buffer_load_dwordx4 a[108:111], v1, s[4:7], s14 offen offset:1024 sc1
    s_waitcnt vmcnt(46)
    s_add_u32 s12, s11, 0x215000
    s_add_u32 s14, s12, 0
    buffer_load_dwordx4 a[112:115], v1, s[4:7], s14 offen offset:0 sc1
    buffer_load_dwordx4 a[116:119], v1, s[4:7], s14 offen offset:1024 sc1
    buffer_load_dwordx4 a[120:123], v1, s[4:7], s14 offen offset:2048 sc1
    buffer_load_dwordx4 a[124:127], v1, s[4:7], s14 offen offset:3072 sc1
    s_add_u32 s14, s12, 4096
    buffer_load_dwordx4 a[128:131], v1, s[4:7], s14 offen offset:0 sc1
    buffer_load_dwordx4 a[132:135], v1, s[4:7], s14 offen offset:1024 sc1
    buffer_load_dwordx4 a[136:139], v1, s[4:7], s14 offen offset:2048 sc1
    buffer_load_dwordx4 a[140:143], v1, s[4:7], s14 offen offset:3072 sc1
    s_add_u32 s14, s12, 8192
    buffer_load_dwordx4 a[144:147], v1, s[4:7], s14 offen offset:0 sc1
    buffer_load_dwordx4 a[148:151], v1, s[4:7], s14 offen offset:1024 sc1
    buffer_load_dwordx4 a[152:155], v1, s[4:7], s14 offen offset:2048 sc1
    buffer_load_dwordx4 a[156:159], v1, s[4:7], s14 offen offset:3072 sc1
    s_add_u32 s14, s12, 12288
    buffer_load_dwordx4 a[160:163], v1, s[4:7], s14 offen offset:0 sc1
    buffer_load_dwordx4 a[164:167], v1, s[4:7], s14 offen offset:1024 sc1
    s_waitcnt vmcnt(46)
    s_add_u32 s12, s11, 0x218800
    s_add_u32 s14, s12, 0
    buffer_load_dwordx4 a[168:171], v1, s[4:7], s14 offen offset:0 sc1
    buffer_load_dwordx4 a[172:175], v1, s[4:7], s14 offen offset:1024 sc1
    buffer_load_dwordx4 a[176:179], v1, s[4:7], s14 offen offset:2048 sc1
    buffer_load_dwordx4 a[180:183], v1, s[4:7], s14 offen offset:3072 sc1
    s_add_u32 s14, s12, 4096
    buffer_load_dwordx4 a[184:187], v1, s[4:7], s14 offen offset:0 sc1
    buffer_load_dwordx4 a[188:191], v1, s[4:7], s14 offen offset:1024 sc1
    buffer_load_dwordx4 a[192:195], v1, s[4:7], s14 offen offset:2048 sc1
    buffer_load_dwordx4 a[196:199], v1, s[4:7], s14 offen offset:3072 sc1
    s_add_u32 s14, s12, 8192
    buffer_load_dwordx4 a[200:203], v1, s[4:7], s14 offen offset:0 sc1
    buffer_load_dwordx4 a[204:207], v1, s[4:7], s14 offen offset:1024 sc1
    buffer_load_dwordx4 a[208:211], v1, s[4:7], s14 offen offset:2048 sc1
    buffer_load_dwordx4 a[212:215], v1, s[4:7], s14 offen offset:3072 sc1
    s_add_u32 s14, s12, 12288
    buffer_load_dwordx4 a[216:219], v1, s[4:7], s14 offen offset:0 sc1
    buffer_load_dwordx4 a[220:223], v1, s[4:7], s14 offen offset:1024 sc1
    s_waitcnt vmcnt(46)
    s_add_u32 s12, s11, 0x238000
    s_add_u32 s14, s12, 0
    buffer_load_dwordx4 a[224:227], v1, s[4:7], s14 offen offset:0 sc1
    buffer_load_dwordx4 a[228:231], v1, s[4:7], s14 offen offset:1024 sc1
    buffer_load_dwordx4 a[232:235], v1, s[4:7], s14 offen offset:2048 sc1
    buffer_load_dwordx4 a[236:239], v1, s[4:7], s14 offen offset:3072 sc1
    s_add_u32 s14, s12, 4096
    buffer_load_dwordx4 a[240:243], v1, s[4:7], s14 offen offset:0 sc1
    buffer_load_dwordx4 a[244:247], v1, s[4:7], s14 offen offset:1024 sc1
    buffer_load_dwordx4 a[248:251], v1, s[4:7], s14 offen offset:2048 sc1
    buffer_load_dwordx4 a[252:255], v1, s[4:7], s14 offen offset:3072 sc1
    s_add_u32 s14, s12, 8192
    buffer_load_dwordx4 v[64:67], v1, s[4:7], s14 offen offset:0 sc1
    buffer_load_dwordx4 v[68:71], v1, s[4:7], s14 offen offset:1024 sc1
    buffer_load_dwordx4 v[72:75], v1, s[4:7], s14 offen offset:2048 sc1
    buffer_load_dwordx4 v[76:79], v1, s[4:7], s14 offen offset:3072 sc1
    s_add_u32 s14, s12, 12288
    buffer_load_dwordx4 v[80:83], v1, s[4:7], s14 offen offset:0 sc1
    buffer_load_dwordx4 v[84:87], v1, s[4:7], s14 offen offset:1024 sc1
    s_waitcnt vmcnt(46)
    s_add_u32 s12, s11, 0x23b800
    s_add_u32 s14, s12, 0
    buffer_load_dwordx4 v[88:91], v1, s[4:7], s14 offen offset:0 sc1
    buffer_load_dwordx4 v[92:95], v1, s[4:7], s14 offen offset:1024 sc1
    buffer_load_dwordx4 v[96:99], v1, s[4:7], s14 offen offset:2048 sc1
    buffer_load_dwordx4 v[100:103], v1, s[4:7], s14 offen offset:3072 sc1
    s_add_u32 s14, s12, 4096
    buffer_load_dwordx4 v[104:107], v1, s[4:7], s14 offen offset:0 sc1
    buffer_load_dwordx4 v[108:111], v1, s[4:7], s14 offen offset:1024 sc1
    buffer_load_dwordx4 v[112:115], v1, s[4:7], s14 offen offset:2048 sc1
    buffer_load_dwordx4 v[116:119], v1, s[4:7], s14 offen offset:3072 sc1
    s_add_u32 s14, s12, 8192
    buffer_load_dwordx4 v[120:123], v1, s[4:7], s14 offen offset:0 sc1
    buffer_load_dwordx4 v[124:127], v1, s[4:7], s14 offen offset:1024 sc1
    buffer_load_dwordx4 v[128:131], v1, s[4:7], s14 offen offset:2048 sc1
    buffer_load_dwordx4 v[132:135], v1, s[4:7], s14 offen offset:3072 sc1
    s_add_u32 s14, s12, 12288
    buffer_load_dwordx4 v[136:139], v1, s[4:7], s14 offen offset:0 sc1
    buffer_load_dwordx4 v[140:143], v1, s[4:7], s14 offen offset:1024 sc1
    s_waitcnt vmcnt(46)
    s_add_u32 s12, s11, 0x24d000
    s_add_u32 s14, s12, 0
    buffer_load_dwordx4 v[144:147], v1, s[4:7], s14 offen offset:0 sc1
    buffer_load_dwordx4 v[148:151], v1, s[4:7], s14 offen offset:1024 sc1
    buffer_load_dwordx4 v[152:155], v1, s[4:7], s14 offen offset:2048 sc1
    buffer_load_dwordx4 v[156:159], v1, s[4:7], s14 offen offset:3072 sc1
    s_add_u32 s14, s12, 4096
    buffer_load_dwordx4 v[160:163], v1, s[4:7], s14 offen offset:0 sc1
    buffer_load_dwordx4 v[164:167], v1, s[4:7], s14 offen offset:1024 sc1
    buffer_load_dwordx4 v[168:171], v1, s[4:7], s14 offen offset:2048 sc1
    buffer_load_dwordx4 v[172:175], v1, s[4:7], s14 offen offset:3072 sc1
    s_add_u32 s14, s12, 8192
    buffer_load_dwordx4 v[176:179], v1, s[4:7], s14 offen offset:0 sc1
    buffer_load_dwordx4 v[180:183], v1, s[4:7], s14 offen offset:1024 sc1
    buffer_load_dwordx4 v[184:187], v1, s[4:7], s14 offen offset:2048 sc1
    buffer_load_dwordx4 v[188:191], v1, s[4:7], s14 offen offset:3072 sc1
    s_add_u32 s14, s12, 12288
    buffer_load_dwordx4 v[192:195], v1, s[4:7], s14 offen offset:0 sc1
    buffer_load_dwordx4 v[196:199], v1, s[4:7], s14 offen offset:1024 sc1
    s_waitcnt vmcnt(46)
    s_add_u32 s12, s11, 0x257800
    s_add_u32 s14, s12, 0
    buffer_load_dwordx4 v[200:203], v1, s[4:7], s14 offen offset:0 sc1
    buffer_load_dwordx4 v[204:207], v1, s[4:7], s14 offen offset:1024 sc1
    buffer_load_dwordx4 v[208:211], v1, s[4:7], s14 offen offset:2048 sc1
    buffer_load_dwordx4 v[212:215], v1, s[4:7], s14 offen offset:3072 sc1
    s_add_u32 s14, s12, 4096
    buffer_load_dwordx4 v[216:219], v1, s[4:7], s14 offen offset:0 sc1
    buffer_load_dwordx4 v[220:223], v1, s[4:7], s14 offen offset:1024 sc1
    buffer_load_dwordx4 v[224:227], v1, s[4:7], s14 offen offset:2048 sc1
    buffer_load_dwordx4 v[228:231], v1, s[4:7], s14 offen offset:3072 sc1
    s_add_u32 s14, s12, 8192
    buffer_load_dwordx4 v[232:235], v1, s[4:7], s14 offen offset:0 sc1
    buffer_load_dwordx4 v[236:239], v1, s[4:7], s14 offen offset:1024 sc1
    buffer_load_dwordx4 v[240:243], v1, s[4:7], s14 offen offset:2048 sc1
    buffer_load_dwordx4 v[244:247], v1, s[4:7], s14 offen offset:3072 sc1
    s_add_u32 s14, s12, 12288
    buffer_load_dwordx4 v[248:251], v1, s[4:7], s14 offen offset:0 sc1
    buffer_load_dwordx4 v[252:255], v1, s[4:7], s14 offen offset:1024 sc1
    s_waitcnt vmcnt(46)
    s_mov_b32 s11, 0x3b02000
    v_min_u32 v4, 63, v0
    v_lshlrev_b32 v4, 4, v4
    s_mov_b32 s22, 0
wt_26:
    buffer_load_dwordx4 v[32:35], v4, s[4:7], s11 offen offset:0 sc1
    buffer_load_dwordx4 v[36:39], v4, s[4:7], s11 offen offset:1024 sc1
    s_waitcnt vmcnt(0)
    v_xor_b32 v32, s80, v32
    v_xor_b32 v33, s81, v33
    v_and_b32 v33, -16, v33
    v_xor_b32 v34, s80, v34
    v_xor_b32 v35, s81, v35
    v_and_b32 v35, -16, v35
    v_xor_b32 v36, s80, v36
    v_xor_b32 v37, s81, v37
    v_and_b32 v37, -16, v37
    v_xor_b32 v38, s80, v38
    v_xor_b32 v39, s81, v39
    v_and_b32 v39, -16, v39
    v_or3_b32 v32, v32, v33, v34
    v_or_b32 v32, v32, v35
    v_or3_b32 v32, v32, v36, v37
    v_or3_b32 v32, v32, v38, v39
    v_cmp_ne_u32 vcc, 0, v32
    s_cbranch_vccz wtok_27
    s_add_u32 s22, s22, 1
    s_cmp_gt_u32 s22, 65536
    s_cbranch_scc1 M_exit
    s_sleep 16
    s_branch wt_26
wtok_27:
    s_mov_b32 s8, 0
    s_waitcnt vmcnt(0)
    s_mov_b32 m0, 0
    s_mov_b32 s40, s4
    s_or_b32 s41, s5, 0x80000
    s_mov_b32 s42, 0x10000000
    s_mov_b32 s43, 0x00020000
    s_mul_i32 s46, s9, 28672
    s_add_u32 s46, s46, 0x1000000
    v_mov_b32 v0, 0
.p2align 8
sw_loop_28:
    v_mov_b32 v32, 0
    v_mov_b32 v33, 0
    v_mov_b32 v34, 0
    v_mov_b32 v35, 0
    v_mov_b32 v36, 0
    v_mov_b32 v37, 0
    v_mov_b32 v38, 0
    v_mov_b32 v39, 0
    v_mov_b32 v40, 0
    v_mov_b32 v41, 0
    v_mov_b32 v42, 0
    v_mov_b32 v43, 0
    v_mov_b32 v44, 0
    v_mov_b32 v45, 0
    v_mov_b32 v46, 0
    v_mov_b32 v47, 0
    v_mov_b32 v48, 0
    v_mov_b32 v49, 0
    v_mov_b32 v50, 0
    v_mov_b32 v51, 0
    v_mov_b32 v52, 0
    v_mov_b32 v53, 0
    v_mov_b32 v54, 0
    v_mov_b32 v55, 0
    v_mov_b32 v56, 0
    v_mov_b32 v57, 0
    v_mov_b32 v58, 0
    v_mov_b32 v59, 0
    v_mov_b32 v60, 0
    v_mov_b32 v61, 0
    v_mov_b32 v62, 0
    v_mov_b32 v63, 0
    s_and_b32 s23, s8, 7
    s_lshl_b32 s23, s23, 13
    s_add_u32 s23, s23, 0x3100000
    s_add_u32 s26, s23, 4096
    s_add_u32 s47, s8, 1
    s_mov_b32 s22, 0
    s_mov_b32 s49, 0x3b00800
    s_cmp_eq_u32 s8, 0
    s_cbranch_scc1 s_go_29
    s_sleep 1
s_go_29:
    s_add_u32 s22, s22, 1
    s_cmp_gt_u32 s22, 65536
    s_cbranch_scc1 M_exit
    s_mov_b64 exec, 1
    buffer_load_dword v0, v1, s[4:7], s49 offen sc1
    s_mov_b64 exec, -1
    s_waitcnt vmcnt(0)
    v_readfirstlane_b32 s48, v0
    s_cmp_le_i32 s48, s8
    s_cbranch_scc1 s_go_29
s_nogo_30:
    s_and_b32 s47, s47, 15
    s_mul_i32 s47, s47, 458752
    s_add_u32 s47, s47, s46
    s_cmp_lt_u32 s8, 1
    s_cbranch_scc1 nosl_31
    s_sleep 12
nosl_31:
    s_mov_b32 s22, 0
    buffer_load_dwordx4 v[8:11], v1, s[4:7], s23 offen offset:1024 sc1
    s_sleep 1
    s_nop 4
    buffer_load_dwordx4 v[12:15], v1, s[4:7], s23 offen offset:2048 sc1
    s_sleep 1
    s_nop 4
    buffer_load_dwordx4 v[8:11], v1, s[4:7], s23 offen offset:1024 sc1
q_33:
    s_waitcnt vmcnt(2)
    v_max3_u32 v0, v8, v9, v10
    v_max_u32 v0, v0, v11
    v_cmp_eq_u32 vcc, -1, v0
    ds_write_b128 v1, v[8:11] offset:1024
    buffer_load_dwordx4 v[12:15], v1, s[4:7], s23 offen offset:2048 sc1
    s_add_u32 s22, s22, 1
    s_cmp_gt_u32 s22, 196608
    s_cbranch_scc1 M_exit
    s_cbranch_vccnz q_34
q_35:
    s_waitcnt vmcnt(2)
    v_max3_u32 v0, v12, v13, v14
    v_max_u32 v0, v0, v15
    v_cmp_eq_u32 vcc, -1, v0
    ds_write_b128 v1, v[12:15] offset:2048
    s_cbranch_vccnz qf_36
qdone_32:
    buffer_load_dword v0, v1, s[40:43], s47 idxen sc1
    v_smfmac_f32_16x16x64_bf16 v[32:35], v[8:11], a[8:15], v2
    v_smfmac_f32_16x16x64_bf16 v[36:39], v[8:11], a[64:71], v2
    v_smfmac_f32_16x16x64_bf16 v[40:43], v[8:11], a[120:127], v2
    v_smfmac_f32_16x16x64_bf16 v[44:47], v[8:11], a[176:183], v2
    s_waitcnt lgkmcnt(0)
    s_barrier
    ds_read_b128 v[4:7], v1 offset:0
    ds_read_b128 v[16:19], v1 offset:3072
    v_smfmac_f32_16x16x64_bf16 v[32:35], v[12:15], a[16:23], v2
    ds_read_b128 v[20:23], v1 offset:4096
    v_smfmac_f32_16x16x64_bf16 v[36:39], v[12:15], a[72:79], v2
    ds_read_b128 v[24:27], v1 offset:5120
    v_smfmac_f32_16x16x64_bf16 v[40:43], v[12:15], a[128:135], v2
    ds_read_b128 v[28:31], v1 offset:6144
    v_smfmac_f32_16x16x64_bf16 v[44:47], v[12:15], a[184:191], v2
    s_waitcnt lgkmcnt(4)
    v_smfmac_f32_16x16x64_bf16 v[32:35], v[4:7], a[0:7], v2
    v_smfmac_f32_16x16x64_bf16 v[36:39], v[4:7], a[56:63], v2
    v_smfmac_f32_16x16x64_bf16 v[40:43], v[4:7], a[112:119], v2
    v_smfmac_f32_16x16x64_bf16 v[44:47], v[4:7], a[168:175], v2
    s_waitcnt lgkmcnt(3)
    v_smfmac_f32_16x16x64_bf16 v[32:35], v[16:19], a[24:31], v2
    v_smfmac_f32_16x16x64_bf16 v[36:39], v[16:19], a[80:87], v2
    v_smfmac_f32_16x16x64_bf16 v[40:43], v[16:19], a[136:143], v2
    v_smfmac_f32_16x16x64_bf16 v[44:47], v[16:19], a[192:199], v2
    s_waitcnt lgkmcnt(2)
    v_smfmac_f32_16x16x64_bf16 v[32:35], v[20:23], a[32:39], v2
    v_smfmac_f32_16x16x64_bf16 v[36:39], v[20:23], a[88:95], v2
    s_waitcnt lgkmcnt(1)
    v_smfmac_f32_16x16x64_bf16 v[32:35], v[24:27], a[40:47], v2
    v_smfmac_f32_16x16x64_bf16 v[36:39], v[24:27], a[96:103], v2
    s_waitcnt lgkmcnt(0)
    v_smfmac_f32_16x16x64_bf16 v[32:35], v[28:31], a[48:55], v2
    v_smfmac_f32_16x16x64_bf16 v[36:39], v[28:31], a[104:111], v2
    v_smfmac_f32_16x16x64_bf16 v[40:43], v[20:23], a[144:151], v2
    v_smfmac_f32_16x16x64_bf16 v[44:47], v[20:23], a[200:207], v2
    v_smfmac_f32_16x16x64_bf16 v[40:43], v[24:27], a[152:159], v2
    v_add_f32 v32, v32, v34
    v_smfmac_f32_16x16x64_bf16 v[44:47], v[24:27], a[208:215], v2
    v_add_f32 v36, v36, v38
    v_smfmac_f32_16x16x64_bf16 v[40:43], v[28:31], a[160:167], v2
    v_add_f32 v33, v33, v35
    v_smfmac_f32_16x16x64_bf16 v[44:47], v[28:31], a[216:223], v2
    v_add_f32 v37, v37, v39
    v_smfmac_f32_16x16x64_bf16 v[48:51], v[4:7], a[224:231], v2
    v_cvt_pk_bf16_f32 v32, v32, v36
    v_smfmac_f32_16x16x64_bf16 v[52:55], v[4:7], v[88:95], v2
    ds_write_b32 v3, v32 offset:8192
    v_cvt_pk_bf16_f32 v33, v33, v37
    v_smfmac_f32_16x16x64_bf16 v[48:51], v[8:11], a[232:239], v2
    ds_write_b32 v3, v33 offset:8208
    v_add_f32 v40, v40, v42
    v_smfmac_f32_16x16x64_bf16 v[52:55], v[8:11], v[96:103], v2
    v_add_f32 v44, v44, v46
    v_smfmac_f32_16x16x64_bf16 v[48:51], v[12:15], a[240:247], v2
    v_add_f32 v41, v41, v43
    v_smfmac_f32_16x16x64_bf16 v[52:55], v[12:15], v[104:111], v2
    v_add_f32 v45, v45, v47
    v_smfmac_f32_16x16x64_bf16 v[48:51], v[16:19], a[248:255], v2
    v_cvt_pk_bf16_f32 v40, v40, v44
    v_smfmac_f32_16x16x64_bf16 v[52:55], v[16:19], v[112:119], v2
    ds_write_b32 v3, v40 offset:9728
    v_cvt_pk_bf16_f32 v41, v41, v45
    v_smfmac_f32_16x16x64_bf16 v[48:51], v[20:23], v[64:71], v2
    ds_write_b32 v3, v41 offset:9744
    v_smfmac_f32_16x16x64_bf16 v[52:55], v[20:23], v[120:127], v2
    v_smfmac_f32_16x16x64_bf16 v[48:51], v[24:27], v[72:79], v2
    v_smfmac_f32_16x16x64_bf16 v[52:55], v[24:27], v[128:135], v2
    v_smfmac_f32_16x16x64_bf16 v[48:51], v[28:31], v[80:87], v2
    v_smfmac_f32_16x16x64_bf16 v[52:55], v[28:31], v[136:143], v2
    s_waitcnt lgkmcnt(0)
    s_barrier
    v_smfmac_f32_16x16x64_bf16 v[56:59], v[4:7], v[144:151], v2
    v_smfmac_f32_16x16x64_bf16 v[56:59], v[8:11], v[152:159], v2
    v_smfmac_f32_16x16x64_bf16 v[56:59], v[12:15], v[160:167], v2
    v_add_f32 v48, v48, v50
    v_smfmac_f32_16x16x64_bf16 v[56:59], v[16:19], v[168:175], v2
    v_add_f32 v52, v52, v54
    v_smfmac_f32_16x16x64_bf16 v[56:59], v[20:23], v[176:183], v2
    v_add_f32 v49, v49, v51
    v_smfmac_f32_16x16x64_bf16 v[56:59], v[24:27], v[184:191], v2
    v_add_f32 v53, v53, v55
    v_smfmac_f32_16x16x64_bf16 v[56:59], v[28:31], v[192:199], v2
    v_cvt_pk_bf16_f32 v48, v48, v52
    v_smfmac_f32_16x16x64_bf16 v[60:63], v[4:7], v[200:207], v2
    ds_write_b32 v3, v48 offset:12288
    v_cvt_pk_bf16_f32 v49, v49, v53
    v_smfmac_f32_16x16x64_bf16 v[60:63], v[8:11], v[208:215], v2
    ds_write_b32 v3, v49 offset:12304
    v_smfmac_f32_16x16x64_bf16 v[60:63], v[12:15], v[216:223], v2
    v_add_f32 v56, v56, v58
    v_add_f32 v57, v57, v59
    v_smfmac_f32_16x16x64_bf16 v[60:63], v[16:19], v[224:231], v2
    v_cvt_pk_bf16_f32 v56, v56, v57
    v_smfmac_f32_16x16x64_bf16 v[60:63], v[20:23], v[232:239], v2
    ds_write_b16 v3, v56 offset:13824
    ds_write_b16_d16_hi v3, v56 offset:13840
    v_smfmac_f32_16x16x64_bf16 v[60:63], v[24:27], v[240:247], v2
    v_smfmac_f32_16x16x64_bf16 v[60:63], v[28:31], v[248:255], v2
    s_nop 5
    s_waitcnt lgkmcnt(0)
    s_barrier
    v_pk_add_f32 v[60:61], v[60:61], v[62:63]
    v_cvt_pk_bf16_f32 v60, v60, v61
    ds_write_addtid_b32 v60 offset:14592
    s_waitcnt lgkmcnt(0)
    s_barrier
    s_add_u32 s13, s9, 16
    s_add_u32 s8, s8, 1
    s_cmp_lt_u32 s8, 63
    s_cbranch_scc1 sw_loop_28
    s_branch M_exit
q_34:
    s_waitcnt vmcnt(2)
    v_max3_u32 v0, v12, v13, v14
    v_max_u32 v0, v0, v15
    v_cmp_eq_u32 vcc, -1, v0
    ds_write_b128 v1, v[12:15] offset:2048
    buffer_load_dwordx4 v[8:11], v1, s[4:7], s23 offen offset:1024 sc1
    s_add_u32 s22, s22, 1
    s_cmp_gt_u32 s22, 196608
    s_cbranch_scc1 M_exit
    s_cbranch_vccnz q_33
q_39:
    s_waitcnt vmcnt(2)
    v_max3_u32 v0, v8, v9, v10
    v_max_u32 v0, v0, v11
    v_cmp_eq_u32 vcc, -1, v0
    ds_write_b128 v1, v[8:11] offset:1024
    s_cbranch_vccnz qf_40
    s_branch qdone_32
q_41:
    s_waitcnt vmcnt(1)
    v_max3_u32 v0, v12, v13, v14
    v_max_u32 v0, v0, v15
    v_cmp_eq_u32 vcc, -1, v0
    ds_write_b128 v1, v[12:15] offset:2048
    s_cbranch_vccnz qf_42
    s_branch qdone_32
q_43:
    s_waitcnt vmcnt(1)
    v_max3_u32 v0, v8, v9, v10
    v_max_u32 v0, v0, v11
    v_cmp_eq_u32 vcc, -1, v0
    ds_write_b128 v1, v[8:11] offset:1024
    s_cbranch_vccnz qf_44
    s_branch qdone_32
qf_36:
    buffer_load_dwordx4 v[12:15], v1, s[4:7], s23 offen offset:2048 sc1
    s_add_u32 s22, s22, 1
    s_cmp_gt_u32 s22, 196608
    s_cbranch_scc1 M_exit
    s_branch q_41
qf_40:
    buffer_load_dwordx4 v[8:11], v1, s[4:7], s23 offen offset:1024 sc1
    s_add_u32 s22, s22, 1
    s_cmp_gt_u32 s22, 196608
    s_cbranch_scc1 M_exit
    s_branch q_43
qf_42:
    buffer_load_dwordx4 v[12:15], v1, s[4:7], s23 offen offset:2048 sc1
    s_add_u32 s22, s22, 1
    s_cmp_gt_u32 s22, 196608
    s_cbranch_scc1 M_exit
    s_branch q_41
qf_44:
    buffer_load_dwordx4 v[8:11], v1, s[4:7], s23 offen offset:1024 sc1
    s_add_u32 s22, s22, 1
    s_cmp_gt_u32 s22, 196608
    s_cbranch_scc1 M_exit
    s_branch q_43
s_w2_5:
    v_and_b32 v0, 63, v0
    v_lshlrev_b32 v1, 4, v0
    v_and_b32 v4, 2, v0
    v_cmp_eq_u32 s[20:21], 0, v4
    v_mov_b32 v2, 0xeeee
    v_mov_b32 v4, 0x4444
    v_cndmask_b32 v2, v2, v4, s[20:21]
    v_bfe_u32 v4, v0, 3, 1
    v_lshlrev_b32 v3, 8, v4
    v_lshrrev_b32 v4, 4, v0
    v_lshl_add_u32 v3, v4, 6, v3
    v_and_b32 v4, 1, v0
    v_lshl_add_u32 v3, v4, 5, v3
    v_bfe_u32 v4, v0, 1, 2
    v_lshl_add_u32 v3, v4, 2, v3
    s_lshl_b32 s11, s9, 6
    s_add_u32 s11, s11, 0x3b02000
    v_min_u32 v4, 3, v0
    v_lshlrev_b32 v4, 4, v4
    s_mov_b32 s22, 0
wt_49:
    buffer_load_dwordx4 v[32:35], v4, s[4:7], s11 offen offset:0 sc1
    s_waitcnt vmcnt(0)
    v_xor_b32 v32, s80, v32
    v_xor_b32 v33, s81, v33
    v_and_b32 v33, -16, v33
    v_xor_b32 v34, s80, v34
    v_xor_b32 v35, s81, v35
    v_and_b32 v35, -16, v35
    v_or3_b32 v32, v32, v33, v34
    v_or_b32 v32, v32, v35
    v_cmp_ne_u32 vcc, 0, v32
    s_cbranch_vccz wtok_50
    s_add_u32 s22, s22, 1
    s_cmp_gt_u32 s22, 65536
    s_cbranch_scc1 M_exit
    s_sleep 16
    s_branch wt_49
wtok_50:
    s_mul_i32 s11, s9, 401408
    s_add_u32 s12, s11, 0x207000
    s_add_u32 s14, s12, 0
    buffer_load_dwordx4 a[0:3], v1, s[4:7], s14 offen offset:0 sc1
    buffer_load_dwordx4 a[4:7], v1, s[4:7], s14 offen offset:1024 sc1
    buffer_load_dwordx4 a[8:11], v1, s[4:7], s14 offen offset:2048 sc1
    buffer_load_dwordx4 a[12:15], v1, s[4:7], s14 offen offset:3072 sc1
    s_add_u32 s14, s12, 4096
    buffer_load_dwordx4 a[16:19], v1, s[4:7], s14 offen offset:0 sc1
    buffer_load_dwordx4 a[20:23], v1, s[4:7], s14 offen offset:1024 sc1
    buffer_load_dwordx4 a[24:27], v1, s[4:7], s14 offen offset:2048 sc1
    buffer_load_dwordx4 a[28:31], v1, s[4:7], s14 offen offset:3072 sc1
    s_add_u32 s14, s12, 8192
    buffer_load_dwordx4 a[32:35], v1, s[4:7], s14 offen offset:0 sc1
    buffer_load_dwordx4 a[36:39], v1, s[4:7], s14 offen offset:1024 sc1
    buffer_load_dwordx4 a[40:43], v1, s[4:7], s14 offen offset:2048 sc1
    buffer_load_dwordx4 a[44:47], v1, s[4:7], s14 offen offset:3072 sc1
    s_add_u32 s14, s12, 12288
    buffer_load_dwordx4 a[48:51], v1, s[4:7], s14 offen offset:0 sc1
    buffer_load_dwordx4 a[52:55], v1, s[4:7], s14 offen offset:1024 sc1
    s_add_u32 s12, s11, 0x20a800
    s_add_u32 s14, s12, 0
    buffer_load_dwordx4 a[56:59], v1, s[4:7], s14 offen offset:0 sc1
    buffer_load_dwordx4 a[60:63], v1, s[4:7], s14 offen offset:1024 sc1
    buffer_load_dwordx4 a[64:67], v1, s[4:7], s14 offen offset:2048 sc1
    buffer_load_dwordx4 a[68:71], v1, s[4:7], s14 offen offset:3072 sc1
    s_add_u32 s14, s12, 4096
    buffer_load_dwordx4 a[72:75], v1, s[4:7], s14 offen offset:0 sc1
    buffer_load_dwordx4 a[76:79], v1, s[4:7], s14 offen offset:1024 sc1
    buffer_load_dwordx4 a[80:83], v1, s[4:7], s14 offen offset:2048 sc1
    buffer_load_dwordx4 a[84:87], v1, s[4:7], s14 offen offset:3072 sc1
    s_add_u32 s14, s12, 8192
    buffer_load_dwordx4 a[88:91], v1, s[4:7], s14 offen offset:0 sc1
    buffer_load_dwordx4 a[92:95], v1, s[4:7], s14 offen offset:1024 sc1
    buffer_load_dwordx4 a[96:99], v1, s[4:7], s14 offen offset:2048 sc1
    buffer_load_dwordx4 a[100:103], v1, s[4:7], s14 offen offset:3072 sc1
    s_add_u32 s14, s12, 12288
    buffer_load_dwordx4 a[104:107], v1, s[4:7], s14 offen offset:0 sc1
    buffer_load_dwordx4 a[108:111], v1, s[4:7], s14 offen offset:1024 sc1
    s_waitcnt vmcnt(46)
    s_add_u32 s12, s11, 0x21c000
    s_add_u32 s14, s12, 0
    buffer_load_dwordx4 a[112:115], v1, s[4:7], s14 offen offset:0 sc1
    buffer_load_dwordx4 a[116:119], v1, s[4:7], s14 offen offset:1024 sc1
    buffer_load_dwordx4 a[120:123], v1, s[4:7], s14 offen offset:2048 sc1
    buffer_load_dwordx4 a[124:127], v1, s[4:7], s14 offen offset:3072 sc1
    s_add_u32 s14, s12, 4096
    buffer_load_dwordx4 a[128:131], v1, s[4:7], s14 offen offset:0 sc1
    buffer_load_dwordx4 a[132:135], v1, s[4:7], s14 offen offset:1024 sc1
    buffer_load_dwordx4 a[136:139], v1, s[4:7], s14 offen offset:2048 sc1
    buffer_load_dwordx4 a[140:143], v1, s[4:7], s14 offen offset:3072 sc1
    s_add_u32 s14, s12, 8192
    buffer_load_dwordx4 a[144:147], v1, s[4:7], s14 offen offset:0 sc1
    buffer_load_dwordx4 a[148:151], v1, s[4:7], s14 offen offset:1024 sc1
    buffer_load_dwordx4 a[152:155], v1, s[4:7], s14 offen offset:2048 sc1
    buffer_load_dwordx4 a[156:159], v1, s[4:7], s14 offen offset:3072 sc1
    s_add_u32 s14, s12, 12288
    buffer_load_dwordx4 a[160:163], v1, s[4:7], s14 offen offset:0 sc1
    buffer_load_dwordx4 a[164:167], v1, s[4:7], s14 offen offset:1024 sc1
    s_waitcnt vmcnt(46)
    s_add_u32 s12, s11, 0x21f800
    s_add_u32 s14, s12, 0
    buffer_load_dwordx4 a[168:171], v1, s[4:7], s14 offen offset:0 sc1
    buffer_load_dwordx4 a[172:175], v1, s[4:7], s14 offen offset:1024 sc1
    buffer_load_dwordx4 a[176:179], v1, s[4:7], s14 offen offset:2048 sc1
    buffer_load_dwordx4 a[180:183], v1, s[4:7], s14 offen offset:3072 sc1
    s_add_u32 s14, s12, 4096
    buffer_load_dwordx4 a[184:187], v1, s[4:7], s14 offen offset:0 sc1
    buffer_load_dwordx4 a[188:191], v1, s[4:7], s14 offen offset:1024 sc1
    buffer_load_dwordx4 a[192:195], v1, s[4:7], s14 offen offset:2048 sc1
    buffer_load_dwordx4 a[196:199], v1, s[4:7], s14 offen offset:3072 sc1
    s_add_u32 s14, s12, 8192
    buffer_load_dwordx4 a[200:203], v1, s[4:7], s14 offen offset:0 sc1
    buffer_load_dwordx4 a[204:207], v1, s[4:7], s14 offen offset:1024 sc1
    buffer_load_dwordx4 a[208:211], v1, s[4:7], s14 offen offset:2048 sc1
    buffer_load_dwordx4 a[212:215], v1, s[4:7], s14 offen offset:3072 sc1
    s_add_u32 s14, s12, 12288
    buffer_load_dwordx4 a[216:219], v1, s[4:7], s14 offen offset:0 sc1
    buffer_load_dwordx4 a[220:223], v1, s[4:7], s14 offen offset:1024 sc1
    s_waitcnt vmcnt(46)
    s_add_u32 s12, s11, 0x23f000
    s_add_u32 s14, s12, 0
    buffer_load_dwordx4 a[224:227], v1, s[4:7], s14 offen offset:0 sc1
    buffer_load_dwordx4 a[228:231], v1, s[4:7], s14 offen offset:1024 sc1
    buffer_load_dwordx4 a[232:235], v1, s[4:7], s14 offen offset:2048 sc1
    buffer_load_dwordx4 a[236:239], v1, s[4:7], s14 offen offset:3072 sc1
    s_add_u32 s14, s12, 4096
    buffer_load_dwordx4 a[240:243], v1, s[4:7], s14 offen offset:0 sc1
    buffer_load_dwordx4 a[244:247], v1, s[4:7], s14 offen offset:1024 sc1
    buffer_load_dwordx4 a[248:251], v1, s[4:7], s14 offen offset:2048 sc1
    buffer_load_dwordx4 a[252:255], v1, s[4:7], s14 offen offset:3072 sc1
    s_add_u32 s14, s12, 8192
    buffer_load_dwordx4 v[64:67], v1, s[4:7], s14 offen offset:0 sc1
    buffer_load_dwordx4 v[68:71], v1, s[4:7], s14 offen offset:1024 sc1
    buffer_load_dwordx4 v[72:75], v1, s[4:7], s14 offen offset:2048 sc1
    buffer_load_dwordx4 v[76:79], v1, s[4:7], s14 offen offset:3072 sc1
    s_add_u32 s14, s12, 12288
    buffer_load_dwordx4 v[80:83], v1, s[4:7], s14 offen offset:0 sc1
    buffer_load_dwordx4 v[84:87], v1, s[4:7], s14 offen offset:1024 sc1
    s_waitcnt vmcnt(46)
    s_add_u32 s12, s11, 0x242800
    s_add_u32 s14, s12, 0
    buffer_load_dwordx4 v[88:91], v1, s[4:7], s14 offen offset:0 sc1
    buffer_load_dwordx4 v[92:95], v1, s[4:7], s14 offen offset:1024 sc1
    buffer_load_dwordx4 v[96:99], v1, s[4:7], s14 offen offset:2048 sc1
    buffer_load_dwordx4 v[100:103], v1, s[4:7], s14 offen offset:3072 sc1
    s_add_u32 s14, s12, 4096
    buffer_load_dwordx4 v[104:107], v1, s[4:7], s14 offen offset:0 sc1
    buffer_load_dwordx4 v[108:111], v1, s[4:7], s14 offen offset:1024 sc1
    buffer_load_dwordx4 v[112:115], v1, s[4:7], s14 offen offset:2048 sc1
    buffer_load_dwordx4 v[116:119], v1, s[4:7], s14 offen offset:3072 sc1
    s_add_u32 s14, s12, 8192
    buffer_load_dwordx4 v[120:123], v1, s[4:7], s14 offen offset:0 sc1
    buffer_load_dwordx4 v[124:127], v1, s[4:7], s14 offen offset:1024 sc1
    buffer_load_dwordx4 v[128:131], v1, s[4:7], s14 offen offset:2048 sc1
    buffer_load_dwordx4 v[132:135], v1, s[4:7], s14 offen offset:3072 sc1
    s_add_u32 s14, s12, 12288
    buffer_load_dwordx4 v[136:139], v1, s[4:7], s14 offen offset:0 sc1
    buffer_load_dwordx4 v[140:143], v1, s[4:7], s14 offen offset:1024 sc1
    s_waitcnt vmcnt(46)
    s_add_u32 s12, s11, 0x250800
    s_add_u32 s14, s12, 0
    buffer_load_dwordx4 v[144:147], v1, s[4:7], s14 offen offset:0 sc1
    buffer_load_dwordx4 v[148:151], v1, s[4:7], s14 offen offset:1024 sc1
    buffer_load_dwordx4 v[152:155], v1, s[4:7], s14 offen offset:2048 sc1
    buffer_load_dwordx4 v[156:159], v1, s[4:7], s14 offen offset:3072 sc1
    s_add_u32 s14, s12, 4096
    buffer_load_dwordx4 v[160:163], v1, s[4:7], s14 offen offset:0 sc1
    buffer_load_dwordx4 v[164:167], v1, s[4:7], s14 offen offset:1024 sc1
    buffer_load_dwordx4 v[168:171], v1, s[4:7], s14 offen offset:2048 sc1
    buffer_load_dwordx4 v[172:175], v1, s[4:7], s14 offen offset:3072 sc1
    s_add_u32 s14, s12, 8192
    buffer_load_dwordx4 v[176:179], v1, s[4:7], s14 offen offset:0 sc1
    buffer_load_dwordx4 v[180:183], v1, s[4:7], s14 offen offset:1024 sc1
    buffer_load_dwordx4 v[184:187], v1, s[4:7], s14 offen offset:2048 sc1
    buffer_load_dwordx4 v[188:191], v1, s[4:7], s14 offen offset:3072 sc1
    s_add_u32 s14, s12, 12288
    buffer_load_dwordx4 v[192:195], v1, s[4:7], s14 offen offset:0 sc1
    buffer_load_dwordx4 v[196:199], v1, s[4:7], s14 offen offset:1024 sc1
    s_waitcnt vmcnt(46)
    s_add_u32 s12, s11, 0x25b000
    s_add_u32 s14, s12, 0
    buffer_load_dwordx4 v[200:203], v1, s[4:7], s14 offen offset:0 sc1
    buffer_load_dwordx4 v[204:207], v1, s[4:7], s14 offen offset:1024 sc1
    buffer_load_dwordx4 v[208:211], v1, s[4:7], s14 offen offset:2048 sc1
    buffer_load_dwordx4 v[212:215], v1, s[4:7], s14 offen offset:3072 sc1
    s_add_u32 s14, s12, 4096
    buffer_load_dwordx4 v[216:219], v1, s[4:7], s14 offen offset:0 sc1
    buffer_load_dwordx4 v[220:223], v1, s[4:7], s14 offen offset:1024 sc1
    buffer_load_dwordx4 v[224:227], v1, s[4:7], s14 offen offset:2048 sc1
    buffer_load_dwordx4 v[228:231], v1, s[4:7], s14 offen offset:3072 sc1
    s_add_u32 s14, s12, 8192
    buffer_load_dwordx4 v[232:235], v1, s[4:7], s14 offen offset:0 sc1
    buffer_load_dwordx4 v[236:239], v1, s[4:7], s14 offen offset:1024 sc1
    buffer_load_dwordx4 v[240:243], v1, s[4:7], s14 offen offset:2048 sc1
    buffer_load_dwordx4 v[244:247], v1, s[4:7], s14 offen offset:3072 sc1
    s_add_u32 s14, s12, 12288
    buffer_load_dwordx4 v[248:251], v1, s[4:7], s14 offen offset:0 sc1
    buffer_load_dwordx4 v[252:255], v1, s[4:7], s14 offen offset:1024 sc1
    s_waitcnt vmcnt(46)
    s_mov_b32 s11, 0x3b02000
    v_min_u32 v4, 63, v0
    v_lshlrev_b32 v4, 4, v4
    s_mov_b32 s22, 0
wt_51:
    buffer_load_dwordx4 v[32:35], v4, s[4:7], s11 offen offset:0 sc1
    buffer_load_dwordx4 v[36:39], v4, s[4:7], s11 offen offset:1024 sc1
    s_waitcnt vmcnt(0)
    v_xor_b32 v32, s80, v32
    v_xor_b32 v33, s81, v33
    v_and_b32 v33, -16, v33
    v_xor_b32 v34, s80, v34
    v_xor_b32 v35, s81, v35
    v_and_b32 v35, -16, v35
    v_xor_b32 v36, s80, v36
    v_xor_b32 v37, s81, v37
    v_and_b32 v37, -16, v37
    v_xor_b32 v38, s80, v38
    v_xor_b32 v39, s81, v39
    v_and_b32 v39, -16, v39
    v_or3_b32 v32, v32, v33, v34
    v_or_b32 v32, v32, v35
    v_or3_b32 v32, v32, v36, v37
    v_or3_b32 v32, v32, v38, v39
    v_cmp_ne_u32 vcc, 0, v32
    s_cbranch_vccz wtok_52
    s_add_u32 s22, s22, 1
    s_cmp_gt_u32 s22, 65536
    s_cbranch_scc1 M_exit
    s_sleep 16
    s_branch wt_51
wtok_52:
    s_mov_b32 s8, 0
    s_waitcnt vmcnt(0)
    s_mov_b32 m0, 0
    s_mov_b32 s40, s4
    s_or_b32 s41, s5, 0x80000
    s_mov_b32 s42, 0x10000000
    s_mov_b32 s43, 0x00020000
    s_mul_i32 s46, s9, 28672
    s_add_u32 s46, s46, 0x1002000
    v_mov_b32 v0, 0
.p2align 8
sw_loop_53:
    v_mov_b32 v32, 0
    v_mov_b32 v33, 0
    v_mov_b32 v34, 0
    v_mov_b32 v35, 0
    v_mov_b32 v36, 0
    v_mov_b32 v37, 0
    v_mov_b32 v38, 0
    v_mov_b32 v39, 0
    v_mov_b32 v40, 0
    v_mov_b32 v41, 0
    v_mov_b32 v42, 0
    v_mov_b32 v43, 0
    v_mov_b32 v44, 0
    v_mov_b32 v45, 0
    v_mov_b32 v46, 0
    v_mov_b32 v47, 0
    v_mov_b32 v48, 0
    v_mov_b32 v49, 0
    v_mov_b32 v50, 0
    v_mov_b32 v51, 0
    v_mov_b32 v52, 0
    v_mov_b32 v53, 0
    v_mov_b32 v54, 0
    v_mov_b32 v55, 0
    v_mov_b32 v56, 0
    v_mov_b32 v57, 0
    v_mov_b32 v58, 0
    v_mov_b32 v59, 0
    v_mov_b32 v60, 0
    v_mov_b32 v61, 0
    v_mov_b32 v62, 0
    v_mov_b32 v63, 0
    s_and_b32 s23, s8, 7
    s_lshl_b32 s23, s23, 13
    s_add_u32 s23, s23, 0x3100000
    s_add_u32 s26, s23, 4096
    s_add_u32 s47, s8, 1
    s_mov_b32 s22, 0
    s_mov_b32 s49, 0x3b00800
    s_cmp_ge_u32 s8, 2
    s_cbranch_scc1 s_nogo_55
    s_cmp_eq_u32 s8, 0
    s_cbranch_scc1 s_go_54
    s_sleep 1
s_go_54:
    s_add_u32 s22, s22, 1
    s_cmp_gt_u32 s22, 65536
    s_cbranch_scc1 M_exit
    s_mov_b64 exec, 1
    buffer_load_dword v0, v1, s[4:7], s49 offen sc1
    s_mov_b64 exec, -1
    s_waitcnt vmcnt(0)
    v_readfirstlane_b32 s48, v0
    s_cmp_le_i32 s48, s8
    s_cbranch_scc1 s_go_54
s_nogo_55:
    s_and_b32 s47, s47, 15
    s_mul_i32 s47, s47, 458752
    s_add_u32 s47, s47, s46
    s_add_u32 s49, s47, 8192
    s_cmp_lt_u32 s8, 2
    s_cbranch_scc1 nosl_56
    s_sleep 17
nosl_56:
    s_mov_b32 s22, 0
    buffer_load_dwordx4 v[16:19], v1, s[4:7], s23 offen offset:3072 sc1
    s_sleep 1
    s_nop 4
    buffer_load_dwordx4 v[20:23], v1, s[4:7], s26 offen offset:0 sc1
    s_sleep 1
    s_nop 4
    buffer_load_dwordx4 v[16:19], v1, s[4:7], s23 offen offset:3072 sc1
q_58:
    s_waitcnt vmcnt(2)
    v_max3_u32 v0, v16, v17, v18
    v_max_u32 v0, v0, v19
    v_cmp_eq_u32 vcc, -1, v0
    ds_write_b128 v1, v[16:19] offset:3072
    buffer_load_dwordx4 v[20:23], v1, s[4:7], s26 offen offset:0 sc1
    s_add_u32 s22, s22, 1
    s_cmp_gt_u32 s22, 196608
    s_cbranch_scc1 M_exit
    s_cbranch_vccnz q_59
q_60:
    s_waitcnt vmcnt(2)
    v_max3_u32 v0, v20, v21, v22
    v_max_u32 v0, v0, v23
    v_cmp_eq_u32 vcc, -1, v0
    ds_write_b128 v1, v[20:23] offset:4096
    s_cbranch_vccnz qf_61
qdone_57:
    buffer_load_dword v0, v1, s[40:43], s47 idxen sc1
    buffer_load_dword v0, v1, s[40:43], s49 idxen sc1
    v_smfmac_f32_16x16x64_bf16 v[32:35], v[16:19], a[24:31], v2
    v_smfmac_f32_16x16x64_bf16 v[36:39], v[16:19], a[80:87], v2
    v_smfmac_f32_16x16x64_bf16 v[40:43], v[16:19], a[136:143], v2
    v_smfmac_f32_16x16x64_bf16 v[44:47], v[16:19], a[192:199], v2
    s_waitcnt lgkmcnt(0)
    s_barrier
    ds_read_b128 v[4:7], v1 offset:0
    ds_read_b128 v[8:11], v1 offset:1024
    v_smfmac_f32_16x16x64_bf16 v[32:35], v[20:23], a[32:39], v2
    ds_read_b128 v[12:15], v1 offset:2048
    v_smfmac_f32_16x16x64_bf16 v[36:39], v[20:23], a[88:95], v2
    ds_read_b128 v[24:27], v1 offset:5120
    v_smfmac_f32_16x16x64_bf16 v[40:43], v[20:23], a[144:151], v2
    ds_read_b128 v[28:31], v1 offset:6144
    v_smfmac_f32_16x16x64_bf16 v[44:47], v[20:23], a[200:207], v2
    s_waitcnt lgkmcnt(4)
    v_smfmac_f32_16x16x64_bf16 v[32:35], v[4:7], a[0:7], v2
    v_smfmac_f32_16x16x64_bf16 v[36:39], v[4:7], a[56:63], v2
    v_smfmac_f32_16x16x64_bf16 v[40:43], v[4:7], a[112:119], v2
    v_smfmac_f32_16x16x64_bf16 v[44:47], v[4:7], a[168:175], v2
    s_waitcnt lgkmcnt(3)
    v_smfmac_f32_16x16x64_bf16 v[32:35], v[8:11], a[8:15], v2
    v_smfmac_f32_16x16x64_bf16 v[36:39], v[8:11], a[64:71], v2
    v_smfmac_f32_16x16x64_bf16 v[40:43], v[8:11], a[120:127], v2
    v_smfmac_f32_16x16x64_bf16 v[44:47], v[8:11], a[176:183], v2
    s_waitcnt lgkmcnt(2)
    v_smfmac_f32_16x16x64_bf16 v[32:35], v[12:15], a[16:23], v2
    v_smfmac_f32_16x16x64_bf16 v[36:39], v[12:15], a[72:79], v2
    s_waitcnt lgkmcnt(1)
    v_smfmac_f32_16x16x64_bf16 v[32:35], v[24:27], a[40:47], v2
    v_smfmac_f32_16x16x64_bf16 v[36:39], v[24:27], a[96:103], v2
    s_waitcnt lgkmcnt(0)
    v_smfmac_f32_16x16x64_bf16 v[32:35], v[28:31], a[48:55], v2
    v_smfmac_f32_16x16x64_bf16 v[36:39], v[28:31], a[104:111], v2
    v_smfmac_f32_16x16x64_bf16 v[40:43], v[12:15], a[128:135], v2
    v_smfmac_f32_16x16x64_bf16 v[44:47], v[12:15], a[184:191], v2
    v_smfmac_f32_16x16x64_bf16 v[40:43], v[24:27], a[152:159], v2
    v_add_f32 v32, v32, v34
    v_smfmac_f32_16x16x64_bf16 v[44:47], v[24:27], a[208:215], v2
    v_add_f32 v36, v36, v38
    v_smfmac_f32_16x16x64_bf16 v[40:43], v[28:31], a[160:167], v2
    v_add_f32 v33, v33, v35
    v_smfmac_f32_16x16x64_bf16 v[44:47], v[28:31], a[216:223], v2
    v_add_f32 v37, v37, v39
    v_smfmac_f32_16x16x64_bf16 v[48:51], v[4:7], a[224:231], v2
    v_cvt_pk_bf16_f32 v32, v32, v36
    v_smfmac_f32_16x16x64_bf16 v[52:55], v[4:7], v[88:95], v2
    ds_write_b32 v3, v32 offset:8704
    v_cvt_pk_bf16_f32 v33, v33, v37
    v_smfmac_f32_16x16x64_bf16 v[48:51], v[8:11], a[232:239], v2
    ds_write_b32 v3, v33 offset:8720
    v_add_f32 v40, v40, v42
    v_smfmac_f32_16x16x64_bf16 v[52:55], v[8:11], v[96:103], v2
    v_add_f32 v44, v44, v46
    v_smfmac_f32_16x16x64_bf16 v[48:51], v[12:15], a[240:247], v2
    v_add_f32 v41, v41, v43
    v_smfmac_f32_16x16x64_bf16 v[52:55], v[12:15], v[104:111], v2
    v_add_f32 v45, v45, v47
    v_smfmac_f32_16x16x64_bf16 v[48:51], v[16:19], a[248:255], v2
    v_cvt_pk_bf16_f32 v40, v40, v44
    v_smfmac_f32_16x16x64_bf16 v[52:55], v[16:19], v[112:119], v2
    ds_write_b32 v3, v40 offset:10240
    v_cvt_pk_bf16_f32 v41, v41, v45
    v_smfmac_f32_16x16x64_bf16 v[48:51], v[20:23], v[64:71], v2
    ds_write_b32 v3, v41 offset:10256
    v_smfmac_f32_16x16x64_bf16 v[52:55], v[20:23], v[120:127], v2
    v_smfmac_f32_16x16x64_bf16 v[48:51], v[24:27], v[72:79], v2
    v_smfmac_f32_16x16x64_bf16 v[52:55], v[24:27], v[128:135], v2
    v_smfmac_f32_16x16x64_bf16 v[48:51], v[28:31], v[80:87], v2
    v_smfmac_f32_16x16x64_bf16 v[52:55], v[28:31], v[136:143], v2
    s_waitcnt lgkmcnt(0)
    s_barrier
    v_smfmac_f32_16x16x64_bf16 v[56:59], v[4:7], v[144:151], v2
    v_smfmac_f32_16x16x64_bf16 v[56:59], v[8:11], v[152:159], v2
    v_smfmac_f32_16x16x64_bf16 v[56:59], v[12:15], v[160:167], v2
    v_add_f32 v48, v48, v50
    v_smfmac_f32_16x16x64_bf16 v[56:59], v[16:19], v[168:175], v2
    v_add_f32 v52, v52, v54
    v_smfmac_f32_16x16x64_bf16 v[56:59], v[20:23], v[176:183], v2
    v_add_f32 v49, v49, v51
    v_smfmac_f32_16x16x64_bf16 v[56:59], v[24:27], v[184:191], v2
    v_add_f32 v53, v53, v55
    v_smfmac_f32_16x16x64_bf16 v[56:59], v[28:31], v[192:199], v2
    v_cvt_pk_bf16_f32 v48, v48, v52
    v_smfmac_f32_16x16x64_bf16 v[60:63], v[4:7], v[200:207], v2
    ds_write_b32 v3, v48 offset:12800
    v_cvt_pk_bf16_f32 v49, v49, v53
    v_smfmac_f32_16x16x64_bf16 v[60:63], v[8:11], v[208:215], v2
    ds_write_b32 v3, v49 offset:12816
    v_smfmac_f32_16x16x64_bf16 v[60:63], v[12:15], v[216:223], v2
    v_add_f32 v56, v56, v58
    v_add_f32 v57, v57, v59
    v_smfmac_f32_16x16x64_bf16 v[60:63], v[16:19], v[224:231], v2
    v_cvt_pk_bf16_f32 v56, v56, v57
    v_smfmac_f32_16x16x64_bf16 v[60:63], v[20:23], v[232:239], v2
    ds_write_b16 v3, v56 offset:13826
    ds_write_b16_d16_hi v3, v56 offset:13842
    v_smfmac_f32_16x16x64_bf16 v[60:63], v[24:27], v[240:247], v2
    v_smfmac_f32_16x16x64_bf16 v[60:63], v[28:31], v[248:255], v2
    s_nop 5
    s_waitcnt lgkmcnt(0)
    s_barrier
    v_pk_add_f32 v[60:61], v[60:61], v[62:63]
    v_cvt_pk_bf16_f32 v60, v60, v61
    ds_write_addtid_b32 v60 offset:14848
    s_waitcnt lgkmcnt(0)
    s_barrier
    s_add_u32 s13, s9, 96
    s_add_u32 s8, s8, 1
    s_cmp_lt_u32 s8, 63
    s_cbranch_scc1 sw_loop_53
    s_branch M_exit
q_59:
    s_waitcnt vmcnt(2)
    v_max3_u32 v0, v20, v21, v22
    v_max_u32 v0, v0, v23
    v_cmp_eq_u32 vcc, -1, v0
    ds_write_b128 v1, v[20:23] offset:4096
    buffer_load_dwordx4 v[16:19], v1, s[4:7], s23 offen offset:3072 sc1
    s_add_u32 s22, s22, 1
    s_cmp_gt_u32 s22, 196608
    s_cbranch_scc1 M_exit
    s_cbranch_vccnz q_58
q_64:
    s_waitcnt vmcnt(2)
    v_max3_u32 v0, v16, v17, v18
    v_max_u32 v0, v0, v19
    v_cmp_eq_u32 vcc, -1, v0
    ds_write_b128 v1, v[16:19] offset:3072
    s_cbranch_vccnz qf_65
    s_branch qdone_57
q_66:
    s_waitcnt vmcnt(1)
    v_max3_u32 v0, v20, v21, v22
    v_max_u32 v0, v0, v23
    v_cmp_eq_u32 vcc, -1, v0
    ds_write_b128 v1, v[20:23] offset:4096
    s_cbranch_vccnz qf_67
    s_branch qdone_57
q_68:
    s_waitcnt vmcnt(1)
    v_max3_u32 v0, v16, v17, v18
    v_max_u32 v0, v0, v19
    v_cmp_eq_u32 vcc, -1, v0
    ds_write_b128 v1, v[16:19] offset:3072
    s_cbranch_vccnz qf_69
    s_branch qdone_57
qf_61:
    buffer_load_dwordx4 v[20:23], v1, s[4:7], s26 offen offset:0 sc1
    s_add_u32 s22, s22, 1
    s_cmp_gt_u32 s22, 196608
    s_cbranch_scc1 M_exit
    s_branch q_66
qf_65:
    buffer_load_dwordx4 v[16:19], v1, s[4:7], s23 offen offset:3072 sc1
    s_add_u32 s22, s22, 1
    s_cmp_gt_u32 s22, 196608
    s_cbranch_scc1 M_exit
    s_branch q_68
qf_67:
    buffer_load_dwordx4 v[20:23], v1, s[4:7], s26 offen offset:0 sc1
    s_add_u32 s22, s22, 1
    s_cmp_gt_u32 s22, 196608
    s_cbranch_scc1 M_exit
    s_branch q_66
qf_69:
    buffer_load_dwordx4 v[16:19], v1, s[4:7], s23 offen offset:3072 sc1
    s_add_u32 s22, s22, 1
    s_cmp_gt_u32 s22, 196608
    s_cbranch_scc1 M_exit
    s_branch q_68
s_w3_6:
    v_and_b32 v0, 63, v0
    v_lshlrev_b32 v1, 4, v0
    v_and_b32 v4, 2, v0
    v_cmp_eq_u32 s[20:21], 0, v4
    v_mov_b32 v2, 0xeeee
    v_mov_b32 v4, 0x4444
    v_cndmask_b32 v2, v2, v4, s[20:21]
    v_bfe_u32 v4, v0, 3, 1
    v_lshlrev_b32 v3, 8, v4
    v_lshrrev_b32 v4, 4, v0
    v_lshl_add_u32 v3, v4, 6, v3
    v_and_b32 v4, 1, v0
    v_lshl_add_u32 v3, v4, 5, v3
    v_bfe_u32 v4, v0, 1, 2
    v_lshl_add_u32 v3, v4, 2, v3
    s_lshl_b32 s11, s9, 6
    s_add_u32 s11, s11, 0x3b02000
    v_min_u32 v4, 3, v0
    v_lshlrev_b32 v4, 4, v4
    s_mov_b32 s22, 0
wt_74:
    buffer_load_dwordx4 v[32:35], v4, s[4:7], s11 offen offset:0 sc1
    s_waitcnt vmcnt(0)
    v_xor_b32 v32, s80, v32
    v_xor_b32 v33, s81, v33
    v_and_b32 v33, -16, v33
    v_xor_b32 v34, s80, v34
    v_xor_b32 v35, s81, v35
    v_and_b32 v35, -16, v35
    v_or3_b32 v32, v32, v33, v34
    v_or_b32 v32, v32, v35
    v_cmp_ne_u32 vcc, 0, v32
    s_cbranch_vccz wtok_75
    s_add_u32 s22, s22, 1
    s_cmp_gt_u32 s22, 65536
    s_cbranch_scc1 M_exit
    s_sleep 16
    s_branch wt_74
wtok_75:
    s_mul_i32 s11, s9, 401408
    s_add_u32 s12, s11, 0x20e000
    s_add_u32 s14, s12, 0
    buffer_load_dwordx4 a[0:3], v1, s[4:7], s14 offen offset:0 sc1
    buffer_load_dwordx4 a[4:7], v1, s[4:7], s14 offen offset:1024 sc1
    buffer_load_dwordx4 a[8:11], v1, s[4:7], s14 offen offset:2048 sc1
    buffer_load_dwordx4 a[12:15], v1, s[4:7], s14 offen offset:3072 sc1
    s_add_u32 s14, s12, 4096
    buffer_load_dwordx4 a[16:19], v1, s[4:7], s14 offen offset:0 sc1
    buffer_load_dwordx4 a[20:23], v1, s[4:7], s14 offen offset:1024 sc1
    buffer_load_dwordx4 a[24:27], v1, s[4:7], s14 offen offset:2048 sc1
    buffer_load_dwordx4 a[28:31], v1, s[4:7], s14 offen offset:3072 sc1
    s_add_u32 s14, s12, 8192
    buffer_load_dwordx4 a[32:35], v1, s[4:7], s14 offen offset:0 sc1
    buffer_load_dwordx4 a[36:39], v1, s[4:7], s14 offen offset:1024 sc1
    buffer_load_dwordx4 a[40:43], v1, s[4:7], s14 offen offset:2048 sc1
    buffer_load_dwordx4 a[44:47], v1, s[4:7], s14 offen offset:3072 sc1
    s_add_u32 s14, s12, 12288
    buffer_load_dwordx4 a[48:51], v1, s[4:7], s14 offen offset:0 sc1
    buffer_load_dwordx4 a[52:55], v1, s[4:7], s14 offen offset:1024 sc1
    s_add_u32 s12, s11, 0x211800
    s_add_u32 s14, s12, 0
    buffer_load_dwordx4 a[56:59], v1, s[4:7], s14 offen offset:0 sc1
    buffer_load_dwordx4 a[60:63], v1, s[4:7], s14 offen offset:1024 sc1
    buffer_load_dwordx4 a[64:67], v1, s[4:7], s14 offen offset:2048 sc1
    buffer_load_dwordx4 a[68:71], v1, s[4:7], s14 offen offset:3072 sc1
    s_add_u32 s14, s12, 4096
    buffer_load_dwordx4 a[72:75], v1, s[4:7], s14 offen offset:0 sc1
    buffer_load_dwordx4 a[76:79], v1, s[4:7], s14 offen offset:1024 sc1
    buffer_load_dwordx4 a[80:83], v1, s[4:7], s14 offen offset:2048 sc1
    buffer_load_dwordx4 a[84:87], v1, s[4:7], s14 offen offset:3072 sc1
    s_add_u32 s14, s12, 8192
    buffer_load_dwordx4 a[88:91], v1, s[4:7], s14 offen offset:0 sc1
    buffer_load_dwordx4 a[92:95], v1, s[4:7], s14 offen offset:1024 sc1
    buffer_load_dwordx4 a[96:99], v1, s[4:7], s14 offen offset:2048 sc1
    buffer_load_dwordx4 a[100:103], v1, s[4:7], s14 offen offset:3072 sc1
    s_add_u32 s14, s12, 12288
    buffer_load_dwordx4 a[104:107], v1, s[4:7], s14 offen offset:0 sc1
    buffer_load_dwordx4 a[108:111], v1, s[4:7], s14 offen offset:1024 sc1
    s_waitcnt vmcnt(46)
    s_add_u32 s12, s11, 0x223000
    s_add_u32 s14, s12, 0
    buffer_load_dwordx4 a[112:115], v1, s[4:7], s14 offen offset:0 sc1
    buffer_load_dwordx4 a[116:119], v1, s[4:7], s14 offen offset:1024 sc1
    buffer_load_dwordx4 a[120:123], v1, s[4:7], s14 offen offset:2048 sc1
    buffer_load_dwordx4 a[124:127], v1, s[4:7], s14 offen offset:3072 sc1
    s_add_u32 s14, s12, 4096
    buffer_load_dwordx4 a[128:131], v1, s[4:7], s14 offen offset:0 sc1
    buffer_load_dwordx4 a[132:135], v1, s[4:7], s14 offen offset:1024 sc1
    buffer_load_dwordx4 a[136:139], v1, s[4:7], s14 offen offset:2048 sc1
    buffer_load_dwordx4 a[140:143], v1, s[4:7], s14 offen offset:3072 sc1
    s_add_u32 s14, s12, 8192
    buffer_load_dwordx4 a[144:147], v1, s[4:7], s14 offen offset:0 sc1
    buffer_load_dwordx4 a[148:151], v1, s[4:7], s14 offen offset:1024 sc1
    buffer_load_dwordx4 a[152:155], v1, s[4:7], s14 offen offset:2048 sc1
    buffer_load_dwordx4 a[156:159], v1, s[4:7], s14 offen offset:3072 sc1
    s_add_u32 s14, s12, 12288
    buffer_load_dwordx4 a[160:163], v1, s[4:7], s14 offen offset:0 sc1
    buffer_load_dwordx4 a[164:167], v1, s[4:7], s14 offen offset:1024 sc1
    s_waitcnt vmcnt(46)
    s_add_u32 s12, s11, 0x226800
    s_add_u32 s14, s12, 0
    buffer_load_dwordx4 a[168:171], v1, s[4:7], s14 offen offset:0 sc1
    buffer_load_dwordx4 a[172:175], v1, s[4:7], s14 offen offset:1024 sc1
    buffer_load_dwordx4 a[176:179], v1, s[4:7], s14 offen offset:2048 sc1
    buffer_load_dwordx4 a[180:183], v1, s[4:7], s14 offen offset:3072 sc1
    s_add_u32 s14, s12, 4096
    buffer_load_dwordx4 a[184:187], v1, s[4:7], s14 offen offset:0 sc1
    buffer_load_dwordx4 a[188:191], v1, s[4:7], s14 offen offset:1024 sc1
    buffer_load_dwordx4 a[192:195], v1, s[4:7], s14 offen offset:2048 sc1
    buffer_load_dwordx4 a[196:199], v1, s[4:7], s14 offen offset:3072 sc1
    s_add_u32 s14, s12, 8192
    buffer_load_dwordx4 a[200:203], v1, s[4:7], s14 offen offset:0 sc1
    buffer_load_dwordx4 a[204:207], v1, s[4:7], s14 offen offset:1024 sc1
    buffer_load_dwordx4 a[208:211], v1, s[4:7], s14 offen offset:2048 sc1
    buffer_load_dwordx4 a[212:215], v1, s[4:7], s14 offen offset:3072 sc1
    s_add_u32 s14, s12, 12288
    buffer_load_dwordx4 a[216:219], v1, s[4:7], s14 offen offset:0 sc1
    buffer_load_dwordx4 a[220:223], v1, s[4:7], s14 offen offset:1024 sc1
    s_waitcnt vmcnt(46)
    s_add_u32 s12, s11, 0x246000
    s_add_u32 s14, s12, 0
    buffer_load_dwordx4 a[224:227], v1, s[4:7], s14 offen offset:0 sc1
    buffer_load_dwordx4 a[228:231], v1, s[4:7], s14 offen offset:1024 sc1
    buffer_load_dwordx4 a[232:235], v1, s[4:7], s14 offen offset:2048 sc1
    buffer_load_dwordx4 a[236:239], v1, s[4:7], s14 offen offset:3072 sc1
    s_add_u32 s14, s12, 4096
    buffer_load_dwordx4 a[240:243], v1, s[4:7], s14 offen offset:0 sc1
    buffer_load_dwordx4 a[244:247], v1, s[4:7], s14 offen offset:1024 sc1
    buffer_load_dwordx4 a[248:251], v1, s[4:7], s14 offen offset:2048 sc1
    buffer_load_dwordx4 a[252:255], v1, s[4:7], s14 offen offset:3072 sc1
    s_add_u32 s14, s12, 8192
    buffer_load_dwordx4 v[64:67], v1, s[4:7], s14 offen offset:0 sc1
    buffer_load_dwordx4 v[68:71], v1, s[4:7], s14 offen offset:1024 sc1
    buffer_load_dwordx4 v[72:75], v1, s[4:7], s14 offen offset:2048 sc1
    buffer_load_dwordx4 v[76:79], v1, s[4:7], s14 offen offset:3072 sc1
    s_add_u32 s14, s12, 12288
    buffer_load_dwordx4 v[80:83], v1, s[4:7], s14 offen offset:0 sc1
    buffer_load_dwordx4 v[84:87], v1, s[4:7], s14 offen offset:1024 sc1
    s_waitcnt vmcnt(46)
    s_add_u32 s12, s11, 0x249800
    s_add_u32 s14, s12, 0
    buffer_load_dwordx4 v[88:91], v1, s[4:7], s14 offen offset:0 sc1
    buffer_load_dwordx4 v[92:95], v1, s[4:7], s14 offen offset:1024 sc1
    buffer_load_dwordx4 v[96:99], v1, s[4:7], s14 offen offset:2048 sc1
    buffer_load_dwordx4 v[100:103], v1, s[4:7], s14 offen offset:3072 sc1
    s_add_u32 s14, s12, 4096
    buffer_load_dwordx4 v[104:107], v1, s[4:7], s14 offen offset:0 sc1
    buffer_load_dwordx4 v[108:111], v1, s[4:7], s14 offen offset:1024 sc1
    buffer_load_dwordx4 v[112:115], v1, s[4:7], s14 offen offset:2048 sc1
    buffer_load_dwordx4 v[116:119], v1, s[4:7], s14 offen offset:3072 sc1
    s_add_u32 s14, s12, 8192
    buffer_load_dwordx4 v[120:123], v1, s[4:7], s14 offen offset:0 sc1
    buffer_load_dwordx4 v[124:127], v1, s[4:7], s14 offen offset:1024 sc1
    buffer_load_dwordx4 v[128:131], v1, s[4:7], s14 offen offset:2048 sc1
    buffer_load_dwordx4 v[132:135], v1, s[4:7], s14 offen offset:3072 sc1
    s_add_u32 s14, s12, 12288
    buffer_load_dwordx4 v[136:139], v1, s[4:7], s14 offen offset:0 sc1
    buffer_load_dwordx4 v[140:143], v1, s[4:7], s14 offen offset:1024 sc1
    s_waitcnt vmcnt(46)
    s_add_u32 s12, s11, 0x254000
    s_add_u32 s14, s12, 0
    buffer_load_dwordx4 v[144:147], v1, s[4:7], s14 offen offset:0 sc1
    buffer_load_dwordx4 v[148:151], v1, s[4:7], s14 offen offset:1024 sc1
    buffer_load_dwordx4 v[152:155], v1, s[4:7], s14 offen offset:2048 sc1
    buffer_load_dwordx4 v[156:159], v1, s[4:7], s14 offen offset:3072 sc1
    s_add_u32 s14, s12, 4096
    buffer_load_dwordx4 v[160:163], v1, s[4:7], s14 offen offset:0 sc1
    buffer_load_dwordx4 v[164:167], v1, s[4:7], s14 offen offset:1024 sc1
    buffer_load_dwordx4 v[168:171], v1, s[4:7], s14 offen offset:2048 sc1
    buffer_load_dwordx4 v[172:175], v1, s[4:7], s14 offen offset:3072 sc1
    s_add_u32 s14, s12, 8192
    buffer_load_dwordx4 v[176:179], v1, s[4:7], s14 offen offset:0 sc1
    buffer_load_dwordx4 v[180:183], v1, s[4:7], s14 offen offset:1024 sc1
    buffer_load_dwordx4 v[184:187], v1, s[4:7], s14 offen offset:2048 sc1
    buffer_load_dwordx4 v[188:191], v1, s[4:7], s14 offen offset:3072 sc1
    s_add_u32 s14, s12, 12288
    buffer_load_dwordx4 v[192:195], v1, s[4:7], s14 offen offset:0 sc1
    buffer_load_dwordx4 v[196:199], v1, s[4:7], s14 offen offset:1024 sc1
    s_waitcnt vmcnt(46)
    s_add_u32 s12, s11, 0x25e800
    s_add_u32 s14, s12, 0
    buffer_load_dwordx4 v[200:203], v1, s[4:7], s14 offen offset:0 sc1
    buffer_load_dwordx4 v[204:207], v1, s[4:7], s14 offen offset:1024 sc1
    buffer_load_dwordx4 v[208:211], v1, s[4:7], s14 offen offset:2048 sc1
    buffer_load_dwordx4 v[212:215], v1, s[4:7], s14 offen offset:3072 sc1
    s_add_u32 s14, s12, 4096
    buffer_load_dwordx4 v[216:219], v1, s[4:7], s14 offen offset:0 sc1
    buffer_load_dwordx4 v[220:223], v1, s[4:7], s14 offen offset:1024 sc1
    buffer_load_dwordx4 v[224:227], v1, s[4:7], s14 offen offset:2048 sc1
    buffer_load_dwordx4 v[228:231], v1, s[4:7], s14 offen offset:3072 sc1
    s_add_u32 s14, s12, 8192
    buffer_load_dwordx4 v[232:235], v1, s[4:7], s14 offen offset:0 sc1
    buffer_load_dwordx4 v[236:239], v1, s[4:7], s14 offen offset:1024 sc1
    buffer_load_dwordx4 v[240:243], v1, s[4:7], s14 offen offset:2048 sc1
    buffer_load_dwordx4 v[244:247], v1, s[4:7], s14 offen offset:3072 sc1
    s_add_u32 s14, s12, 12288
    buffer_load_dwordx4 v[248:251], v1, s[4:7], s14 offen offset:0 sc1
    buffer_load_dwordx4 v[252:255], v1, s[4:7], s14 offen offset:1024 sc1
    s_waitcnt vmcnt(46)
    s_mov_b32 s11, 0x3b02000
    v_min_u32 v4, 63, v0
    v_lshlrev_b32 v4, 4, v4
    s_mov_b32 s22, 0
wt_76:
    buffer_load_dwordx4 v[32:35], v4, s[4:7], s11 offen offset:0 sc1
    buffer_load_dwordx4 v[36:39], v4, s[4:7], s11 offen offset:1024 sc1
    s_waitcnt vmcnt(0)
    v_xor_b32 v32, s80, v32
    v_xor_b32 v33, s81, v33
    v_and_b32 v33, -16, v33
    v_xor_b32 v34, s80, v34
    v_xor_b32 v35, s81, v35
    v_and_b32 v35, -16, v35
    v_xor_b32 v36, s80, v36
    v_xor_b32 v37, s81, v37
    v_and_b32 v37, -16, v37
    v_xor_b32 v38, s80, v38
    v_xor_b32 v39, s81, v39
    v_and_b32 v39, -16, v39
    v_or3_b32 v32, v32, v33, v34
    v_or_b32 v32, v32, v35
    v_or3_b32 v32, v32, v36, v37
    v_or3_b32 v32, v32, v38, v39
    v_cmp_ne_u32 vcc, 0, v32
    s_cbranch_vccz wtok_77
    s_add_u32 s22, s22, 1
    s_cmp_gt_u32 s22, 65536
    s_cbranch_scc1 M_exit
    s_sleep 16
    s_branch wt_76
wtok_77:
    s_mov_b32 s8, 0
    s_waitcnt vmcnt(0)
    s_mov_b32 m0, 0
    s_mov_b32 s40, s4
    s_or_b32 s41, s5, 0x80000
    s_mov_b32 s42, 0x10000000
    s_mov_b32 s43, 0x00020000
    s_mul_i32 s46, s9, 28672
    s_add_u32 s46, s46, 0x1005000
    v_mov_b32 v0, 0
.p2align 8
sw_loop_78:
    v_mov_b32 v32, 0
    v_mov_b32 v33, 0
    v_mov_b32 v34, 0
    v_mov_b32 v35, 0
    v_mov_b32 v36, 0
    v_mov_b32 v37, 0
    v_mov_b32 v38, 0
    v_mov_b32 v39, 0
    v_mov_b32 v40, 0
    v_mov_b32 v41, 0
    v_mov_b32 v42, 0
    v_mov_b32 v43, 0
    v_mov_b32 v44, 0
    v_mov_b32 v45, 0
    v_mov_b32 v46, 0
    v_mov_b32 v47, 0
    v_mov_b32 v48, 0
    v_mov_b32 v49, 0
    v_mov_b32 v50, 0
    v_mov_b32 v51, 0
    v_mov_b32 v52, 0
    v_mov_b32 v53, 0
    v_mov_b32 v54, 0
    v_mov_b32 v55, 0
    v_mov_b32 v56, 0
    v_mov_b32 v57, 0
    v_mov_b32 v58, 0
    v_mov_b32 v59, 0
    v_mov_b32 v60, 0
    v_mov_b32 v61, 0
    v_mov_b32 v62, 0
    v_mov_b32 v63, 0
    s_and_b32 s23, s8, 7
    s_lshl_b32 s23, s23, 13
    s_add_u32 s23, s23, 0x3100000
    s_add_u32 s26, s23, 4096
    s_add_u32 s47, s8, 1
    s_mov_b32 s22, 0
    s_mov_b32 s49, 0x3b00800
    s_cmp_ge_u32 s8, 2
    s_cbranch_scc1 s_nogo_80
    s_cmp_eq_u32 s8, 0
    s_cbranch_scc1 s_go_79
    s_sleep 1
s_go_79:
    s_add_u32 s22, s22, 1
    s_cmp_gt_u32 s22, 65536
    s_cbranch_scc1 M_exit
    s_mov_b64 exec, 1
    buffer_load_dword v0, v1, s[4:7], s49 offen sc1
    s_mov_b64 exec, -1
    s_waitcnt vmcnt(0)
    v_readfirstlane_b32 s48, v0
    s_cmp_le_i32 s48, s8
    s_cbranch_scc1 s_go_79
s_nogo_80:
    s_and_b32 s47, s47, 15
    s_mul_i32 s47, s47, 458752
    s_add_u32 s47, s47, s46
    s_add_u32 s49, s8, 2
    s_min_u32 s49, s49, 63
    s_mul_i32 s49, s49, 28672
    s_mul_i32 s48, s9, 1792
    s_add_u32 s49, s49, s48
    s_cmp_lt_u32 s8, 2
    s_cbranch_scc1 nosl_81
    s_sleep 17
nosl_81:
    s_mov_b32 s22, 0
    buffer_load_dwordx4 v[24:27], v1, s[4:7], s26 offen offset:1024 sc1
    s_sleep 1
    s_nop 4
    buffer_load_dwordx4 v[28:31], v1, s[4:7], s26 offen offset:2048 sc1
    s_sleep 1
    s_nop 4
    buffer_load_dwordx4 v[24:27], v1, s[4:7], s26 offen offset:1024 sc1
q_83:
    s_waitcnt vmcnt(2)
    v_max3_u32 v0, v24, v25, v26
    v_max_u32 v0, v0, v27
    v_cmp_eq_u32 vcc, -1, v0
    ds_write_b128 v1, v[24:27] offset:5120
    buffer_load_dwordx4 v[28:31], v1, s[4:7], s26 offen offset:2048 sc1
    s_add_u32 s22, s22, 1
    s_cmp_gt_u32 s22, 196608
    s_cbranch_scc1 M_exit
    s_cbranch_vccnz q_84
q_85:
    s_waitcnt vmcnt(2)
    v_max3_u32 v0, v28, v29, v30
    v_max_u32 v0, v0, v31
    v_cmp_eq_u32 vcc, -1, v0
    ds_write_b128 v1, v[28:31] offset:6144
    s_cbranch_vccnz qf_86
qdone_82:
    buffer_load_dword v0, v1, s[40:43], s47 idxen sc1
    s_mov_b64 exec, 0x3fff
    buffer_load_dword v0, v1, s[40:43], s49 idxen sc1
    s_mov_b64 exec, -1
    v_smfmac_f32_16x16x64_bf16 v[32:35], v[24:27], a[40:47], v2
    v_smfmac_f32_16x16x64_bf16 v[36:39], v[24:27], a[96:103], v2
    v_smfmac_f32_16x16x64_bf16 v[40:43], v[24:27], a[152:159], v2
    v_smfmac_f32_16x16x64_bf16 v[44:47], v[24:27], a[208:215], v2
    s_waitcnt lgkmcnt(0)
    s_barrier
    ds_read_b128 v[4:7], v1 offset:0
    ds_read_b128 v[8:11], v1 offset:1024
    v_smfmac_f32_16x16x64_bf16 v[32:35], v[28:31], a[48:55], v2
    ds_read_b128 v[12:15], v1 offset:2048
    v_smfmac_f32_16x16x64_bf16 v[36:39], v[28:31], a[104:111], v2
    ds_read_b128 v[16:19], v1 offset:3072
    v_smfmac_f32_16x16x64_bf16 v[40:43], v[28:31], a[160:167], v2
    ds_read_b128 v[20:23], v1 offset:4096
    v_smfmac_f32_16x16x64_bf16 v[44:47], v[28:31], a[216:223], v2
    s_waitcnt lgkmcnt(4)
    v_smfmac_f32_16x16x64_bf16 v[32:35], v[4:7], a[0:7], v2
    v_smfmac_f32_16x16x64_bf16 v[36:39], v[4:7], a[56:63], v2
    v_smfmac_f32_16x16x64_bf16 v[40:43], v[4:7], a[112:119], v2
    v_smfmac_f32_16x16x64_bf16 v[44:47], v[4:7], a[168:175], v2
    s_waitcnt lgkmcnt(3)
    v_smfmac_f32_16x16x64_bf16 v[32:35], v[8:11], a[8:15], v2
    v_smfmac_f32_16x16x64_bf16 v[36:39], v[8:11], a[64:71], v2
    v_smfmac_f32_16x16x64_bf16 v[40:43], v[8:11], a[120:127], v2
    v_smfmac_f32_16x16x64_bf16 v[44:47], v[8:11], a[176:183], v2
    s_waitcnt lgkmcnt(2)
    v_smfmac_f32_16x16x64_bf16 v[32:35], v[12:15], a[16:23], v2
    v_smfmac_f32_16x16x64_bf16 v[36:39], v[12:15], a[72:79], v2
    s_waitcnt lgkmcnt(1)
    v_smfmac_f32_16x16x64_bf16 v[32:35], v[16:19], a[24:31], v2
    v_smfmac_f32_16x16x64_bf16 v[36:39], v[16:19], a[80:87], v2
    s_waitcnt lgkmcnt(0)
    v_smfmac_f32_16x16x64_bf16 v[32:35], v[20:23], a[32:39], v2
    v_smfmac_f32_16x16x64_bf16 v[36:39], v[20:23], a[88:95], v2
    v_smfmac_f32_16x16x64_bf16 v[40:43], v[12:15], a[128:135], v2
    v_smfmac_f32_16x16x64_bf16 v[44:47], v[12:15], a[184:191], v2
    v_smfmac_f32_16x16x64_bf16 v[40:43], v[16:19], a[136:143], v2
    v_add_f32 v32, v32, v34
    v_smfmac_f32_16x16x64_bf16 v[44:47], v[16:19], a[192:199], v2
    v_add_f32 v36, v36, v38
    v_smfmac_f32_16x16x64_bf16 v[40:43], v[20:23], a[144:151], v2
    v_add_f32 v33, v33, v35
    v_smfmac_f32_16x16x64_bf16 v[44:47], v[20:23], a[200:207], v2
    v_add_f32 v37, v37, v39
    v_smfmac_f32_16x16x64_bf16 v[48:51], v[4:7], a[224:231], v2
    v_cvt_pk_bf16_f32 v32, v32, v36
    v_smfmac_f32_16x16x64_bf16 v[52:55], v[4:7], v[88:95], v2
    ds_write_b32 v3, v32 offset:9216
    v_cvt_pk_bf16_f32 v33, v33, v37
    v_smfmac_f32_16x16x64_bf16 v[48:51], v[8:11], a[232:239], v2
    ds_write_b32 v3, v33 offset:9232
    v_add_f32 v40, v40, v42
    v_smfmac_f32_16x16x64_bf16 v[52:55], v[8:11], v[96:103], v2
    v_add_f32 v44, v44, v46
    v_smfmac_f32_16x16x64_bf16 v[48:51], v[12:15], a[240:247], v2
    v_add_f32 v41, v41, v43
    v_smfmac_f32_16x16x64_bf16 v[52:55], v[12:15], v[104:111], v2
    v_add_f32 v45, v45, v47
    v_smfmac_f32_16x16x64_bf16 v[48:51], v[16:19], a[248:255], v2
    v_cvt_pk_bf16_f32 v40, v40, v44
    v_smfmac_f32_16x16x64_bf16 v[52:55], v[16:19], v[112:119], v2
    ds_write_b32 v3, v40 offset:10752
    v_cvt_pk_bf16_f32 v41, v41, v45
    v_smfmac_f32_16x16x64_bf16 v[48:51], v[20:23], v[64:71], v2
    ds_write_b32 v3, v41 offset:10768
    v_smfmac_f32_16x16x64_bf16 v[52:55], v[20:23], v[120:127], v2
    v_smfmac_f32_16x16x64_bf16 v[48:51], v[24:27], v[72:79], v2
    v_smfmac_f32_16x16x64_bf16 v[52:55], v[24:27], v[128:135], v2
    v_smfmac_f32_16x16x64_bf16 v[48:51], v[28:31], v[80:87], v2
    v_smfmac_f32_16x16x64_bf16 v[52:55], v[28:31], v[136:143], v2
    s_waitcnt lgkmcnt(0)
    s_barrier
    v_smfmac_f32_16x16x64_bf16 v[56:59], v[4:7], v[144:151], v2
    v_smfmac_f32_16x16x64_bf16 v[56:59], v[8:11], v[152:159], v2
    v_smfmac_f32_16x16x64_bf16 v[56:59], v[12:15], v[160:167], v2
    v_add_f32 v48, v48, v50
    v_smfmac_f32_16x16x64_bf16 v[56:59], v[16:19], v[168:175], v2
    v_add_f32 v52, v52, v54
    v_smfmac_f32_16x16x64_bf16 v[56:59], v[20:23], v[176:183], v2
    v_add_f32 v49, v49, v51
    v_smfmac_f32_16x16x64_bf16 v[56:59], v[24:27], v[184:191], v2
    v_add_f32 v53, v53, v55
    v_smfmac_f32_16x16x64_bf16 v[56:59], v[28:31], v[192:199], v2
    v_cvt_pk_bf16_f32 v48, v48, v52
    v_smfmac_f32_16x16x64_bf16 v[60:63], v[4:7], v[200:207], v2
    ds_write_b32 v3, v48 offset:13312
    v_cvt_pk_bf16_f32 v49, v49, v53
    v_smfmac_f32_16x16x64_bf16 v[60:63], v[8:11], v[208:215], v2
    ds_write_b32 v3, v49 offset:13328
    v_smfmac_f32_16x16x64_bf16 v[60:63], v[12:15], v[216:223], v2
    v_add_f32 v56, v56, v58
    v_add_f32 v57, v57, v59
    v_smfmac_f32_16x16x64_bf16 v[60:63], v[16:19], v[224:231], v2
    v_cvt_pk_bf16_f32 v56, v56, v57
    v_smfmac_f32_16x16x64_bf16 v[60:63], v[20:23], v[232:239], v2
    ds_write_addtid_b32 v56 offset:14336
    v_smfmac_f32_16x16x64_bf16 v[60:63], v[24:27], v[240:247], v2
    v_smfmac_f32_16x16x64_bf16 v[60:63], v[28:31], v[248:255], v2
    s_nop 5
    s_waitcnt lgkmcnt(0)
    s_barrier
    v_pk_add_f32 v[60:61], v[60:61], v[62:63]
    v_cvt_pk_bf16_f32 v60, v60, v61
    ds_write_addtid_b32 v60 offset:15104
    s_waitcnt lgkmcnt(0)
    s_barrier
    s_add_u32 s13, s9, 112
    s_add_u32 s8, s8, 1
    s_cmp_lt_u32 s8, 63
    s_cbranch_scc1 sw_loop_78
    s_branch M_exit
q_84:
    s_waitcnt vmcnt(2)
    v_max3_u32 v0, v28, v29, v30
    v_max_u32 v0, v0, v31
    v_cmp_eq_u32 vcc, -1, v0
    ds_write_b128 v1, v[28:31] offset:6144
    buffer_load_dwordx4 v[24:27], v1, s[4:7], s26 offen offset:1024 sc1
    s_add_u32 s22, s22, 1
    s_cmp_gt_u32 s22, 196608
    s_cbranch_scc1 M_exit
    s_cbranch_vccnz q_83
q_89:
    s_waitcnt vmcnt(2)
    v_max3_u32 v0, v24, v25, v26
    v_max_u32 v0, v0, v27
    v_cmp_eq_u32 vcc, -1, v0
    ds_write_b128 v1, v[24:27] offset:5120
    s_cbranch_vccnz qf_90
    s_branch qdone_82
q_91:
    s_waitcnt vmcnt(1)
    v_max3_u32 v0, v28, v29, v30
    v_max_u32 v0, v0, v31
    v_cmp_eq_u32 vcc, -1, v0
    ds_write_b128 v1, v[28:31] offset:6144
    s_cbranch_vccnz qf_92
    s_branch qdone_82
q_93:
    s_waitcnt vmcnt(1)
    v_max3_u32 v0, v24, v25, v26
    v_max_u32 v0, v0, v27
    v_cmp_eq_u32 vcc, -1, v0
    ds_write_b128 v1, v[24:27] offset:5120
    s_cbranch_vccnz qf_94
    s_branch qdone_82
qf_86:
    buffer_load_dwordx4 v[28:31], v1, s[4:7], s26 offen offset:2048 sc1
    s_add_u32 s22, s22, 1
    s_cmp_gt_u32 s22, 196608
    s_cbranch_scc1 M_exit
    s_branch q_91
qf_90:
    buffer_load_dwordx4 v[24:27], v1, s[4:7], s26 offen offset:1024 sc1
    s_add_u32 s22, s22, 1
    s_cmp_gt_u32 s22, 196608
    s_cbranch_scc1 M_exit
    s_branch q_93
qf_92:
    buffer_load_dwordx4 v[28:31], v1, s[4:7], s26 offen offset:2048 sc1
    s_add_u32 s22, s22, 1
    s_cmp_gt_u32 s22, 196608
    s_cbranch_scc1 M_exit
    s_branch q_91
qf_94:
    buffer_load_dwordx4 v[24:27], v1, s[4:7], s26 offen offset:1024 sc1
    s_add_u32 s22, s22, 1
    s_cmp_gt_u32 s22, 196608
    s_cbranch_scc1 M_exit
    s_branch q_93
role_v_1:
    s_sub_u32 s9, s9, 16
    s_cmp_eq_u32 s10, 1
    s_cbranch_scc1 v_w1_100
    s_cmp_eq_u32 s10, 2
    s_cbranch_scc1 v_w2_101
    s_cmp_eq_u32 s10, 3
    s_cbranch_scc1 v_w3_102
v_w0_99:
    v_and_b32 v0, 63, v0
    v_lshlrev_b32 v1, 4, v0
    v_and_b32 v164, 2, v0
    v_cmp_eq_u32 s[20:21], 0, v164
    v_mov_b32 v2, 0xeeee
    v_mov_b32 v164, 0x4444
    v_cndmask_b32 v2, v2, v164, s[20:21]
    v_and_b32 v168, 16, v1
    v_mov_b32 v166, 0
    v_mov_b32 v3, 0x1111
    v_mov_b32 v164, 0x4444
    v_cndmask_b32 v3, v3, v164, s[20:21]
    v_mov_b32 v160, 0xbbbb
    v_mov_b32 v164, 0xeeee
    v_cndmask_b32 v160, v160, v164, s[20:21]
    v_mov_b32 v162, -1
    v_add_u32 v163, 12288, v1
    v_bfe_u32 v164, v0, 1, 2
    v_lshlrev_b32 v157, 2, v164
    v_bfe_u32 v164, v0, 3, 1
    v_lshl_add_u32 v157, v164, 8, v157
    v_bfe_u32 v164, v0, 4, 1
    v_lshl_add_u32 v157, v164, 7, v157
    v_bfe_u32 v164, v0, 0, 1
    v_lshl_add_u32 v157, v164, 5, v157
    v_bfe_u32 v164, v0, 5, 1
    v_lshl_add_u32 v157, v164, 4, v157
    v_lshlrev_b32 v157, 1, v157
    v_add_u32 v157, 8192, v157
    v_lshlrev_b32 v158, 3, v0
    s_lshl_b32 s11, s9, 9
    v_lshlrev_b32 v159, 2, v0
    v_add_u32 v159, s11, v159
    s_sleep 30
    s_lshl_b32 s11, s10, 8
    s_add_u32 s11, s11, 0x3b02400
    v_min_u32 v4, 15, v0
    v_lshlrev_b32 v4, 4, v4
    s_mov_b32 s22, 0
wt_105:
    buffer_load_dwordx4 v[32:35], v4, s[4:7], s11 offen offset:0 sc1
    s_waitcnt vmcnt(0)
    v_xor_b32 v32, s80, v32
    v_xor_b32 v33, s81, v33
    v_and_b32 v33, -16, v33
    v_xor_b32 v34, s80, v34
    v_xor_b32 v35, s81, v35
    v_and_b32 v35, -16, v35
    v_or3_b32 v32, v32, v33, v34
    v_or_b32 v32, v32, v35
    v_cmp_ne_u32 vcc, 0, v32
    s_cbranch_vccz wtok_106
    s_add_u32 s22, s22, 1
    s_cmp_gt_u32 s22, 65536
    s_cbranch_scc1 M_exit
    s_sleep 16
    s_branch wt_105
wtok_106:
    s_mul_i32 s11, s9, 458752
    s_mov_b32 m0, 12288
    s_add_u32 s12, s11, 0x93f000
    buffer_load_dwordx4 v1, s[4:7], s12 offen offset:0 sc1 lds
    buffer_load_dwordx4 v1, s[4:7], s12 offen offset:1024 sc1 lds
    buffer_load_dwordx4 v1, s[4:7], s12 offen offset:2048 sc1 lds
    buffer_load_dwordx4 v1, s[4:7], s12 offen offset:3072 sc1 lds
    s_mov_b32 m0, 16384
    s_add_u32 s12, s11, 0x940000
    buffer_load_dwordx4 v1, s[4:7], s12 offen offset:0 sc1 lds
    buffer_load_dwordx4 v1, s[4:7], s12 offen offset:1024 sc1 lds
    buffer_load_dwordx4 v1, s[4:7], s12 offen offset:2048 sc1 lds
    buffer_load_dwordx4 v1, s[4:7], s12 offen offset:3072 sc1 lds
    s_mov_b32 m0, 20480
    s_add_u32 s12, s11, 0x941000
    buffer_load_dwordx4 v1, s[4:7], s12 offen offset:0 sc1 lds
    buffer_load_dwordx4 v1, s[4:7], s12 offen offset:1024 sc1 lds
    buffer_load_dwordx4 v1, s[4:7], s12 offen offset:2048 sc1 lds
    buffer_load_dwordx4 v1, s[4:7], s12 offen offset:3072 sc1 lds
    s_mov_b32 m0, 24576
    s_add_u32 s12, s11, 0x942000
    buffer_load_dwordx4 v1, s[4:7], s12 offen offset:0 sc1 lds
    buffer_load_dwordx4 v1, s[4:7], s12 offen offset:1024 sc1 lds
    buffer_load_dwordx4 v1, s[4:7], s12 offen offset:2048 sc1 lds
    buffer_load_dwordx4 v1, s[4:7], s12 offen offset:3072 sc1 lds
    s_mov_b32 m0, 28672
    s_add_u32 s12, s11, 0x943000
    buffer_load_dwordx4 v1, s[4:7], s12 offen offset:0 sc1 lds
    buffer_load_dwordx4 v1, s[4:7], s12 offen offset:1024 sc1 lds
    buffer_load_dwordx4 v1, s[4:7], s12 offen offset:2048 sc1 lds
    buffer_load_dwordx4 v1, s[4:7], s12 offen offset:3072 sc1 lds
    s_mov_b32 m0, 32768
    s_add_u32 s12, s11, 0x944000
    buffer_load_dwordx4 v1, s[4:7], s12 offen offset:0 sc1 lds
    buffer_load_dwordx4 v1, s[4:7], s12 offen offset:1024 sc1 lds
    buffer_load_dwordx4 v1, s[4:7], s12 offen offset:2048 sc1 lds
    buffer_load_dwordx4 v1, s[4:7], s12 offen offset:3072 sc1 lds
    s_mov_b32 m0, 36864
    s_add_u32 s12, s11, 0x945000
    buffer_load_dwordx4 v1, s[4:7], s12 offen offset:0 sc1 lds
    buffer_load_dwordx4 v1, s[4:7], s12 offen offset:1024 sc1 lds
    buffer_load_dwordx4 v1, s[4:7], s12 offen offset:2048 sc1 lds
    buffer_load_dwordx4 v1, s[4:7], s12 offen offset:3072 sc1 lds
    s_mov_b32 s25, s11
    s_lshl_b32 s29, s9, 5
    s_add_u32 s29, s29, 0x3b00000
    s_add_u32 s12, s25, 0x900000
    s_add_u32 s14, s12, 0
    buffer_load_dwordx4 a[0:3], v1, s[4:7], s14 offen offset:0 sc1
    buffer_load_dwordx4 a[4:7], v1, s[4:7], s14 offen offset:1024 sc1
    buffer_load_dwordx4 a[8:11], v1, s[4:7], s14 offen offset:2048 sc1
    buffer_load_dwordx4 a[12:15], v1, s[4:7], s14 offen offset:3072 sc1
    s_add_u32 s14, s12, 4096
    buffer_load_dwordx4 a[16:19], v1, s[4:7], s14 offen offset:0 sc1
    buffer_load_dwordx4 a[20:23], v1, s[4:7], s14 offen offset:1024 sc1
    buffer_load_dwordx4 a[24:27], v1, s[4:7], s14 offen offset:2048 sc1
    buffer_load_dwordx4 a[28:31], v1, s[4:7], s14 offen offset:3072 sc1
    s_add_u32 s14, s12, 8192
    buffer_load_dwordx4 a[32:35], v1, s[4:7], s14 offen offset:0 sc1
    buffer_load_dwordx4 a[36:39], v1, s[4:7], s14 offen offset:1024 sc1
    buffer_load_dwordx4 a[40:43], v1, s[4:7], s14 offen offset:2048 sc1
    buffer_load_dwordx4 a[44:47], v1, s[4:7], s14 offen offset:3072 sc1
    s_add_u32 s14, s12, 12288
    buffer_load_dwordx4 a[48:51], v1, s[4:7], s14 offen offset:0 sc1
    buffer_load_dwordx4 a[52:55], v1, s[4:7], s14 offen offset:1024 sc1
    s_add_u32 s12, s25, 0x903800
    s_add_u32 s14, s12, 0
    buffer_load_dwordx4 a[56:59], v1, s[4:7], s14 offen offset:0 sc1
    buffer_load_dwordx4 a[60:63], v1, s[4:7], s14 offen offset:1024 sc1
    buffer_load_dwordx4 a[64:67], v1, s[4:7], s14 offen offset:2048 sc1
    buffer_load_dwordx4 a[68:71], v1, s[4:7], s14 offen offset:3072 sc1
    s_add_u32 s14, s12, 4096
    buffer_load_dwordx4 a[72:75], v1, s[4:7], s14 offen offset:0 sc1
    buffer_load_dwordx4 a[76:79], v1, s[4:7], s14 offen offset:1024 sc1
    buffer_load_dwordx4 a[80:83], v1, s[4:7], s14 offen offset:2048 sc1
    buffer_load_dwordx4 a[84:87], v1, s[4:7], s14 offen offset:3072 sc1
    s_add_u32 s14, s12, 8192
    buffer_load_dwordx4 a[88:91], v1, s[4:7], s14 offen offset:0 sc1
    buffer_load_dwordx4 a[92:95], v1, s[4:7], s14 offen offset:1024 sc1
    buffer_load_dwordx4 a[96:99], v1, s[4:7], s14 offen offset:2048 sc1
    buffer_load_dwordx4 a[100:103], v1, s[4:7], s14 offen offset:3072 sc1
    s_add_u32 s14, s12, 12288
    buffer_load_dwordx4 a[104:107], v1, s[4:7], s14 offen offset:0 sc1
    buffer_load_dwordx4 a[108:111], v1, s[4:7], s14 offen offset:1024 sc1
    s_waitcnt vmcnt(46)
    s_add_u32 s12, s25, 0x907000
    s_add_u32 s14, s12, 0
    buffer_load_dwordx4 a[112:115], v1, s[4:7], s14 offen offset:0 sc1
    buffer_load_dwordx4 a[116:119], v1, s[4:7], s14 offen offset:1024 sc1
    buffer_load_dwordx4 a[120:123], v1, s[4:7], s14 offen offset:2048 sc1
    buffer_load_dwordx4 a[124:127], v1, s[4:7], s14 offen offset:3072 sc1
    s_add_u32 s14, s12, 4096
    buffer_load_dwordx4 a[128:131], v1, s[4:7], s14 offen offset:0 sc1
    buffer_load_dwordx4 a[132:135], v1, s[4:7], s14 offen offset:1024 sc1
    buffer_load_dwordx4 a[136:139], v1, s[4:7], s14 offen offset:2048 sc1
    buffer_load_dwordx4 a[140:143], v1, s[4:7], s14 offen offset:3072 sc1
    s_add_u32 s14, s12, 8192
    buffer_load_dwordx4 a[144:147], v1, s[4:7], s14 offen offset:0 sc1
    buffer_load_dwordx4 a[148:151], v1, s[4:7], s14 offen offset:1024 sc1
    buffer_load_dwordx4 a[152:155], v1, s[4:7], s14 offen offset:2048 sc1
    buffer_load_dwordx4 a[156:159], v1, s[4:7], s14 offen offset:3072 sc1
    s_add_u32 s14, s12, 12288
    buffer_load_dwordx4 a[160:163], v1, s[4:7], s14 offen offset:0 sc1
    buffer_load_dwordx4 a[164:167], v1, s[4:7], s14 offen offset:1024 sc1
    s_waitcnt vmcnt(46)
    s_mov_b32 s11, 0x3b02000
    v_min_u32 v4, 63, v0
    v_lshlrev_b32 v4, 4, v4
    s_mov_b32 s22, 0
wt_107:
    buffer_load_dwordx4 v[32:35], v4, s[4:7], s11 offen offset:0 sc1
    buffer_load_dwordx4 v[36:39], v4, s[4:7], s11 offen offset:1024 sc1
    s_waitcnt vmcnt(0)
    v_xor_b32 v32, s80, v32
    v_xor_b32 v33, s81, v33
    v_and_b32 v33, -16, v33
    v_xor_b32 v34, s80, v34
    v_xor_b32 v35, s81, v35
    v_and_b32 v35, -16, v35
    v_xor_b32 v36, s80, v36
    v_xor_b32 v37, s81, v37
    v_and_b32 v37, -16, v37
    v_xor_b32 v38, s80, v38
    v_xor_b32 v39, s81, v39
    v_and_b32 v39, -16, v39
    v_or3_b32 v32, v32, v33, v34
    v_or_b32 v32, v32, v35
    v_or3_b32 v32, v32, v36, v37
    v_or3_b32 v32, v32, v38, v39
    v_cmp_ne_u32 vcc, 0, v32
    s_cbranch_vccz wtok_108
    s_add_u32 s22, s22, 1
    s_cmp_gt_u32 s22, 65536
    s_cbranch_scc1 M_exit
    s_sleep 16
    s_branch wt_107
wtok_108:
    s_mov_b32 s30, 0
    s_getreg_b32 s27, hwreg(HW_REG_XCC_ID, 0, 4)
    v_min_u32 v165, 31, v0
    v_lshlrev_b32 v165, 3, v165
    s_mov_b32 s11, 0x3b02000
    buffer_load_dword v164, v165, s[4:7], s11 offen offset:4 sc1
    s_waitcnt vmcnt(0)
    v_and_b32 v164, 15, v164
    v_cmp_ne_u32 vcc, s27, v164
    s_cbranch_vccnz mf_109
    s_mov_b32 s30, 1
mf_109:
    s_add_u32 s12, s25, 0x90a800
    s_add_u32 s14, s12, 0
    buffer_load_dwordx4 a[168:171], v1, s[4:7], s14 offen offset:0 sc1
    buffer_load_dwordx4 a[172:175], v1, s[4:7], s14 offen offset:1024 sc1
    buffer_load_dwordx4 a[176:179], v1, s[4:7], s14 offen offset:2048 sc1
    buffer_load_dwordx4 a[180:183], v1, s[4:7], s14 offen offset:3072 sc1
    s_add_u32 s14, s12, 4096
    buffer_load_dwordx4 a[184:187], v1, s[4:7], s14 offen offset:0 sc1
    buffer_load_dwordx4 a[188:191], v1, s[4:7], s14 offen offset:1024 sc1
    buffer_load_dwordx4 a[192:195], v1, s[4:7], s14 offen offset:2048 sc1
    buffer_load_dwordx4 a[196:199], v1, s[4:7], s14 offen offset:3072 sc1
    s_add_u32 s14, s12, 8192
    buffer_load_dwordx4 a[200:203], v1, s[4:7], s14 offen offset:0 sc1
    buffer_load_dwordx4 a[204:207], v1, s[4:7], s14 offen offset:1024 sc1
    buffer_load_dwordx4 a[208:211], v1, s[4:7], s14 offen offset:2048 sc1
    buffer_load_dwordx4 a[212:215], v1, s[4:7], s14 offen offset:3072 sc1
    s_add_u32 s14, s12, 12288
    buffer_load_dwordx4 a[216:219], v1, s[4:7], s14 offen offset:0 sc1
    buffer_load_dwordx4 a[220:223], v1, s[4:7], s14 offen offset:1024 sc1
    s_waitcnt vmcnt(46)
    s_add_u32 s12, s25, 0x938000
    s_add_u32 s14, s12, 0
    buffer_load_dwordx4 a[224:227], v1, s[4:7], s14 offen offset:0 sc1
    buffer_load_dwordx4 a[228:231], v1, s[4:7], s14 offen offset:1024 sc1
    buffer_load_dwordx4 a[232:235], v1, s[4:7], s14 offen offset:2048 sc1
    buffer_load_dwordx4 a[236:239], v1, s[4:7], s14 offen offset:3072 sc1
    s_add_u32 s14, s12, 4096
    buffer_load_dwordx4 a[240:243], v1, s[4:7], s14 offen offset:0 sc1
    buffer_load_dwordx4 a[244:247], v1, s[4:7], s14 offen offset:1024 sc1
    buffer_load_dwordx4 a[248:251], v1, s[4:7], s14 offen offset:2048 sc1
    buffer_load_dwordx4 a[252:255], v1, s[4:7], s14 offen offset:3072 sc1
    s_add_u32 s14, s12, 8192
    buffer_load_dwordx4 v[176:179], v1, s[4:7], s14 offen offset:0 sc1
    buffer_load_dwordx4 v[180:183], v1, s[4:7], s14 offen offset:1024 sc1
    buffer_load_dwordx4 v[184:187], v1, s[4:7], s14 offen offset:2048 sc1
    buffer_load_dwordx4 v[188:191], v1, s[4:7], s14 offen offset:3072 sc1
    s_add_u32 s14, s12, 12288
    buffer_load_dwordx4 v[192:195], v1, s[4:7], s14 offen offset:0 sc1
    buffer_load_dwordx4 v[196:199], v1, s[4:7], s14 offen offset:1024 sc1
    s_waitcnt vmcnt(46)
    s_add_u32 s12, s25, 0x93b800
    s_add_u32 s14, s12, 0
    buffer_load_dwordx4 v[200:203], v1, s[4:7], s14 offen offset:0 sc1
    buffer_load_dwordx4 v[204:207], v1, s[4:7], s14 offen offset:1024 sc1
    buffer_load_dwordx4 v[208:211], v1, s[4:7], s14 offen offset:2048 sc1
    buffer_load_dwordx4 v[212:215], v1, s[4:7], s14 offen offset:3072 sc1
    s_add_u32 s14, s12, 4096
    buffer_load_dwordx4 v[216:219], v1, s[4:7], s14 offen offset:0 sc1
    buffer_load_dwordx4 v[220:223], v1, s[4:7], s14 offen offset:1024 sc1
    buffer_load_dwordx4 v[224:227], v1, s[4:7], s14 offen offset:2048 sc1
    buffer_load_dwordx4 v[228:231], v1, s[4:7], s14 offen offset:3072 sc1
    s_add_u32 s14, s12, 8192
    buffer_load_dwordx4 v[232:235], v1, s[4:7], s14 offen offset:0 sc1
    buffer_load_dwordx4 v[236:239], v1, s[4:7], s14 offen offset:1024 sc1
    buffer_load_dwordx4 v[240:243], v1, s[4:7], s14 offen offset:2048 sc1
    buffer_load_dwordx4 v[244:247], v1, s[4:7], s14 offen offset:3072 sc1
    s_add_u32 s14, s12, 12288
    buffer_load_dwordx4 v[248:251], v1, s[4:7], s14 offen offset:0 sc1
    buffer_load_dwordx4 v[252:255], v1, s[4:7], s14 offen offset:1024 sc1
    s_waitcnt vmcnt(46)
    s_mov_b32 s8, 0
    v_mov_b32 v32, 0
    v_mov_b32 v33, 0
    v_mov_b32 v34, 0
    v_mov_b32 v35, 0
    v_mov_b32 v36, 0
    v_mov_b32 v37, 0
    v_mov_b32 v38, 0
    v_mov_b32 v39, 0
    v_mov_b32 v40, 0
    v_mov_b32 v41, 0
    v_mov_b32 v42, 0
    v_mov_b32 v43, 0
    v_mov_b32 v44, 0
    v_mov_b32 v45, 0
    v_mov_b32 v46, 0
    v_mov_b32 v47, 0
    v_mov_b32 v48, 0
    v_mov_b32 v49, 0
    v_mov_b32 v50, 0
    v_mov_b32 v51, 0
    v_mov_b32 v52, 0
    v_mov_b32 v53, 0
    v_mov_b32 v54, 0
    v_mov_b32 v55, 0
    v_mov_b32 v56, 0
    v_mov_b32 v57, 0
    v_mov_b32 v58, 0
    v_mov_b32 v59, 0
    v_mov_b32 v60, 0
    v_mov_b32 v61, 0
    v_mov_b32 v62, 0
    v_mov_b32 v63, 0
    s_mov_b32 s22, 0
v_u0_110:
    s_add_u32 s22, s22, 1
    s_cmp_gt_u32 s22, 65536
    s_cbranch_scc1 M_exit
    buffer_load_dword v166, v168, s[4:7], s29 offen sc1
    s_waitcnt vmcnt(0)
    v_cmp_eq_u32 vcc, 0, v166
    s_cbranch_vccnz v_u0_110
    v_and_b32 v167, 3, v0
    v_lshlrev_b32 v167, 2, v167
    s_cmp_eq_u32 s30, 0
    s_cbranch_scc1 v_mode_111
.p2align 8
v_dry_103:
v_loop_112:
    v_mov_b32 v140, 0
    v_mov_b32 v141, 0
    v_mov_b32 v142, 0
    v_mov_b32 v143, 0
    v_mov_b32 v144, 0
    v_mov_b32 v145, 0
    v_mov_b32 v146, 0
    v_mov_b32 v147, 0
    s_and_b32 s23, s8, 7
    s_lshl_b32 s23, s23, 13
    s_add_u32 s23, s23, 0x3100000
    s_add_u32 s26, s23, 4096
    ds_read_b128 v[64:67], v163 offset:0
    ds_read_b128 v[68:71], v163 offset:1024
    ds_read_b128 v[72:75], v163 offset:2048
    ds_read_b128 v[76:79], v163 offset:3072
    ds_read_b128 v[80:83], v163 offset:4096
    ds_read_b128 v[84:87], v163 offset:5120
    s_and_b32 s11, s8, 15
    s_mul_i32 s11, s11, 458752
    s_lshl_b32 s12, s9, 15
    s_add_u32 s11, s11, s12
    s_add_u32 s11, s11, 0x1000000
    s_add_u32 s12, s11, 16384
    s_mov_b32 s22, 0
    buffer_load_dwordx4 v[4:7], v1, s[4:7], s23 offen offset:0 sc1
poll_114:
    s_waitcnt vmcnt(0)
    buffer_load_dwordx4 v[4:7], v1, s[4:7], s23 offen offset:0 sc1
    v_max3_u32 v156, v4, v5, v6
    v_max_u32 v156, v156, v7
    v_cmp_eq_u32 vcc, -1, v156
    ds_write_b128 v1, v[4:7] offset:0
    s_add_u32 s22, s22, 1
    s_cmp_gt_u32 s22, 65536
    s_cbranch_scc1 M_exit
    s_cbranch_vccnz poll_114
pok_113:
    v_smfmac_f32_16x16x64_bf16 v[32:35], v[4:7], a[0:7], v2
    v_smfmac_f32_16x16x64_bf16 v[36:39], v[4:7], a[56:63], v2
    v_smfmac_f32_16x16x64_bf16 v[40:43], v[4:7], a[112:119], v2
    v_smfmac_f32_16x16x64_bf16 v[44:47], v[4:7], a[168:175], v2
    s_waitcnt lgkmcnt(0)
    s_barrier
    ds_read_b128 v[8:11], v1 offset:1024
    ds_read_b128 v[12:15], v1 offset:2048
    buffer_load_dwordx4 v[88:91], v1, s[4:7], s11 offen offset:0 sc1
    v_smfmac_f32_16x16x64_bf16 v[56:59], v[4:7], v[64:71], v2
    ds_read_b128 v[16:19], v1 offset:3072
    s_waitcnt lgkmcnt(2)
    v_smfmac_f32_16x16x64_bf16 v[32:35], v[8:11], a[8:15], v2
    ds_read_b128 v[20:23], v1 offset:4096
    ds_read_b128 v[64:67], v163 offset:6144
    v_smfmac_f32_16x16x64_bf16 v[36:39], v[8:11], a[64:71], v2
    ds_read_b128 v[24:27], v1 offset:5120
    ds_read_b128 v[68:71], v163 offset:7168
    v_smfmac_f32_16x16x64_bf16 v[40:43], v[8:11], a[120:127], v2
    ds_read_b128 v[28:31], v1 offset:6144
    buffer_load_dwordx4 v[92:95], v1, s[4:7], s11 offen offset:1024 sc1
    v_smfmac_f32_16x16x64_bf16 v[56:59], v[8:11], v[72:79], v2
    s_waitcnt lgkmcnt(6)
    v_smfmac_f32_16x16x64_bf16 v[32:35], v[12:15], a[16:23], v2
    ds_read_b128 v[72:75], v163 offset:8192
    v_smfmac_f32_16x16x64_bf16 v[36:39], v[12:15], a[72:79], v2
    ds_read_b128 v[76:79], v163 offset:9216
    v_smfmac_f32_16x16x64_bf16 v[40:43], v[12:15], a[128:135], v2
    buffer_load_dwordx4 v[96:99], v1, s[4:7], s11 offen offset:2048 sc1
    v_smfmac_f32_16x16x64_bf16 v[56:59], v[12:15], v[80:87], v2
    s_waitcnt lgkmcnt(7)
    v_smfmac_f32_16x16x64_bf16 v[32:35], v[16:19], a[24:31], v2
    ds_read_b128 v[80:83], v163 offset:10240
    v_smfmac_f32_16x16x64_bf16 v[36:39], v[16:19], a[80:87], v2
    ds_read_b128 v[84:87], v163 offset:11264
    v_smfmac_f32_16x16x64_bf16 v[40:43], v[16:19], a[136:143], v2
    buffer_load_dwordx4 v[100:103], v1, s[4:7], s11 offen offset:3072 sc1
    s_waitcnt lgkmcnt(5)
    v_smfmac_f32_16x16x64_bf16 v[56:59], v[16:19], v[64:71], v2
    v_smfmac_f32_16x16x64_bf16 v[32:35], v[20:23], a[32:39], v2
    ds_read_b128 v[64:67], v163 offset:12288
    v_smfmac_f32_16x16x64_bf16 v[36:39], v[20:23], a[88:95], v2
    ds_read_b128 v[68:71], v163 offset:13312
    v_smfmac_f32_16x16x64_bf16 v[40:43], v[20:23], a[144:151], v2
    buffer_load_dwordx4 v[104:107], v1, s[4:7], s12 offen offset:0 sc1
    s_waitcnt lgkmcnt(4)
    v_smfmac_f32_16x16x64_bf16 v[56:59], v[20:23], v[72:79], v2
    v_smfmac_f32_16x16x64_bf16 v[32:35], v[24:27], a[40:47], v2
    ds_read_b128 v[72:75], v163 offset:14336
    v_smfmac_f32_16x16x64_bf16 v[36:39], v[24:27], a[96:103], v2
    ds_read_b128 v[76:79], v163 offset:15360
    v_smfmac_f32_16x16x64_bf16 v[40:43], v[24:27], a[152:159], v2
    buffer_load_dwordx4 v[108:111], v1, s[4:7], s12 offen offset:1024 sc1
    s_waitcnt lgkmcnt(4)
    v_smfmac_f32_16x16x64_bf16 v[56:59], v[24:27], v[80:87], v2
    v_smfmac_f32_16x16x64_bf16 v[32:35], v[28:31], a[48:55], v2
    ds_read_b128 v[80:83], v163 offset:16384
    v_smfmac_f32_16x16x64_bf16 v[36:39], v[28:31], a[104:111], v2
    ds_read_b128 v[84:87], v163 offset:17408
    v_smfmac_f32_16x16x64_bf16 v[40:43], v[28:31], a[160:167], v2
    buffer_load_dwordx4 v[112:115], v1, s[4:7], s12 offen offset:2048 sc1
    s_waitcnt lgkmcnt(4)
    v_smfmac_f32_16x16x64_bf16 v[56:59], v[28:31], v[64:71], v2
    ds_read_b128 v[64:67], v163 offset:18432
    v_smfmac_f32_16x16x64_bf16 v[48:51], v[4:7], a[224:231], v2
    ds_read_b128 v[68:71], v163 offset:19456
    v_add_f32 v32, v32, v34
    v_smfmac_f32_16x16x64_bf16 v[52:55], v[4:7], v[200:207], v2
    buffer_load_dwordx4 v[116:119], v1, s[4:7], s12 offen offset:3072 sc1
    v_add_f32 v33, v33, v35
    s_waitcnt lgkmcnt(4)
    v_smfmac_f32_16x16x64_bf16 v[60:63], v[4:7], v[72:79], v2
    v_cvt_pk_bf16_f32 v132, v32, v33
    v_smfmac_f32_16x16x64_bf16 v[44:47], v[8:11], a[176:183], v2
    ds_read_b128 v[72:75], v163 offset:20480
    v_add_f32 v36, v36, v38
    v_smfmac_f32_16x16x64_bf16 v[48:51], v[8:11], a[232:239], v2
    ds_read_b128 v[76:79], v163 offset:21504
    v_add_f32 v37, v37, v39
    v_smfmac_f32_16x16x64_bf16 v[52:55], v[8:11], v[208:215], v2
    v_cvt_pk_bf16_f32 v134, v36, v37
    s_waitcnt lgkmcnt(4)
    v_smfmac_f32_16x16x64_bf16 v[60:63], v[8:11], v[80:87], v2
    v_add_f32 v40, v40, v42
    v_smfmac_f32_16x16x64_bf16 v[44:47], v[12:15], a[184:191], v2
    ds_read_b128 v[80:83], v163 offset:22528
    v_add_f32 v41, v41, v43
    v_smfmac_f32_16x16x64_bf16 v[48:51], v[12:15], a[240:247], v2
    ds_read_b128 v[84:87], v163 offset:23552
    v_cvt_pk_bf16_f32 v136, v40, v41
    v_smfmac_f32_16x16x64_bf16 v[52:55], v[12:15], v[216:223], v2
    v_add_f32 v56, v56, v58
    s_waitcnt lgkmcnt(4)
    v_smfmac_f32_16x16x64_bf16 v[60:63], v[12:15], v[64:71], v2
    v_add_f32 v57, v57, v59
    v_smfmac_f32_16x16x64_bf16 v[44:47], v[16:19], a[192:199], v2
    ds_read_b128 v[64:67], v163 offset:24576
    v_cvt_pk_bf16_f32 v137, v56, v57
    v_smfmac_f32_16x16x64_bf16 v[48:51], v[16:19], a[248:255], v2
    ds_read_b128 v[68:71], v163 offset:25600
    v_smfmac_f32_16x16x64_bf16 v[52:55], v[16:19], v[224:231], v2
    s_waitcnt lgkmcnt(4)
    v_smfmac_f32_16x16x64_bf16 v[60:63], v[16:19], v[72:79], v2
    v_smfmac_f32_16x16x64_bf16 v[44:47], v[20:23], a[200:207], v2
    ds_read_b128 v[72:75], v163 offset:26624
    v_smfmac_f32_16x16x64_bf16 v[48:51], v[20:23], v[176:183], v2
    ds_read_b128 v[76:79], v163 offset:27648
    v_smfmac_f32_16x16x64_bf16 v[52:55], v[20:23], v[232:239], v2
    s_waitcnt lgkmcnt(4)
    v_smfmac_f32_16x16x64_bf16 v[60:63], v[20:23], v[80:87], v2
    v_smfmac_f32_16x16x64_bf16 v[44:47], v[24:27], a[208:215], v2
    v_smfmac_f32_16x16x64_bf16 v[48:51], v[24:27], v[184:191], v2
    v_smfmac_f32_16x16x64_bf16 v[52:55], v[24:27], v[240:247], v2
    s_waitcnt lgkmcnt(2)
    v_smfmac_f32_16x16x64_bf16 v[60:63], v[24:27], v[64:71], v2
    v_smfmac_f32_16x16x64_bf16 v[44:47], v[28:31], a[216:223], v2
    v_smfmac_f32_16x16x64_bf16 v[48:51], v[28:31], v[192:199], v2
    v_smfmac_f32_16x16x64_bf16 v[52:55], v[28:31], v[248:255], v2
    s_waitcnt lgkmcnt(0)
    v_smfmac_f32_16x16x64_bf16 v[60:63], v[28:31], v[72:79], v2
    v_add_f32 v44, v44, v46
    s_and_b32 s11, s8, 3
    s_lshl_b32 s11, s11, 14
    s_add_u32 s25, s11, 0x3112000
    s_add_u32 s24, s11, 0x3110000
    s_add_u32 s11, s8, 1
    s_and_b32 s12, s11, 7
    s_lshl_b32 s12, s12, 13
    s_add_u32 s12, s12, 0x3100000
    s_mov_b32 s22, 0
    buffer_load_dwordx4 v[120:123], v1, s[4:7], s24 offen sc1
    buffer_load_dwordx4 v[124:127], v1, s[4:7], s24 offen offset:1024 sc1
    buffer_load_dwordx4 v[128:131], v1, s[4:7], s25 offen sc1
    v_add_f32 v45, v45, v47
    v_cvt_pk_bf16_f32 v138, v44, v45
    v_add_f32 v48, v48, v50
    v_add_f32 v49, v49, v51
    v_cvt_pk_bf16_f32 v133, v48, v49
    v_add_f32 v52, v52, v54
    v_add_f32 v53, v53, v55
    v_cvt_pk_bf16_f32 v135, v52, v53
    v_add_f32 v60, v60, v62
    v_add_f32 v61, v61, v63
    v_cvt_pk_bf16_f32 v139, v60, v61
    v_mov_b32 v32, 0
    v_mov_b32 v33, 0
    v_mov_b32 v34, 0
    v_mov_b32 v35, 0
    v_mov_b32 v36, 0
    v_mov_b32 v37, 0
    v_mov_b32 v38, 0
    v_mov_b32 v39, 0
    v_mov_b32 v40, 0
    v_mov_b32 v41, 0
    v_mov_b32 v42, 0
    v_mov_b32 v43, 0
    v_mov_b32 v44, 0
    v_mov_b32 v45, 0
    v_mov_b32 v46, 0
    v_mov_b32 v47, 0
    v_mov_b32 v48, 0
    v_mov_b32 v49, 0
    v_mov_b32 v50, 0
    v_mov_b32 v51, 0
    v_mov_b32 v52, 0
    v_mov_b32 v53, 0
    v_mov_b32 v54, 0
    v_mov_b32 v55, 0
    v_mov_b32 v56, 0
    v_mov_b32 v57, 0
    v_mov_b32 v58, 0
    v_mov_b32 v59, 0
    v_mov_b32 v60, 0
    v_mov_b32 v61, 0
    v_mov_b32 v62, 0
    v_mov_b32 v63, 0
q_116:
    s_waitcnt vmcnt(2)
    v_max3_u32 v156, v120, v121, v122
    v_max_u32 v156, v156, v123
    v_cmp_eq_u32 vcc, -1, v156
    buffer_load_dwordx4 v[120:123], v1, s[4:7], s24 offen sc1
    s_add_u32 s22, s22, 1
    s_cmp_gt_u32 s22, 196608
    s_cbranch_scc1 M_exit
    s_cbranch_vccnz q_117
    v_smfmac_f32_16x16x64_bf16 v[140:143], v[120:123], v[88:95], v2
    v_smfmac_f32_16x16x64_bf16 v[144:147], v[120:123], v[104:111], v2
q_118:
    s_waitcnt vmcnt(2)
    v_max3_u32 v156, v124, v125, v126
    v_max_u32 v156, v156, v127
    v_cmp_eq_u32 vcc, -1, v156
    s_cbranch_vccnz qf_119
    v_smfmac_f32_16x16x64_bf16 v[140:143], v[124:127], v[96:103], v2
    v_smfmac_f32_16x16x64_bf16 v[144:147], v[124:127], v[112:119], v2
q_120:
    s_waitcnt vmcnt(1)
    v_max3_u32 v156, v128, v129, v130
    v_max_u32 v156, v156, v131
    v_cmp_eq_u32 vcc, -1, v156
    s_cbranch_vccnz qf_121
    v_smfmac_f32_16x16x64_bf16 v[140:143], v[128:131], v[132:139], v3
    v_smfmac_f32_16x16x64_bf16 v[144:147], v[128:131], v[132:139], v160
qdone_115:
    s_nop 6
    v_add_f32 v148, v140, v142
    v_add_f32 v150, v141, v143
    v_add_f32 v149, v144, v146
    v_add_f32 v151, v145, v147
    ds_write2_b64 v157, v[148:149], v[150:151] offset0:0 offset1:16
    s_waitcnt lgkmcnt(0)
    s_barrier
    ds_read_b64 v[148:149], v158 offset:8192
    ds_read_b64 v[150:151], v158 offset:9216
    ds_read_b64 v[152:153], v158 offset:10240
    ds_read_b64 v[154:155], v158 offset:11264
    s_waitcnt lgkmcnt(2)
    v_pk_add_f32 v[148:149], v[148:149], v[150:151]
    s_waitcnt lgkmcnt(1)
    v_pk_add_f32 v[148:149], v[148:149], v[152:153]
    s_waitcnt lgkmcnt(0)
    v_pk_add_f32 v[148:149], v[148:149], v[154:155]
    v_cvt_pk_bf16_f32 v164, v148, v149
    v_min_u32 v164, -2, v164
    buffer_store_dword v164, v159, s[4:7], s12 offen offset:0
    s_xor_b32 s12, s12, 0x8000
    buffer_store_dword v162, v159, s[4:7], s12 offen offset:0
    s_add_u32 s13, s9, 32
    s_add_u32 s8, s8, 1
    s_cmp_lt_u32 s8, 63
    s_cbranch_scc1 v_loop_112
    s_mov_b32 s13, 0x30fe000
    buffer_store_dword v164, v159, s[4:7], s13 offen offset:0 sc1
    s_branch M_exit
q_117:
    s_waitcnt vmcnt(2)
    v_max3_u32 v156, v124, v125, v126
    v_max_u32 v156, v156, v127
    v_cmp_eq_u32 vcc, -1, v156
    buffer_load_dwordx4 v[124:127], v1, s[4:7], s24 offen offset:1024 sc1
    s_add_u32 s22, s22, 1
    s_cmp_gt_u32 s22, 196608
    s_cbranch_scc1 M_exit
    s_cbranch_vccnz q_123
    v_smfmac_f32_16x16x64_bf16 v[140:143], v[124:127], v[96:103], v2
    v_smfmac_f32_16x16x64_bf16 v[144:147], v[124:127], v[112:119], v2
q_124:
    s_waitcnt vmcnt(2)
    v_max3_u32 v156, v128, v129, v130
    v_max_u32 v156, v156, v131
    v_cmp_eq_u32 vcc, -1, v156
    s_cbranch_vccnz qf_125
    v_smfmac_f32_16x16x64_bf16 v[140:143], v[128:131], v[132:139], v3
    v_smfmac_f32_16x16x64_bf16 v[144:147], v[128:131], v[132:139], v160
q_126:
    s_waitcnt vmcnt(1)
    v_max3_u32 v156, v120, v121, v122
    v_max_u32 v156, v156, v123
    v_cmp_eq_u32 vcc, -1, v156
    s_cbranch_vccnz qf_127
    v_smfmac_f32_16x16x64_bf16 v[140:143], v[120:123], v[88:95], v2
    v_smfmac_f32_16x16x64_bf16 v[144:147], v[120:123], v[104:111], v2
    s_branch qdone_115
q_128:
    s_waitcnt vmcnt(2)
    v_max3_u32 v156, v128, v129, v130
    v_max_u32 v156, v156, v131
    v_cmp_eq_u32 vcc, -1, v156
    s_cbranch_vccnz qf_129
    v_smfmac_f32_16x16x64_bf16 v[140:143], v[128:131], v[132:139], v3
    v_smfmac_f32_16x16x64_bf16 v[144:147], v[128:131], v[132:139], v160
q_130:
    s_waitcnt vmcnt(0)
    v_max3_u32 v156, v124, v125, v126
    v_max_u32 v156, v156, v127
    v_cmp_eq_u32 vcc, -1, v156
    s_cbranch_vccnz qf_131
    v_smfmac_f32_16x16x64_bf16 v[140:143], v[124:127], v[96:103], v2
    v_smfmac_f32_16x16x64_bf16 v[144:147], v[124:127], v[112:119], v2
    s_branch qdone_115
q_132:
    s_waitcnt vmcnt(0)
    v_max3_u32 v156, v128, v129, v130
    v_max_u32 v156, v156, v131
    v_cmp_eq_u32 vcc, -1, v156
    s_cbranch_vccnz qf_133
    v_smfmac_f32_16x16x64_bf16 v[140:143], v[128:131], v[132:139], v3
    v_smfmac_f32_16x16x64_bf16 v[144:147], v[128:131], v[132:139], v160
    s_branch qdone_115
q_123:
    s_waitcnt vmcnt(2)
    v_max3_u32 v156, v128, v129, v130
    v_max_u32 v156, v156, v131
    v_cmp_eq_u32 vcc, -1, v156
    buffer_load_dwordx4 v[128:131], v1, s[4:7], s25 offen sc1
    s_add_u32 s22, s22, 1
    s_cmp_gt_u32 s22, 196608
    s_cbranch_scc1 M_exit
    s_cbranch_vccnz q_116
    v_smfmac_f32_16x16x64_bf16 v[140:143], v[128:131], v[132:139], v3
    v_smfmac_f32_16x16x64_bf16 v[144:147], v[128:131], v[132:139], v160
q_136:
    s_waitcnt vmcnt(2)
    v_max3_u32 v156, v120, v121, v122
    v_max_u32 v156, v156, v123
    v_cmp_eq_u32 vcc, -1, v156
    s_cbranch_vccnz qf_137
    v_smfmac_f32_16x16x64_bf16 v[140:143], v[120:123], v[88:95], v2
    v_smfmac_f32_16x16x64_bf16 v[144:147], v[120:123], v[104:111], v2
q_138:
    s_waitcnt vmcnt(1)
    v_max3_u32 v156, v124, v125, v126
    v_max_u32 v156, v156, v127
    v_cmp_eq_u32 vcc, -1, v156
    s_cbranch_vccnz qf_139
    v_smfmac_f32_16x16x64_bf16 v[140:143], v[124:127], v[96:103], v2
    v_smfmac_f32_16x16x64_bf16 v[144:147], v[124:127], v[112:119], v2
    s_branch qdone_115
q_140:
    s_waitcnt vmcnt(2)
    v_max3_u32 v156, v120, v121, v122
    v_max_u32 v156, v156, v123
    v_cmp_eq_u32 vcc, -1, v156
    s_cbranch_vccnz qf_141
    v_smfmac_f32_16x16x64_bf16 v[140:143], v[120:123], v[88:95], v2
    v_smfmac_f32_16x16x64_bf16 v[144:147], v[120:123], v[104:111], v2
    s_branch q_132
q_143:
    s_waitcnt vmcnt(0)
    v_max3_u32 v156, v120, v121, v122
    v_max_u32 v156, v156, v123
    v_cmp_eq_u32 vcc, -1, v156
    s_cbranch_vccnz qf_144
    v_smfmac_f32_16x16x64_bf16 v[140:143], v[120:123], v[88:95], v2
    v_smfmac_f32_16x16x64_bf16 v[144:147], v[120:123], v[104:111], v2
    s_branch qdone_115
q_145:
    s_waitcnt vmcnt(1)
    v_max3_u32 v156, v124, v125, v126
    v_max_u32 v156, v156, v127
    v_cmp_eq_u32 vcc, -1, v156
    s_cbranch_vccnz qf_146
    v_smfmac_f32_16x16x64_bf16 v[140:143], v[124:127], v[96:103], v2
    v_smfmac_f32_16x16x64_bf16 v[144:147], v[124:127], v[112:119], v2
    s_branch q_132
q_148:
    s_waitcnt vmcnt(2)
    v_max3_u32 v156, v124, v125, v126
    v_max_u32 v156, v156, v127
    v_cmp_eq_u32 vcc, -1, v156
    s_cbranch_vccnz qf_149
    v_smfmac_f32_16x16x64_bf16 v[140:143], v[124:127], v[96:103], v2
    v_smfmac_f32_16x16x64_bf16 v[144:147], v[124:127], v[112:119], v2
    s_branch q_143
q_151:
    s_waitcnt vmcnt(1)
    v_max3_u32 v156, v128, v129, v130
    v_max_u32 v156, v156, v131
    v_cmp_eq_u32 vcc, -1, v156
    s_cbranch_vccnz qf_152
    v_smfmac_f32_16x16x64_bf16 v[140:143], v[128:131], v[132:139], v3
    v_smfmac_f32_16x16x64_bf16 v[144:147], v[128:131], v[132:139], v160
    s_branch q_143
q_154:
    s_waitcnt vmcnt(1)
    v_max3_u32 v156, v128, v129, v130
    v_max_u32 v156, v156, v131
    v_cmp_eq_u32 vcc, -1, v156
    s_cbranch_vccnz qf_155
    v_smfmac_f32_16x16x64_bf16 v[140:143], v[128:131], v[132:139], v3
    v_smfmac_f32_16x16x64_bf16 v[144:147], v[128:131], v[132:139], v160
    s_branch q_130
q_157:
    s_waitcnt vmcnt(1)
    v_max3_u32 v156, v120, v121, v122
    v_max_u32 v156, v156, v123
    v_cmp_eq_u32 vcc, -1, v156
    s_cbranch_vccnz qf_158
    v_smfmac_f32_16x16x64_bf16 v[140:143], v[120:123], v[88:95], v2
    v_smfmac_f32_16x16x64_bf16 v[144:147], v[120:123], v[104:111], v2
    s_branch q_130
q_160:
    s_waitcnt vmcnt(1)
    v_max3_u32 v156, v120, v121, v122
    v_max_u32 v156, v156, v123
    v_cmp_eq_u32 vcc, -1, v156
    s_cbranch_vccnz qf_161
    v_smfmac_f32_16x16x64_bf16 v[140:143], v[120:123], v[88:95], v2
    v_smfmac_f32_16x16x64_bf16 v[144:147], v[120:123], v[104:111], v2
    s_branch q_132
q_163:
    s_waitcnt vmcnt(1)
    v_max3_u32 v156, v124, v125, v126
    v_max_u32 v156, v156, v127
    v_cmp_eq_u32 vcc, -1, v156
    s_cbranch_vccnz qf_164
    v_smfmac_f32_16x16x64_bf16 v[140:143], v[124:127], v[96:103], v2
    v_smfmac_f32_16x16x64_bf16 v[144:147], v[124:127], v[112:119], v2
    s_branch q_143
qf_119:
    buffer_load_dwordx4 v[124:127], v1, s[4:7], s24 offen offset:1024 sc1
    s_add_u32 s22, s22, 1
    s_cmp_gt_u32 s22, 196608
    s_cbranch_scc1 M_exit
    s_branch q_128
qf_121:
    buffer_load_dwordx4 v[128:131], v1, s[4:7], s25 offen sc1
    s_add_u32 s22, s22, 1
    s_cmp_gt_u32 s22, 196608
    s_cbranch_scc1 M_exit
    s_branch q_132
qf_125:
    buffer_load_dwordx4 v[128:131], v1, s[4:7], s25 offen sc1
    s_add_u32 s22, s22, 1
    s_cmp_gt_u32 s22, 196608
    s_cbranch_scc1 M_exit
    s_branch q_140
qf_127:
    buffer_load_dwordx4 v[120:123], v1, s[4:7], s24 offen sc1
    s_add_u32 s22, s22, 1
    s_cmp_gt_u32 s22, 196608
    s_cbranch_scc1 M_exit
    s_branch q_143
qf_129:
    buffer_load_dwordx4 v[128:131], v1, s[4:7], s25 offen sc1
    s_add_u32 s22, s22, 1
    s_cmp_gt_u32 s22, 196608
    s_cbranch_scc1 M_exit
    s_branch q_145
qf_131:
    buffer_load_dwordx4 v[124:127], v1, s[4:7], s24 offen offset:1024 sc1
    s_add_u32 s22, s22, 1
    s_cmp_gt_u32 s22, 196608
    s_cbranch_scc1 M_exit
    s_branch q_130
qf_133:
    buffer_load_dwordx4 v[128:131], v1, s[4:7], s25 offen sc1
    s_add_u32 s22, s22, 1
    s_cmp_gt_u32 s22, 196608
    s_cbranch_scc1 M_exit
    s_branch q_132
qf_137:
    buffer_load_dwordx4 v[120:123], v1, s[4:7], s24 offen sc1
    s_add_u32 s22, s22, 1
    s_cmp_gt_u32 s22, 196608
    s_cbranch_scc1 M_exit
    s_branch q_148
qf_139:
    buffer_load_dwordx4 v[124:127], v1, s[4:7], s24 offen offset:1024 sc1
    s_add_u32 s22, s22, 1
    s_cmp_gt_u32 s22, 196608
    s_cbranch_scc1 M_exit
    s_branch q_130
qf_141:
    buffer_load_dwordx4 v[120:123], v1, s[4:7], s24 offen sc1
    s_add_u32 s22, s22, 1
    s_cmp_gt_u32 s22, 196608
    s_cbranch_scc1 M_exit
    s_branch q_151
qf_144:
    buffer_load_dwordx4 v[120:123], v1, s[4:7], s24 offen sc1
    s_add_u32 s22, s22, 1
    s_cmp_gt_u32 s22, 196608
    s_cbranch_scc1 M_exit
    s_branch q_143
qf_146:
    buffer_load_dwordx4 v[124:127], v1, s[4:7], s24 offen offset:1024 sc1
    s_add_u32 s22, s22, 1
    s_cmp_gt_u32 s22, 196608
    s_cbranch_scc1 M_exit
    s_branch q_154
qf_149:
    buffer_load_dwordx4 v[124:127], v1, s[4:7], s24 offen offset:1024 sc1
    s_add_u32 s22, s22, 1
    s_cmp_gt_u32 s22, 196608
    s_cbranch_scc1 M_exit
    s_branch q_157
qf_152:
    buffer_load_dwordx4 v[128:131], v1, s[4:7], s25 offen sc1
    s_add_u32 s22, s22, 1
    s_cmp_gt_u32 s22, 196608
    s_cbranch_scc1 M_exit
    s_branch q_160
qf_155:
    buffer_load_dwordx4 v[128:131], v1, s[4:7], s25 offen sc1
    s_add_u32 s22, s22, 1
    s_cmp_gt_u32 s22, 196608
    s_cbranch_scc1 M_exit
    s_branch q_145
qf_158:
    buffer_load_dwordx4 v[120:123], v1, s[4:7], s24 offen sc1
    s_add_u32 s22, s22, 1
    s_cmp_gt_u32 s22, 196608
    s_cbranch_scc1 M_exit
    s_branch q_163
qf_161:
    buffer_load_dwordx4 v[120:123], v1, s[4:7], s24 offen sc1
    s_add_u32 s22, s22, 1
    s_cmp_gt_u32 s22, 196608
    s_cbranch_scc1 M_exit
    s_branch q_151
qf_164:
    buffer_load_dwordx4 v[124:127], v1, s[4:7], s24 offen offset:1024 sc1
    s_add_u32 s22, s22, 1
    s_cmp_gt_u32 s22, 196608
    s_cbranch_scc1 M_exit
    s_branch q_157
v_mode_111:
.p2align 8
v_loop_184:
    v_mov_b32 v140, 0
    v_mov_b32 v141, 0
    v_mov_b32 v142, 0
    v_mov_b32 v143, 0
    v_mov_b32 v144, 0
    v_mov_b32 v145, 0
    v_mov_b32 v146, 0
    v_mov_b32 v147, 0
    s_and_b32 s23, s8, 7
    s_lshl_b32 s23, s23, 13
    s_add_u32 s23, s23, 0x3100000
    s_add_u32 s26, s23, 4096
    ds_read_b128 v[64:67], v163 offset:0
    ds_read_b128 v[68:71], v163 offset:1024
    ds_read_b128 v[72:75], v163 offset:2048
    ds_read_b128 v[76:79], v163 offset:3072
    ds_read_b128 v[80:83], v163 offset:4096
    ds_read_b128 v[84:87], v163 offset:5120
    s_and_b32 s11, s8, 15
    s_mul_i32 s11, s11, 458752
    s_lshl_b32 s12, s9, 15
    s_add_u32 s11, s11, s12
    s_add_u32 s11, s11, 0x1000000
    s_add_u32 s12, s11, 16384
    s_mov_b32 s22, 0
    buffer_load_dwordx4 v[4:7], v1, s[4:7], s23 offen offset:0 sc1
poll_186:
    s_waitcnt vmcnt(0)
    buffer_load_dwordx4 v[4:7], v1, s[4:7], s23 offen offset:0 sc1
    v_max3_u32 v156, v4, v5, v6
    v_max_u32 v156, v156, v7
    v_cmp_eq_u32 vcc, -1, v156
    ds_write_b128 v1, v[4:7] offset:0
    s_add_u32 s22, s22, 1
    s_cmp_gt_u32 s22, 65536
    s_cbranch_scc1 M_exit
    s_cbranch_vccnz poll_186
pok_185:
    v_smfmac_f32_16x16x64_bf16 v[32:35], v[4:7], a[0:7], v2
    v_smfmac_f32_16x16x64_bf16 v[36:39], v[4:7], a[56:63], v2
    v_smfmac_f32_16x16x64_bf16 v[40:43], v[4:7], a[112:119], v2
    v_smfmac_f32_16x16x64_bf16 v[44:47], v[4:7], a[168:175], v2
    s_waitcnt lgkmcnt(0)
    s_barrier
    ds_read_b128 v[8:11], v1 offset:1024
    ds_read_b128 v[12:15], v1 offset:2048
    buffer_load_dwordx4 v[88:91], v1, s[4:7], s11 offen offset:0 sc1
    v_smfmac_f32_16x16x64_bf16 v[56:59], v[4:7], v[64:71], v2
    ds_read_b128 v[16:19], v1 offset:3072
    s_waitcnt lgkmcnt(2)
    v_smfmac_f32_16x16x64_bf16 v[32:35], v[8:11], a[8:15], v2
    ds_read_b128 v[20:23], v1 offset:4096
    ds_read_b128 v[64:67], v163 offset:6144
    v_smfmac_f32_16x16x64_bf16 v[36:39], v[8:11], a[64:71], v2
    ds_read_b128 v[24:27], v1 offset:5120
    ds_read_b128 v[68:71], v163 offset:7168
    v_smfmac_f32_16x16x64_bf16 v[40:43], v[8:11], a[120:127], v2
    ds_read_b128 v[28:31], v1 offset:6144
    buffer_load_dwordx4 v[92:95], v1, s[4:7], s11 offen offset:1024 sc1
    v_smfmac_f32_16x16x64_bf16 v[56:59], v[8:11], v[72:79], v2
    s_waitcnt lgkmcnt(6)
    v_smfmac_f32_16x16x64_bf16 v[32:35], v[12:15], a[16:23], v2
    ds_read_b128 v[72:75], v163 offset:8192
    v_smfmac_f32_16x16x64_bf16 v[36:39], v[12:15], a[72:79], v2
    ds_read_b128 v[76:79], v163 offset:9216
    v_smfmac_f32_16x16x64_bf16 v[40:43], v[12:15], a[128:135], v2
    buffer_load_dwordx4 v[96:99], v1, s[4:7], s11 offen offset:2048 sc1
    v_smfmac_f32_16x16x64_bf16 v[56:59], v[12:15], v[80:87], v2
    s_waitcnt lgkmcnt(7)
    v_smfmac_f32_16x16x64_bf16 v[32:35], v[16:19], a[24:31], v2
    ds_read_b128 v[80:83], v163 offset:10240
    v_smfmac_f32_16x16x64_bf16 v[36:39], v[16:19], a[80:87], v2
    ds_read_b128 v[84:87], v163 offset:11264
    v_smfmac_f32_16x16x64_bf16 v[40:43], v[16:19], a[136:143], v2
    buffer_load_dwordx4 v[100:103], v1, s[4:7], s11 offen offset:3072 sc1
    s_waitcnt lgkmcnt(5)
    v_smfmac_f32_16x16x64_bf16 v[56:59], v[16:19], v[64:71], v2
    v_smfmac_f32_16x16x64_bf16 v[32:35], v[20:23], a[32:39], v2
    ds_read_b128 v[64:67], v163 offset:12288
    v_smfmac_f32_16x16x64_bf16 v[36:39], v[20:23], a[88:95], v2
    ds_read_b128 v[68:71], v163 offset:13312
    v_smfmac_f32_16x16x64_bf16 v[40:43], v[20:23], a[144:151], v2
    buffer_load_dwordx4 v[104:107], v1, s[4:7], s12 offen offset:0 sc1
    s_waitcnt lgkmcnt(4)
    v_smfmac_f32_16x16x64_bf16 v[56:59], v[20:23], v[72:79], v2
    v_smfmac_f32_16x16x64_bf16 v[32:35], v[24:27], a[40:47], v2
    ds_read_b128 v[72:75], v163 offset:14336
    v_smfmac_f32_16x16x64_bf16 v[36:39], v[24:27], a[96:103], v2
    ds_read_b128 v[76:79], v163 offset:15360
    v_smfmac_f32_16x16x64_bf16 v[40:43], v[24:27], a[152:159], v2
    buffer_load_dwordx4 v[108:111], v1, s[4:7], s12 offen offset:1024 sc1
    s_waitcnt lgkmcnt(4)
    v_smfmac_f32_16x16x64_bf16 v[56:59], v[24:27], v[80:87], v2
    v_smfmac_f32_16x16x64_bf16 v[32:35], v[28:31], a[48:55], v2
    ds_read_b128 v[80:83], v163 offset:16384
    v_smfmac_f32_16x16x64_bf16 v[36:39], v[28:31], a[104:111], v2
    ds_read_b128 v[84:87], v163 offset:17408
    v_smfmac_f32_16x16x64_bf16 v[40:43], v[28:31], a[160:167], v2
    buffer_load_dwordx4 v[112:115], v1, s[4:7], s12 offen offset:2048 sc1
    s_waitcnt lgkmcnt(4)
    v_smfmac_f32_16x16x64_bf16 v[56:59], v[28:31], v[64:71], v2
    ds_read_b128 v[64:67], v163 offset:18432
    v_smfmac_f32_16x16x64_bf16 v[48:51], v[4:7], a[224:231], v2
    ds_read_b128 v[68:71], v163 offset:19456
    v_add_f32 v32, v32, v34
    v_smfmac_f32_16x16x64_bf16 v[52:55], v[4:7], v[200:207], v2
    buffer_load_dwordx4 v[116:119], v1, s[4:7], s12 offen offset:3072 sc1
    v_add_f32 v33, v33, v35
    s_waitcnt lgkmcnt(4)
    v_smfmac_f32_16x16x64_bf16 v[60:63], v[4:7], v[72:79], v2
    v_cvt_pk_bf16_f32 v132, v32, v33
    v_smfmac_f32_16x16x64_bf16 v[44:47], v[8:11], a[176:183], v2
    ds_read_b128 v[72:75], v163 offset:20480
    v_add_f32 v36, v36, v38
    v_smfmac_f32_16x16x64_bf16 v[48:51], v[8:11], a[232:239], v2
    ds_read_b128 v[76:79], v163 offset:21504
    v_add_f32 v37, v37, v39
    v_smfmac_f32_16x16x64_bf16 v[52:55], v[8:11], v[208:215], v2
    v_cvt_pk_bf16_f32 v134, v36, v37
    s_waitcnt lgkmcnt(4)
    v_smfmac_f32_16x16x64_bf16 v[60:63], v[8:11], v[80:87], v2
    v_add_f32 v40, v40, v42
    v_smfmac_f32_16x16x64_bf16 v[44:47], v[12:15], a[184:191], v2
    ds_read_b128 v[80:83], v163 offset:22528
    v_add_f32 v41, v41, v43
    v_smfmac_f32_16x16x64_bf16 v[48:51], v[12:15], a[240:247], v2
    ds_read_b128 v[84:87], v163 offset:23552
    v_cvt_pk_bf16_f32 v136, v40, v41
    v_smfmac_f32_16x16x64_bf16 v[52:55], v[12:15], v[216:223], v2
    v_add_f32 v56, v56, v58
    s_waitcnt lgkmcnt(4)
    v_smfmac_f32_16x16x64_bf16 v[60:63], v[12:15], v[64:71], v2
    v_add_f32 v57, v57, v59
    v_smfmac_f32_16x16x64_bf16 v[44:47], v[16:19], a[192:199], v2
    ds_read_b128 v[64:67], v163 offset:24576
    v_cvt_pk_bf16_f32 v137, v56, v57
    v_smfmac_f32_16x16x64_bf16 v[48:51], v[16:19], a[248:255], v2
    ds_read_b128 v[68:71], v163 offset:25600
    v_smfmac_f32_16x16x64_bf16 v[52:55], v[16:19], v[224:231], v2
    s_waitcnt lgkmcnt(4)
    v_smfmac_f32_16x16x64_bf16 v[60:63], v[16:19], v[72:79], v2
    v_smfmac_f32_16x16x64_bf16 v[44:47], v[20:23], a[200:207], v2
    ds_read_b128 v[72:75], v163 offset:26624
    v_smfmac_f32_16x16x64_bf16 v[48:51], v[20:23], v[176:183], v2
    ds_read_b128 v[76:79], v163 offset:27648
    v_smfmac_f32_16x16x64_bf16 v[52:55], v[20:23], v[232:239], v2
    s_waitcnt lgkmcnt(4)
    v_smfmac_f32_16x16x64_bf16 v[60:63], v[20:23], v[80:87], v2
    v_smfmac_f32_16x16x64_bf16 v[44:47], v[24:27], a[208:215], v2
    v_smfmac_f32_16x16x64_bf16 v[48:51], v[24:27], v[184:191], v2
    v_smfmac_f32_16x16x64_bf16 v[52:55], v[24:27], v[240:247], v2
    s_waitcnt lgkmcnt(2)
    v_smfmac_f32_16x16x64_bf16 v[60:63], v[24:27], v[64:71], v2
    v_smfmac_f32_16x16x64_bf16 v[44:47], v[28:31], a[216:223], v2
    v_smfmac_f32_16x16x64_bf16 v[48:51], v[28:31], v[192:199], v2
    v_smfmac_f32_16x16x64_bf16 v[52:55], v[28:31], v[248:255], v2
    s_waitcnt lgkmcnt(0)
    v_smfmac_f32_16x16x64_bf16 v[60:63], v[28:31], v[72:79], v2
    v_add_f32 v44, v44, v46
    s_and_b32 s11, s8, 3
    s_lshl_b32 s11, s11, 14
    s_add_u32 s25, s11, 0x3112000
    s_add_u32 s24, s11, 0x3110000
    s_add_u32 s11, s8, 1
    s_and_b32 s12, s11, 7
    s_lshl_b32 s12, s12, 13
    s_add_u32 s12, s12, 0x3100000
    s_mov_b32 s22, 0
    buffer_load_dwordx4 v[120:123], v1, s[4:7], s24 offen sc1
    buffer_load_dwordx4 v[124:127], v1, s[4:7], s24 offen offset:1024 sc1
    buffer_load_dwordx4 v[128:131], v1, s[4:7], s25 offen sc1
    v_add_f32 v45, v45, v47
    v_cvt_pk_bf16_f32 v138, v44, v45
    v_add_f32 v48, v48, v50
    v_add_f32 v49, v49, v51
    v_cvt_pk_bf16_f32 v133, v48, v49
    v_add_f32 v52, v52, v54
    v_add_f32 v53, v53, v55
    v_cvt_pk_bf16_f32 v135, v52, v53
    v_add_f32 v60, v60, v62
    v_add_f32 v61, v61, v63
    v_cvt_pk_bf16_f32 v139, v60, v61
    v_mov_b32 v32, 0
    v_mov_b32 v33, 0
    v_mov_b32 v34, 0
    v_mov_b32 v35, 0
    v_mov_b32 v36, 0
    v_mov_b32 v37, 0
    v_mov_b32 v38, 0
    v_mov_b32 v39, 0
    v_mov_b32 v40, 0
    v_mov_b32 v41, 0
    v_mov_b32 v42, 0
    v_mov_b32 v43, 0
    v_mov_b32 v44, 0
    v_mov_b32 v45, 0
    v_mov_b32 v46, 0
    v_mov_b32 v47, 0
    v_mov_b32 v48, 0
    v_mov_b32 v49, 0
    v_mov_b32 v50, 0
    v_mov_b32 v51, 0
    v_mov_b32 v52, 0
    v_mov_b32 v53, 0
    v_mov_b32 v54, 0
    v_mov_b32 v55, 0
    v_mov_b32 v56, 0
    v_mov_b32 v57, 0
    v_mov_b32 v58, 0
    v_mov_b32 v59, 0
    v_mov_b32 v60, 0
    v_mov_b32 v61, 0
    v_mov_b32 v62, 0
    v_mov_b32 v63, 0
q_188:
    s_waitcnt vmcnt(2)
    v_max3_u32 v156, v120, v121, v122
    v_max_u32 v156, v156, v123
    v_cmp_eq_u32 vcc, -1, v156
    buffer_load_dwordx4 v[120:123], v1, s[4:7], s24 offen sc1
    s_add_u32 s22, s22, 1
    s_cmp_gt_u32 s22, 196608
    s_cbranch_scc1 M_exit
    s_cbranch_vccnz q_189
    v_smfmac_f32_16x16x64_bf16 v[140:143], v[120:123], v[88:95], v2
    v_smfmac_f32_16x16x64_bf16 v[144:147], v[120:123], v[104:111], v2
q_190:
    s_waitcnt vmcnt(2)
    v_max3_u32 v156, v124, v125, v126
    v_max_u32 v156, v156, v127
    v_cmp_eq_u32 vcc, -1, v156
    s_cbranch_vccnz qf_191
    v_smfmac_f32_16x16x64_bf16 v[140:143], v[124:127], v[96:103], v2
    v_smfmac_f32_16x16x64_bf16 v[144:147], v[124:127], v[112:119], v2
q_192:
    s_waitcnt vmcnt(1)
    v_max3_u32 v156, v128, v129, v130
    v_max_u32 v156, v156, v131
    v_cmp_eq_u32 vcc, -1, v156
    s_cbranch_vccnz qf_193
    v_smfmac_f32_16x16x64_bf16 v[140:143], v[128:131], v[132:139], v3
    v_smfmac_f32_16x16x64_bf16 v[144:147], v[128:131], v[132:139], v160
qdone_187:
    s_nop 6
    v_add_f32 v148, v140, v142
    v_add_f32 v150, v141, v143
    v_add_f32 v149, v144, v146
    v_add_f32 v151, v145, v147
    ds_write2_b64 v157, v[148:149], v[150:151] offset0:0 offset1:16
    s_waitcnt lgkmcnt(0)
    s_barrier
    ds_read_b64 v[148:149], v158 offset:8192
    ds_read_b64 v[150:151], v158 offset:9216
    ds_read_b64 v[152:153], v158 offset:10240
    ds_read_b64 v[154:155], v158 offset:11264
    s_waitcnt lgkmcnt(2)
    v_pk_add_f32 v[148:149], v[148:149], v[150:151]
    s_waitcnt lgkmcnt(1)
    v_pk_add_f32 v[148:149], v[148:149], v[152:153]
    s_waitcnt lgkmcnt(0)
    v_pk_add_f32 v[148:149], v[148:149], v[154:155]
    v_cvt_pk_bf16_f32 v164, v148, v149
    v_min_u32 v164, -2, v164
    buffer_store_dword v164, v159, s[4:7], s12 offen offset:0 sc1
    s_xor_b32 s12, s12, 0x8000
    buffer_store_dword v162, v159, s[4:7], s12 offen offset:0 sc1
    s_add_u32 s13, s9, 32
    s_add_u32 s8, s8, 1
    s_cmp_lt_u32 s8, 63
    s_cbranch_scc1 v_loop_184
    s_mov_b32 s13, 0x30fe000
    buffer_store_dword v164, v159, s[4:7], s13 offen offset:0 sc1
    s_branch M_exit
q_189:
    s_waitcnt vmcnt(2)
    v_max3_u32 v156, v124, v125, v126
    v_max_u32 v156, v156, v127
    v_cmp_eq_u32 vcc, -1, v156
    buffer_load_dwordx4 v[124:127], v1, s[4:7], s24 offen offset:1024 sc1
    s_add_u32 s22, s22, 1
    s_cmp_gt_u32 s22, 196608
    s_cbranch_scc1 M_exit
    s_cbranch_vccnz q_195
    v_smfmac_f32_16x16x64_bf16 v[140:143], v[124:127], v[96:103], v2
    v_smfmac_f32_16x16x64_bf16 v[144:147], v[124:127], v[112:119], v2
q_196:
    s_waitcnt vmcnt(2)
    v_max3_u32 v156, v128, v129, v130
    v_max_u32 v156, v156, v131
    v_cmp_eq_u32 vcc, -1, v156
    s_cbranch_vccnz qf_197
    v_smfmac_f32_16x16x64_bf16 v[140:143], v[128:131], v[132:139], v3
    v_smfmac_f32_16x16x64_bf16 v[144:147], v[128:131], v[132:139], v160
q_198:
    s_waitcnt vmcnt(1)
    v_max3_u32 v156, v120, v121, v122
    v_max_u32 v156, v156, v123
    v_cmp_eq_u32 vcc, -1, v156
    s_cbranch_vccnz qf_199
    v_smfmac_f32_16x16x64_bf16 v[140:143], v[120:123], v[88:95], v2
    v_smfmac_f32_16x16x64_bf16 v[144:147], v[120:123], v[104:111], v2
    s_branch qdone_187
q_200:
    s_waitcnt vmcnt(2)
    v_max3_u32 v156, v128, v129, v130
    v_max_u32 v156, v156, v131
    v_cmp_eq_u32 vcc, -1, v156
    s_cbranch_vccnz qf_201
    v_smfmac_f32_16x16x64_bf16 v[140:143], v[128:131], v[132:139], v3
    v_smfmac_f32_16x16x64_bf16 v[144:147], v[128:131], v[132:139], v160
q_202:
    s_waitcnt vmcnt(0)
    v_max3_u32 v156, v124, v125, v126
    v_max_u32 v156, v156, v127
    v_cmp_eq_u32 vcc, -1, v156
    s_cbranch_vccnz qf_203
    v_smfmac_f32_16x16x64_bf16 v[140:143], v[124:127], v[96:103], v2
    v_smfmac_f32_16x16x64_bf16 v[144:147], v[124:127], v[112:119], v2
    s_branch qdone_187
q_204:
    s_waitcnt vmcnt(0)
    v_max3_u32 v156, v128, v129, v130
    v_max_u32 v156, v156, v131
    v_cmp_eq_u32 vcc, -1, v156
    s_cbranch_vccnz qf_205
    v_smfmac_f32_16x16x64_bf16 v[140:143], v[128:131], v[132:139], v3
    v_smfmac_f32_16x16x64_bf16 v[144:147], v[128:131], v[132:139], v160
    s_branch qdone_187
q_195:
    s_waitcnt vmcnt(2)
    v_max3_u32 v156, v128, v129, v130
    v_max_u32 v156, v156, v131
    v_cmp_eq_u32 vcc, -1, v156
    buffer_load_dwordx4 v[128:131], v1, s[4:7], s25 offen sc1
    s_add_u32 s22, s22, 1
    s_cmp_gt_u32 s22, 196608
    s_cbranch_scc1 M_exit
    s_cbranch_vccnz q_188
    v_smfmac_f32_16x16x64_bf16 v[140:143], v[128:131], v[132:139], v3
    v_smfmac_f32_16x16x64_bf16 v[144:147], v[128:131], v[132:139], v160
q_208:
    s_waitcnt vmcnt(2)
    v_max3_u32 v156, v120, v121, v122
    v_max_u32 v156, v156, v123
    v_cmp_eq_u32 vcc, -1, v156
    s_cbranch_vccnz qf_209
    v_smfmac_f32_16x16x64_bf16 v[140:143], v[120:123], v[88:95], v2
    v_smfmac_f32_16x16x64_bf16 v[144:147], v[120:123], v[104:111], v2
q_210:
    s_waitcnt vmcnt(1)
    v_max3_u32 v156, v124, v125, v126
    v_max_u32 v156, v156, v127
    v_cmp_eq_u32 vcc, -1, v156
    s_cbranch_vccnz qf_211
    v_smfmac_f32_16x16x64_bf16 v[140:143], v[124:127], v[96:103], v2
    v_smfmac_f32_16x16x64_bf16 v[144:147], v[124:127], v[112:119], v2
    s_branch qdone_187
q_212:
    s_waitcnt vmcnt(2)
    v_max3_u32 v156, v120, v121, v122
    v_max_u32 v156, v156, v123
    v_cmp_eq_u32 vcc, -1, v156
    s_cbranch_vccnz qf_213
    v_smfmac_f32_16x16x64_bf16 v[140:143], v[120:123], v[88:95], v2
    v_smfmac_f32_16x16x64_bf16 v[144:147], v[120:123], v[104:111], v2
    s_branch q_204
q_215:
    s_waitcnt vmcnt(0)
    v_max3_u32 v156, v120, v121, v122
    v_max_u32 v156, v156, v123
    v_cmp_eq_u32 vcc, -1, v156
    s_cbranch_vccnz qf_216
    v_smfmac_f32_16x16x64_bf16 v[140:143], v[120:123], v[88:95], v2
    v_smfmac_f32_16x16x64_bf16 v[144:147], v[120:123], v[104:111], v2
    s_branch qdone_187
q_217:
    s_waitcnt vmcnt(1)
    v_max3_u32 v156, v124, v125, v126
    v_max_u32 v156, v156, v127
    v_cmp_eq_u32 vcc, -1, v156
    s_cbranch_vccnz qf_218
    v_smfmac_f32_16x16x64_bf16 v[140:143], v[124:127], v[96:103], v2
    v_smfmac_f32_16x16x64_bf16 v[144:147], v[124:127], v[112:119], v2
    s_branch q_204
q_220:
    s_waitcnt vmcnt(2)
    v_max3_u32 v156, v124, v125, v126
    v_max_u32 v156, v156, v127
    v_cmp_eq_u32 vcc, -1, v156
    s_cbranch_vccnz qf_221
    v_smfmac_f32_16x16x64_bf16 v[140:143], v[124:127], v[96:103], v2
    v_smfmac_f32_16x16x64_bf16 v[144:147], v[124:127], v[112:119], v2
    s_branch q_215
q_223:
    s_waitcnt vmcnt(1)
    v_max3_u32 v156, v128, v129, v130
    v_max_u32 v156, v156, v131
    v_cmp_eq_u32 vcc, -1, v156
    s_cbranch_vccnz qf_224
    v_smfmac_f32_16x16x64_bf16 v[140:143], v[128:131], v[132:139], v3
    v_smfmac_f32_16x16x64_bf16 v[144:147], v[128:131], v[132:139], v160
    s_branch q_215
q_226:
    s_waitcnt vmcnt(1)
    v_max3_u32 v156, v128, v129, v130
    v_max_u32 v156, v156, v131
    v_cmp_eq_u32 vcc, -1, v156
    s_cbranch_vccnz qf_227
    v_smfmac_f32_16x16x64_bf16 v[140:143], v[128:131], v[132:139], v3
    v_smfmac_f32_16x16x64_bf16 v[144:147], v[128:131], v[132:139], v160
    s_branch q_202
q_229:
    s_waitcnt vmcnt(1)
    v_max3_u32 v156, v120, v121, v122
    v_max_u32 v156, v156, v123
    v_cmp_eq_u32 vcc, -1, v156
    s_cbranch_vccnz qf_230
    v_smfmac_f32_16x16x64_bf16 v[140:143], v[120:123], v[88:95], v2
    v_smfmac_f32_16x16x64_bf16 v[144:147], v[120:123], v[104:111], v2
    s_branch q_202
q_232:
    s_waitcnt vmcnt(1)
    v_max3_u32 v156, v120, v121, v122
    v_max_u32 v156, v156, v123
    v_cmp_eq_u32 vcc, -1, v156
    s_cbranch_vccnz qf_233
    v_smfmac_f32_16x16x64_bf16 v[140:143], v[120:123], v[88:95], v2
    v_smfmac_f32_16x16x64_bf16 v[144:147], v[120:123], v[104:111], v2
    s_branch q_204
q_235:
    s_waitcnt vmcnt(1)
    v_max3_u32 v156, v124, v125, v126
    v_max_u32 v156, v156, v127
    v_cmp_eq_u32 vcc, -1, v156
    s_cbranch_vccnz qf_236
    v_smfmac_f32_16x16x64_bf16 v[140:143], v[124:127], v[96:103], v2
    v_smfmac_f32_16x16x64_bf16 v[144:147], v[124:127], v[112:119], v2
    s_branch q_215
qf_191:
    buffer_load_dwordx4 v[124:127], v1, s[4:7], s24 offen offset:1024 sc1
    s_add_u32 s22, s22, 1
    s_cmp_gt_u32 s22, 196608
    s_cbranch_scc1 M_exit
    s_branch q_200
qf_193:
    buffer_load_dwordx4 v[128:131], v1, s[4:7], s25 offen sc1
    s_add_u32 s22, s22, 1
    s_cmp_gt_u32 s22, 196608
    s_cbranch_scc1 M_exit
    s_branch q_204
qf_197:
    buffer_load_dwordx4 v[128:131], v1, s[4:7], s25 offen sc1
    s_add_u32 s22, s22, 1
    s_cmp_gt_u32 s22, 196608
    s_cbranch_scc1 M_exit
    s_branch q_212
qf_199:
    buffer_load_dwordx4 v[120:123], v1, s[4:7], s24 offen sc1
    s_add_u32 s22, s22, 1
    s_cmp_gt_u32 s22, 196608
    s_cbranch_scc1 M_exit
    s_branch q_215
qf_201:
    buffer_load_dwordx4 v[128:131], v1, s[4:7], s25 offen sc1
    s_add_u32 s22, s22, 1
    s_cmp_gt_u32 s22, 196608
    s_cbranch_scc1 M_exit
    s_branch q_217
qf_203:
    buffer_load_dwordx4 v[124:127], v1, s[4:7], s24 offen offset:1024 sc1
    s_add_u32 s22, s22, 1
    s_cmp_gt_u32 s22, 196608
    s_cbranch_scc1 M_exit
    s_branch q_202
qf_205:
    buffer_load_dwordx4 v[128:131], v1, s[4:7], s25 offen sc1
    s_add_u32 s22, s22, 1
    s_cmp_gt_u32 s22, 196608
    s_cbranch_scc1 M_exit
    s_branch q_204
qf_209:
    buffer_load_dwordx4 v[120:123], v1, s[4:7], s24 offen sc1
    s_add_u32 s22, s22, 1
    s_cmp_gt_u32 s22, 196608
    s_cbranch_scc1 M_exit
    s_branch q_220
qf_211:
    buffer_load_dwordx4 v[124:127], v1, s[4:7], s24 offen offset:1024 sc1
    s_add_u32 s22, s22, 1
    s_cmp_gt_u32 s22, 196608
    s_cbranch_scc1 M_exit
    s_branch q_202
qf_213:
    buffer_load_dwordx4 v[120:123], v1, s[4:7], s24 offen sc1
    s_add_u32 s22, s22, 1
    s_cmp_gt_u32 s22, 196608
    s_cbranch_scc1 M_exit
    s_branch q_223
qf_216:
    buffer_load_dwordx4 v[120:123], v1, s[4:7], s24 offen sc1
    s_add_u32 s22, s22, 1
    s_cmp_gt_u32 s22, 196608
    s_cbranch_scc1 M_exit
    s_branch q_215
qf_218:
    buffer_load_dwordx4 v[124:127], v1, s[4:7], s24 offen offset:1024 sc1
    s_add_u32 s22, s22, 1
    s_cmp_gt_u32 s22, 196608
    s_cbranch_scc1 M_exit
    s_branch q_226
qf_221:
    buffer_load_dwordx4 v[124:127], v1, s[4:7], s24 offen offset:1024 sc1
    s_add_u32 s22, s22, 1
    s_cmp_gt_u32 s22, 196608
    s_cbranch_scc1 M_exit
    s_branch q_229
qf_224:
    buffer_load_dwordx4 v[128:131], v1, s[4:7], s25 offen sc1
    s_add_u32 s22, s22, 1
    s_cmp_gt_u32 s22, 196608
    s_cbranch_scc1 M_exit
    s_branch q_232
qf_227:
    buffer_load_dwordx4 v[128:131], v1, s[4:7], s25 offen sc1
    s_add_u32 s22, s22, 1
    s_cmp_gt_u32 s22, 196608
    s_cbranch_scc1 M_exit
    s_branch q_217
qf_230:
    buffer_load_dwordx4 v[120:123], v1, s[4:7], s24 offen sc1
    s_add_u32 s22, s22, 1
    s_cmp_gt_u32 s22, 196608
    s_cbranch_scc1 M_exit
    s_branch q_235
qf_233:
    buffer_load_dwordx4 v[120:123], v1, s[4:7], s24 offen sc1
    s_add_u32 s22, s22, 1
    s_cmp_gt_u32 s22, 196608
    s_cbranch_scc1 M_exit
    s_branch q_223
qf_236:
    buffer_load_dwordx4 v[124:127], v1, s[4:7], s24 offen offset:1024 sc1
    s_add_u32 s22, s22, 1
    s_cmp_gt_u32 s22, 196608
    s_cbranch_scc1 M_exit
    s_branch q_229
v_w1_100:
    v_and_b32 v0, 63, v0
    v_lshlrev_b32 v1, 4, v0
    v_and_b32 v164, 2, v0
    v_cmp_eq_u32 s[20:21], 0, v164
    v_mov_b32 v2, 0xeeee
    v_mov_b32 v164, 0x4444
    v_cndmask_b32 v2, v2, v164, s[20:21]
    v_and_b32 v168, 16, v1
    v_mov_b32 v166, 0
    v_mov_b32 v3, 0x1111
    v_mov_b32 v164, 0x4444
    v_cndmask_b32 v3, v3, v164, s[20:21]
    v_mov_b32 v160, 0xbbbb
    v_mov_b32 v164, 0xeeee
    v_cndmask_b32 v160, v160, v164, s[20:21]
    v_mov_b32 v162, -1
    v_add_u32 v163, 40960, v1
    v_bfe_u32 v164, v0, 1, 2
    v_lshlrev_b32 v157, 2, v164
    v_bfe_u32 v164, v0, 3, 1
    v_lshl_add_u32 v157, v164, 8, v157
    v_bfe_u32 v164, v0, 4, 1
    v_lshl_add_u32 v157, v164, 7, v157
    v_bfe_u32 v164, v0, 0, 1
    v_lshl_add_u32 v157, v164, 5, v157
    v_bfe_u32 v164, v0, 5, 1
    v_lshl_add_u32 v157, v164, 4, v157
    v_lshlrev_b32 v157, 1, v157
    v_add_u32 v157, 9216, v157
    v_lshlrev_b32 v158, 3, v0
    s_lshl_b32 s11, s9, 9
    v_lshlrev_b32 v159, 2, v0
    v_add_u32 v159, s11, v159
    s_sleep 30
    s_lshl_b32 s11, s10, 8
    s_add_u32 s11, s11, 0x3b02400
    v_min_u32 v4, 15, v0
    v_lshlrev_b32 v4, 4, v4
    s_mov_b32 s22, 0
wt_258:
    buffer_load_dwordx4 v[32:35], v4, s[4:7], s11 offen offset:0 sc1
    s_waitcnt vmcnt(0)
    v_xor_b32 v32, s80, v32
    v_xor_b32 v33, s81, v33
    v_and_b32 v33, -16, v33
    v_xor_b32 v34, s80, v34
    v_xor_b32 v35, s81, v35
    v_and_b32 v35, -16, v35
    v_or3_b32 v32, v32, v33, v34
    v_or_b32 v32, v32, v35
    v_cmp_ne_u32 vcc, 0, v32
    s_cbranch_vccz wtok_259
    s_add_u32 s22, s22, 1
    s_cmp_gt_u32 s22, 65536
    s_cbranch_scc1 M_exit
    s_sleep 16
    s_branch wt_258
wtok_259:
    s_mul_i32 s11, s9, 458752
    s_mov_b32 m0, 40960
    s_add_u32 s12, s11, 0x94d000
    buffer_load_dwordx4 v1, s[4:7], s12 offen offset:0 sc1 lds
    buffer_load_dwordx4 v1, s[4:7], s12 offen offset:1024 sc1 lds
    buffer_load_dwordx4 v1, s[4:7], s12 offen offset:2048 sc1 lds
    buffer_load_dwordx4 v1, s[4:7], s12 offen offset:3072 sc1 lds
    s_mov_b32 m0, 45056
    s_add_u32 s12, s11, 0x94e000
    buffer_load_dwordx4 v1, s[4:7], s12 offen offset:0 sc1 lds
    buffer_load_dwordx4 v1, s[4:7], s12 offen offset:1024 sc1 lds
    buffer_load_dwordx4 v1, s[4:7], s12 offen offset:2048 sc1 lds
    buffer_load_dwordx4 v1, s[4:7], s12 offen offset:3072 sc1 lds
    s_mov_b32 m0, 49152
    s_add_u32 s12, s11, 0x94f000
    buffer_load_dwordx4 v1, s[4:7], s12 offen offset:0 sc1 lds
    buffer_load_dwordx4 v1, s[4:7], s12 offen offset:1024 sc1 lds
    buffer_load_dwordx4 v1, s[4:7], s12 offen offset:2048 sc1 lds
    buffer_load_dwordx4 v1, s[4:7], s12 offen offset:3072 sc1 lds
    s_mov_b32 m0, 53248
    s_add_u32 s12, s11, 0x950000
    buffer_load_dwordx4 v1, s[4:7], s12 offen offset:0 sc1 lds
    buffer_load_dwordx4 v1, s[4:7], s12 offen offset:1024 sc1 lds
    buffer_load_dwordx4 v1, s[4:7], s12 offen offset:2048 sc1 lds
    buffer_load_dwordx4 v1, s[4:7], s12 offen offset:3072 sc1 lds
    s_mov_b32 m0, 57344
    s_add_u32 s12, s11, 0x951000
    buffer_load_dwordx4 v1, s[4:7], s12 offen offset:0 sc1 lds
    buffer_load_dwordx4 v1, s[4:7], s12 offen offset:1024 sc1 lds
    buffer_load_dwordx4 v1, s[4:7], s12 offen offset:2048 sc1 lds
    buffer_load_dwordx4 v1, s[4:7], s12 offen offset:3072 sc1 lds
    s_mov_b32 m0, 61440
    s_add_u32 s12, s11, 0x952000
    buffer_load_dwordx4 v1, s[4:7], s12 offen offset:0 sc1 lds
    buffer_load_dwordx4 v1, s[4:7], s12 offen offset:1024 sc1 lds
    buffer_load_dwordx4 v1, s[4:7], s12 offen offset:2048 sc1 lds
    buffer_load_dwordx4 v1, s[4:7], s12 offen offset:3072 sc1 lds
    s_mov_b32 m0, 65536
    s_add_u32 s12, s11, 0x953000
    buffer_load_dwordx4 v1, s[4:7], s12 offen offset:0 sc1 lds
    buffer_load_dwordx4 v1, s[4:7], s12 offen offset:1024 sc1 lds
    buffer_load_dwordx4 v1, s[4:7], s12 offen offset:2048 sc1 lds
    buffer_load_dwordx4 v1, s[4:7], s12 offen offset:3072 sc1 lds
    s_mov_b32 s25, s11
    s_lshl_b32 s29, s9, 5
    s_add_u32 s29, s29, 0x3b00000
    s_add_u32 s12, s25, 0x90e000
    s_add_u32 s14, s12, 0
    buffer_load_dwordx4 a[0:3], v1, s[4:7], s14 offen offset:0 sc1
    buffer_load_dwordx4 a[4:7], v1, s[4:7], s14 offen offset:1024 sc1
    buffer_load_dwordx4 a[8:11], v1, s[4:7], s14 offen offset:2048 sc1
    buffer_load_dwordx4 a[12:15], v1, s[4:7], s14 offen offset:3072 sc1
    s_add_u32 s14, s12, 4096
    buffer_load_dwordx4 a[16:19], v1, s[4:7], s14 offen offset:0 sc1
    buffer_load_dwordx4 a[20:23], v1, s[4:7], s14 offen offset:1024 sc1
    buffer_load_dwordx4 a[24:27], v1, s[4:7], s14 offen offset:2048 sc1
    buffer_load_dwordx4 a[28:31], v1, s[4:7], s14 offen offset:3072 sc1
    s_add_u32 s14, s12, 8192
    buffer_load_dwordx4 a[32:35], v1, s[4:7], s14 offen offset:0 sc1
    buffer_load_dwordx4 a[36:39], v1, s[4:7], s14 offen offset:1024 sc1
    buffer_load_dwordx4 a[40:43], v1, s[4:7], s14 offen offset:2048 sc1
    buffer_load_dwordx4 a[44:47], v1, s[4:7], s14 offen offset:3072 sc1
    s_add_u32 s14, s12, 12288
    buffer_load_dwordx4 a[48:51], v1, s[4:7], s14 offen offset:0 sc1
    buffer_load_dwordx4 a[52:55], v1, s[4:7], s14 offen offset:1024 sc1
    s_add_u32 s12, s25, 0x911800
    s_add_u32 s14, s12, 0
    buffer_load_dwordx4 a[56:59], v1, s[4:7], s14 offen offset:0 sc1
    buffer_load_dwordx4 a[60:63], v1, s[4:7], s14 offen offset:1024 sc1
    buffer_load_dwordx4 a[64:67], v1, s[4:7], s14 offen offset:2048 sc1
    buffer_load_dwordx4 a[68:71], v1, s[4:7], s14 offen offset:3072 sc1
    s_add_u32 s14, s12, 4096
    buffer_load_dwordx4 a[72:75], v1, s[4:7], s14 offen offset:0 sc1
    buffer_load_dwordx4 a[76:79], v1, s[4:7], s14 offen offset:1024 sc1
    buffer_load_dwordx4 a[80:83], v1, s[4:7], s14 offen offset:2048 sc1
    buffer_load_dwordx4 a[84:87], v1, s[4:7], s14 offen offset:3072 sc1
    s_add_u32 s14, s12, 8192
    buffer_load_dwordx4 a[88:91], v1, s[4:7], s14 offen offset:0 sc1
    buffer_load_dwordx4 a[92:95], v1, s[4:7], s14 offen offset:1024 sc1
    buffer_load_dwordx4 a[96:99], v1, s[4:7], s14 offen offset:2048 sc1
    buffer_load_dwordx4 a[100:103], v1, s[4:7], s14 offen offset:3072 sc1
    s_add_u32 s14, s12, 12288
    buffer_load_dwordx4 a[104:107], v1, s[4:7], s14 offen offset:0 sc1
    buffer_load_dwordx4 a[108:111], v1, s[4:7], s14 offen offset:1024 sc1
    s_waitcnt vmcnt(46)
    s_add_u32 s12, s25, 0x915000
    s_add_u32 s14, s12, 0
    buffer_load_dwordx4 a[112:115], v1, s[4:7], s14 offen offset:0 sc1
    buffer_load_dwordx4 a[116:119], v1, s[4:7], s14 offen offset:1024 sc1
    buffer_load_dwordx4 a[120:123], v1, s[4:7], s14 offen offset:2048 sc1
    buffer_load_dwordx4 a[124:127], v1, s[4:7], s14 offen offset:3072 sc1
    s_add_u32 s14, s12, 4096
    buffer_load_dwordx4 a[128:131], v1, s[4:7], s14 offen offset:0 sc1
    buffer_load_dwordx4 a[132:135], v1, s[4:7], s14 offen offset:1024 sc1
    buffer_load_dwordx4 a[136:139], v1, s[4:7], s14 offen offset:2048 sc1
    buffer_load_dwordx4 a[140:143], v1, s[4:7], s14 offen offset:3072 sc1
    s_add_u32 s14, s12, 8192
    buffer_load_dwordx4 a[144:147], v1, s[4:7], s14 offen offset:0 sc1
    buffer_load_dwordx4 a[148:151], v1, s[4:7], s14 offen offset:1024 sc1
    buffer_load_dwordx4 a[152:155], v1, s[4:7], s14 offen offset:2048 sc1
    buffer_load_dwordx4 a[156:159], v1, s[4:7], s14 offen offset:3072 sc1
    s_add_u32 s14, s12, 12288
    buffer_load_dwordx4 a[160:163], v1, s[4:7], s14 offen offset:0 sc1
    buffer_load_dwordx4 a[164:167], v1, s[4:7], s14 offen offset:1024 sc1
    s_waitcnt vmcnt(46)
    s_mov_b32 s11, 0x3b02000
    v_min_u32 v4, 63, v0
    v_lshlrev_b32 v4, 4, v4
    s_mov_b32 s22, 0
wt_260:
    buffer_load_dwordx4 v[32:35], v4, s[4:7], s11 offen offset:0 sc1
    buffer_load_dwordx4 v[36:39], v4, s[4:7], s11 offen offset:1024 sc1
    s_waitcnt vmcnt(0)
    v_xor_b32 v32, s80, v32
    v_xor_b32 v33, s81, v33
    v_and_b32 v33, -16, v33
    v_xor_b32 v34, s80, v34
    v_xor_b32 v35, s81, v35
    v_and_b32 v35, -16, v35
    v_xor_b32 v36, s80, v36
    v_xor_b32 v37, s81, v37
    v_and_b32 v37, -16, v37
    v_xor_b32 v38, s80, v38
    v_xor_b32 v39, s81, v39
    v_and_b32 v39, -16, v39
    v_or3_b32 v32, v32, v33, v34
    v_or_b32 v32, v32, v35
    v_or3_b32 v32, v32, v36, v37
    v_or3_b32 v32, v32, v38, v39
    v_cmp_ne_u32 vcc, 0, v32
    s_cbranch_vccz wtok_261
    s_add_u32 s22, s22, 1
    s_cmp_gt_u32 s22, 65536
    s_cbranch_scc1 M_exit
    s_sleep 16
    s_branch wt_260
wtok_261:
    s_mov_b32 s30, 0
    s_getreg_b32 s27, hwreg(HW_REG_XCC_ID, 0, 4)
    v_min_u32 v165, 31, v0
    v_lshlrev_b32 v165, 3, v165
    s_mov_b32 s11, 0x3b02000
    buffer_load_dword v164, v165, s[4:7], s11 offen offset:4 sc1
    s_waitcnt vmcnt(0)
    v_and_b32 v164, 15, v164
    v_cmp_ne_u32 vcc, s27, v164
    s_cbranch_vccnz mf_262
    s_mov_b32 s30, 1
mf_262:
    s_add_u32 s12, s25, 0x918800
    s_add_u32 s14, s12, 0
    buffer_load_dwordx4 a[168:171], v1, s[4:7], s14 offen offset:0 sc1
    buffer_load_dwordx4 a[172:175], v1, s[4:7], s14 offen offset:1024 sc1
    buffer_load_dwordx4 a[176:179], v1, s[4:7], s14 offen offset:2048 sc1
    buffer_load_dwordx4 a[180:183], v1, s[4:7], s14 offen offset:3072 sc1
    s_add_u32 s14, s12, 4096
    buffer_load_dwordx4 a[184:187], v1, s[4:7], s14 offen offset:0 sc1
    buffer_load_dwordx4 a[188:191], v1, s[4:7], s14 offen offset:1024 sc1
    buffer_load_dwordx4 a[192:195], v1, s[4:7], s14 offen offset:2048 sc1
    buffer_load_dwordx4 a[196:199], v1, s[4:7], s14 offen offset:3072 sc1
    s_add_u32 s14, s12, 8192
    buffer_load_dwordx4 a[200:203], v1, s[4:7], s14 offen offset:0 sc1
    buffer_load_dwordx4 a[204:207], v1, s[4:7], s14 offen offset:1024 sc1
    buffer_load_dwordx4 a[208:211], v1, s[4:7], s14 offen offset:2048 sc1
    buffer_load_dwordx4 a[212:215], v1, s[4:7], s14 offen offset:3072 sc1
    s_add_u32 s14, s12, 12288
    buffer_load_dwordx4 a[216:219], v1, s[4:7], s14 offen offset:0 sc1
    buffer_load_dwordx4 a[220:223], v1, s[4:7], s14 offen offset:1024 sc1
    s_waitcnt vmcnt(46)
    s_add_u32 s12, s25, 0x946000
    s_add_u32 s14, s12, 0
    buffer_load_dwordx4 a[224:227], v1, s[4:7], s14 offen offset:0 sc1
    buffer_load_dwordx4 a[228:231], v1, s[4:7], s14 offen offset:1024 sc1
    buffer_load_dwordx4 a[232:235], v1, s[4:7], s14 offen offset:2048 sc1
    buffer_load_dwordx4 a[236:239], v1, s[4:7], s14 offen offset:3072 sc1
    s_add_u32 s14, s12, 4096
    buffer_load_dwordx4 a[240:243], v1, s[4:7], s14 offen offset:0 sc1
    buffer_load_dwordx4 a[244:247], v1, s[4:7], s14 offen offset:1024 sc1
    buffer_load_dwordx4 a[248:251], v1, s[4:7], s14 offen offset:2048 sc1
    buffer_load_dwordx4 a[252:255], v1, s[4:7], s14 offen offset:3072 sc1
    s_add_u32 s14, s12, 8192
    buffer_load_dwordx4 v[176:179], v1, s[4:7], s14 offen offset:0 sc1
    buffer_load_dwordx4 v[180:183], v1, s[4:7], s14 offen offset:1024 sc1
    buffer_load_dwordx4 v[184:187], v1, s[4:7], s14 offen offset:2048 sc1
    buffer_load_dwordx4 v[188:191], v1, s[4:7], s14 offen offset:3072 sc1
    s_add_u32 s14, s12, 12288
    buffer_load_dwordx4 v[192:195], v1, s[4:7], s14 offen offset:0 sc1
    buffer_load_dwordx4 v[196:199], v1, s[4:7], s14 offen offset:1024 sc1
    s_waitcnt vmcnt(46)
    s_add_u32 s12, s25, 0x949800
    s_add_u32 s14, s12, 0
    buffer_load_dwordx4 v[200:203], v1, s[4:7], s14 offen offset:0 sc1
    buffer_load_dwordx4 v[204:207], v1, s[4:7], s14 offen offset:1024 sc1
    buffer_load_dwordx4 v[208:211], v1, s[4:7], s14 offen offset:2048 sc1
    buffer_load_dwordx4 v[212:215], v1, s[4:7], s14 offen offset:3072 sc1
    s_add_u32 s14, s12, 4096
    buffer_load_dwordx4 v[216:219], v1, s[4:7], s14 offen offset:0 sc1
    buffer_load_dwordx4 v[220:223], v1, s[4:7], s14 offen offset:1024 sc1
    buffer_load_dwordx4 v[224:227], v1, s[4:7], s14 offen offset:2048 sc1
    buffer_load_dwordx4 v[228:231], v1, s[4:7], s14 offen offset:3072 sc1
    s_add_u32 s14, s12, 8192
    buffer_load_dwordx4 v[232:235], v1, s[4:7], s14 offen offset:0 sc1
    buffer_load_dwordx4 v[236:239], v1, s[4:7], s14 offen offset:1024 sc1
    buffer_load_dwordx4 v[240:243], v1, s[4:7], s14 offen offset:2048 sc1
    buffer_load_dwordx4 v[244:247], v1, s[4:7], s14 offen offset:3072 sc1
    s_add_u32 s14, s12, 12288
    buffer_load_dwordx4 v[248:251], v1, s[4:7], s14 offen offset:0 sc1
    buffer_load_dwordx4 v[252:255], v1, s[4:7], s14 offen offset:1024 sc1
    s_waitcnt vmcnt(46)
    s_mov_b32 s8, 0
    v_mov_b32 v32, 0
    v_mov_b32 v33, 0
    v_mov_b32 v34, 0
    v_mov_b32 v35, 0
    v_mov_b32 v36, 0
    v_mov_b32 v37, 0
    v_mov_b32 v38, 0
    v_mov_b32 v39, 0
    v_mov_b32 v40, 0
    v_mov_b32 v41, 0
    v_mov_b32 v42, 0
    v_mov_b32 v43, 0
    v_mov_b32 v44, 0
    v_mov_b32 v45, 0
    v_mov_b32 v46, 0
    v_mov_b32 v47, 0
    v_mov_b32 v48, 0
    v_mov_b32 v49, 0
    v_mov_b32 v50, 0
    v_mov_b32 v51, 0
    v_mov_b32 v52, 0
    v_mov_b32 v53, 0
    v_mov_b32 v54, 0
    v_mov_b32 v55, 0
    v_mov_b32 v56, 0
    v_mov_b32 v57, 0
    v_mov_b32 v58, 0
    v_mov_b32 v59, 0
    v_mov_b32 v60, 0
    v_mov_b32 v61, 0
    v_mov_b32 v62, 0
    v_mov_b32 v63, 0
    s_mov_b32 s22, 0
v_u0_263:
    s_add_u32 s22, s22, 1
    s_cmp_gt_u32 s22, 65536
    s_cbranch_scc1 M_exit
    buffer_load_dword v166, v168, s[4:7], s29 offen sc1
    s_waitcnt vmcnt(0)
    v_cmp_eq_u32 vcc, 0, v166
    s_cbranch_vccnz v_u0_263
    v_and_b32 v167, 3, v0
    v_lshlrev_b32 v167, 2, v167
    s_cmp_eq_u32 s30, 0
    s_cbranch_scc1 v_mode_264
.p2align 8
v_dry_256:
v_loop_265:
    v_mov_b32 v140, 0
    v_mov_b32 v141, 0
    v_mov_b32 v142, 0
    v_mov_b32 v143, 0
    v_mov_b32 v144, 0
    v_mov_b32 v145, 0
    v_mov_b32 v146, 0
    v_mov_b32 v147, 0
    s_and_b32 s23, s8, 7
    s_lshl_b32 s23, s23, 13
    s_add_u32 s23, s23, 0x3100000
    s_add_u32 s26, s23, 4096
    ds_read_b128 v[64:67], v163 offset:2048
    ds_read_b128 v[68:71], v163 offset:3072
    ds_read_b128 v[72:75], v163 offset:4096
    ds_read_b128 v[76:79], v163 offset:5120
    ds_read_b128 v[80:83], v163 offset:0
    ds_read_b128 v[84:87], v163 offset:1024
    s_and_b32 s11, s8, 15
    s_mul_i32 s11, s11, 458752
    s_lshl_b32 s12, s9, 15
    s_add_u32 s11, s11, s12
    s_add_u32 s11, s11, 0x1001000
    s_add_u32 s12, s11, 16384
    s_mov_b32 s22, 0
    buffer_load_dwordx4 v[8:11], v1, s[4:7], s23 offen offset:1024 sc1
    buffer_load_dwordx4 v[12:15], v1, s[4:7], s23 offen offset:2048 sc1
poll_267:
    s_waitcnt vmcnt(0)
    buffer_load_dwordx4 v[8:11], v1, s[4:7], s23 offen offset:1024 sc1
    buffer_load_dwordx4 v[12:15], v1, s[4:7], s23 offen offset:2048 sc1
    v_max3_u32 v156, v8, v9, v10
    v_max3_u32 v156, v156, v11, v12
    v_max3_u32 v156, v156, v13, v14
    v_max_u32 v156, v156, v15
    v_cmp_eq_u32 vcc, -1, v156
    ds_write_b128 v1, v[8:11] offset:1024
    ds_write_b128 v1, v[12:15] offset:2048
    s_add_u32 s22, s22, 1
    s_cmp_gt_u32 s22, 65536
    s_cbranch_scc1 M_exit
    s_cbranch_vccnz poll_267
pok_266:
    v_smfmac_f32_16x16x64_bf16 v[32:35], v[8:11], a[8:15], v2
    v_smfmac_f32_16x16x64_bf16 v[36:39], v[8:11], a[64:71], v2
    v_smfmac_f32_16x16x64_bf16 v[40:43], v[8:11], a[120:127], v2
    v_smfmac_f32_16x16x64_bf16 v[44:47], v[8:11], a[176:183], v2
    s_waitcnt lgkmcnt(0)
    s_barrier
    ds_read_b128 v[4:7], v1 offset:0
    ds_read_b128 v[16:19], v1 offset:3072
    buffer_load_dwordx4 v[88:91], v1, s[4:7], s11 offen offset:0 sc1
    v_smfmac_f32_16x16x64_bf16 v[56:59], v[8:11], v[64:71], v2
    ds_read_b128 v[20:23], v1 offset:4096
    v_smfmac_f32_16x16x64_bf16 v[32:35], v[12:15], a[16:23], v2
    ds_read_b128 v[24:27], v1 offset:5120
    ds_read_b128 v[64:67], v163 offset:6144
    v_smfmac_f32_16x16x64_bf16 v[36:39], v[12:15], a[72:79], v2
    ds_read_b128 v[28:31], v1 offset:6144
    ds_read_b128 v[68:71], v163 offset:7168
    v_smfmac_f32_16x16x64_bf16 v[40:43], v[12:15], a[128:135], v2
    buffer_load_dwordx4 v[92:95], v1, s[4:7], s11 offen offset:1024 sc1
    v_smfmac_f32_16x16x64_bf16 v[56:59], v[12:15], v[72:79], v2
    s_waitcnt lgkmcnt(6)
    v_smfmac_f32_16x16x64_bf16 v[32:35], v[4:7], a[0:7], v2
    ds_read_b128 v[72:75], v163 offset:8192
    v_smfmac_f32_16x16x64_bf16 v[36:39], v[4:7], a[56:63], v2
    ds_read_b128 v[76:79], v163 offset:9216
    v_smfmac_f32_16x16x64_bf16 v[40:43], v[4:7], a[112:119], v2
    buffer_load_dwordx4 v[96:99], v1, s[4:7], s11 offen offset:2048 sc1
    v_smfmac_f32_16x16x64_bf16 v[56:59], v[4:7], v[80:87], v2
    s_waitcnt lgkmcnt(7)
    v_smfmac_f32_16x16x64_bf16 v[32:35], v[16:19], a[24:31], v2
    ds_read_b128 v[80:83], v163 offset:10240
    v_smfmac_f32_16x16x64_bf16 v[36:39], v[16:19], a[80:87], v2
    ds_read_b128 v[84:87], v163 offset:11264
    v_smfmac_f32_16x16x64_bf16 v[40:43], v[16:19], a[136:143], v2
    buffer_load_dwordx4 v[100:103], v1, s[4:7], s11 offen offset:3072 sc1
    s_waitcnt lgkmcnt(4)
    v_smfmac_f32_16x16x64_bf16 v[56:59], v[16:19], v[64:71], v2
    v_smfmac_f32_16x16x64_bf16 v[32:35], v[20:23], a[32:39], v2
    ds_read_b128 v[64:67], v163 offset:12288
    v_smfmac_f32_16x16x64_bf16 v[36:39], v[20:23], a[88:95], v2
    ds_read_b128 v[68:71], v163 offset:13312
    v_smfmac_f32_16x16x64_bf16 v[40:43], v[20:23], a[144:151], v2
    buffer_load_dwordx4 v[104:107], v1, s[4:7], s12 offen offset:0 sc1
    s_waitcnt lgkmcnt(4)
    v_smfmac_f32_16x16x64_bf16 v[56:59], v[20:23], v[72:79], v2
    v_smfmac_f32_16x16x64_bf16 v[32:35], v[24:27], a[40:47], v2
    ds_read_b128 v[72:75], v163 offset:16384
    v_smfmac_f32_16x16x64_bf16 v[36:39], v[24:27], a[96:103], v2
    ds_read_b128 v[76:79], v163 offset:17408
    v_smfmac_f32_16x16x64_bf16 v[40:43], v[24:27], a[152:159], v2
    buffer_load_dwordx4 v[108:111], v1, s[4:7], s12 offen offset:1024 sc1
    s_waitcnt lgkmcnt(4)
    v_smfmac_f32_16x16x64_bf16 v[56:59], v[24:27], v[80:87], v2
    v_smfmac_f32_16x16x64_bf16 v[32:35], v[28:31], a[48:55], v2
    ds_read_b128 v[80:83], v163 offset:18432
    v_smfmac_f32_16x16x64_bf16 v[36:39], v[28:31], a[104:111], v2
    ds_read_b128 v[84:87], v163 offset:19456
    v_smfmac_f32_16x16x64_bf16 v[40:43], v[28:31], a[160:167], v2
    buffer_load_dwordx4 v[112:115], v1, s[4:7], s12 offen offset:2048 sc1
    s_waitcnt lgkmcnt(4)
    v_smfmac_f32_16x16x64_bf16 v[56:59], v[28:31], v[64:71], v2
    ds_read_b128 v[64:67], v163 offset:14336
    v_smfmac_f32_16x16x64_bf16 v[48:51], v[8:11], a[232:239], v2
    ds_read_b128 v[68:71], v163 offset:15360
    v_add_f32 v32, v32, v34
    v_smfmac_f32_16x16x64_bf16 v[52:55], v[8:11], v[208:215], v2
    buffer_load_dwordx4 v[116:119], v1, s[4:7], s12 offen offset:3072 sc1
    v_add_f32 v33, v33, v35
    s_waitcnt lgkmcnt(4)
    v_smfmac_f32_16x16x64_bf16 v[60:63], v[8:11], v[72:79], v2
    v_cvt_pk_bf16_f32 v132, v32, v33
    v_smfmac_f32_16x16x64_bf16 v[44:47], v[12:15], a[184:191], v2
    ds_read_b128 v[72:75], v163 offset:20480
    v_add_f32 v36, v36, v38
    v_smfmac_f32_16x16x64_bf16 v[48:51], v[12:15], a[240:247], v2
    ds_read_b128 v[76:79], v163 offset:21504
    v_add_f32 v37, v37, v39
    v_smfmac_f32_16x16x64_bf16 v[52:55], v[12:15], v[216:223], v2
    v_cvt_pk_bf16_f32 v134, v36, v37
    s_waitcnt lgkmcnt(4)
    v_smfmac_f32_16x16x64_bf16 v[60:63], v[12:15], v[80:87], v2
    v_add_f32 v40, v40, v42
    v_smfmac_f32_16x16x64_bf16 v[44:47], v[4:7], a[168:175], v2
    ds_read_b128 v[80:83], v163 offset:22528
    v_add_f32 v41, v41, v43
    v_smfmac_f32_16x16x64_bf16 v[48:51], v[4:7], a[224:231], v2
    ds_read_b128 v[84:87], v163 offset:23552
    v_cvt_pk_bf16_f32 v136, v40, v41
    v_smfmac_f32_16x16x64_bf16 v[52:55], v[4:7], v[200:207], v2
    v_add_f32 v56, v56, v58
    s_waitcnt lgkmcnt(4)
    v_smfmac_f32_16x16x64_bf16 v[60:63], v[4:7], v[64:71], v2
    v_add_f32 v57, v57, v59
    v_smfmac_f32_16x16x64_bf16 v[44:47], v[16:19], a[192:199], v2
    ds_read_b128 v[64:67], v163 offset:24576
    v_cvt_pk_bf16_f32 v137, v56, v57
    v_smfmac_f32_16x16x64_bf16 v[48:51], v[16:19], a[248:255], v2
    ds_read_b128 v[68:71], v163 offset:25600
    v_smfmac_f32_16x16x64_bf16 v[52:55], v[16:19], v[224:231], v2
    s_waitcnt lgkmcnt(4)
    v_smfmac_f32_16x16x64_bf16 v[60:63], v[16:19], v[72:79], v2
    v_smfmac_f32_16x16x64_bf16 v[44:47], v[20:23], a[200:207], v2
    ds_read_b128 v[72:75], v163 offset:26624
    v_smfmac_f32_16x16x64_bf16 v[48:51], v[20:23], v[176:183], v2
    ds_read_b128 v[76:79], v163 offset:27648
    v_smfmac_f32_16x16x64_bf16 v[52:55], v[20:23], v[232:239], v2
    s_waitcnt lgkmcnt(4)
    v_smfmac_f32_16x16x64_bf16 v[60:63], v[20:23], v[80:87], v2
    v_smfmac_f32_16x16x64_bf16 v[44:47], v[24:27], a[208:215], v2
    v_smfmac_f32_16x16x64_bf16 v[48:51], v[24:27], v[184:191], v2
    v_smfmac_f32_16x16x64_bf16 v[52:55], v[24:27], v[240:247], v2
    s_waitcnt lgkmcnt(2)
    v_smfmac_f32_16x16x64_bf16 v[60:63], v[24:27], v[64:71], v2
    v_smfmac_f32_16x16x64_bf16 v[44:47], v[28:31], a[216:223], v2
    v_smfmac_f32_16x16x64_bf16 v[48:51], v[28:31], v[192:199], v2
    v_smfmac_f32_16x16x64_bf16 v[52:55], v[28:31], v[248:255], v2
    s_waitcnt lgkmcnt(0)
    v_smfmac_f32_16x16x64_bf16 v[60:63], v[28:31], v[72:79], v2
    v_add_f32 v44, v44, v46
    s_and_b32 s11, s8, 3
    s_lshl_b32 s11, s11, 14
    s_add_u32 s25, s11, 0x3112400
    s_add_u32 s24, s11, 0x3110800
    s_add_u32 s11, s8, 1
    s_and_b32 s12, s11, 7
    s_lshl_b32 s12, s12, 13
    s_add_u32 s12, s12, 0x3100000
    s_mov_b32 s22, 0
    buffer_load_dwordx4 v[120:123], v1, s[4:7], s24 offen sc1
    buffer_load_dwordx4 v[124:127], v1, s[4:7], s24 offen offset:1024 sc1
    buffer_load_dwordx4 v[128:131], v1, s[4:7], s25 offen sc1
    v_add_f32 v45, v45, v47
    v_cvt_pk_bf16_f32 v138, v44, v45
    v_add_f32 v48, v48, v50
    v_add_f32 v49, v49, v51
    v_cvt_pk_bf16_f32 v133, v48, v49
    v_add_f32 v52, v52, v54
    v_add_f32 v53, v53, v55
    v_cvt_pk_bf16_f32 v135, v52, v53
    v_add_f32 v60, v60, v62
    v_add_f32 v61, v61, v63
    v_cvt_pk_bf16_f32 v139, v60, v61
    v_mov_b32 v32, 0
    v_mov_b32 v33, 0
    v_mov_b32 v34, 0
    v_mov_b32 v35, 0
    v_mov_b32 v36, 0
    v_mov_b32 v37, 0
    v_mov_b32 v38, 0
    v_mov_b32 v39, 0
    v_mov_b32 v40, 0
    v_mov_b32 v41, 0
    v_mov_b32 v42, 0
    v_mov_b32 v43, 0
    v_mov_b32 v44, 0
    v_mov_b32 v45, 0
    v_mov_b32 v46, 0
    v_mov_b32 v47, 0
    v_mov_b32 v48, 0
    v_mov_b32 v49, 0
    v_mov_b32 v50, 0
    v_mov_b32 v51, 0
    v_mov_b32 v52, 0
    v_mov_b32 v53, 0
    v_mov_b32 v54, 0
    v_mov_b32 v55, 0
    v_mov_b32 v56, 0
    v_mov_b32 v57, 0
    v_mov_b32 v58, 0
    v_mov_b32 v59, 0
    v_mov_b32 v60, 0
    v_mov_b32 v61, 0
    v_mov_b32 v62, 0
    v_mov_b32 v63, 0
q_269:
    s_waitcnt vmcnt(2)
    v_max3_u32 v156, v120, v121, v122
    v_max_u32 v156, v156, v123
    v_cmp_eq_u32 vcc, -1, v156
    buffer_load_dwordx4 v[120:123], v1, s[4:7], s24 offen sc1
    s_add_u32 s22, s22, 1
    s_cmp_gt_u32 s22, 196608
    s_cbranch_scc1 M_exit
    s_cbranch_vccnz q_270
    v_smfmac_f32_16x16x64_bf16 v[140:143], v[120:123], v[88:95], v2
    v_smfmac_f32_16x16x64_bf16 v[144:147], v[120:123], v[104:111], v2
q_271:
    s_waitcnt vmcnt(2)
    v_max3_u32 v156, v124, v125, v126
    v_max_u32 v156, v156, v127
    v_cmp_eq_u32 vcc, -1, v156
    s_cbranch_vccnz qf_272
    v_smfmac_f32_16x16x64_bf16 v[140:143], v[124:127], v[96:103], v2
    v_smfmac_f32_16x16x64_bf16 v[144:147], v[124:127], v[112:119], v2
q_273:
    s_waitcnt vmcnt(1)
    v_max3_u32 v156, v128, v129, v130
    v_max_u32 v156, v156, v131
    v_cmp_eq_u32 vcc, -1, v156
    s_cbranch_vccnz qf_274
    v_smfmac_f32_16x16x64_bf16 v[140:143], v[128:131], v[132:139], v3
    v_smfmac_f32_16x16x64_bf16 v[144:147], v[128:131], v[132:139], v160
qdone_268:
    s_nop 6
    v_add_f32 v148, v140, v142
    v_add_f32 v150, v141, v143
    v_add_f32 v149, v144, v146
    v_add_f32 v151, v145, v147
    ds_write2_b64 v157, v[148:149], v[150:151] offset0:0 offset1:16
    s_waitcnt lgkmcnt(0)
    s_barrier
    ds_read_b64 v[148:149], v158 offset:8704
    ds_read_b64 v[150:151], v158 offset:9728
    ds_read_b64 v[152:153], v158 offset:10752
    ds_read_b64 v[154:155], v158 offset:11776
    s_waitcnt lgkmcnt(2)
    v_pk_add_f32 v[148:149], v[148:149], v[150:151]
    s_waitcnt lgkmcnt(1)
    v_pk_add_f32 v[148:149], v[148:149], v[152:153]
    s_waitcnt lgkmcnt(0)
    v_pk_add_f32 v[148:149], v[148:149], v[154:155]
    v_cvt_pk_bf16_f32 v164, v148, v149
    v_min_u32 v164, -2, v164
    buffer_store_dword v164, v159, s[4:7], s12 offen offset:256
    s_xor_b32 s12, s12, 0x8000
    buffer_store_dword v162, v159, s[4:7], s12 offen offset:256
    s_add_u32 s13, s9, 48
    s_add_u32 s8, s8, 1
    s_cmp_lt_u32 s8, 63
    s_cbranch_scc1 v_loop_265
    s_mov_b32 s13, 0x30fe000
    buffer_store_dword v164, v159, s[4:7], s13 offen offset:256 sc1
    s_branch M_exit
q_270:
    s_waitcnt vmcnt(2)
    v_max3_u32 v156, v124, v125, v126
    v_max_u32 v156, v156, v127
    v_cmp_eq_u32 vcc, -1, v156
    buffer_load_dwordx4 v[124:127], v1, s[4:7], s24 offen offset:1024 sc1
    s_add_u32 s22, s22, 1
    s_cmp_gt_u32 s22, 196608
    s_cbranch_scc1 M_exit
    s_cbranch_vccnz q_276
    v_smfmac_f32_16x16x64_bf16 v[140:143], v[124:127], v[96:103], v2
    v_smfmac_f32_16x16x64_bf16 v[144:147], v[124:127], v[112:119], v2
q_277:
    s_waitcnt vmcnt(2)
    v_max3_u32 v156, v128, v129, v130
    v_max_u32 v156, v156, v131
    v_cmp_eq_u32 vcc, -1, v156
    s_cbranch_vccnz qf_278
    v_smfmac_f32_16x16x64_bf16 v[140:143], v[128:131], v[132:139], v3
    v_smfmac_f32_16x16x64_bf16 v[144:147], v[128:131], v[132:139], v160
q_279:
    s_waitcnt vmcnt(1)
    v_max3_u32 v156, v120, v121, v122
    v_max_u32 v156, v156, v123
    v_cmp_eq_u32 vcc, -1, v156
    s_cbranch_vccnz qf_280
    v_smfmac_f32_16x16x64_bf16 v[140:143], v[120:123], v[88:95], v2
    v_smfmac_f32_16x16x64_bf16 v[144:147], v[120:123], v[104:111], v2
    s_branch qdone_268
q_281:
    s_waitcnt vmcnt(2)
    v_max3_u32 v156, v128, v129, v130
    v_max_u32 v156, v156, v131
    v_cmp_eq_u32 vcc, -1, v156
    s_cbranch_vccnz qf_282
    v_smfmac_f32_16x16x64_bf16 v[140:143], v[128:131], v[132:139], v3
    v_smfmac_f32_16x16x64_bf16 v[144:147], v[128:131], v[132:139], v160
q_283:
    s_waitcnt vmcnt(0)
    v_max3_u32 v156, v124, v125, v126
    v_max_u32 v156, v156, v127
    v_cmp_eq_u32 vcc, -1, v156
    s_cbranch_vccnz qf_284
    v_smfmac_f32_16x16x64_bf16 v[140:143], v[124:127], v[96:103], v2
    v_smfmac_f32_16x16x64_bf16 v[144:147], v[124:127], v[112:119], v2
    s_branch qdone_268
q_285:
    s_waitcnt vmcnt(0)
    v_max3_u32 v156, v128, v129, v130
    v_max_u32 v156, v156, v131
    v_cmp_eq_u32 vcc, -1, v156
    s_cbranch_vccnz qf_286
    v_smfmac_f32_16x16x64_bf16 v[140:143], v[128:131], v[132:139], v3
    v_smfmac_f32_16x16x64_bf16 v[144:147], v[128:131], v[132:139], v160
    s_branch qdone_268
q_276:
    s_waitcnt vmcnt(2)
    v_max3_u32 v156, v128, v129, v130
    v_max_u32 v156, v156, v131
    v_cmp_eq_u32 vcc, -1, v156
    buffer_load_dwordx4 v[128:131], v1, s[4:7], s25 offen sc1
    s_add_u32 s22, s22, 1
    s_cmp_gt_u32 s22, 196608
    s_cbranch_scc1 M_exit
    s_cbranch_vccnz q_269
    v_smfmac_f32_16x16x64_bf16 v[140:143], v[128:131], v[132:139], v3
    v_smfmac_f32_16x16x64_bf16 v[144:147], v[128:131], v[132:139], v160
q_289:
    s_waitcnt vmcnt(2)
    v_max3_u32 v156, v120, v121, v122
    v_max_u32 v156, v156, v123
    v_cmp_eq_u32 vcc, -1, v156
    s_cbranch_vccnz qf_290
    v_smfmac_f32_16x16x64_bf16 v[140:143], v[120:123], v[88:95], v2
    v_smfmac_f32_16x16x64_bf16 v[144:147], v[120:123], v[104:111], v2
q_291:
    s_waitcnt vmcnt(1)
    v_max3_u32 v156, v124, v125, v126
    v_max_u32 v156, v156, v127
    v_cmp_eq_u32 vcc, -1, v156
    s_cbranch_vccnz qf_292
    v_smfmac_f32_16x16x64_bf16 v[140:143], v[124:127], v[96:103], v2
    v_smfmac_f32_16x16x64_bf16 v[144:147], v[124:127], v[112:119], v2
    s_branch qdone_268
q_293:
    s_waitcnt vmcnt(2)
    v_max3_u32 v156, v120, v121, v122
    v_max_u32 v156, v156, v123
    v_cmp_eq_u32 vcc, -1, v156
    s_cbranch_vccnz qf_294
    v_smfmac_f32_16x16x64_bf16 v[140:143], v[120:123], v[88:95], v2
    v_smfmac_f32_16x16x64_bf16 v[144:147], v[120:123], v[104:111], v2
    s_branch q_285
q_296:
    s_waitcnt vmcnt(0)
    v_max3_u32 v156, v120, v121, v122
    v_max_u32 v156, v156, v123
    v_cmp_eq_u32 vcc, -1, v156
    s_cbranch_vccnz qf_297
    v_smfmac_f32_16x16x64_bf16 v[140:143], v[120:123], v[88:95], v2
    v_smfmac_f32_16x16x64_bf16 v[144:147], v[120:123], v[104:111], v2
    s_branch qdone_268
q_298:
    s_waitcnt vmcnt(1)
    v_max3_u32 v156, v124, v125, v126
    v_max_u32 v156, v156, v127
    v_cmp_eq_u32 vcc, -1, v156
    s_cbranch_vccnz qf_299
    v_smfmac_f32_16x16x64_bf16 v[140:143], v[124:127], v[96:103], v2
    v_smfmac_f32_16x16x64_bf16 v[144:147], v[124:127], v[112:119], v2
    s_branch q_285
q_301:
    s_waitcnt vmcnt(2)
    v_max3_u32 v156, v124, v125, v126
    v_max_u32 v156, v156, v127
    v_cmp_eq_u32 vcc, -1, v156
    s_cbranch_vccnz qf_302
    v_smfmac_f32_16x16x64_bf16 v[140:143], v[124:127], v[96:103], v2
    v_smfmac_f32_16x16x64_bf16 v[144:147], v[124:127], v[112:119], v2
    s_branch q_296
q_304:
    s_waitcnt vmcnt(1)
    v_max3_u32 v156, v128, v129, v130
    v_max_u32 v156, v156, v131
    v_cmp_eq_u32 vcc, -1, v156
    s_cbranch_vccnz qf_305
    v_smfmac_f32_16x16x64_bf16 v[140:143], v[128:131], v[132:139], v3
    v_smfmac_f32_16x16x64_bf16 v[144:147], v[128:131], v[132:139], v160
    s_branch q_296
q_307:
    s_waitcnt vmcnt(1)
    v_max3_u32 v156, v128, v129, v130
    v_max_u32 v156, v156, v131
    v_cmp_eq_u32 vcc, -1, v156
    s_cbranch_vccnz qf_308
    v_smfmac_f32_16x16x64_bf16 v[140:143], v[128:131], v[132:139], v3
    v_smfmac_f32_16x16x64_bf16 v[144:147], v[128:131], v[132:139], v160
    s_branch q_283
q_310:
    s_waitcnt vmcnt(1)
    v_max3_u32 v156, v120, v121, v122
    v_max_u32 v156, v156, v123
    v_cmp_eq_u32 vcc, -1, v156
    s_cbranch_vccnz qf_311
    v_smfmac_f32_16x16x64_bf16 v[140:143], v[120:123], v[88:95], v2
    v_smfmac_f32_16x16x64_bf16 v[144:147], v[120:123], v[104:111], v2
    s_branch q_283
q_313:
    s_waitcnt vmcnt(1)
    v_max3_u32 v156, v120, v121, v122
    v_max_u32 v156, v156, v123
    v_cmp_eq_u32 vcc, -1, v156
    s_cbranch_vccnz qf_314
    v_smfmac_f32_16x16x64_bf16 v[140:143], v[120:123], v[88:95], v2
    v_smfmac_f32_16x16x64_bf16 v[144:147], v[120:123], v[104:111], v2
    s_branch q_285
q_316:
    s_waitcnt vmcnt(1)
    v_max3_u32 v156, v124, v125, v126
    v_max_u32 v156, v156, v127
    v_cmp_eq_u32 vcc, -1, v156
    s_cbranch_vccnz qf_317
    v_smfmac_f32_16x16x64_bf16 v[140:143], v[124:127], v[96:103], v2
    v_smfmac_f32_16x16x64_bf16 v[144:147], v[124:127], v[112:119], v2
    s_branch q_296
qf_272:
    buffer_load_dwordx4 v[124:127], v1, s[4:7], s24 offen offset:1024 sc1
    s_add_u32 s22, s22, 1
    s_cmp_gt_u32 s22, 196608
    s_cbranch_scc1 M_exit
    s_branch q_281
qf_274:
    buffer_load_dwordx4 v[128:131], v1, s[4:7], s25 offen sc1
    s_add_u32 s22, s22, 1
    s_cmp_gt_u32 s22, 196608
    s_cbranch_scc1 M_exit
    s_branch q_285
qf_278:
    buffer_load_dwordx4 v[128:131], v1, s[4:7], s25 offen sc1
    s_add_u32 s22, s22, 1
    s_cmp_gt_u32 s22, 196608
    s_cbranch_scc1 M_exit
    s_branch q_293
qf_280:
    buffer_load_dwordx4 v[120:123], v1, s[4:7], s24 offen sc1
    s_add_u32 s22, s22, 1
    s_cmp_gt_u32 s22, 196608
    s_cbranch_scc1 M_exit
    s_branch q_296
qf_282:
    buffer_load_dwordx4 v[128:131], v1, s[4:7], s25 offen sc1
    s_add_u32 s22, s22, 1
    s_cmp_gt_u32 s22, 196608
    s_cbranch_scc1 M_exit
    s_branch q_298
qf_284:
    buffer_load_dwordx4 v[124:127], v1, s[4:7], s24 offen offset:1024 sc1
    s_add_u32 s22, s22, 1
    s_cmp_gt_u32 s22, 196608
    s_cbranch_scc1 M_exit
    s_branch q_283
qf_286:
    buffer_load_dwordx4 v[128:131], v1, s[4:7], s25 offen sc1
    s_add_u32 s22, s22, 1
    s_cmp_gt_u32 s22, 196608
    s_cbranch_scc1 M_exit
    s_branch q_285
qf_290:
    buffer_load_dwordx4 v[120:123], v1, s[4:7], s24 offen sc1
    s_add_u32 s22, s22, 1
    s_cmp_gt_u32 s22, 196608
    s_cbranch_scc1 M_exit
    s_branch q_301
qf_292:
    buffer_load_dwordx4 v[124:127], v1, s[4:7], s24 offen offset:1024 sc1
    s_add_u32 s22, s22, 1
    s_cmp_gt_u32 s22, 196608
    s_cbranch_scc1 M_exit
    s_branch q_283
qf_294:
    buffer_load_dwordx4 v[120:123], v1, s[4:7], s24 offen sc1
    s_add_u32 s22, s22, 1
    s_cmp_gt_u32 s22, 196608
    s_cbranch_scc1 M_exit
    s_branch q_304
qf_297:
    buffer_load_dwordx4 v[120:123], v1, s[4:7], s24 offen sc1
    s_add_u32 s22, s22, 1
    s_cmp_gt_u32 s22, 196608
    s_cbranch_scc1 M_exit
    s_branch q_296
qf_299:
    buffer_load_dwordx4 v[124:127], v1, s[4:7], s24 offen offset:1024 sc1
    s_add_u32 s22, s22, 1
    s_cmp_gt_u32 s22, 196608
    s_cbranch_scc1 M_exit
    s_branch q_307
qf_302:
    buffer_load_dwordx4 v[124:127], v1, s[4:7], s24 offen offset:1024 sc1
    s_add_u32 s22, s22, 1
    s_cmp_gt_u32 s22, 196608
    s_cbranch_scc1 M_exit
    s_branch q_310
qf_305:
    buffer_load_dwordx4 v[128:131], v1, s[4:7], s25 offen sc1
    s_add_u32 s22, s22, 1
    s_cmp_gt_u32 s22, 196608
    s_cbranch_scc1 M_exit
    s_branch q_313
qf_308:
    buffer_load_dwordx4 v[128:131], v1, s[4:7], s25 offen sc1
    s_add_u32 s22, s22, 1
    s_cmp_gt_u32 s22, 196608
    s_cbranch_scc1 M_exit
    s_branch q_298
qf_311:
    buffer_load_dwordx4 v[120:123], v1, s[4:7], s24 offen sc1
    s_add_u32 s22, s22, 1
    s_cmp_gt_u32 s22, 196608
    s_cbranch_scc1 M_exit
    s_branch q_316
qf_314:
    buffer_load_dwordx4 v[120:123], v1, s[4:7], s24 offen sc1
    s_add_u32 s22, s22, 1
    s_cmp_gt_u32 s22, 196608
    s_cbranch_scc1 M_exit
    s_branch q_304
qf_317:
    buffer_load_dwordx4 v[124:127], v1, s[4:7], s24 offen offset:1024 sc1
    s_add_u32 s22, s22, 1
    s_cmp_gt_u32 s22, 196608
    s_cbranch_scc1 M_exit
    s_branch q_310
v_mode_264:
.p2align 8
v_loop_337:
    v_mov_b32 v140, 0
    v_mov_b32 v141, 0
    v_mov_b32 v142, 0
    v_mov_b32 v143, 0
    v_mov_b32 v144, 0
    v_mov_b32 v145, 0
    v_mov_b32 v146, 0
    v_mov_b32 v147, 0
    s_and_b32 s23, s8, 7
    s_lshl_b32 s23, s23, 13
    s_add_u32 s23, s23, 0x3100000
    s_add_u32 s26, s23, 4096
    ds_read_b128 v[64:67], v163 offset:2048
    ds_read_b128 v[68:71], v163 offset:3072
    ds_read_b128 v[72:75], v163 offset:4096
    ds_read_b128 v[76:79], v163 offset:5120
    ds_read_b128 v[80:83], v163 offset:0
    ds_read_b128 v[84:87], v163 offset:1024
    s_and_b32 s11, s8, 15
    s_mul_i32 s11, s11, 458752
    s_lshl_b32 s12, s9, 15
    s_add_u32 s11, s11, s12
    s_add_u32 s11, s11, 0x1001000
    s_add_u32 s12, s11, 16384
    s_mov_b32 s22, 0
    buffer_load_dwordx4 v[8:11], v1, s[4:7], s23 offen offset:1024 sc1
    buffer_load_dwordx4 v[12:15], v1, s[4:7], s23 offen offset:2048 sc1
poll_339:
    s_waitcnt vmcnt(0)
    buffer_load_dwordx4 v[8:11], v1, s[4:7], s23 offen offset:1024 sc1
    buffer_load_dwordx4 v[12:15], v1, s[4:7], s23 offen offset:2048 sc1
    v_max3_u32 v156, v8, v9, v10
    v_max3_u32 v156, v156, v11, v12
    v_max3_u32 v156, v156, v13, v14
    v_max_u32 v156, v156, v15
    v_cmp_eq_u32 vcc, -1, v156
    ds_write_b128 v1, v[8:11] offset:1024
    ds_write_b128 v1, v[12:15] offset:2048
    s_add_u32 s22, s22, 1
    s_cmp_gt_u32 s22, 65536
    s_cbranch_scc1 M_exit
    s_cbranch_vccnz poll_339
pok_338:
    v_smfmac_f32_16x16x64_bf16 v[32:35], v[8:11], a[8:15], v2
    v_smfmac_f32_16x16x64_bf16 v[36:39], v[8:11], a[64:71], v2
    v_smfmac_f32_16x16x64_bf16 v[40:43], v[8:11], a[120:127], v2
    v_smfmac_f32_16x16x64_bf16 v[44:47], v[8:11], a[176:183], v2
    s_waitcnt lgkmcnt(0)
    s_barrier
    ds_read_b128 v[4:7], v1 offset:0
    ds_read_b128 v[16:19], v1 offset:3072
    buffer_load_dwordx4 v[88:91], v1, s[4:7], s11 offen offset:0 sc1
    v_smfmac_f32_16x16x64_bf16 v[56:59], v[8:11], v[64:71], v2
    ds_read_b128 v[20:23], v1 offset:4096
    v_smfmac_f32_16x16x64_bf16 v[32:35], v[12:15], a[16:23], v2
    ds_read_b128 v[24:27], v1 offset:5120
    ds_read_b128 v[64:67], v163 offset:6144
    v_smfmac_f32_16x16x64_bf16 v[36:39], v[12:15], a[72:79], v2
    ds_read_b128 v[28:31], v1 offset:6144
    ds_read_b128 v[68:71], v163 offset:7168
    v_smfmac_f32_16x16x64_bf16 v[40:43], v[12:15], a[128:135], v2
    buffer_load_dwordx4 v[92:95], v1, s[4:7], s11 offen offset:1024 sc1
    v_smfmac_f32_16x16x64_bf16 v[56:59], v[12:15], v[72:79], v2
    s_waitcnt lgkmcnt(6)
    v_smfmac_f32_16x16x64_bf16 v[32:35], v[4:7], a[0:7], v2
    ds_read_b128 v[72:75], v163 offset:8192
    v_smfmac_f32_16x16x64_bf16 v[36:39], v[4:7], a[56:63], v2
    ds_read_b128 v[76:79], v163 offset:9216
    v_smfmac_f32_16x16x64_bf16 v[40:43], v[4:7], a[112:119], v2
    buffer_load_dwordx4 v[96:99], v1, s[4:7], s11 offen offset:2048 sc1
    v_smfmac_f32_16x16x64_bf16 v[56:59], v[4:7], v[80:87], v2
    s_waitcnt lgkmcnt(7)
    v_smfmac_f32_16x16x64_bf16 v[32:35], v[16:19], a[24:31], v2
    ds_read_b128 v[80:83], v163 offset:10240
    v_smfmac_f32_16x16x64_bf16 v[36:39], v[16:19], a[80:87], v2
    ds_read_b128 v[84:87], v163 offset:11264
    v_smfmac_f32_16x16x64_bf16 v[40:43], v[16:19], a[136:143], v2
    buffer_load_dwordx4 v[100:103], v1, s[4:7], s11 offen offset:3072 sc1
    s_waitcnt lgkmcnt(4)
    v_smfmac_f32_16x16x64_bf16 v[56:59], v[16:19], v[64:71], v2
    v_smfmac_f32_16x16x64_bf16 v[32:35], v[20:23], a[32:39], v2
    ds_read_b128 v[64:67], v163 offset:12288
    v_smfmac_f32_16x16x64_bf16 v[36:39], v[20:23], a[88:95], v2
    ds_read_b128 v[68:71], v163 offset:13312
    v_smfmac_f32_16x16x64_bf16 v[40:43], v[20:23], a[144:151], v2
    buffer_load_dwordx4 v[104:107], v1, s[4:7], s12 offen offset:0 sc1
    s_waitcnt lgkmcnt(4)
    v_smfmac_f32_16x16x64_bf16 v[56:59], v[20:23], v[72:79], v2
    v_smfmac_f32_16x16x64_bf16 v[32:35], v[24:27], a[40:47], v2
    ds_read_b128 v[72:75], v163 offset:16384
    v_smfmac_f32_16x16x64_bf16 v[36:39], v[24:27], a[96:103], v2
    ds_read_b128 v[76:79], v163 offset:17408
    v_smfmac_f32_16x16x64_bf16 v[40:43], v[24:27], a[152:159], v2
    buffer_load_dwordx4 v[108:111], v1, s[4:7], s12 offen offset:1024 sc1
    s_waitcnt lgkmcnt(4)
    v_smfmac_f32_16x16x64_bf16 v[56:59], v[24:27], v[80:87], v2
    v_smfmac_f32_16x16x64_bf16 v[32:35], v[28:31], a[48:55], v2
    ds_read_b128 v[80:83], v163 offset:18432
    v_smfmac_f32_16x16x64_bf16 v[36:39], v[28:31], a[104:111], v2
    ds_read_b128 v[84:87], v163 offset:19456
    v_smfmac_f32_16x16x64_bf16 v[40:43], v[28:31], a[160:167], v2
    buffer_load_dwordx4 v[112:115], v1, s[4:7], s12 offen offset:2048 sc1
    s_waitcnt lgkmcnt(4)
    v_smfmac_f32_16x16x64_bf16 v[56:59], v[28:31], v[64:71], v2
    ds_read_b128 v[64:67], v163 offset:14336
    v_smfmac_f32_16x16x64_bf16 v[48:51], v[8:11], a[232:239], v2
    ds_read_b128 v[68:71], v163 offset:15360
    v_add_f32 v32, v32, v34
    v_smfmac_f32_16x16x64_bf16 v[52:55], v[8:11], v[208:215], v2
    buffer_load_dwordx4 v[116:119], v1, s[4:7], s12 offen offset:3072 sc1
    v_add_f32 v33, v33, v35
    s_waitcnt lgkmcnt(4)
    v_smfmac_f32_16x16x64_bf16 v[60:63], v[8:11], v[72:79], v2
    v_cvt_pk_bf16_f32 v132, v32, v33
    v_smfmac_f32_16x16x64_bf16 v[44:47], v[12:15], a[184:191], v2
    ds_read_b128 v[72:75], v163 offset:20480
    v_add_f32 v36, v36, v38
    v_smfmac_f32_16x16x64_bf16 v[48:51], v[12:15], a[240:247], v2
    ds_read_b128 v[76:79], v163 offset:21504
    v_add_f32 v37, v37, v39
    v_smfmac_f32_16x16x64_bf16 v[52:55], v[12:15], v[216:223], v2
    v_cvt_pk_bf16_f32 v134, v36, v37
    s_waitcnt lgkmcnt(4)
    v_smfmac_f32_16x16x64_bf16 v[60:63], v[12:15], v[80:87], v2
    v_add_f32 v40, v40, v42
    v_smfmac_f32_16x16x64_bf16 v[44:47], v[4:7], a[168:175], v2
    ds_read_b128 v[80:83], v163 offset:22528
    v_add_f32 v41, v41, v43
    v_smfmac_f32_16x16x64_bf16 v[48:51], v[4:7], a[224:231], v2
    ds_read_b128 v[84:87], v163 offset:23552
    v_cvt_pk_bf16_f32 v136, v40, v41
    v_smfmac_f32_16x16x64_bf16 v[52:55], v[4:7], v[200:207], v2
    v_add_f32 v56, v56, v58
    s_waitcnt lgkmcnt(4)
    v_smfmac_f32_16x16x64_bf16 v[60:63], v[4:7], v[64:71], v2
    v_add_f32 v57, v57, v59
    v_smfmac_f32_16x16x64_bf16 v[44:47], v[16:19], a[192:199], v2
    ds_read_b128 v[64:67], v163 offset:24576
    v_cvt_pk_bf16_f32 v137, v56, v57
    v_smfmac_f32_16x16x64_bf16 v[48:51], v[16:19], a[248:255], v2
    ds_read_b128 v[68:71], v163 offset:25600
    v_smfmac_f32_16x16x64_bf16 v[52:55], v[16:19], v[224:231], v2
    s_waitcnt lgkmcnt(4)
    v_smfmac_f32_16x16x64_bf16 v[60:63], v[16:19], v[72:79], v2
    v_smfmac_f32_16x16x64_bf16 v[44:47], v[20:23], a[200:207], v2
    ds_read_b128 v[72:75], v163 offset:26624
    v_smfmac_f32_16x16x64_bf16 v[48:51], v[20:23], v[176:183], v2
    ds_read_b128 v[76:79], v163 offset:27648
    v_smfmac_f32_16x16x64_bf16 v[52:55], v[20:23], v[232:239], v2
    s_waitcnt lgkmcnt(4)
    v_smfmac_f32_16x16x64_bf16 v[60:63], v[20:23], v[80:87], v2
    v_smfmac_f32_16x16x64_bf16 v[44:47], v[24:27], a[208:215], v2
    v_smfmac_f32_16x16x64_bf16 v[48:51], v[24:27], v[184:191], v2
    v_smfmac_f32_16x16x64_bf16 v[52:55], v[24:27], v[240:247], v2
    s_waitcnt lgkmcnt(2)
    v_smfmac_f32_16x16x64_bf16 v[60:63], v[24:27], v[64:71], v2
    v_smfmac_f32_16x16x64_bf16 v[44:47], v[28:31], a[216:223], v2
    v_smfmac_f32_16x16x64_bf16 v[48:51], v[28:31], v[192:199], v2
    v_smfmac_f32_16x16x64_bf16 v[52:55], v[28:31], v[248:255], v2
    s_waitcnt lgkmcnt(0)
    v_smfmac_f32_16x16x64_bf16 v[60:63], v[28:31], v[72:79], v2
    v_add_f32 v44, v44, v46
    s_and_b32 s11, s8, 3
    s_lshl_b32 s11, s11, 14
    s_add_u32 s25, s11, 0x3112400
    s_add_u32 s24, s11, 0x3110800
    s_add_u32 s11, s8, 1
    s_and_b32 s12, s11, 7
    s_lshl_b32 s12, s12, 13
    s_add_u32 s12, s12, 0x3100000
    s_mov_b32 s22, 0
    buffer_load_dwordx4 v[120:123], v1, s[4:7], s24 offen sc1
    buffer_load_dwordx4 v[124:127], v1, s[4:7], s24 offen offset:1024 sc1
    buffer_load_dwordx4 v[128:131], v1, s[4:7], s25 offen sc1
    v_add_f32 v45, v45, v47
    v_cvt_pk_bf16_f32 v138, v44, v45
    v_add_f32 v48, v48, v50
    v_add_f32 v49, v49, v51
    v_cvt_pk_bf16_f32 v133, v48, v49
    v_add_f32 v52, v52, v54
    v_add_f32 v53, v53, v55
    v_cvt_pk_bf16_f32 v135, v52, v53
    v_add_f32 v60, v60, v62
    v_add_f32 v61, v61, v63
    v_cvt_pk_bf16_f32 v139, v60, v61
    v_mov_b32 v32, 0
    v_mov_b32 v33, 0
    v_mov_b32 v34, 0
    v_mov_b32 v35, 0
    v_mov_b32 v36, 0
    v_mov_b32 v37, 0
    v_mov_b32 v38, 0
    v_mov_b32 v39, 0
    v_mov_b32 v40, 0
    v_mov_b32 v41, 0
    v_mov_b32 v42, 0
    v_mov_b32 v43, 0
    v_mov_b32 v44, 0
    v_mov_b32 v45, 0
    v_mov_b32 v46, 0
    v_mov_b32 v47, 0
    v_mov_b32 v48, 0
    v_mov_b32 v49, 0
    v_mov_b32 v50, 0
    v_mov_b32 v51, 0
    v_mov_b32 v52, 0
    v_mov_b32 v53, 0
    v_mov_b32 v54, 0
    v_mov_b32 v55, 0
    v_mov_b32 v56, 0
    v_mov_b32 v57, 0
    v_mov_b32 v58, 0
    v_mov_b32 v59, 0
    v_mov_b32 v60, 0
    v_mov_b32 v61, 0
    v_mov_b32 v62, 0
    v_mov_b32 v63, 0
q_341:
    s_waitcnt vmcnt(2)
    v_max3_u32 v156, v120, v121, v122
    v_max_u32 v156, v156, v123
    v_cmp_eq_u32 vcc, -1, v156
    buffer_load_dwordx4 v[120:123], v1, s[4:7], s24 offen sc1
    s_add_u32 s22, s22, 1
    s_cmp_gt_u32 s22, 196608
    s_cbranch_scc1 M_exit
    s_cbranch_vccnz q_342
    v_smfmac_f32_16x16x64_bf16 v[140:143], v[120:123], v[88:95], v2
    v_smfmac_f32_16x16x64_bf16 v[144:147], v[120:123], v[104:111], v2
q_343:
    s_waitcnt vmcnt(2)
    v_max3_u32 v156, v124, v125, v126
    v_max_u32 v156, v156, v127
    v_cmp_eq_u32 vcc, -1, v156
    s_cbranch_vccnz qf_344
    v_smfmac_f32_16x16x64_bf16 v[140:143], v[124:127], v[96:103], v2
    v_smfmac_f32_16x16x64_bf16 v[144:147], v[124:127], v[112:119], v2
q_345:
    s_waitcnt vmcnt(1)
    v_max3_u32 v156, v128, v129, v130
    v_max_u32 v156, v156, v131
    v_cmp_eq_u32 vcc, -1, v156
    s_cbranch_vccnz qf_346
    v_smfmac_f32_16x16x64_bf16 v[140:143], v[128:131], v[132:139], v3
    v_smfmac_f32_16x16x64_bf16 v[144:147], v[128:131], v[132:139], v160
qdone_340:
    s_nop 6
    v_add_f32 v148, v140, v142
    v_add_f32 v150, v141, v143
    v_add_f32 v149, v144, v146
    v_add_f32 v151, v145, v147
    ds_write2_b64 v157, v[148:149], v[150:151] offset0:0 offset1:16
    s_waitcnt lgkmcnt(0)
    s_barrier
    ds_read_b64 v[148:149], v158 offset:8704
    ds_read_b64 v[150:151], v158 offset:9728
    ds_read_b64 v[152:153], v158 offset:10752
    ds_read_b64 v[154:155], v158 offset:11776
    s_waitcnt lgkmcnt(2)
    v_pk_add_f32 v[148:149], v[148:149], v[150:151]
    s_waitcnt lgkmcnt(1)
    v_pk_add_f32 v[148:149], v[148:149], v[152:153]
    s_waitcnt lgkmcnt(0)
    v_pk_add_f32 v[148:149], v[148:149], v[154:155]
    v_cvt_pk_bf16_f32 v164, v148, v149
    v_min_u32 v164, -2, v164
    buffer_store_dword v164, v159, s[4:7], s12 offen offset:256 sc1
    s_xor_b32 s12, s12, 0x8000
    buffer_store_dword v162, v159, s[4:7], s12 offen offset:256 sc1
    s_add_u32 s13, s9, 48
    s_add_u32 s8, s8, 1
    s_cmp_lt_u32 s8, 63
    s_cbranch_scc1 v_loop_337
    s_mov_b32 s13, 0x30fe000
    buffer_store_dword v164, v159, s[4:7], s13 offen offset:256 sc1
    s_branch M_exit
q_342:
    s_waitcnt vmcnt(2)
    v_max3_u32 v156, v124, v125, v126
    v_max_u32 v156, v156, v127
    v_cmp_eq_u32 vcc, -1, v156
    buffer_load_dwordx4 v[124:127], v1, s[4:7], s24 offen offset:1024 sc1
    s_add_u32 s22, s22, 1
    s_cmp_gt_u32 s22, 196608
    s_cbranch_scc1 M_exit
    s_cbranch_vccnz q_348
    v_smfmac_f32_16x16x64_bf16 v[140:143], v[124:127], v[96:103], v2
    v_smfmac_f32_16x16x64_bf16 v[144:147], v[124:127], v[112:119], v2
q_349:
    s_waitcnt vmcnt(2)
    v_max3_u32 v156, v128, v129, v130
    v_max_u32 v156, v156, v131
    v_cmp_eq_u32 vcc, -1, v156
    s_cbranch_vccnz qf_350
    v_smfmac_f32_16x16x64_bf16 v[140:143], v[128:131], v[132:139], v3
    v_smfmac_f32_16x16x64_bf16 v[144:147], v[128:131], v[132:139], v160
q_351:
    s_waitcnt vmcnt(1)
    v_max3_u32 v156, v120, v121, v122
    v_max_u32 v156, v156, v123
    v_cmp_eq_u32 vcc, -1, v156
    s_cbranch_vccnz qf_352
    v_smfmac_f32_16x16x64_bf16 v[140:143], v[120:123], v[88:95], v2
    v_smfmac_f32_16x16x64_bf16 v[144:147], v[120:123], v[104:111], v2
    s_branch qdone_340
q_353:
    s_waitcnt vmcnt(2)
    v_max3_u32 v156, v128, v129, v130
    v_max_u32 v156, v156, v131
    v_cmp_eq_u32 vcc, -1, v156
    s_cbranch_vccnz qf_354
    v_smfmac_f32_16x16x64_bf16 v[140:143], v[128:131], v[132:139], v3
    v_smfmac_f32_16x16x64_bf16 v[144:147], v[128:131], v[132:139], v160
q_355:
    s_waitcnt vmcnt(0)
    v_max3_u32 v156, v124, v125, v126
    v_max_u32 v156, v156, v127
    v_cmp_eq_u32 vcc, -1, v156
    s_cbranch_vccnz qf_356
    v_smfmac_f32_16x16x64_bf16 v[140:143], v[124:127], v[96:103], v2
    v_smfmac_f32_16x16x64_bf16 v[144:147], v[124:127], v[112:119], v2
    s_branch qdone_340
q_357:
    s_waitcnt vmcnt(0)
    v_max3_u32 v156, v128, v129, v130
    v_max_u32 v156, v156, v131
    v_cmp_eq_u32 vcc, -1, v156
    s_cbranch_vccnz qf_358
    v_smfmac_f32_16x16x64_bf16 v[140:143], v[128:131], v[132:139], v3
    v_smfmac_f32_16x16x64_bf16 v[144:147], v[128:131], v[132:139], v160
    s_branch qdone_340
q_348:
    s_waitcnt vmcnt(2)
    v_max3_u32 v156, v128, v129, v130
    v_max_u32 v156, v156, v131
    v_cmp_eq_u32 vcc, -1, v156
    buffer_load_dwordx4 v[128:131], v1, s[4:7], s25 offen sc1
    s_add_u32 s22, s22, 1
    s_cmp_gt_u32 s22, 196608
    s_cbranch_scc1 M_exit
    s_cbranch_vccnz q_341
    v_smfmac_f32_16x16x64_bf16 v[140:143], v[128:131], v[132:139], v3
    v_smfmac_f32_16x16x64_bf16 v[144:147], v[128:131], v[132:139], v160
q_361:
    s_waitcnt vmcnt(2)
    v_max3_u32 v156, v120, v121, v122
    v_max_u32 v156, v156, v123
    v_cmp_eq_u32 vcc, -1, v156
    s_cbranch_vccnz qf_362
    v_smfmac_f32_16x16x64_bf16 v[140:143], v[120:123], v[88:95], v2
    v_smfmac_f32_16x16x64_bf16 v[144:147], v[120:123], v[104:111], v2
q_363:
    s_waitcnt vmcnt(1)
    v_max3_u32 v156, v124, v125, v126
    v_max_u32 v156, v156, v127
    v_cmp_eq_u32 vcc, -1, v156
    s_cbranch_vccnz qf_364
    v_smfmac_f32_16x16x64_bf16 v[140:143], v[124:127], v[96:103], v2
    v_smfmac_f32_16x16x64_bf16 v[144:147], v[124:127], v[112:119], v2
    s_branch qdone_340
q_365:
    s_waitcnt vmcnt(2)
    v_max3_u32 v156, v120, v121, v122
    v_max_u32 v156, v156, v123
    v_cmp_eq_u32 vcc, -1, v156
    s_cbranch_vccnz qf_366
    v_smfmac_f32_16x16x64_bf16 v[140:143], v[120:123], v[88:95], v2
    v_smfmac_f32_16x16x64_bf16 v[144:147], v[120:123], v[104:111], v2
    s_branch q_357
q_368:
    s_waitcnt vmcnt(0)
    v_max3_u32 v156, v120, v121, v122
    v_max_u32 v156, v156, v123
    v_cmp_eq_u32 vcc, -1, v156
    s_cbranch_vccnz qf_369
    v_smfmac_f32_16x16x64_bf16 v[140:143], v[120:123], v[88:95], v2
    v_smfmac_f32_16x16x64_bf16 v[144:147], v[120:123], v[104:111], v2
    s_branch qdone_340
q_370:
    s_waitcnt vmcnt(1)
    v_max3_u32 v156, v124, v125, v126
    v_max_u32 v156, v156, v127
    v_cmp_eq_u32 vcc, -1, v156
    s_cbranch_vccnz qf_371
    v_smfmac_f32_16x16x64_bf16 v[140:143], v[124:127], v[96:103], v2
    v_smfmac_f32_16x16x64_bf16 v[144:147], v[124:127], v[112:119], v2
    s_branch q_357
q_373:
    s_waitcnt vmcnt(2)
    v_max3_u32 v156, v124, v125, v126
    v_max_u32 v156, v156, v127
    v_cmp_eq_u32 vcc, -1, v156
    s_cbranch_vccnz qf_374
    v_smfmac_f32_16x16x64_bf16 v[140:143], v[124:127], v[96:103], v2
    v_smfmac_f32_16x16x64_bf16 v[144:147], v[124:127], v[112:119], v2
    s_branch q_368
q_376:
    s_waitcnt vmcnt(1)
    v_max3_u32 v156, v128, v129, v130
    v_max_u32 v156, v156, v131
    v_cmp_eq_u32 vcc, -1, v156
    s_cbranch_vccnz qf_377
    v_smfmac_f32_16x16x64_bf16 v[140:143], v[128:131], v[132:139], v3
    v_smfmac_f32_16x16x64_bf16 v[144:147], v[128:131], v[132:139], v160
    s_branch q_368
q_379:
    s_waitcnt vmcnt(1)
    v_max3_u32 v156, v128, v129, v130
    v_max_u32 v156, v156, v131
    v_cmp_eq_u32 vcc, -1, v156
    s_cbranch_vccnz qf_380
    v_smfmac_f32_16x16x64_bf16 v[140:143], v[128:131], v[132:139], v3
    v_smfmac_f32_16x16x64_bf16 v[144:147], v[128:131], v[132:139], v160
    s_branch q_355
q_382:
    s_waitcnt vmcnt(1)
    v_max3_u32 v156, v120, v121, v122
    v_max_u32 v156, v156, v123
    v_cmp_eq_u32 vcc, -1, v156
    s_cbranch_vccnz qf_383
    v_smfmac_f32_16x16x64_bf16 v[140:143], v[120:123], v[88:95], v2
    v_smfmac_f32_16x16x64_bf16 v[144:147], v[120:123], v[104:111], v2
    s_branch q_355
q_385:
    s_waitcnt vmcnt(1)
    v_max3_u32 v156, v120, v121, v122
    v_max_u32 v156, v156, v123
    v_cmp_eq_u32 vcc, -1, v156
    s_cbranch_vccnz qf_386
    v_smfmac_f32_16x16x64_bf16 v[140:143], v[120:123], v[88:95], v2
    v_smfmac_f32_16x16x64_bf16 v[144:147], v[120:123], v[104:111], v2
    s_branch q_357
q_388:
    s_waitcnt vmcnt(1)
    v_max3_u32 v156, v124, v125, v126
    v_max_u32 v156, v156, v127
    v_cmp_eq_u32 vcc, -1, v156
    s_cbranch_vccnz qf_389
    v_smfmac_f32_16x16x64_bf16 v[140:143], v[124:127], v[96:103], v2
    v_smfmac_f32_16x16x64_bf16 v[144:147], v[124:127], v[112:119], v2
    s_branch q_368
qf_344:
    buffer_load_dwordx4 v[124:127], v1, s[4:7], s24 offen offset:1024 sc1
    s_add_u32 s22, s22, 1
    s_cmp_gt_u32 s22, 196608
    s_cbranch_scc1 M_exit
    s_branch q_353
qf_346:
    buffer_load_dwordx4 v[128:131], v1, s[4:7], s25 offen sc1
    s_add_u32 s22, s22, 1
    s_cmp_gt_u32 s22, 196608
    s_cbranch_scc1 M_exit
    s_branch q_357
qf_350:
    buffer_load_dwordx4 v[128:131], v1, s[4:7], s25 offen sc1
    s_add_u32 s22, s22, 1
    s_cmp_gt_u32 s22, 196608
    s_cbranch_scc1 M_exit
    s_branch q_365
qf_352:
    buffer_load_dwordx4 v[120:123], v1, s[4:7], s24 offen sc1
    s_add_u32 s22, s22, 1
    s_cmp_gt_u32 s22, 196608
    s_cbranch_scc1 M_exit
    s_branch q_368
qf_354:
    buffer_load_dwordx4 v[128:131], v1, s[4:7], s25 offen sc1
    s_add_u32 s22, s22, 1
    s_cmp_gt_u32 s22, 196608
    s_cbranch_scc1 M_exit
    s_branch q_370
qf_356:
    buffer_load_dwordx4 v[124:127], v1, s[4:7], s24 offen offset:1024 sc1
    s_add_u32 s22, s22, 1
    s_cmp_gt_u32 s22, 196608
    s_cbranch_scc1 M_exit
    s_branch q_355
qf_358:
    buffer_load_dwordx4 v[128:131], v1, s[4:7], s25 offen sc1
    s_add_u32 s22, s22, 1
    s_cmp_gt_u32 s22, 196608
    s_cbranch_scc1 M_exit
    s_branch q_357
qf_362:
    buffer_load_dwordx4 v[120:123], v1, s[4:7], s24 offen sc1
    s_add_u32 s22, s22, 1
    s_cmp_gt_u32 s22, 196608
    s_cbranch_scc1 M_exit
    s_branch q_373
qf_364:
    buffer_load_dwordx4 v[124:127], v1, s[4:7], s24 offen offset:1024 sc1
    s_add_u32 s22, s22, 1
    s_cmp_gt_u32 s22, 196608
    s_cbranch_scc1 M_exit
    s_branch q_355
qf_366:
    buffer_load_dwordx4 v[120:123], v1, s[4:7], s24 offen sc1
    s_add_u32 s22, s22, 1
    s_cmp_gt_u32 s22, 196608
    s_cbranch_scc1 M_exit
    s_branch q_376
qf_369:
    buffer_load_dwordx4 v[120:123], v1, s[4:7], s24 offen sc1
    s_add_u32 s22, s22, 1
    s_cmp_gt_u32 s22, 196608
    s_cbranch_scc1 M_exit
    s_branch q_368
qf_371:
    buffer_load_dwordx4 v[124:127], v1, s[4:7], s24 offen offset:1024 sc1
    s_add_u32 s22, s22, 1
    s_cmp_gt_u32 s22, 196608
    s_cbranch_scc1 M_exit
    s_branch q_379
qf_374:
    buffer_load_dwordx4 v[124:127], v1, s[4:7], s24 offen offset:1024 sc1
    s_add_u32 s22, s22, 1
    s_cmp_gt_u32 s22, 196608
    s_cbranch_scc1 M_exit
    s_branch q_382
qf_377:
    buffer_load_dwordx4 v[128:131], v1, s[4:7], s25 offen sc1
    s_add_u32 s22, s22, 1
    s_cmp_gt_u32 s22, 196608
    s_cbranch_scc1 M_exit
    s_branch q_385
qf_380:
    buffer_load_dwordx4 v[128:131], v1, s[4:7], s25 offen sc1
    s_add_u32 s22, s22, 1
    s_cmp_gt_u32 s22, 196608
    s_cbranch_scc1 M_exit
    s_branch q_370
qf_383:
    buffer_load_dwordx4 v[120:123], v1, s[4:7], s24 offen sc1
    s_add_u32 s22, s22, 1
    s_cmp_gt_u32 s22, 196608
    s_cbranch_scc1 M_exit
    s_branch q_388
qf_386:
    buffer_load_dwordx4 v[120:123], v1, s[4:7], s24 offen sc1
    s_add_u32 s22, s22, 1
    s_cmp_gt_u32 s22, 196608
    s_cbranch_scc1 M_exit
    s_branch q_376
qf_389:
    buffer_load_dwordx4 v[124:127], v1, s[4:7], s24 offen offset:1024 sc1
    s_add_u32 s22, s22, 1
    s_cmp_gt_u32 s22, 196608
    s_cbranch_scc1 M_exit
    s_branch q_382
v_w2_101:
    v_and_b32 v0, 63, v0
    v_lshlrev_b32 v1, 4, v0
    v_and_b32 v164, 2, v0
    v_cmp_eq_u32 s[20:21], 0, v164
    v_mov_b32 v2, 0xeeee
    v_mov_b32 v164, 0x4444
    v_cndmask_b32 v2, v2, v164, s[20:21]
    v_and_b32 v168, 16, v1
    v_mov_b32 v166, 0
    v_mov_b32 v3, 0x1111
    v_mov_b32 v164, 0x4444
    v_cndmask_b32 v3, v3, v164, s[20:21]
    v_mov_b32 v160, 0xbbbb
    v_mov_b32 v164, 0xeeee
    v_cndmask_b32 v160, v160, v164, s[20:21]
    v_mov_b32 v162, -1
    v_add_u32 v163, 69632, v1
    v_bfe_u32 v164, v0, 1, 2
    v_lshlrev_b32 v157, 2, v164
    v_bfe_u32 v164, v0, 3, 1
    v_lshl_add_u32 v157, v164, 8, v157
    v_bfe_u32 v164, v0, 4, 1
    v_lshl_add_u32 v157, v164, 7, v157
    v_bfe_u32 v164, v0, 0, 1
    v_lshl_add_u32 v157, v164, 5, v157
    v_bfe_u32 v164, v0, 5, 1
    v_lshl_add_u32 v157, v164, 4, v157
    v_lshlrev_b32 v157, 1, v157
    v_add_u32 v157, 10240, v157
    v_lshlrev_b32 v158, 3, v0
    s_lshl_b32 s11, s9, 9
    v_lshlrev_b32 v159, 2, v0
    v_add_u32 v159, s11, v159
    s_sleep 30
    s_lshl_b32 s11, s10, 8
    s_add_u32 s11, s11, 0x3b02400
    v_min_u32 v4, 15, v0
    v_lshlrev_b32 v4, 4, v4
    s_mov_b32 s22, 0
wt_411:
    buffer_load_dwordx4 v[32:35], v4, s[4:7], s11 offen offset:0 sc1
    s_waitcnt vmcnt(0)
    v_xor_b32 v32, s80, v32
    v_xor_b32 v33, s81, v33
    v_and_b32 v33, -16, v33
    v_xor_b32 v34, s80, v34
    v_xor_b32 v35, s81, v35
    v_and_b32 v35, -16, v35
    v_or3_b32 v32, v32, v33, v34
    v_or_b32 v32, v32, v35
    v_cmp_ne_u32 vcc, 0, v32
    s_cbranch_vccz wtok_412
    s_add_u32 s22, s22, 1
    s_cmp_gt_u32 s22, 65536
    s_cbranch_scc1 M_exit
    s_sleep 16
    s_branch wt_411
wtok_412:
    s_mul_i32 s11, s9, 458752
    s_mov_b32 m0, 69632
    s_add_u32 s12, s11, 0x95b000
    buffer_load_dwordx4 v1, s[4:7], s12 offen offset:0 sc1 lds
    buffer_load_dwordx4 v1, s[4:7], s12 offen offset:1024 sc1 lds
    buffer_load_dwordx4 v1, s[4:7], s12 offen offset:2048 sc1 lds
    buffer_load_dwordx4 v1, s[4:7], s12 offen offset:3072 sc1 lds
    s_mov_b32 m0, 73728
    s_add_u32 s12, s11, 0x95c000
    buffer_load_dwordx4 v1, s[4:7], s12 offen offset:0 sc1 lds
    buffer_load_dwordx4 v1, s[4:7], s12 offen offset:1024 sc1 lds
    buffer_load_dwordx4 v1, s[4:7], s12 offen offset:2048 sc1 lds
    buffer_load_dwordx4 v1, s[4:7], s12 offen offset:3072 sc1 lds
    s_mov_b32 m0, 77824
    s_add_u32 s12, s11, 0x95d000
    buffer_load_dwordx4 v1, s[4:7], s12 offen offset:0 sc1 lds
    buffer_load_dwordx4 v1, s[4:7], s12 offen offset:1024 sc1 lds
    buffer_load_dwordx4 v1, s[4:7], s12 offen offset:2048 sc1 lds
    buffer_load_dwordx4 v1, s[4:7], s12 offen offset:3072 sc1 lds
    s_mov_b32 m0, 81920
    s_add_u32 s12, s11, 0x95e000
    buffer_load_dwordx4 v1, s[4:7], s12 offen offset:0 sc1 lds
    buffer_load_dwordx4 v1, s[4:7], s12 offen offset:1024 sc1 lds
    buffer_load_dwordx4 v1, s[4:7], s12 offen offset:2048 sc1 lds
    buffer_load_dwordx4 v1, s[4:7], s12 offen offset:3072 sc1 lds
    s_mov_b32 m0, 86016
    s_add_u32 s12, s11, 0x95f000
    buffer_load_dwordx4 v1, s[4:7], s12 offen offset:0 sc1 lds
    buffer_load_dwordx4 v1, s[4:7], s12 offen offset:1024 sc1 lds
    buffer_load_dwordx4 v1, s[4:7], s12 offen offset:2048 sc1 lds
    buffer_load_dwordx4 v1, s[4:7], s12 offen offset:3072 sc1 lds
    s_mov_b32 m0, 90112
    s_add_u32 s12, s11, 0x960000
    buffer_load_dwordx4 v1, s[4:7], s12 offen offset:0 sc1 lds
    buffer_load_dwordx4 v1, s[4:7], s12 offen offset:1024 sc1 lds
    buffer_load_dwordx4 v1, s[4:7], s12 offen offset:2048 sc1 lds
    buffer_load_dwordx4 v1, s[4:7], s12 offen offset:3072 sc1 lds
    s_mov_b32 m0, 94208
    s_add_u32 s12, s11, 0x961000
    buffer_load_dwordx4 v1, s[4:7], s12 offen offset:0 sc1 lds
    buffer_load_dwordx4 v1, s[4:7], s12 offen offset:1024 sc1 lds
    buffer_load_dwordx4 v1, s[4:7], s12 offen offset:2048 sc1 lds
    buffer_load_dwordx4 v1, s[4:7], s12 offen offset:3072 sc1 lds
    s_mov_b32 s25, s11
    s_lshl_b32 s29, s9, 5
    s_add_u32 s29, s29, 0x3b00000
    s_add_u32 s12, s25, 0x91c000
    s_add_u32 s14, s12, 0
    buffer_load_dwordx4 a[0:3], v1, s[4:7], s14 offen offset:0 sc1
    buffer_load_dwordx4 a[4:7], v1, s[4:7], s14 offen offset:1024 sc1
    buffer_load_dwordx4 a[8:11], v1, s[4:7], s14 offen offset:2048 sc1
    buffer_load_dwordx4 a[12:15], v1, s[4:7], s14 offen offset:3072 sc1
    s_add_u32 s14, s12, 4096
    buffer_load_dwordx4 a[16:19], v1, s[4:7], s14 offen offset:0 sc1
    buffer_load_dwordx4 a[20:23], v1, s[4:7], s14 offen offset:1024 sc1
    buffer_load_dwordx4 a[24:27], v1, s[4:7], s14 offen offset:2048 sc1
    buffer_load_dwordx4 a[28:31], v1, s[4:7], s14 offen offset:3072 sc1
    s_add_u32 s14, s12, 8192
    buffer_load_dwordx4 a[32:35], v1, s[4:7], s14 offen offset:0 sc1
    buffer_load_dwordx4 a[36:39], v1, s[4:7], s14 offen offset:1024 sc1
    buffer_load_dwordx4 a[40:43], v1, s[4:7], s14 offen offset:2048 sc1
    buffer_load_dwordx4 a[44:47], v1, s[4:7], s14 offen offset:3072 sc1
    s_add_u32 s14, s12, 12288
    buffer_load_dwordx4 a[48:51], v1, s[4:7], s14 offen offset:0 sc1
    buffer_load_dwordx4 a[52:55], v1, s[4:7], s14 offen offset:1024 sc1
    s_add_u32 s12, s25, 0x91f800
    s_add_u32 s14, s12, 0
    buffer_load_dwordx4 a[56:59], v1, s[4:7], s14 offen offset:0 sc1
    buffer_load_dwordx4 a[60:63], v1, s[4:7], s14 offen offset:1024 sc1
    buffer_load_dwordx4 a[64:67], v1, s[4:7], s14 offen offset:2048 sc1
    buffer_load_dwordx4 a[68:71], v1, s[4:7], s14 offen offset:3072 sc1
    s_add_u32 s14, s12, 4096
    buffer_load_dwordx4 a[72:75], v1, s[4:7], s14 offen offset:0 sc1
    buffer_load_dwordx4 a[76:79], v1, s[4:7], s14 offen offset:1024 sc1
    buffer_load_dwordx4 a[80:83], v1, s[4:7], s14 offen offset:2048 sc1
    buffer_load_dwordx4 a[84:87], v1, s[4:7], s14 offen offset:3072 sc1
    s_add_u32 s14, s12, 8192
    buffer_load_dwordx4 a[88:91], v1, s[4:7], s14 offen offset:0 sc1
    buffer_load_dwordx4 a[92:95], v1, s[4:7], s14 offen offset:1024 sc1
    buffer_load_dwordx4 a[96:99], v1, s[4:7], s14 offen offset:2048 sc1
    buffer_load_dwordx4 a[100:103], v1, s[4:7], s14 offen offset:3072 sc1
    s_add_u32 s14, s12, 12288
    buffer_load_dwordx4 a[104:107], v1, s[4:7], s14 offen offset:0 sc1
    buffer_load_dwordx4 a[108:111], v1, s[4:7], s14 offen offset:1024 sc1
    s_waitcnt vmcnt(46)
    s_add_u32 s12, s25, 0x923000
    s_add_u32 s14, s12, 0
    buffer_load_dwordx4 a[112:115], v1, s[4:7], s14 offen offset:0 sc1
    buffer_load_dwordx4 a[116:119], v1, s[4:7], s14 offen offset:1024 sc1
    buffer_load_dwordx4 a[120:123], v1, s[4:7], s14 offen offset:2048 sc1
    buffer_load_dwordx4 a[124:127], v1, s[4:7], s14 offen offset:3072 sc1
    s_add_u32 s14, s12, 4096
    buffer_load_dwordx4 a[128:131], v1, s[4:7], s14 offen offset:0 sc1
    buffer_load_dwordx4 a[132:135], v1, s[4:7], s14 offen offset:1024 sc1
    buffer_load_dwordx4 a[136:139], v1, s[4:7], s14 offen offset:2048 sc1
    buffer_load_dwordx4 a[140:143], v1, s[4:7], s14 offen offset:3072 sc1
    s_add_u32 s14, s12, 8192
    buffer_load_dwordx4 a[144:147], v1, s[4:7], s14 offen offset:0 sc1
    buffer_load_dwordx4 a[148:151], v1, s[4:7], s14 offen offset:1024 sc1
    buffer_load_dwordx4 a[152:155], v1, s[4:7], s14 offen offset:2048 sc1
    buffer_load_dwordx4 a[156:159], v1, s[4:7], s14 offen offset:3072 sc1
    s_add_u32 s14, s12, 12288
    buffer_load_dwordx4 a[160:163], v1, s[4:7], s14 offen offset:0 sc1
    buffer_load_dwordx4 a[164:167], v1, s[4:7], s14 offen offset:1024 sc1
    s_waitcnt vmcnt(46)
    s_mov_b32 s11, 0x3b02000
    v_min_u32 v4, 63, v0
    v_lshlrev_b32 v4, 4, v4
    s_mov_b32 s22, 0
wt_413:
    buffer_load_dwordx4 v[32:35], v4, s[4:7], s11 offen offset:0 sc1
    buffer_load_dwordx4 v[36:39], v4, s[4:7], s11 offen offset:1024 sc1
    s_waitcnt vmcnt(0)
    v_xor_b32 v32, s80, v32
    v_xor_b32 v33, s81, v33
    v_and_b32 v33, -16, v33
    v_xor_b32 v34, s80, v34
    v_xor_b32 v35, s81, v35
    v_and_b32 v35, -16, v35
    v_xor_b32 v36, s80, v36
    v_xor_b32 v37, s81, v37
    v_and_b32 v37, -16, v37
    v_xor_b32 v38, s80, v38
    v_xor_b32 v39, s81, v39
    v_and_b32 v39, -16, v39
    v_or3_b32 v32, v32, v33, v34
    v_or_b32 v32, v32, v35
    v_or3_b32 v32, v32, v36, v37
    v_or3_b32 v32, v32, v38, v39
    v_cmp_ne_u32 vcc, 0, v32
    s_cbranch_vccz wtok_414
    s_add_u32 s22, s22, 1
    s_cmp_gt_u32 s22, 65536
    s_cbranch_scc1 M_exit
    s_sleep 16
    s_branch wt_413
wtok_414:
    s_mov_b32 s30, 0
    s_getreg_b32 s27, hwreg(HW_REG_XCC_ID, 0, 4)
    v_min_u32 v165, 31, v0
    v_lshlrev_b32 v165, 3, v165
    s_mov_b32 s11, 0x3b02000
    buffer_load_dword v164, v165, s[4:7], s11 offen offset:4 sc1
    s_waitcnt vmcnt(0)
    v_and_b32 v164, 15, v164
    v_cmp_ne_u32 vcc, s27, v164
    s_cbranch_vccnz mf_415
    s_mov_b32 s30, 1
mf_415:
    s_add_u32 s12, s25, 0x926800
    s_add_u32 s14, s12, 0
    buffer_load_dwordx4 a[168:171], v1, s[4:7], s14 offen offset:0 sc1
    buffer_load_dwordx4 a[172:175], v1, s[4:7], s14 offen offset:1024 sc1
    buffer_load_dwordx4 a[176:179], v1, s[4:7], s14 offen offset:2048 sc1
    buffer_load_dwordx4 a[180:183], v1, s[4:7], s14 offen offset:3072 sc1
    s_add_u32 s14, s12, 4096
    buffer_load_dwordx4 a[184:187], v1, s[4:7], s14 offen offset:0 sc1
    buffer_load_dwordx4 a[188:191], v1, s[4:7], s14 offen offset:1024 sc1
    buffer_load_dwordx4 a[192:195], v1, s[4:7], s14 offen offset:2048 sc1
    buffer_load_dwordx4 a[196:199], v1, s[4:7], s14 offen offset:3072 sc1
    s_add_u32 s14, s12, 8192
    buffer_load_dwordx4 a[200:203], v1, s[4:7], s14 offen offset:0 sc1
    buffer_load_dwordx4 a[204:207], v1, s[4:7], s14 offen offset:1024 sc1
    buffer_load_dwordx4 a[208:211], v1, s[4:7], s14 offen offset:2048 sc1
    buffer_load_dwordx4 a[212:215], v1, s[4:7], s14 offen offset:3072 sc1
    s_add_u32 s14, s12, 12288
    buffer_load_dwordx4 a[216:219], v1, s[4:7], s14 offen offset:0 sc1
    buffer_load_dwordx4 a[220:223], v1, s[4:7], s14 offen offset:1024 sc1
    s_waitcnt vmcnt(46)
    s_add_u32 s12, s25, 0x954000
    s_add_u32 s14, s12, 0
    buffer_load_dwordx4 a[224:227], v1, s[4:7], s14 offen offset:0 sc1
    buffer_load_dwordx4 a[228:231], v1, s[4:7], s14 offen offset:1024 sc1
    buffer_load_dwordx4 a[232:235], v1, s[4:7], s14 offen offset:2048 sc1
    buffer_load_dwordx4 a[236:239], v1, s[4:7], s14 offen offset:3072 sc1
    s_add_u32 s14, s12, 4096
    buffer_load_dwordx4 a[240:243], v1, s[4:7], s14 offen offset:0 sc1
    buffer_load_dwordx4 a[244:247], v1, s[4:7], s14 offen offset:1024 sc1
    buffer_load_dwordx4 a[248:251], v1, s[4:7], s14 offen offset:2048 sc1
    buffer_load_dwordx4 a[252:255], v1, s[4:7], s14 offen offset:3072 sc1
    s_add_u32 s14, s12, 8192
    buffer_load_dwordx4 v[176:179], v1, s[4:7], s14 offen offset:0 sc1
    buffer_load_dwordx4 v[180:183], v1, s[4:7], s14 offen offset:1024 sc1
    buffer_load_dwordx4 v[184:187], v1, s[4:7], s14 offen offset:2048 sc1
    buffer_load_dwordx4 v[188:191], v1, s[4:7], s14 offen offset:3072 sc1
    s_add_u32 s14, s12, 12288
    buffer_load_dwordx4 v[192:195], v1, s[4:7], s14 offen offset:0 sc1
    buffer_load_dwordx4 v[196:199], v1, s[4:7], s14 offen offset:1024 sc1
    s_waitcnt vmcnt(46)
    s_add_u32 s12, s25, 0x957800
    s_add_u32 s14, s12, 0
    buffer_load_dwordx4 v[200:203], v1, s[4:7], s14 offen offset:0 sc1
    buffer_load_dwordx4 v[204:207], v1, s[4:7], s14 offen offset:1024 sc1
    buffer_load_dwordx4 v[208:211], v1, s[4:7], s14 offen offset:2048 sc1
    buffer_load_dwordx4 v[212:215], v1, s[4:7], s14 offen offset:3072 sc1
    s_add_u32 s14, s12, 4096
    buffer_load_dwordx4 v[216:219], v1, s[4:7], s14 offen offset:0 sc1
    buffer_load_dwordx4 v[220:223], v1, s[4:7], s14 offen offset:1024 sc1
    buffer_load_dwordx4 v[224:227], v1, s[4:7], s14 offen offset:2048 sc1
    buffer_load_dwordx4 v[228:231], v1, s[4:7], s14 offen offset:3072 sc1
    s_add_u32 s14, s12, 8192
    buffer_load_dwordx4 v[232:235], v1, s[4:7], s14 offen offset:0 sc1
    buffer_load_dwordx4 v[236:239], v1, s[4:7], s14 offen offset:1024 sc1
    buffer_load_dwordx4 v[240:243], v1, s[4:7], s14 offen offset:2048 sc1
    buffer_load_dwordx4 v[244:247], v1, s[4:7], s14 offen offset:3072 sc1
    s_add_u32 s14, s12, 12288
    buffer_load_dwordx4 v[248:251], v1, s[4:7], s14 offen offset:0 sc1
    buffer_load_dwordx4 v[252:255], v1, s[4:7], s14 offen offset:1024 sc1
    s_waitcnt vmcnt(46)
    s_mov_b32 s8, 0
    v_mov_b32 v32, 0
    v_mov_b32 v33, 0
    v_mov_b32 v34, 0
    v_mov_b32 v35, 0
    v_mov_b32 v36, 0
    v_mov_b32 v37, 0
    v_mov_b32 v38, 0
    v_mov_b32 v39, 0
    v_mov_b32 v40, 0
    v_mov_b32 v41, 0
    v_mov_b32 v42, 0
    v_mov_b32 v43, 0
    v_mov_b32 v44, 0
    v_mov_b32 v45, 0
    v_mov_b32 v46, 0
    v_mov_b32 v47, 0
    v_mov_b32 v48, 0
    v_mov_b32 v49, 0
    v_mov_b32 v50, 0
    v_mov_b32 v51, 0
    v_mov_b32 v52, 0
    v_mov_b32 v53, 0
    v_mov_b32 v54, 0
    v_mov_b32 v55, 0
    v_mov_b32 v56, 0
    v_mov_b32 v57, 0
    v_mov_b32 v58, 0
    v_mov_b32 v59, 0
    v_mov_b32 v60, 0
    v_mov_b32 v61, 0
    v_mov_b32 v62, 0
    v_mov_b32 v63, 0
    s_mov_b32 s22, 0
v_u0_416:
    s_add_u32 s22, s22, 1
    s_cmp_gt_u32 s22, 65536
    s_cbranch_scc1 M_exit
    buffer_load_dword v166, v168, s[4:7], s29 offen sc1
    s_waitcnt vmcnt(0)
    v_cmp_eq_u32 vcc, 0, v166
    s_cbranch_vccnz v_u0_416
    v_and_b32 v167, 3, v0
    v_lshlrev_b32 v167, 2, v167
.p2align 8
v_dry_409:
v_loop_418:
    v_mov_b32 v140, 0
    v_mov_b32 v141, 0
    v_mov_b32 v142, 0
    v_mov_b32 v143, 0
    v_mov_b32 v144, 0
    v_mov_b32 v145, 0
    v_mov_b32 v146, 0
    v_mov_b32 v147, 0
    s_and_b32 s23, s8, 7
    s_lshl_b32 s23, s23, 13
    s_add_u32 s23, s23, 0x3100000
    s_add_u32 s26, s23, 4096
    ds_read_b128 v[64:67], v163 offset:6144
    ds_read_b128 v[68:71], v163 offset:7168
    ds_read_b128 v[72:75], v163 offset:8192
    ds_read_b128 v[76:79], v163 offset:9216
    ds_read_b128 v[80:83], v163 offset:0
    ds_read_b128 v[84:87], v163 offset:1024
    s_and_b32 s11, s8, 15
    s_mul_i32 s11, s11, 458752
    s_lshl_b32 s12, s9, 15
    s_add_u32 s11, s11, s12
    s_add_u32 s11, s11, 0x1002000
    s_add_u32 s12, s11, 16384
    s_sleep 4
    s_mov_b32 s22, 0
    buffer_load_dwordx4 v[16:19], v1, s[4:7], s23 offen offset:3072 sc1
    buffer_load_dwordx4 v[20:23], v1, s[4:7], s26 offen offset:0 sc1
poll_420:
    s_waitcnt vmcnt(0)
    buffer_load_dwordx4 v[16:19], v1, s[4:7], s23 offen offset:3072 sc1
    buffer_load_dwordx4 v[20:23], v1, s[4:7], s26 offen offset:0 sc1
    v_max3_u32 v156, v16, v17, v18
    v_max3_u32 v156, v156, v19, v20
    v_max3_u32 v156, v156, v21, v22
    v_max_u32 v156, v156, v23
    v_cmp_eq_u32 vcc, -1, v156
    ds_write_b128 v1, v[16:19] offset:3072
    ds_write_b128 v1, v[20:23] offset:4096
    s_add_u32 s22, s22, 1
    s_cmp_gt_u32 s22, 65536
    s_cbranch_scc1 M_exit
    s_cbranch_vccnz poll_420
pok_419:
    v_smfmac_f32_16x16x64_bf16 v[32:35], v[16:19], a[24:31], v2
    v_smfmac_f32_16x16x64_bf16 v[36:39], v[16:19], a[80:87], v2
    v_smfmac_f32_16x16x64_bf16 v[40:43], v[16:19], a[136:143], v2
    v_smfmac_f32_16x16x64_bf16 v[44:47], v[16:19], a[192:199], v2
    s_waitcnt lgkmcnt(0)
    s_barrier
    ds_read_b128 v[4:7], v1 offset:0
    ds_read_b128 v[8:11], v1 offset:1024
    buffer_load_dwordx4 v[88:91], v1, s[4:7], s11 offen offset:0 sc1
    v_smfmac_f32_16x16x64_bf16 v[56:59], v[16:19], v[64:71], v2
    ds_read_b128 v[12:15], v1 offset:2048
    v_smfmac_f32_16x16x64_bf16 v[32:35], v[20:23], a[32:39], v2
    ds_read_b128 v[24:27], v1 offset:5120
    ds_read_b128 v[64:67], v163 offset:2048
    v_smfmac_f32_16x16x64_bf16 v[36:39], v[20:23], a[88:95], v2
    ds_read_b128 v[28:31], v1 offset:6144
    ds_read_b128 v[68:71], v163 offset:3072
    v_smfmac_f32_16x16x64_bf16 v[40:43], v[20:23], a[144:151], v2
    buffer_load_dwordx4 v[92:95], v1, s[4:7], s11 offen offset:1024 sc1
    v_smfmac_f32_16x16x64_bf16 v[56:59], v[20:23], v[72:79], v2
    s_waitcnt lgkmcnt(6)
    v_smfmac_f32_16x16x64_bf16 v[32:35], v[4:7], a[0:7], v2
    ds_read_b128 v[72:75], v163 offset:4096
    v_smfmac_f32_16x16x64_bf16 v[36:39], v[4:7], a[56:63], v2
    ds_read_b128 v[76:79], v163 offset:5120
    v_smfmac_f32_16x16x64_bf16 v[40:43], v[4:7], a[112:119], v2
    buffer_load_dwordx4 v[96:99], v1, s[4:7], s11 offen offset:2048 sc1
    v_smfmac_f32_16x16x64_bf16 v[56:59], v[4:7], v[80:87], v2
    s_waitcnt lgkmcnt(7)
    v_smfmac_f32_16x16x64_bf16 v[32:35], v[8:11], a[8:15], v2
    ds_read_b128 v[80:83], v163 offset:10240
    v_smfmac_f32_16x16x64_bf16 v[36:39], v[8:11], a[64:71], v2
    ds_read_b128 v[84:87], v163 offset:11264
    v_smfmac_f32_16x16x64_bf16 v[40:43], v[8:11], a[120:127], v2
    buffer_load_dwordx4 v[100:103], v1, s[4:7], s11 offen offset:3072 sc1
    s_waitcnt lgkmcnt(4)
    v_smfmac_f32_16x16x64_bf16 v[56:59], v[8:11], v[64:71], v2
    v_smfmac_f32_16x16x64_bf16 v[32:35], v[12:15], a[16:23], v2
    ds_read_b128 v[64:67], v163 offset:12288
    v_smfmac_f32_16x16x64_bf16 v[36:39], v[12:15], a[72:79], v2
    ds_read_b128 v[68:71], v163 offset:13312
    v_smfmac_f32_16x16x64_bf16 v[40:43], v[12:15], a[128:135], v2
    buffer_load_dwordx4 v[104:107], v1, s[4:7], s12 offen offset:0 sc1
    s_waitcnt lgkmcnt(4)
    v_smfmac_f32_16x16x64_bf16 v[56:59], v[12:15], v[72:79], v2
    v_smfmac_f32_16x16x64_bf16 v[32:35], v[24:27], a[40:47], v2
    ds_read_b128 v[72:75], v163 offset:20480
    v_smfmac_f32_16x16x64_bf16 v[36:39], v[24:27], a[96:103], v2
    ds_read_b128 v[76:79], v163 offset:21504
    v_smfmac_f32_16x16x64_bf16 v[40:43], v[24:27], a[152:159], v2
    buffer_load_dwordx4 v[108:111], v1, s[4:7], s12 offen offset:1024 sc1
    s_waitcnt lgkmcnt(4)
    v_smfmac_f32_16x16x64_bf16 v[56:59], v[24:27], v[80:87], v2
    v_smfmac_f32_16x16x64_bf16 v[32:35], v[28:31], a[48:55], v2
    ds_read_b128 v[80:83], v163 offset:22528
    v_smfmac_f32_16x16x64_bf16 v[36:39], v[28:31], a[104:111], v2
    ds_read_b128 v[84:87], v163 offset:23552
    v_smfmac_f32_16x16x64_bf16 v[40:43], v[28:31], a[160:167], v2
    buffer_load_dwordx4 v[112:115], v1, s[4:7], s12 offen offset:2048 sc1
    s_waitcnt lgkmcnt(4)
    v_smfmac_f32_16x16x64_bf16 v[56:59], v[28:31], v[64:71], v2
    ds_read_b128 v[64:67], v163 offset:14336
    v_smfmac_f32_16x16x64_bf16 v[48:51], v[16:19], a[248:255], v2
    ds_read_b128 v[68:71], v163 offset:15360
    v_add_f32 v32, v32, v34
    v_smfmac_f32_16x16x64_bf16 v[52:55], v[16:19], v[224:231], v2
    buffer_load_dwordx4 v[116:119], v1, s[4:7], s12 offen offset:3072 sc1
    v_add_f32 v33, v33, v35
    s_waitcnt lgkmcnt(4)
    v_smfmac_f32_16x16x64_bf16 v[60:63], v[16:19], v[72:79], v2
    v_cvt_pk_bf16_f32 v132, v32, v33
    v_smfmac_f32_16x16x64_bf16 v[44:47], v[20:23], a[200:207], v2
    ds_read_b128 v[72:75], v163 offset:16384
    v_add_f32 v36, v36, v38
    v_smfmac_f32_16x16x64_bf16 v[48:51], v[20:23], v[176:183], v2
    ds_read_b128 v[76:79], v163 offset:17408
    v_add_f32 v37, v37, v39
    v_smfmac_f32_16x16x64_bf16 v[52:55], v[20:23], v[232:239], v2
    v_cvt_pk_bf16_f32 v134, v36, v37
    s_waitcnt lgkmcnt(4)
    v_smfmac_f32_16x16x64_bf16 v[60:63], v[20:23], v[80:87], v2
    v_add_f32 v40, v40, v42
    v_smfmac_f32_16x16x64_bf16 v[44:47], v[4:7], a[168:175], v2
    ds_read_b128 v[80:83], v163 offset:18432
    v_add_f32 v41, v41, v43
    v_smfmac_f32_16x16x64_bf16 v[48:51], v[4:7], a[224:231], v2
    ds_read_b128 v[84:87], v163 offset:19456
    v_cvt_pk_bf16_f32 v136, v40, v41
    v_smfmac_f32_16x16x64_bf16 v[52:55], v[4:7], v[200:207], v2
    v_add_f32 v56, v56, v58
    s_waitcnt lgkmcnt(4)
    v_smfmac_f32_16x16x64_bf16 v[60:63], v[4:7], v[64:71], v2
    v_add_f32 v57, v57, v59
    v_smfmac_f32_16x16x64_bf16 v[44:47], v[8:11], a[176:183], v2
    ds_read_b128 v[64:67], v163 offset:24576
    v_cvt_pk_bf16_f32 v137, v56, v57
    v_smfmac_f32_16x16x64_bf16 v[48:51], v[8:11], a[232:239], v2
    ds_read_b128 v[68:71], v163 offset:25600
    v_smfmac_f32_16x16x64_bf16 v[52:55], v[8:11], v[208:215], v2
    s_waitcnt lgkmcnt(4)
    v_smfmac_f32_16x16x64_bf16 v[60:63], v[8:11], v[72:79], v2
    v_smfmac_f32_16x16x64_bf16 v[44:47], v[12:15], a[184:191], v2
    ds_read_b128 v[72:75], v163 offset:26624
    v_smfmac_f32_16x16x64_bf16 v[48:51], v[12:15], a[240:247], v2
    ds_read_b128 v[76:79], v163 offset:27648
    v_smfmac_f32_16x16x64_bf16 v[52:55], v[12:15], v[216:223], v2
    s_waitcnt lgkmcnt(4)
    v_smfmac_f32_16x16x64_bf16 v[60:63], v[12:15], v[80:87], v2
    v_smfmac_f32_16x16x64_bf16 v[44:47], v[24:27], a[208:215], v2
    v_smfmac_f32_16x16x64_bf16 v[48:51], v[24:27], v[184:191], v2
    v_smfmac_f32_16x16x64_bf16 v[52:55], v[24:27], v[240:247], v2
    s_waitcnt lgkmcnt(2)
    v_smfmac_f32_16x16x64_bf16 v[60:63], v[24:27], v[64:71], v2
    v_smfmac_f32_16x16x64_bf16 v[44:47], v[28:31], a[216:223], v2
    v_smfmac_f32_16x16x64_bf16 v[48:51], v[28:31], v[192:199], v2
    v_smfmac_f32_16x16x64_bf16 v[52:55], v[28:31], v[248:255], v2
    s_waitcnt lgkmcnt(0)
    v_smfmac_f32_16x16x64_bf16 v[60:63], v[28:31], v[72:79], v2
    v_add_f32 v44, v44, v46
    s_and_b32 s11, s8, 3
    s_lshl_b32 s11, s11, 14
    s_add_u32 s25, s11, 0x3112800
    s_add_u32 s24, s11, 0x3111000
    s_add_u32 s11, s8, 1
    s_and_b32 s12, s11, 7
    s_lshl_b32 s12, s12, 13
    s_add_u32 s12, s12, 0x3100000
    s_mov_b32 s22, 0
    buffer_load_dwordx4 v[120:123], v1, s[4:7], s24 offen sc1
    buffer_load_dwordx4 v[124:127], v1, s[4:7], s24 offen offset:1024 sc1
    buffer_load_dwordx4 v[128:131], v1, s[4:7], s25 offen sc1
    v_add_f32 v45, v45, v47
    v_cvt_pk_bf16_f32 v138, v44, v45
    v_add_f32 v48, v48, v50
    v_add_f32 v49, v49, v51
    v_cvt_pk_bf16_f32 v133, v48, v49
    v_add_f32 v52, v52, v54
    v_add_f32 v53, v53, v55
    v_cvt_pk_bf16_f32 v135, v52, v53
    v_add_f32 v60, v60, v62
    v_add_f32 v61, v61, v63
    v_cvt_pk_bf16_f32 v139, v60, v61
    v_mov_b32 v32, 0
    v_mov_b32 v33, 0
    v_mov_b32 v34, 0
    v_mov_b32 v35, 0
    v_mov_b32 v36, 0
    v_mov_b32 v37, 0
    v_mov_b32 v38, 0
    v_mov_b32 v39, 0
    v_mov_b32 v40, 0
    v_mov_b32 v41, 0
    v_mov_b32 v42, 0
    v_mov_b32 v43, 0
    v_mov_b32 v44, 0
    v_mov_b32 v45, 0
    v_mov_b32 v46, 0
    v_mov_b32 v47, 0
    v_mov_b32 v48, 0
    v_mov_b32 v49, 0
    v_mov_b32 v50, 0
    v_mov_b32 v51, 0
    v_mov_b32 v52, 0
    v_mov_b32 v53, 0
    v_mov_b32 v54, 0
    v_mov_b32 v55, 0
    v_mov_b32 v56, 0
    v_mov_b32 v57, 0
    v_mov_b32 v58, 0
    v_mov_b32 v59, 0
    v_mov_b32 v60, 0
    v_mov_b32 v61, 0
    v_mov_b32 v62, 0
    v_mov_b32 v63, 0
q_422:
    s_waitcnt vmcnt(2)
    v_max3_u32 v156, v120, v121, v122
    v_max_u32 v156, v156, v123
    v_cmp_eq_u32 vcc, -1, v156
    buffer_load_dwordx4 v[120:123], v1, s[4:7], s24 offen sc1
    s_add_u32 s22, s22, 1
    s_cmp_gt_u32 s22, 196608
    s_cbranch_scc1 M_exit
    s_cbranch_vccnz q_423
    v_smfmac_f32_16x16x64_bf16 v[140:143], v[120:123], v[88:95], v2
    v_smfmac_f32_16x16x64_bf16 v[144:147], v[120:123], v[104:111], v2
q_424:
    s_waitcnt vmcnt(2)
    v_max3_u32 v156, v124, v125, v126
    v_max_u32 v156, v156, v127
    v_cmp_eq_u32 vcc, -1, v156
    s_cbranch_vccnz qf_425
    v_smfmac_f32_16x16x64_bf16 v[140:143], v[124:127], v[96:103], v2
    v_smfmac_f32_16x16x64_bf16 v[144:147], v[124:127], v[112:119], v2
q_426:
    s_waitcnt vmcnt(1)
    v_max3_u32 v156, v128, v129, v130
    v_max_u32 v156, v156, v131
    v_cmp_eq_u32 vcc, -1, v156
    s_cbranch_vccnz qf_427
    v_smfmac_f32_16x16x64_bf16 v[140:143], v[128:131], v[132:139], v3
    v_smfmac_f32_16x16x64_bf16 v[144:147], v[128:131], v[132:139], v160
qdone_421:
    s_nop 6
    v_add_f32 v148, v140, v142
    v_add_f32 v150, v141, v143
    v_add_f32 v149, v144, v146
    v_add_f32 v151, v145, v147
    ds_write2_b64 v157, v[148:149], v[150:151] offset0:0 offset1:16
    s_waitcnt lgkmcnt(0)
    s_barrier
    s_add_u32 s13, s9, 64
    s_add_u32 s8, s8, 1
    s_cmp_lt_u32 s8, 63
    s_cbranch_scc1 v_loop_418
    s_branch M_exit
q_423:
    s_waitcnt vmcnt(2)
    v_max3_u32 v156, v124, v125, v126
    v_max_u32 v156, v156, v127
    v_cmp_eq_u32 vcc, -1, v156
    buffer_load_dwordx4 v[124:127], v1, s[4:7], s24 offen offset:1024 sc1
    s_add_u32 s22, s22, 1
    s_cmp_gt_u32 s22, 196608
    s_cbranch_scc1 M_exit
    s_cbranch_vccnz q_429
    v_smfmac_f32_16x16x64_bf16 v[140:143], v[124:127], v[96:103], v2
    v_smfmac_f32_16x16x64_bf16 v[144:147], v[124:127], v[112:119], v2
q_430:
    s_waitcnt vmcnt(2)
    v_max3_u32 v156, v128, v129, v130
    v_max_u32 v156, v156, v131
    v_cmp_eq_u32 vcc, -1, v156
    s_cbranch_vccnz qf_431
    v_smfmac_f32_16x16x64_bf16 v[140:143], v[128:131], v[132:139], v3
    v_smfmac_f32_16x16x64_bf16 v[144:147], v[128:131], v[132:139], v160
q_432:
    s_waitcnt vmcnt(1)
    v_max3_u32 v156, v120, v121, v122
    v_max_u32 v156, v156, v123
    v_cmp_eq_u32 vcc, -1, v156
    s_cbranch_vccnz qf_433
    v_smfmac_f32_16x16x64_bf16 v[140:143], v[120:123], v[88:95], v2
    v_smfmac_f32_16x16x64_bf16 v[144:147], v[120:123], v[104:111], v2
    s_branch qdone_421
q_434:
    s_waitcnt vmcnt(2)
    v_max3_u32 v156, v128, v129, v130
    v_max_u32 v156, v156, v131
    v_cmp_eq_u32 vcc, -1, v156
    s_cbranch_vccnz qf_435
    v_smfmac_f32_16x16x64_bf16 v[140:143], v[128:131], v[132:139], v3
    v_smfmac_f32_16x16x64_bf16 v[144:147], v[128:131], v[132:139], v160
q_436:
    s_waitcnt vmcnt(0)
    v_max3_u32 v156, v124, v125, v126
    v_max_u32 v156, v156, v127
    v_cmp_eq_u32 vcc, -1, v156
    s_cbranch_vccnz qf_437
    v_smfmac_f32_16x16x64_bf16 v[140:143], v[124:127], v[96:103], v2
    v_smfmac_f32_16x16x64_bf16 v[144:147], v[124:127], v[112:119], v2
    s_branch qdone_421
q_438:
    s_waitcnt vmcnt(0)
    v_max3_u32 v156, v128, v129, v130
    v_max_u32 v156, v156, v131
    v_cmp_eq_u32 vcc, -1, v156
    s_cbranch_vccnz qf_439
    v_smfmac_f32_16x16x64_bf16 v[140:143], v[128:131], v[132:139], v3
    v_smfmac_f32_16x16x64_bf16 v[144:147], v[128:131], v[132:139], v160
    s_branch qdone_421
q_429:
    s_waitcnt vmcnt(2)
    v_max3_u32 v156, v128, v129, v130
    v_max_u32 v156, v156, v131
    v_cmp_eq_u32 vcc, -1, v156
    buffer_load_dwordx4 v[128:131], v1, s[4:7], s25 offen sc1
    s_add_u32 s22, s22, 1
    s_cmp_gt_u32 s22, 196608
    s_cbranch_scc1 M_exit
    s_cbranch_vccnz q_422
    v_smfmac_f32_16x16x64_bf16 v[140:143], v[128:131], v[132:139], v3
    v_smfmac_f32_16x16x64_bf16 v[144:147], v[128:131], v[132:139], v160
q_442:
    s_waitcnt vmcnt(2)
    v_max3_u32 v156, v120, v121, v122
    v_max_u32 v156, v156, v123
    v_cmp_eq_u32 vcc, -1, v156
    s_cbranch_vccnz qf_443
    v_smfmac_f32_16x16x64_bf16 v[140:143], v[120:123], v[88:95], v2
    v_smfmac_f32_16x16x64_bf16 v[144:147], v[120:123], v[104:111], v2
q_444:
    s_waitcnt vmcnt(1)
    v_max3_u32 v156, v124, v125, v126
    v_max_u32 v156, v156, v127
    v_cmp_eq_u32 vcc, -1, v156
    s_cbranch_vccnz qf_445
    v_smfmac_f32_16x16x64_bf16 v[140:143], v[124:127], v[96:103], v2
    v_smfmac_f32_16x16x64_bf16 v[144:147], v[124:127], v[112:119], v2
    s_branch qdone_421
q_446:
    s_waitcnt vmcnt(2)
    v_max3_u32 v156, v120, v121, v122
    v_max_u32 v156, v156, v123
    v_cmp_eq_u32 vcc, -1, v156
    s_cbranch_vccnz qf_447
    v_smfmac_f32_16x16x64_bf16 v[140:143], v[120:123], v[88:95], v2
    v_smfmac_f32_16x16x64_bf16 v[144:147], v[120:123], v[104:111], v2
    s_branch q_438
q_449:
    s_waitcnt vmcnt(0)
    v_max3_u32 v156, v120, v121, v122
    v_max_u32 v156, v156, v123
    v_cmp_eq_u32 vcc, -1, v156
    s_cbranch_vccnz qf_450
    v_smfmac_f32_16x16x64_bf16 v[140:143], v[120:123], v[88:95], v2
    v_smfmac_f32_16x16x64_bf16 v[144:147], v[120:123], v[104:111], v2
    s_branch qdone_421
q_451:
    s_waitcnt vmcnt(1)
    v_max3_u32 v156, v124, v125, v126
    v_max_u32 v156, v156, v127
    v_cmp_eq_u32 vcc, -1, v156
    s_cbranch_vccnz qf_452
    v_smfmac_f32_16x16x64_bf16 v[140:143], v[124:127], v[96:103], v2
    v_smfmac_f32_16x16x64_bf16 v[144:147], v[124:127], v[112:119], v2
    s_branch q_438
q_454:
    s_waitcnt vmcnt(2)
    v_max3_u32 v156, v124, v125, v126
    v_max_u32 v156, v156, v127
    v_cmp_eq_u32 vcc, -1, v156
    s_cbranch_vccnz qf_455
    v_smfmac_f32_16x16x64_bf16 v[140:143], v[124:127], v[96:103], v2
    v_smfmac_f32_16x16x64_bf16 v[144:147], v[124:127], v[112:119], v2
    s_branch q_449
q_457:
    s_waitcnt vmcnt(1)
    v_max3_u32 v156, v128, v129, v130
    v_max_u32 v156, v156, v131
    v_cmp_eq_u32 vcc, -1, v156
    s_cbranch_vccnz qf_458
    v_smfmac_f32_16x16x64_bf16 v[140:143], v[128:131], v[132:139], v3
    v_smfmac_f32_16x16x64_bf16 v[144:147], v[128:131], v[132:139], v160
    s_branch q_449
q_460:
    s_waitcnt vmcnt(1)
    v_max3_u32 v156, v128, v129, v130
    v_max_u32 v156, v156, v131
    v_cmp_eq_u32 vcc, -1, v156
    s_cbranch_vccnz qf_461
    v_smfmac_f32_16x16x64_bf16 v[140:143], v[128:131], v[132:139], v3
    v_smfmac_f32_16x16x64_bf16 v[144:147], v[128:131], v[132:139], v160
    s_branch q_436
q_463:
    s_waitcnt vmcnt(1)
    v_max3_u32 v156, v120, v121, v122
    v_max_u32 v156, v156, v123
    v_cmp_eq_u32 vcc, -1, v156
    s_cbranch_vccnz qf_464
    v_smfmac_f32_16x16x64_bf16 v[140:143], v[120:123], v[88:95], v2
    v_smfmac_f32_16x16x64_bf16 v[144:147], v[120:123], v[104:111], v2
    s_branch q_436
q_466:
    s_waitcnt vmcnt(1)
    v_max3_u32 v156, v120, v121, v122
    v_max_u32 v156, v156, v123
    v_cmp_eq_u32 vcc, -1, v156
    s_cbranch_vccnz qf_467
    v_smfmac_f32_16x16x64_bf16 v[140:143], v[120:123], v[88:95], v2
    v_smfmac_f32_16x16x64_bf16 v[144:147], v[120:123], v[104:111], v2
    s_branch q_438
q_469:
    s_waitcnt vmcnt(1)
    v_max3_u32 v156, v124, v125, v126
    v_max_u32 v156, v156, v127
    v_cmp_eq_u32 vcc, -1, v156
    s_cbranch_vccnz qf_470
    v_smfmac_f32_16x16x64_bf16 v[140:143], v[124:127], v[96:103], v2
    v_smfmac_f32_16x16x64_bf16 v[144:147], v[124:127], v[112:119], v2
    s_branch q_449
qf_425:
    buffer_load_dwordx4 v[124:127], v1, s[4:7], s24 offen offset:1024 sc1
    s_add_u32 s22, s22, 1
    s_cmp_gt_u32 s22, 196608
    s_cbranch_scc1 M_exit
    s_branch q_434
qf_427:
    buffer_load_dwordx4 v[128:131], v1, s[4:7], s25 offen sc1
    s_add_u32 s22, s22, 1
    s_cmp_gt_u32 s22, 196608
    s_cbranch_scc1 M_exit
    s_branch q_438
qf_431:
    buffer_load_dwordx4 v[128:131], v1, s[4:7], s25 offen sc1
    s_add_u32 s22, s22, 1
    s_cmp_gt_u32 s22, 196608
    s_cbranch_scc1 M_exit
    s_branch q_446
qf_433:
    buffer_load_dwordx4 v[120:123], v1, s[4:7], s24 offen sc1
    s_add_u32 s22, s22, 1
    s_cmp_gt_u32 s22, 196608
    s_cbranch_scc1 M_exit
    s_branch q_449
qf_435:
    buffer_load_dwordx4 v[128:131], v1, s[4:7], s25 offen sc1
    s_add_u32 s22, s22, 1
    s_cmp_gt_u32 s22, 196608
    s_cbranch_scc1 M_exit
    s_branch q_451
qf_437:
    buffer_load_dwordx4 v[124:127], v1, s[4:7], s24 offen offset:1024 sc1
    s_add_u32 s22, s22, 1
    s_cmp_gt_u32 s22, 196608
    s_cbranch_scc1 M_exit
    s_branch q_436
qf_439:
    buffer_load_dwordx4 v[128:131], v1, s[4:7], s25 offen sc1
    s_add_u32 s22, s22, 1
    s_cmp_gt_u32 s22, 196608
    s_cbranch_scc1 M_exit
    s_branch q_438
qf_443:
    buffer_load_dwordx4 v[120:123], v1, s[4:7], s24 offen sc1
    s_add_u32 s22, s22, 1
    s_cmp_gt_u32 s22, 196608
    s_cbranch_scc1 M_exit
    s_branch q_454
qf_445:
    buffer_load_dwordx4 v[124:127], v1, s[4:7], s24 offen offset:1024 sc1
    s_add_u32 s22, s22, 1
    s_cmp_gt_u32 s22, 196608
    s_cbranch_scc1 M_exit
    s_branch q_436
qf_447:
    buffer_load_dwordx4 v[120:123], v1, s[4:7], s24 offen sc1
    s_add_u32 s22, s22, 1
    s_cmp_gt_u32 s22, 196608
    s_cbranch_scc1 M_exit
    s_branch q_457
qf_450:
    buffer_load_dwordx4 v[120:123], v1, s[4:7], s24 offen sc1
    s_add_u32 s22, s22, 1
    s_cmp_gt_u32 s22, 196608
    s_cbranch_scc1 M_exit
    s_branch q_449
qf_452:
    buffer_load_dwordx4 v[124:127], v1, s[4:7], s24 offen offset:1024 sc1
    s_add_u32 s22, s22, 1
    s_cmp_gt_u32 s22, 196608
    s_cbranch_scc1 M_exit
    s_branch q_460
qf_455:
    buffer_load_dwordx4 v[124:127], v1, s[4:7], s24 offen offset:1024 sc1
    s_add_u32 s22, s22, 1
    s_cmp_gt_u32 s22, 196608
    s_cbranch_scc1 M_exit
    s_branch q_463
qf_458:
    buffer_load_dwordx4 v[128:131], v1, s[4:7], s25 offen sc1
    s_add_u32 s22, s22, 1
    s_cmp_gt_u32 s22, 196608
    s_cbranch_scc1 M_exit
    s_branch q_466
qf_461:
    buffer_load_dwordx4 v[128:131], v1, s[4:7], s25 offen sc1
    s_add_u32 s22, s22, 1
    s_cmp_gt_u32 s22, 196608
    s_cbranch_scc1 M_exit
    s_branch q_451
qf_464:
    buffer_load_dwordx4 v[120:123], v1, s[4:7], s24 offen sc1
    s_add_u32 s22, s22, 1
    s_cmp_gt_u32 s22, 196608
    s_cbranch_scc1 M_exit
    s_branch q_469
qf_467:
    buffer_load_dwordx4 v[120:123], v1, s[4:7], s24 offen sc1
    s_add_u32 s22, s22, 1
    s_cmp_gt_u32 s22, 196608
    s_cbranch_scc1 M_exit
    s_branch q_457
qf_470:
    buffer_load_dwordx4 v[124:127], v1, s[4:7], s24 offen offset:1024 sc1
    s_add_u32 s22, s22, 1
    s_cmp_gt_u32 s22, 196608
    s_cbranch_scc1 M_exit
    s_branch q_463
v_w3_102:
    v_and_b32 v0, 63, v0
    v_lshlrev_b32 v1, 4, v0
    v_and_b32 v164, 2, v0
    v_cmp_eq_u32 s[20:21], 0, v164
    v_mov_b32 v2, 0xeeee
    v_mov_b32 v164, 0x4444
    v_cndmask_b32 v2, v2, v164, s[20:21]
    v_and_b32 v168, 16, v1
    v_mov_b32 v166, 0
    v_mov_b32 v3, 0x1111
    v_mov_b32 v164, 0x4444
    v_cndmask_b32 v3, v3, v164, s[20:21]
    v_mov_b32 v160, 0xbbbb
    v_mov_b32 v164, 0xeeee
    v_cndmask_b32 v160, v160, v164, s[20:21]
    v_mov_b32 v162, -1
    v_add_u32 v163, 98304, v1
    v_bfe_u32 v164, v0, 1, 2
    v_lshlrev_b32 v157, 2, v164
    v_bfe_u32 v164, v0, 3, 1
    v_lshl_add_u32 v157, v164, 8, v157
    v_bfe_u32 v164, v0, 4, 1
    v_lshl_add_u32 v157, v164, 7, v157
    v_bfe_u32 v164, v0, 0, 1
    v_lshl_add_u32 v157, v164, 5, v157
    v_bfe_u32 v164, v0, 5, 1
    v_lshl_add_u32 v157, v164, 4, v157
    v_lshlrev_b32 v157, 1, v157
    v_add_u32 v157, 11264, v157
    v_lshlrev_b32 v158, 3, v0
    s_lshl_b32 s11, s9, 9
    v_lshlrev_b32 v159, 2, v0
    v_add_u32 v159, s11, v159
    s_sleep 30
    s_lshl_b32 s11, s10, 8
    s_add_u32 s11, s11, 0x3b02400
    v_min_u32 v4, 15, v0
    v_lshlrev_b32 v4, 4, v4
    s_mov_b32 s22, 0
wt_492:
    buffer_load_dwordx4 v[32:35], v4, s[4:7], s11 offen offset:0 sc1
    s_waitcnt vmcnt(0)
    v_xor_b32 v32, s80, v32
    v_xor_b32 v33, s81, v33
    v_and_b32 v33, -16, v33
    v_xor_b32 v34, s80, v34
    v_xor_b32 v35, s81, v35
    v_and_b32 v35, -16, v35
    v_or3_b32 v32, v32, v33, v34
    v_or_b32 v32, v32, v35
    v_cmp_ne_u32 vcc, 0, v32
    s_cbranch_vccz wtok_493
    s_add_u32 s22, s22, 1
    s_cmp_gt_u32 s22, 65536
    s_cbranch_scc1 M_exit
    s_sleep 16
    s_branch wt_492
wtok_493:
    s_mul_i32 s11, s9, 458752
    s_mov_b32 m0, 98304
    s_add_u32 s12, s11, 0x969000
    buffer_load_dwordx4 v1, s[4:7], s12 offen offset:0 sc1 lds
    buffer_load_dwordx4 v1, s[4:7], s12 offen offset:1024 sc1 lds
    buffer_load_dwordx4 v1, s[4:7], s12 offen offset:2048 sc1 lds
    buffer_load_dwordx4 v1, s[4:7], s12 offen offset:3072 sc1 lds
    s_mov_b32 m0, 102400
    s_add_u32 s12, s11, 0x96a000
    buffer_load_dwordx4 v1, s[4:7], s12 offen offset:0 sc1 lds
    buffer_load_dwordx4 v1, s[4:7], s12 offen offset:1024 sc1 lds
    buffer_load_dwordx4 v1, s[4:7], s12 offen offset:2048 sc1 lds
    buffer_load_dwordx4 v1, s[4:7], s12 offen offset:3072 sc1 lds
    s_mov_b32 m0, 106496
    s_add_u32 s12, s11, 0x96b000
    buffer_load_dwordx4 v1, s[4:7], s12 offen offset:0 sc1 lds
    buffer_load_dwordx4 v1, s[4:7], s12 offen offset:1024 sc1 lds
    buffer_load_dwordx4 v1, s[4:7], s12 offen offset:2048 sc1 lds
    buffer_load_dwordx4 v1, s[4:7], s12 offen offset:3072 sc1 lds
    s_mov_b32 m0, 110592
    s_add_u32 s12, s11, 0x96c000
    buffer_load_dwordx4 v1, s[4:7], s12 offen offset:0 sc1 lds
    buffer_load_dwordx4 v1, s[4:7], s12 offen offset:1024 sc1 lds
    buffer_load_dwordx4 v1, s[4:7], s12 offen offset:2048 sc1 lds
    buffer_load_dwordx4 v1, s[4:7], s12 offen offset:3072 sc1 lds
    s_mov_b32 m0, 114688
    s_add_u32 s12, s11, 0x96d000
    buffer_load_dwordx4 v1, s[4:7], s12 offen offset:0 sc1 lds
    buffer_load_dwordx4 v1, s[4:7], s12 offen offset:1024 sc1 lds
    buffer_load_dwordx4 v1, s[4:7], s12 offen offset:2048 sc1 lds
    buffer_load_dwordx4 v1, s[4:7], s12 offen offset:3072 sc1 lds
    s_mov_b32 m0, 118784
    s_add_u32 s12, s11, 0x96e000
    buffer_load_dwordx4 v1, s[4:7], s12 offen offset:0 sc1 lds
    buffer_load_dwordx4 v1, s[4:7], s12 offen offset:1024 sc1 lds
    buffer_load_dwordx4 v1, s[4:7], s12 offen offset:2048 sc1 lds
    buffer_load_dwordx4 v1, s[4:7], s12 offen offset:3072 sc1 lds
    s_mov_b32 m0, 122880
    s_add_u32 s12, s11, 0x96f000
    buffer_load_dwordx4 v1, s[4:7], s12 offen offset:0 sc1 lds
    buffer_load_dwordx4 v1, s[4:7], s12 offen offset:1024 sc1 lds
    buffer_load_dwordx4 v1, s[4:7], s12 offen offset:2048 sc1 lds
    buffer_load_dwordx4 v1, s[4:7], s12 offen offset:3072 sc1 lds
    s_mov_b32 s25, s11
    s_lshl_b32 s29, s9, 5
    s_add_u32 s29, s29, 0x3b00000
    s_add_u32 s12, s25, 0x92a000
    s_add_u32 s14, s12, 0
    buffer_load_dwordx4 a[0:3], v1, s[4:7], s14 offen offset:0 sc1
    buffer_load_dwordx4 a[4:7], v1, s[4:7], s14 offen offset:1024 sc1
    buffer_load_dwordx4 a[8:11], v1, s[4:7], s14 offen offset:2048 sc1
    buffer_load_dwordx4 a[12:15], v1, s[4:7], s14 offen offset:3072 sc1
    s_add_u32 s14, s12, 4096
    buffer_load_dwordx4 a[16:19], v1, s[4:7], s14 offen offset:0 sc1
    buffer_load_dwordx4 a[20:23], v1, s[4:7], s14 offen offset:1024 sc1
    buffer_load_dwordx4 a[24:27], v1, s[4:7], s14 offen offset:2048 sc1
    buffer_load_dwordx4 a[28:31], v1, s[4:7], s14 offen offset:3072 sc1
    s_add_u32 s14, s12, 8192
    buffer_load_dwordx4 a[32:35], v1, s[4:7], s14 offen offset:0 sc1
    buffer_load_dwordx4 a[36:39], v1, s[4:7], s14 offen offset:1024 sc1
    buffer_load_dwordx4 a[40:43], v1, s[4:7], s14 offen offset:2048 sc1
    buffer_load_dwordx4 a[44:47], v1, s[4:7], s14 offen offset:3072 sc1
    s_add_u32 s14, s12, 12288
    buffer_load_dwordx4 a[48:51], v1, s[4:7], s14 offen offset:0 sc1
    buffer_load_dwordx4 a[52:55], v1, s[4:7], s14 offen offset:1024 sc1
    s_add_u32 s12, s25, 0x92d800
    s_add_u32 s14, s12, 0
    buffer_load_dwordx4 a[56:59], v1, s[4:7], s14 offen offset:0 sc1
    buffer_load_dwordx4 a[60:63], v1, s[4:7], s14 offen offset:1024 sc1
    buffer_load_dwordx4 a[64:67], v1, s[4:7], s14 offen offset:2048 sc1
    buffer_load_dwordx4 a[68:71], v1, s[4:7], s14 offen offset:3072 sc1
    s_add_u32 s14, s12, 4096
    buffer_load_dwordx4 a[72:75], v1, s[4:7], s14 offen offset:0 sc1
    buffer_load_dwordx4 a[76:79], v1, s[4:7], s14 offen offset:1024 sc1
    buffer_load_dwordx4 a[80:83], v1, s[4:7], s14 offen offset:2048 sc1
    buffer_load_dwordx4 a[84:87], v1, s[4:7], s14 offen offset:3072 sc1
    s_add_u32 s14, s12, 8192
    buffer_load_dwordx4 a[88:91], v1, s[4:7], s14 offen offset:0 sc1
    buffer_load_dwordx4 a[92:95], v1, s[4:7], s14 offen offset:1024 sc1
    buffer_load_dwordx4 a[96:99], v1, s[4:7], s14 offen offset:2048 sc1
    buffer_load_dwordx4 a[100:103], v1, s[4:7], s14 offen offset:3072 sc1
    s_add_u32 s14, s12, 12288
    buffer_load_dwordx4 a[104:107], v1, s[4:7], s14 offen offset:0 sc1
    buffer_load_dwordx4 a[108:111], v1, s[4:7], s14 offen offset:1024 sc1
    s_waitcnt vmcnt(46)
    s_add_u32 s12, s25, 0x931000
    s_add_u32 s14, s12, 0
    buffer_load_dwordx4 a[112:115], v1, s[4:7], s14 offen offset:0 sc1
    buffer_load_dwordx4 a[116:119], v1, s[4:7], s14 offen offset:1024 sc1
    buffer_load_dwordx4 a[120:123], v1, s[4:7], s14 offen offset:2048 sc1
    buffer_load_dwordx4 a[124:127], v1, s[4:7], s14 offen offset:3072 sc1
    s_add_u32 s14, s12, 4096
    buffer_load_dwordx4 a[128:131], v1, s[4:7], s14 offen offset:0 sc1
    buffer_load_dwordx4 a[132:135], v1, s[4:7], s14 offen offset:1024 sc1
    buffer_load_dwordx4 a[136:139], v1, s[4:7], s14 offen offset:2048 sc1
    buffer_load_dwordx4 a[140:143], v1, s[4:7], s14 offen offset:3072 sc1
    s_add_u32 s14, s12, 8192
    buffer_load_dwordx4 a[144:147], v1, s[4:7], s14 offen offset:0 sc1
    buffer_load_dwordx4 a[148:151], v1, s[4:7], s14 offen offset:1024 sc1
    buffer_load_dwordx4 a[152:155], v1, s[4:7], s14 offen offset:2048 sc1
    buffer_load_dwordx4 a[156:159], v1, s[4:7], s14 offen offset:3072 sc1
    s_add_u32 s14, s12, 12288
    buffer_load_dwordx4 a[160:163], v1, s[4:7], s14 offen offset:0 sc1
    buffer_load_dwordx4 a[164:167], v1, s[4:7], s14 offen offset:1024 sc1
    s_waitcnt vmcnt(46)
    s_mov_b32 s11, 0x3b02000
    v_min_u32 v4, 63, v0
    v_lshlrev_b32 v4, 4, v4
    s_mov_b32 s22, 0
wt_494:
    buffer_load_dwordx4 v[32:35], v4, s[4:7], s11 offen offset:0 sc1
    buffer_load_dwordx4 v[36:39], v4, s[4:7], s11 offen offset:1024 sc1
    s_waitcnt vmcnt(0)
    v_xor_b32 v32, s80, v32
    v_xor_b32 v33, s81, v33
    v_and_b32 v33, -16, v33
    v_xor_b32 v34, s80, v34
    v_xor_b32 v35, s81, v35
    v_and_b32 v35, -16, v35
    v_xor_b32 v36, s80, v36
    v_xor_b32 v37, s81, v37
    v_and_b32 v37, -16, v37
    v_xor_b32 v38, s80, v38
    v_xor_b32 v39, s81, v39
    v_and_b32 v39, -16, v39
    v_or3_b32 v32, v32, v33, v34
    v_or_b32 v32, v32, v35
    v_or3_b32 v32, v32, v36, v37
    v_or3_b32 v32, v32, v38, v39
    v_cmp_ne_u32 vcc, 0, v32
    s_cbranch_vccz wtok_495
    s_add_u32 s22, s22, 1
    s_cmp_gt_u32 s22, 65536
    s_cbranch_scc1 M_exit
    s_sleep 16
    s_branch wt_494
wtok_495:
    s_mov_b32 s30, 0
    s_getreg_b32 s27, hwreg(HW_REG_XCC_ID, 0, 4)
    v_min_u32 v165, 31, v0
    v_lshlrev_b32 v165, 3, v165
    s_mov_b32 s11, 0x3b02000
    buffer_load_dword v164, v165, s[4:7], s11 offen offset:4 sc1
    s_waitcnt vmcnt(0)
    v_and_b32 v164, 15, v164
    v_cmp_ne_u32 vcc, s27, v164
    s_cbranch_vccnz mf_496
    s_mov_b32 s30, 1
mf_496:
    s_add_u32 s12, s25, 0x934800
    s_add_u32 s14, s12, 0
    buffer_load_dwordx4 a[168:171], v1, s[4:7], s14 offen offset:0 sc1
    buffer_load_dwordx4 a[172:175], v1, s[4:7], s14 offen offset:1024 sc1
    buffer_load_dwordx4 a[176:179], v1, s[4:7], s14 offen offset:2048 sc1
    buffer_load_dwordx4 a[180:183], v1, s[4:7], s14 offen offset:3072 sc1
    s_add_u32 s14, s12, 4096
    buffer_load_dwordx4 a[184:187], v1, s[4:7], s14 offen offset:0 sc1
    buffer_load_dwordx4 a[188:191], v1, s[4:7], s14 offen offset:1024 sc1
    buffer_load_dwordx4 a[192:195], v1, s[4:7], s14 offen offset:2048 sc1
    buffer_load_dwordx4 a[196:199], v1, s[4:7], s14 offen offset:3072 sc1
    s_add_u32 s14, s12, 8192
    buffer_load_dwordx4 a[200:203], v1, s[4:7], s14 offen offset:0 sc1
    buffer_load_dwordx4 a[204:207], v1, s[4:7], s14 offen offset:1024 sc1
    buffer_load_dwordx4 a[208:211], v1, s[4:7], s14 offen offset:2048 sc1
    buffer_load_dwordx4 a[212:215], v1, s[4:7], s14 offen offset:3072 sc1
    s_add_u32 s14, s12, 12288
    buffer_load_dwordx4 a[216:219], v1, s[4:7], s14 offen offset:0 sc1
    buffer_load_dwordx4 a[220:223], v1, s[4:7], s14 offen offset:1024 sc1
    s_waitcnt vmcnt(46)
    s_add_u32 s12, s25, 0x962000
    s_add_u32 s14, s12, 0
    buffer_load_dwordx4 a[224:227], v1, s[4:7], s14 offen offset:0 sc1
    buffer_load_dwordx4 a[228:231], v1, s[4:7], s14 offen offset:1024 sc1
    buffer_load_dwordx4 a[232:235], v1, s[4:7], s14 offen offset:2048 sc1
    buffer_load_dwordx4 a[236:239], v1, s[4:7], s14 offen offset:3072 sc1
    s_add_u32 s14, s12, 4096
    buffer_load_dwordx4 a[240:243], v1, s[4:7], s14 offen offset:0 sc1
    buffer_load_dwordx4 a[244:247], v1, s[4:7], s14 offen offset:1024 sc1
    buffer_load_dwordx4 a[248:251], v1, s[4:7], s14 offen offset:2048 sc1
    buffer_load_dwordx4 a[252:255], v1, s[4:7], s14 offen offset:3072 sc1
    s_add_u32 s14, s12, 8192
    buffer_load_dwordx4 v[176:179], v1, s[4:7], s14 offen offset:0 sc1
    buffer_load_dwordx4 v[180:183], v1, s[4:7], s14 offen offset:1024 sc1
    buffer_load_dwordx4 v[184:187], v1, s[4:7], s14 offen offset:2048 sc1
    buffer_load_dwordx4 v[188:191], v1, s[4:7], s14 offen offset:3072 sc1
    s_add_u32 s14, s12, 12288
    buffer_load_dwordx4 v[192:195], v1, s[4:7], s14 offen offset:0 sc1
    buffer_load_dwordx4 v[196:199], v1, s[4:7], s14 offen offset:1024 sc1
    s_waitcnt vmcnt(46)
    s_add_u32 s12, s25, 0x965800
    s_add_u32 s14, s12, 0
    buffer_load_dwordx4 v[200:203], v1, s[4:7], s14 offen offset:0 sc1
    buffer_load_dwordx4 v[204:207], v1, s[4:7], s14 offen offset:1024 sc1
    buffer_load_dwordx4 v[208:211], v1, s[4:7], s14 offen offset:2048 sc1
    buffer_load_dwordx4 v[212:215], v1, s[4:7], s14 offen offset:3072 sc1
    s_add_u32 s14, s12, 4096
    buffer_load_dwordx4 v[216:219], v1, s[4:7], s14 offen offset:0 sc1
    buffer_load_dwordx4 v[220:223], v1, s[4:7], s14 offen offset:1024 sc1
    buffer_load_dwordx4 v[224:227], v1, s[4:7], s14 offen offset:2048 sc1
    buffer_load_dwordx4 v[228:231], v1, s[4:7], s14 offen offset:3072 sc1
    s_add_u32 s14, s12, 8192
    buffer_load_dwordx4 v[232:235], v1, s[4:7], s14 offen offset:0 sc1
    buffer_load_dwordx4 v[236:239], v1, s[4:7], s14 offen offset:1024 sc1
    buffer_load_dwordx4 v[240:243], v1, s[4:7], s14 offen offset:2048 sc1
    buffer_load_dwordx4 v[244:247], v1, s[4:7], s14 offen offset:3072 sc1
    s_add_u32 s14, s12, 12288
    buffer_load_dwordx4 v[248:251], v1, s[4:7], s14 offen offset:0 sc1
    buffer_load_dwordx4 v[252:255], v1, s[4:7], s14 offen offset:1024 sc1
    s_waitcnt vmcnt(46)
    s_mov_b32 s8, 0
    v_mov_b32 v32, 0
    v_mov_b32 v33, 0
    v_mov_b32 v34, 0
    v_mov_b32 v35, 0
    v_mov_b32 v36, 0
    v_mov_b32 v37, 0
    v_mov_b32 v38, 0
    v_mov_b32 v39, 0
    v_mov_b32 v40, 0
    v_mov_b32 v41, 0
    v_mov_b32 v42, 0
    v_mov_b32 v43, 0
    v_mov_b32 v44, 0
    v_mov_b32 v45, 0
    v_mov_b32 v46, 0
    v_mov_b32 v47, 0
    v_mov_b32 v48, 0
    v_mov_b32 v49, 0
    v_mov_b32 v50, 0
    v_mov_b32 v51, 0
    v_mov_b32 v52, 0
    v_mov_b32 v53, 0
    v_mov_b32 v54, 0
    v_mov_b32 v55, 0
    v_mov_b32 v56, 0
    v_mov_b32 v57, 0
    v_mov_b32 v58, 0
    v_mov_b32 v59, 0
    v_mov_b32 v60, 0
    v_mov_b32 v61, 0
    v_mov_b32 v62, 0
    v_mov_b32 v63, 0
    s_mov_b32 s22, 0
v_u0_497:
    s_add_u32 s22, s22, 1
    s_cmp_gt_u32 s22, 65536
    s_cbranch_scc1 M_exit
    buffer_load_dword v166, v168, s[4:7], s29 offen sc1
    s_waitcnt vmcnt(0)
    v_cmp_eq_u32 vcc, 0, v166
    s_cbranch_vccnz v_u0_497
    v_and_b32 v167, 3, v0
    v_lshlrev_b32 v167, 2, v167
.p2align 8
v_dry_490:
v_loop_499:
    v_mov_b32 v140, 0
    v_mov_b32 v141, 0
    v_mov_b32 v142, 0
    v_mov_b32 v143, 0
    v_mov_b32 v144, 0
    v_mov_b32 v145, 0
    v_mov_b32 v146, 0
    v_mov_b32 v147, 0
    s_and_b32 s23, s8, 7
    s_lshl_b32 s23, s23, 13
    s_add_u32 s23, s23, 0x3100000
    s_add_u32 s26, s23, 4096
    ds_read_b128 v[64:67], v163 offset:10240
    ds_read_b128 v[68:71], v163 offset:11264
    ds_read_b128 v[72:75], v163 offset:12288
    ds_read_b128 v[76:79], v163 offset:13312
    ds_read_b128 v[80:83], v163 offset:0
    ds_read_b128 v[84:87], v163 offset:1024
    s_and_b32 s11, s8, 15
    s_mul_i32 s11, s11, 458752
    s_lshl_b32 s12, s9, 15
    s_add_u32 s11, s11, s12
    s_add_u32 s11, s11, 0x1003000
    s_add_u32 s12, s11, 16384
    s_sleep 4
    s_mov_b32 s22, 0
    buffer_load_dwordx4 v[24:27], v1, s[4:7], s26 offen offset:1024 sc1
    buffer_load_dwordx4 v[28:31], v1, s[4:7], s26 offen offset:2048 sc1
poll_501:
    s_waitcnt vmcnt(0)
    buffer_load_dwordx4 v[24:27], v1, s[4:7], s26 offen offset:1024 sc1
    buffer_load_dwordx4 v[28:31], v1, s[4:7], s26 offen offset:2048 sc1
    v_max3_u32 v156, v24, v25, v26
    v_max3_u32 v156, v156, v27, v28
    v_max3_u32 v156, v156, v29, v30
    v_max_u32 v156, v156, v31
    v_cmp_eq_u32 vcc, -1, v156
    ds_write_b128 v1, v[24:27] offset:5120
    ds_write_b128 v1, v[28:31] offset:6144
    s_add_u32 s22, s22, 1
    s_cmp_gt_u32 s22, 65536
    s_cbranch_scc1 M_exit
    s_cbranch_vccnz poll_501
pok_500:
    v_smfmac_f32_16x16x64_bf16 v[32:35], v[24:27], a[40:47], v2
    v_smfmac_f32_16x16x64_bf16 v[36:39], v[24:27], a[96:103], v2
    v_smfmac_f32_16x16x64_bf16 v[40:43], v[24:27], a[152:159], v2
    v_smfmac_f32_16x16x64_bf16 v[44:47], v[24:27], a[208:215], v2
    s_waitcnt lgkmcnt(0)
    s_barrier
    ds_read_b128 v[4:7], v1 offset:0
    ds_read_b128 v[8:11], v1 offset:1024
    buffer_load_dwordx4 v[88:91], v1, s[4:7], s11 offen offset:0 sc1
    v_smfmac_f32_16x16x64_bf16 v[56:59], v[24:27], v[64:71], v2
    ds_read_b128 v[12:15], v1 offset:2048
    v_smfmac_f32_16x16x64_bf16 v[32:35], v[28:31], a[48:55], v2
    ds_read_b128 v[16:19], v1 offset:3072
    ds_read_b128 v[64:67], v163 offset:2048
    v_smfmac_f32_16x16x64_bf16 v[36:39], v[28:31], a[104:111], v2
    ds_read_b128 v[20:23], v1 offset:4096
    ds_read_b128 v[68:71], v163 offset:3072
    v_smfmac_f32_16x16x64_bf16 v[40:43], v[28:31], a[160:167], v2
    buffer_load_dwordx4 v[92:95], v1, s[4:7], s11 offen offset:1024 sc1
    v_smfmac_f32_16x16x64_bf16 v[56:59], v[28:31], v[72:79], v2
    s_waitcnt lgkmcnt(6)
    v_smfmac_f32_16x16x64_bf16 v[32:35], v[4:7], a[0:7], v2
    ds_read_b128 v[72:75], v163 offset:4096
    v_smfmac_f32_16x16x64_bf16 v[36:39], v[4:7], a[56:63], v2
    ds_read_b128 v[76:79], v163 offset:5120
    v_smfmac_f32_16x16x64_bf16 v[40:43], v[4:7], a[112:119], v2
    buffer_load_dwordx4 v[96:99], v1, s[4:7], s11 offen offset:2048 sc1
    v_smfmac_f32_16x16x64_bf16 v[56:59], v[4:7], v[80:87], v2
    s_waitcnt lgkmcnt(7)
    v_smfmac_f32_16x16x64_bf16 v[32:35], v[8:11], a[8:15], v2
    ds_read_b128 v[80:83], v163 offset:6144
    v_smfmac_f32_16x16x64_bf16 v[36:39], v[8:11], a[64:71], v2
    ds_read_b128 v[84:87], v163 offset:7168
    v_smfmac_f32_16x16x64_bf16 v[40:43], v[8:11], a[120:127], v2
    buffer_load_dwordx4 v[100:103], v1, s[4:7], s11 offen offset:3072 sc1
    s_waitcnt lgkmcnt(4)
    v_smfmac_f32_16x16x64_bf16 v[56:59], v[8:11], v[64:71], v2
    v_smfmac_f32_16x16x64_bf16 v[32:35], v[12:15], a[16:23], v2
    ds_read_b128 v[64:67], v163 offset:8192
    v_smfmac_f32_16x16x64_bf16 v[36:39], v[12:15], a[72:79], v2
    ds_read_b128 v[68:71], v163 offset:9216
    v_smfmac_f32_16x16x64_bf16 v[40:43], v[12:15], a[128:135], v2
    buffer_load_dwordx4 v[104:107], v1, s[4:7], s12 offen offset:0 sc1
    s_waitcnt lgkmcnt(4)
    v_smfmac_f32_16x16x64_bf16 v[56:59], v[12:15], v[72:79], v2
    v_smfmac_f32_16x16x64_bf16 v[32:35], v[16:19], a[24:31], v2
    ds_read_b128 v[72:75], v163 offset:24576
    v_smfmac_f32_16x16x64_bf16 v[36:39], v[16:19], a[80:87], v2
    ds_read_b128 v[76:79], v163 offset:25600
    v_smfmac_f32_16x16x64_bf16 v[40:43], v[16:19], a[136:143], v2
    buffer_load_dwordx4 v[108:111], v1, s[4:7], s12 offen offset:1024 sc1
    s_waitcnt lgkmcnt(4)
    v_smfmac_f32_16x16x64_bf16 v[56:59], v[16:19], v[80:87], v2
    v_smfmac_f32_16x16x64_bf16 v[32:35], v[20:23], a[32:39], v2
    ds_read_b128 v[80:83], v163 offset:26624
    v_smfmac_f32_16x16x64_bf16 v[36:39], v[20:23], a[88:95], v2
    ds_read_b128 v[84:87], v163 offset:27648
    v_smfmac_f32_16x16x64_bf16 v[40:43], v[20:23], a[144:151], v2
    buffer_load_dwordx4 v[112:115], v1, s[4:7], s12 offen offset:2048 sc1
    s_waitcnt lgkmcnt(4)
    v_smfmac_f32_16x16x64_bf16 v[56:59], v[20:23], v[64:71], v2
    ds_read_b128 v[64:67], v163 offset:14336
    v_smfmac_f32_16x16x64_bf16 v[48:51], v[24:27], v[184:191], v2
    ds_read_b128 v[68:71], v163 offset:15360
    v_add_f32 v32, v32, v34
    v_smfmac_f32_16x16x64_bf16 v[52:55], v[24:27], v[240:247], v2
    buffer_load_dwordx4 v[116:119], v1, s[4:7], s12 offen offset:3072 sc1
    v_add_f32 v33, v33, v35
    s_waitcnt lgkmcnt(4)
    v_smfmac_f32_16x16x64_bf16 v[60:63], v[24:27], v[72:79], v2
    v_cvt_pk_bf16_f32 v132, v32, v33
    v_smfmac_f32_16x16x64_bf16 v[44:47], v[28:31], a[216:223], v2
    ds_read_b128 v[72:75], v163 offset:16384
    v_add_f32 v36, v36, v38
    v_smfmac_f32_16x16x64_bf16 v[48:51], v[28:31], v[192:199], v2
    ds_read_b128 v[76:79], v163 offset:17408
    v_add_f32 v37, v37, v39
    v_smfmac_f32_16x16x64_bf16 v[52:55], v[28:31], v[248:255], v2
    v_cvt_pk_bf16_f32 v134, v36, v37
    s_waitcnt lgkmcnt(4)
    v_smfmac_f32_16x16x64_bf16 v[60:63], v[28:31], v[80:87], v2
    v_add_f32 v40, v40, v42
    v_smfmac_f32_16x16x64_bf16 v[44:47], v[4:7], a[168:175], v2
    ds_read_b128 v[80:83], v163 offset:18432
    v_add_f32 v41, v41, v43
    v_smfmac_f32_16x16x64_bf16 v[48:51], v[4:7], a[224:231], v2
    ds_read_b128 v[84:87], v163 offset:19456
    v_cvt_pk_bf16_f32 v136, v40, v41
    v_smfmac_f32_16x16x64_bf16 v[52:55], v[4:7], v[200:207], v2
    v_add_f32 v56, v56, v58
    s_waitcnt lgkmcnt(4)
    v_smfmac_f32_16x16x64_bf16 v[60:63], v[4:7], v[64:71], v2
    v_add_f32 v57, v57, v59
    v_smfmac_f32_16x16x64_bf16 v[44:47], v[8:11], a[176:183], v2
    ds_read_b128 v[64:67], v163 offset:20480
    v_cvt_pk_bf16_f32 v137, v56, v57
    v_smfmac_f32_16x16x64_bf16 v[48:51], v[8:11], a[232:239], v2
    ds_read_b128 v[68:71], v163 offset:21504
    v_smfmac_f32_16x16x64_bf16 v[52:55], v[8:11], v[208:215], v2
    s_waitcnt lgkmcnt(4)
    v_smfmac_f32_16x16x64_bf16 v[60:63], v[8:11], v[72:79], v2
    v_smfmac_f32_16x16x64_bf16 v[44:47], v[12:15], a[184:191], v2
    ds_read_b128 v[72:75], v163 offset:22528
    v_smfmac_f32_16x16x64_bf16 v[48:51], v[12:15], a[240:247], v2
    ds_read_b128 v[76:79], v163 offset:23552
    v_smfmac_f32_16x16x64_bf16 v[52:55], v[12:15], v[216:223], v2
    s_waitcnt lgkmcnt(4)
    v_smfmac_f32_16x16x64_bf16 v[60:63], v[12:15], v[80:87], v2
    v_smfmac_f32_16x16x64_bf16 v[44:47], v[16:19], a[192:199], v2
    v_smfmac_f32_16x16x64_bf16 v[48:51], v[16:19], a[248:255], v2
    v_smfmac_f32_16x16x64_bf16 v[52:55], v[16:19], v[224:231], v2
    s_waitcnt lgkmcnt(2)
    v_smfmac_f32_16x16x64_bf16 v[60:63], v[16:19], v[64:71], v2
    v_smfmac_f32_16x16x64_bf16 v[44:47], v[20:23], a[200:207], v2
    v_smfmac_f32_16x16x64_bf16 v[48:51], v[20:23], v[176:183], v2
    v_smfmac_f32_16x16x64_bf16 v[52:55], v[20:23], v[232:239], v2
    s_waitcnt lgkmcnt(0)
    v_smfmac_f32_16x16x64_bf16 v[60:63], v[20:23], v[72:79], v2
    v_add_f32 v44, v44, v46
    s_and_b32 s11, s8, 3
    s_lshl_b32 s11, s11, 14
    s_add_u32 s25, s11, 0x3112c00
    s_add_u32 s24, s11, 0x3111800
    s_add_u32 s11, s8, 1
    s_and_b32 s12, s11, 7
    s_lshl_b32 s12, s12, 13
    s_add_u32 s12, s12, 0x3100000
    s_mov_b32 s22, 0
    buffer_load_dwordx4 v[120:123], v1, s[4:7], s24 offen sc1
    buffer_load_dwordx4 v[124:127], v1, s[4:7], s24 offen offset:1024 sc1
    buffer_load_dwordx4 v[128:131], v1, s[4:7], s25 offen sc1
    v_add_f32 v45, v45, v47
    v_cvt_pk_bf16_f32 v138, v44, v45
    v_add_f32 v48, v48, v50
    v_add_f32 v49, v49, v51
    v_cvt_pk_bf16_f32 v133, v48, v49
    v_add_f32 v52, v52, v54
    v_add_f32 v53, v53, v55
    v_cvt_pk_bf16_f32 v135, v52, v53
    v_add_f32 v60, v60, v62
    v_add_f32 v61, v61, v63
    v_cvt_pk_bf16_f32 v139, v60, v61
    v_mov_b32 v32, 0
    v_mov_b32 v33, 0
    v_mov_b32 v34, 0
    v_mov_b32 v35, 0
    v_mov_b32 v36, 0
    v_mov_b32 v37, 0
    v_mov_b32 v38, 0
    v_mov_b32 v39, 0
    v_mov_b32 v40, 0
    v_mov_b32 v41, 0
    v_mov_b32 v42, 0
    v_mov_b32 v43, 0
    v_mov_b32 v44, 0
    v_mov_b32 v45, 0
    v_mov_b32 v46, 0
    v_mov_b32 v47, 0
    v_mov_b32 v48, 0
    v_mov_b32 v49, 0
    v_mov_b32 v50, 0
    v_mov_b32 v51, 0
    v_mov_b32 v52, 0
    v_mov_b32 v53, 0
    v_mov_b32 v54, 0
    v_mov_b32 v55, 0
    v_mov_b32 v56, 0
    v_mov_b32 v57, 0
    v_mov_b32 v58, 0
    v_mov_b32 v59, 0
    v_mov_b32 v60, 0
    v_mov_b32 v61, 0
    v_mov_b32 v62, 0
    v_mov_b32 v63, 0
q_503:
    s_waitcnt vmcnt(2)
    v_max3_u32 v156, v120, v121, v122
    v_max_u32 v156, v156, v123
    v_cmp_eq_u32 vcc, -1, v156
    buffer_load_dwordx4 v[120:123], v1, s[4:7], s24 offen sc1
    s_add_u32 s22, s22, 1
    s_cmp_gt_u32 s22, 196608
    s_cbranch_scc1 M_exit
    s_cbranch_vccnz q_504
    v_smfmac_f32_16x16x64_bf16 v[140:143], v[120:123], v[88:95], v2
    v_smfmac_f32_16x16x64_bf16 v[144:147], v[120:123], v[104:111], v2
q_505:
    s_waitcnt vmcnt(2)
    v_max3_u32 v156, v124, v125, v126
    v_max_u32 v156, v156, v127
    v_cmp_eq_u32 vcc, -1, v156
    s_cbranch_vccnz qf_506
    v_smfmac_f32_16x16x64_bf16 v[140:143], v[124:127], v[96:103], v2
    v_smfmac_f32_16x16x64_bf16 v[144:147], v[124:127], v[112:119], v2
q_507:
    s_waitcnt vmcnt(1)
    v_max3_u32 v156, v128, v129, v130
    v_max_u32 v156, v156, v131
    v_cmp_eq_u32 vcc, -1, v156
    s_cbranch_vccnz qf_508
    v_smfmac_f32_16x16x64_bf16 v[140:143], v[128:131], v[132:139], v3
    v_smfmac_f32_16x16x64_bf16 v[144:147], v[128:131], v[132:139], v160
qdone_502:
    s_nop 6
    v_add_f32 v148, v140, v142
    v_add_f32 v150, v141, v143
    v_add_f32 v149, v144, v146
    v_add_f32 v151, v145, v147
    ds_write2_b64 v157, v[148:149], v[150:151] offset0:0 offset1:16
    s_waitcnt lgkmcnt(0)
    s_barrier
    s_add_u32 s13, s9, 80
    s_add_u32 s8, s8, 1
    s_cmp_lt_u32 s8, 63
    s_cbranch_scc1 v_loop_499
    s_branch M_exit
q_504:
    s_waitcnt vmcnt(2)
    v_max3_u32 v156, v124, v125, v126
    v_max_u32 v156, v156, v127
    v_cmp_eq_u32 vcc, -1, v156
    buffer_load_dwordx4 v[124:127], v1, s[4:7], s24 offen offset:1024 sc1
    s_add_u32 s22, s22, 1
    s_cmp_gt_u32 s22, 196608
    s_cbranch_scc1 M_exit
    s_cbranch_vccnz q_510
    v_smfmac_f32_16x16x64_bf16 v[140:143], v[124:127], v[96:103], v2
    v_smfmac_f32_16x16x64_bf16 v[144:147], v[124:127], v[112:119], v2
q_511:
    s_waitcnt vmcnt(2)
    v_max3_u32 v156, v128, v129, v130
    v_max_u32 v156, v156, v131
    v_cmp_eq_u32 vcc, -1, v156
    s_cbranch_vccnz qf_512
    v_smfmac_f32_16x16x64_bf16 v[140:143], v[128:131], v[132:139], v3
    v_smfmac_f32_16x16x64_bf16 v[144:147], v[128:131], v[132:139], v160
q_513:
    s_waitcnt vmcnt(1)
    v_max3_u32 v156, v120, v121, v122
    v_max_u32 v156, v156, v123
    v_cmp_eq_u32 vcc, -1, v156
    s_cbranch_vccnz qf_514
    v_smfmac_f32_16x16x64_bf16 v[140:143], v[120:123], v[88:95], v2
    v_smfmac_f32_16x16x64_bf16 v[144:147], v[120:123], v[104:111], v2
    s_branch qdone_502
q_515:
    s_waitcnt vmcnt(2)
    v_max3_u32 v156, v128, v129, v130
    v_max_u32 v156, v156, v131
    v_cmp_eq_u32 vcc, -1, v156
    s_cbranch_vccnz qf_516
    v_smfmac_f32_16x16x64_bf16 v[140:143], v[128:131], v[132:139], v3
    v_smfmac_f32_16x16x64_bf16 v[144:147], v[128:131], v[132:139], v160
q_517:
    s_waitcnt vmcnt(0)
    v_max3_u32 v156, v124, v125, v126
    v_max_u32 v156, v156, v127
    v_cmp_eq_u32 vcc, -1, v156
    s_cbranch_vccnz qf_518
    v_smfmac_f32_16x16x64_bf16 v[140:143], v[124:127], v[96:103], v2
    v_smfmac_f32_16x16x64_bf16 v[144:147], v[124:127], v[112:119], v2
    s_branch qdone_502
q_519:
    s_waitcnt vmcnt(0)
    v_max3_u32 v156, v128, v129, v130
    v_max_u32 v156, v156, v131
    v_cmp_eq_u32 vcc, -1, v156
    s_cbranch_vccnz qf_520
    v_smfmac_f32_16x16x64_bf16 v[140:143], v[128:131], v[132:139], v3
    v_smfmac_f32_16x16x64_bf16 v[144:147], v[128:131], v[132:139], v160
    s_branch qdone_502
q_510:
    s_waitcnt vmcnt(2)
    v_max3_u32 v156, v128, v129, v130
    v_max_u32 v156, v156, v131
    v_cmp_eq_u32 vcc, -1, v156
    buffer_load_dwordx4 v[128:131], v1, s[4:7], s25 offen sc1
    s_add_u32 s22, s22, 1
    s_cmp_gt_u32 s22, 196608
    s_cbranch_scc1 M_exit
    s_cbranch_vccnz q_503
    v_smfmac_f32_16x16x64_bf16 v[140:143], v[128:131], v[132:139], v3
    v_smfmac_f32_16x16x64_bf16 v[144:147], v[128:131], v[132:139], v160
q_523:
    s_waitcnt vmcnt(2)
    v_max3_u32 v156, v120, v121, v122
    v_max_u32 v156, v156, v123
    v_cmp_eq_u32 vcc, -1, v156
    s_cbranch_vccnz qf_524
    v_smfmac_f32_16x16x64_bf16 v[140:143], v[120:123], v[88:95], v2
    v_smfmac_f32_16x16x64_bf16 v[144:147], v[120:123], v[104:111], v2
q_525:
    s_waitcnt vmcnt(1)
    v_max3_u32 v156, v124, v125, v126
    v_max_u32 v156, v156, v127
    v_cmp_eq_u32 vcc, -1, v156
    s_cbranch_vccnz qf_526
    v_smfmac_f32_16x16x64_bf16 v[140:143], v[124:127], v[96:103], v2
    v_smfmac_f32_16x16x64_bf16 v[144:147], v[124:127], v[112:119], v2
    s_branch qdone_502
q_527:
    s_waitcnt vmcnt(2)
    v_max3_u32 v156, v120, v121, v122
    v_max_u32 v156, v156, v123
    v_cmp_eq_u32 vcc, -1, v156
    s_cbranch_vccnz qf_528
    v_smfmac_f32_16x16x64_bf16 v[140:143], v[120:123], v[88:95], v2
    v_smfmac_f32_16x16x64_bf16 v[144:147], v[120:123], v[104:111], v2
    s_branch q_519
q_530:
    s_waitcnt vmcnt(0)
    v_max3_u32 v156, v120, v121, v122
    v_max_u32 v156, v156, v123
    v_cmp_eq_u32 vcc, -1, v156
    s_cbranch_vccnz qf_531
    v_smfmac_f32_16x16x64_bf16 v[140:143], v[120:123], v[88:95], v2
    v_smfmac_f32_16x16x64_bf16 v[144:147], v[120:123], v[104:111], v2
    s_branch qdone_502
q_532:
    s_waitcnt vmcnt(1)
    v_max3_u32 v156, v124, v125, v126
    v_max_u32 v156, v156, v127
    v_cmp_eq_u32 vcc, -1, v156
    s_cbranch_vccnz qf_533
    v_smfmac_f32_16x16x64_bf16 v[140:143], v[124:127], v[96:103], v2
    v_smfmac_f32_16x16x64_bf16 v[144:147], v[124:127], v[112:119], v2
    s_branch q_519
q_535:
    s_waitcnt vmcnt(2)
    v_max3_u32 v156, v124, v125, v126
    v_max_u32 v156, v156, v127
    v_cmp_eq_u32 vcc, -1, v156
    s_cbranch_vccnz qf_536
    v_smfmac_f32_16x16x64_bf16 v[140:143], v[124:127], v[96:103], v2
    v_smfmac_f32_16x16x64_bf16 v[144:147], v[124:127], v[112:119], v2
    s_branch q_530
q_538:
    s_waitcnt vmcnt(1)
    v_max3_u32 v156, v128, v129, v130
    v_max_u32 v156, v156, v131
    v_cmp_eq_u32 vcc, -1, v156
    s_cbranch_vccnz qf_539
    v_smfmac_f32_16x16x64_bf16 v[140:143], v[128:131], v[132:139], v3
    v_smfmac_f32_16x16x64_bf16 v[144:147], v[128:131], v[132:139], v160
    s_branch q_530
q_541:
    s_waitcnt vmcnt(1)
    v_max3_u32 v156, v128, v129, v130
    v_max_u32 v156, v156, v131
    v_cmp_eq_u32 vcc, -1, v156
    s_cbranch_vccnz qf_542
    v_smfmac_f32_16x16x64_bf16 v[140:143], v[128:131], v[132:139], v3
    v_smfmac_f32_16x16x64_bf16 v[144:147], v[128:131], v[132:139], v160
    s_branch q_517
q_544:
    s_waitcnt vmcnt(1)
    v_max3_u32 v156, v120, v121, v122
    v_max_u32 v156, v156, v123
    v_cmp_eq_u32 vcc, -1, v156
    s_cbranch_vccnz qf_545
    v_smfmac_f32_16x16x64_bf16 v[140:143], v[120:123], v[88:95], v2
    v_smfmac_f32_16x16x64_bf16 v[144:147], v[120:123], v[104:111], v2
    s_branch q_517
q_547:
    s_waitcnt vmcnt(1)
    v_max3_u32 v156, v120, v121, v122
    v_max_u32 v156, v156, v123
    v_cmp_eq_u32 vcc, -1, v156
    s_cbranch_vccnz qf_548
    v_smfmac_f32_16x16x64_bf16 v[140:143], v[120:123], v[88:95], v2
    v_smfmac_f32_16x16x64_bf16 v[144:147], v[120:123], v[104:111], v2
    s_branch q_519
q_550:
    s_waitcnt vmcnt(1)
    v_max3_u32 v156, v124, v125, v126
    v_max_u32 v156, v156, v127
    v_cmp_eq_u32 vcc, -1, v156
    s_cbranch_vccnz qf_551
    v_smfmac_f32_16x16x64_bf16 v[140:143], v[124:127], v[96:103], v2
    v_smfmac_f32_16x16x64_bf16 v[144:147], v[124:127], v[112:119], v2
    s_branch q_530
qf_506:
    buffer_load_dwordx4 v[124:127], v1, s[4:7], s24 offen offset:1024 sc1
    s_add_u32 s22, s22, 1
    s_cmp_gt_u32 s22, 196608
    s_cbranch_scc1 M_exit
    s_branch q_515
qf_508:
    buffer_load_dwordx4 v[128:131], v1, s[4:7], s25 offen sc1
    s_add_u32 s22, s22, 1
    s_cmp_gt_u32 s22, 196608
    s_cbranch_scc1 M_exit
    s_branch q_519
qf_512:
    buffer_load_dwordx4 v[128:131], v1, s[4:7], s25 offen sc1
    s_add_u32 s22, s22, 1
    s_cmp_gt_u32 s22, 196608
    s_cbranch_scc1 M_exit
    s_branch q_527
qf_514:
    buffer_load_dwordx4 v[120:123], v1, s[4:7], s24 offen sc1
    s_add_u32 s22, s22, 1
    s_cmp_gt_u32 s22, 196608
    s_cbranch_scc1 M_exit
    s_branch q_530
qf_516:
    buffer_load_dwordx4 v[128:131], v1, s[4:7], s25 offen sc1
    s_add_u32 s22, s22, 1
    s_cmp_gt_u32 s22, 196608
    s_cbranch_scc1 M_exit
    s_branch q_532
qf_518:
    buffer_load_dwordx4 v[124:127], v1, s[4:7], s24 offen offset:1024 sc1
    s_add_u32 s22, s22, 1
    s_cmp_gt_u32 s22, 196608
    s_cbranch_scc1 M_exit
    s_branch q_517
qf_520:
    buffer_load_dwordx4 v[128:131], v1, s[4:7], s25 offen sc1
    s_add_u32 s22, s22, 1
    s_cmp_gt_u32 s22, 196608
    s_cbranch_scc1 M_exit
    s_branch q_519
qf_524:
    buffer_load_dwordx4 v[120:123], v1, s[4:7], s24 offen sc1
    s_add_u32 s22, s22, 1
    s_cmp_gt_u32 s22, 196608
    s_cbranch_scc1 M_exit
    s_branch q_535
qf_526:
    buffer_load_dwordx4 v[124:127], v1, s[4:7], s24 offen offset:1024 sc1
    s_add_u32 s22, s22, 1
    s_cmp_gt_u32 s22, 196608
    s_cbranch_scc1 M_exit
    s_branch q_517
qf_528:
    buffer_load_dwordx4 v[120:123], v1, s[4:7], s24 offen sc1
    s_add_u32 s22, s22, 1
    s_cmp_gt_u32 s22, 196608
    s_cbranch_scc1 M_exit
    s_branch q_538
qf_531:
    buffer_load_dwordx4 v[120:123], v1, s[4:7], s24 offen sc1
    s_add_u32 s22, s22, 1
    s_cmp_gt_u32 s22, 196608
    s_cbranch_scc1 M_exit
    s_branch q_530
qf_533:
    buffer_load_dwordx4 v[124:127], v1, s[4:7], s24 offen offset:1024 sc1
    s_add_u32 s22, s22, 1
    s_cmp_gt_u32 s22, 196608
    s_cbranch_scc1 M_exit
    s_branch q_541
qf_536:
    buffer_load_dwordx4 v[124:127], v1, s[4:7], s24 offen offset:1024 sc1
    s_add_u32 s22, s22, 1
    s_cmp_gt_u32 s22, 196608
    s_cbranch_scc1 M_exit
    s_branch q_544
qf_539:
    buffer_load_dwordx4 v[128:131], v1, s[4:7], s25 offen sc1
    s_add_u32 s22, s22, 1
    s_cmp_gt_u32 s22, 196608
    s_cbranch_scc1 M_exit
    s_branch q_547
qf_542:
    buffer_load_dwordx4 v[128:131], v1, s[4:7], s25 offen sc1
    s_add_u32 s22, s22, 1
    s_cmp_gt_u32 s22, 196608
    s_cbranch_scc1 M_exit
    s_branch q_532
qf_545:
    buffer_load_dwordx4 v[120:123], v1, s[4:7], s24 offen sc1
    s_add_u32 s22, s22, 1
    s_cmp_gt_u32 s22, 196608
    s_cbranch_scc1 M_exit
    s_branch q_550
qf_548:
    buffer_load_dwordx4 v[120:123], v1, s[4:7], s24 offen sc1
    s_add_u32 s22, s22, 1
    s_cmp_gt_u32 s22, 196608
    s_cbranch_scc1 M_exit
    s_branch q_538
qf_551:
    buffer_load_dwordx4 v[124:127], v1, s[4:7], s24 offen offset:1024 sc1
    s_add_u32 s22, s22, 1
    s_cmp_gt_u32 s22, 196608
    s_cbranch_scc1 M_exit
    s_branch q_544
role_pf_2:
    s_cmp_lg_u32 s9, 30
    s_cbranch_scc1 gate_571
    s_mov_b32 s11, 0x3b03000
    v_min_u32 v4, 0, v0
    v_lshlrev_b32 v4, 4, v4
    s_mov_b32 s22, 0
wt_572:
    buffer_load_dwordx4 v[32:35], v4, s[4:7], s11 offen offset:0 sc1
    s_waitcnt vmcnt(0)
    v_xor_b32 v32, s80, v32
    v_xor_b32 v33, s81, v33
    v_and_b32 v33, -16, v33
    v_xor_b32 v34, s80, v34
    v_xor_b32 v35, s81, v35
    v_and_b32 v35, -16, v35
    v_or3_b32 v32, v32, v33, v34
    v_or_b32 v32, v32, v35
    v_cmp_ne_u32 vcc, 0, v32
    s_cbranch_vccz wtok_573
    s_add_u32 s22, s22, 1
    s_cmp_gt_u32 s22, 65536
    s_cbranch_scc1 M_exit
    s_sleep 16
    s_branch wt_572
wtok_573:
    v_lshlrev_b32 v21, 7, v0
    s_lshl_b32 s12, s10, 15
    s_add_u32 s12, s12, 0x3100000
    buffer_load_dword v20, v21, s[4:7], s12 offen sc1
    s_add_u32 s12, s12, 8192
    buffer_load_dword v20, v21, s[4:7], s12 offen sc1
    s_add_u32 s12, s12, 8192
    buffer_load_dword v20, v21, s[4:7], s12 offen sc1
    s_add_u32 s12, s12, 8192
    buffer_load_dword v20, v21, s[4:7], s12 offen sc1
    s_add_u32 s12, s12, 8192
    s_mov_b32 s30, 0
    s_getreg_b32 s27, hwreg(HW_REG_XCC_ID, 0, 4)
    v_min_u32 v7, 31, v0
    v_lshlrev_b32 v7, 3, v7
    s_mov_b32 s11, 0x3b02000
    buffer_load_dword v6, v7, s[4:7], s11 offen offset:4 sc1
    s_waitcnt vmcnt(0)
    v_and_b32 v6, 15, v6
    v_cmp_ne_u32 vcc, s27, v6
    s_cbranch_vccnz mf_574
    s_mov_b32 s30, 1
mf_574:
    v_lshlrev_b32 v1, 4, v0
    v_mov_b32 v2, 0
    s_lshl_b32 s29, s10, 11
    s_lshl_b32 s28, s10, 4
    s_add_u32 s28, s28, 0x3b00400
    s_cmp_eq_u32 s10, 3
    s_cselect_b32 s25, 0, 1024
    s_mov_b32 s8, 1
pf_loop_575:
    s_cmp_lg_u32 s8, 11
    s_cbranch_scc1 pf_two_577
    s_mov_b32 s11, 0x3b02800
    v_min_u32 v20, 51, v0
    v_lshlrev_b32 v20, 4, v20
    s_mov_b32 s22, 0
wt_578:
    buffer_load_dwordx4 v[32:35], v20, s[4:7], s11 offen offset:0 sc1
    s_waitcnt vmcnt(0)
    v_xor_b32 v32, s80, v32
    v_xor_b32 v33, s81, v33
    v_and_b32 v33, -16, v33
    v_xor_b32 v34, s80, v34
    v_xor_b32 v35, s81, v35
    v_and_b32 v35, -16, v35
    v_or3_b32 v32, v32, v33, v34
    v_or_b32 v32, v32, v35
    v_cmp_ne_u32 vcc, 0, v32
    s_cbranch_vccz wtok_579
    s_add_u32 s22, s22, 1
    s_cmp_gt_u32 s22, 65536
    s_cbranch_scc1 M_exit
    s_sleep 24
    s_branch wt_578
wtok_579:
pf_two_577:
    s_and_b32 s11, s8, 7
    s_lshl_b32 s11, s11, 13
    s_add_u32 s11, s11, s29
    s_add_u32 s11, s11, 0x3100000
    s_add_u32 s12, s11, s25
    s_lshl_b32 s13, s8, 13
    s_add_u32 s13, s13, s29
    s_add_u32 s13, s13, 0x3080000
    s_add_u32 s14, s13, s25
    s_mov_b32 s22, 0
pf_wait_576:
    s_add_u32 s22, s22, 1
    s_cmp_gt_u32 s22, 65536
    s_cbranch_scc1 M_exit
    s_sleep 1
    buffer_load_dwordx4 v[4:7], v1, s[4:7], s11 offen sc1
    buffer_load_dwordx4 v[8:11], v1, s[4:7], s12 offen sc1
    s_waitcnt vmcnt(0)
    v_max3_u32 v3, v4, v5, v6
    v_max3_u32 v3, v3, v7, v8
    v_max3_u32 v3, v3, v9, v10
    v_max_u32 v3, v3, v11
    v_cmp_eq_u32 vcc, -1, v3
    s_cbranch_vccnz pf_wait_576
    v_mov_b32 v3, s8
    s_mov_b64 exec, 1
    s_cmp_eq_u32 s30, 0
    s_cbranch_scc1 pf_sl_580
    buffer_store_dword v3, v2, s[4:7], s28 offen
    s_branch pf_ak_581
pf_sl_580:
    buffer_store_dword v3, v2, s[4:7], s28 offen sc1
pf_ak_581:
    s_mov_b64 exec, -1
    buffer_store_dwordx4 v[4:7], v1, s[4:7], s13 offen sc1
    buffer_store_dwordx4 v[8:11], v1, s[4:7], s14 offen sc1
    s_add_u32 s8, s8, 1
    s_cmp_lt_u32 s8, 63
    s_cbranch_scc1 pf_loop_575
    s_branch M_exit
gate_571:
    s_cmp_lg_u32 s10, 0
    s_cbranch_scc1 M_exit
    s_mov_b32 s11, 0x3b02000
    v_min_u32 v4, 63, v0
    v_lshlrev_b32 v4, 4, v4
    s_mov_b32 s22, 0
wt_583:
    buffer_load_dwordx4 v[32:35], v4, s[4:7], s11 offen offset:0 sc1
    buffer_load_dwordx4 v[36:39], v4, s[4:7], s11 offen offset:1024 sc1
    s_waitcnt vmcnt(0)
    v_xor_b32 v32, s80, v32
    v_xor_b32 v33, s81, v33
    v_and_b32 v33, -16, v33
    v_xor_b32 v34, s80, v34
    v_xor_b32 v35, s81, v35
    v_and_b32 v35, -16, v35
    v_xor_b32 v36, s80, v36
    v_xor_b32 v37, s81, v37
    v_and_b32 v37, -16, v37
    v_xor_b32 v38, s80, v38
    v_xor_b32 v39, s81, v39
    v_and_b32 v39, -16, v39
    v_or3_b32 v32, v32, v33, v34
    v_or_b32 v32, v32, v35
    v_or3_b32 v32, v32, v36, v37
    v_or3_b32 v32, v32, v38, v39
    v_cmp_ne_u32 vcc, 0, v32
    s_cbranch_vccz wtok_584
    s_add_u32 s22, s22, 1
    s_cmp_gt_u32 s22, 65536
    s_cbranch_scc1 M_exit
    s_sleep 24
    s_branch wt_583
wtok_584:
    v_mov_b32 v12, s80
    v_mov_b32 v13, s81
    v_mov_b32 v14, s80
    v_mov_b32 v15, s81
    s_mov_b32 s24, 0x3b03000
    v_lshlrev_b32 v1, 4, v0
    v_mov_b32 v2, 0
    v_and_b32 v3, 3, v0
    v_lshlrev_b32 v3, 4, v3
    v_lshrrev_b32 v4, 5, v0
    v_add_u32 v4, -2, v4
    v_and_b32 v5, 31, v0
    v_cmp_gt_u32 s[20:21], 28, v5
    v_mov_b32 v9, 1000
    s_mov_b32 s12, 0x3b00000
    s_mov_b32 s13, 0x3b00400
    s_mov_b32 s14, 0x3b00800
    s_mov_b32 s8, 0
    s_mov_b32 s28, -1
    s_getreg_b32 s27, hwreg(HW_REG_XCC_ID, 0, 4)
    v_min_u32 v7, 31, v0
    v_lshlrev_b32 v7, 3, v7
    s_mov_b32 s11, 0x3b02000
    buffer_load_dword v6, v7, s[4:7], s11 offen offset:4 sc1
    s_waitcnt vmcnt(0)
    v_and_b32 v6, 15, v6
    v_cmp_ne_u32 vcc, s27, v6
    s_cbranch_vccnz gate_mode_585
gate_re_587:
    s_mov_b32 s22, 0
gate_loop_586:
    s_add_u32 s22, s22, 1
    s_cmp_gt_u32 s22, 65536
    s_cbranch_scc1 M_exit
    s_sleep 6
    buffer_load_dword v7, v3, s[4:7], s13 offen sc1
    s_waitcnt vmcnt(0)
    s_nop 1
    v_min_i32_dpp v7, v7, v7 quad_perm:[1,0,3,2] row_mask:0xf bank_mask:0xf
    s_nop 1
    v_min_i32_dpp v7, v7, v7 quad_perm:[2,3,0,1] row_mask:0xf bank_mask:0xf
    s_nop 0
    v_readfirstlane_b32 s11, v7
    s_add_u32 s11, s11, 4
    s_cmp_lt_i32 s28, s11
    s_cbranch_scc1 gate_dou_589
    s_cmp_le_i32 s11, s8
    s_cbranch_scc1 gate_loop_586
    s_add_u32 s29, s11, 2
    s_cmp_ge_i32 s28, s29
    s_cbranch_scc1 gate_nou_588
gate_dou_589:
    buffer_load_dword v6, v1, s[4:7], s12 offen sc1
    s_waitcnt vmcnt(0)
    v_lshl_add_u32 v6, v6, 1, v4
    v_cndmask_b32 v6, v9, v6, s[20:21]
    s_nop 1
    v_min_i32_dpp v6, v6, v6 row_ror:8 row_mask:0xf bank_mask:0xf
    s_nop 1
    v_min_i32_dpp v6, v6, v6 row_ror:4 row_mask:0xf bank_mask:0xf
    s_nop 1
    v_min_i32_dpp v6, v6, v6 row_ror:2 row_mask:0xf bank_mask:0xf
    s_nop 1
    v_min_i32_dpp v6, v6, v6 row_ror:1 row_mask:0xf bank_mask:0xf
    v_mov_b32 v8, v6
    s_nop 1
    v_permlane32_swap_b32 v6, v8
    v_min_i32 v6, v6, v8
    v_mov_b32 v8, v6
    s_nop 1
    v_permlane16_swap_b32 v6, v8
    v_min_i32 v6, v6, v8
    s_nop 0
    v_readfirstlane_b32 s28, v6
    s_cmp_eq_u32 s28, 0
    s_cselect_b32 s28, 1, s28
gate_nou_588:
    s_min_i32 s11, s11, s28
    v_mov_b32 v6, s11
    s_cmp_le_i32 s11, s8
    s_cbranch_scc1 gate_loop_586
    s_mov_b64 exec, 1
    buffer_store_dword v6, v2, s[4:7], s14 offen
    s_cmp_ge_i32 s8, 2
    s_cbranch_scc1 gate_nogo_590
    s_cmp_lt_i32 s11, 2
    s_cbranch_scc1 gate_nogo_590
    buffer_store_dwordx4 v[12:15], v2, s[4:7], s24 offen sc1
gate_nogo_590:
    s_mov_b64 exec, -1
    s_mov_b32 s8, s11
    s_cmp_lt_u32 s8, 63
    s_cbranch_scc1 gate_re_587
    s_branch M_exit
gate_mode_585:
gate_re_592:
    s_mov_b32 s22, 0
gate_loop_591:
    s_add_u32 s22, s22, 1
    s_cmp_gt_u32 s22, 65536
    s_cbranch_scc1 M_exit
    s_sleep 6
    buffer_load_dword v7, v3, s[4:7], s13 offen sc1
    s_waitcnt vmcnt(0)
    s_nop 1
    v_min_i32_dpp v7, v7, v7 quad_perm:[1,0,3,2] row_mask:0xf bank_mask:0xf
    s_nop 1
    v_min_i32_dpp v7, v7, v7 quad_perm:[2,3,0,1] row_mask:0xf bank_mask:0xf
    s_nop 0
    v_readfirstlane_b32 s11, v7
    s_add_u32 s11, s11, 4
    s_cmp_lt_i32 s28, s11
    s_cbranch_scc1 gate_dou_594
    s_cmp_le_i32 s11, s8
    s_cbranch_scc1 gate_loop_591
    s_add_u32 s29, s11, 2
    s_cmp_ge_i32 s28, s29
    s_cbranch_scc1 gate_nou_593
gate_dou_594:
    buffer_load_dword v6, v1, s[4:7], s12 offen sc1
    s_waitcnt vmcnt(0)
    v_lshl_add_u32 v6, v6, 1, v4
    v_cndmask_b32 v6, v9, v6, s[20:21]
    s_nop 1
    v_min_i32_dpp v6, v6, v6 row_ror:8 row_mask:0xf bank_mask:0xf
    s_nop 1
    v_min_i32_dpp v6, v6, v6 row_ror:4 row_mask:0xf bank_mask:0xf
    s_nop 1
    v_min_i32_dpp v6, v6, v6 row_ror:2 row_mask:0xf bank_mask:0xf
    s_nop 1
    v_min_i32_dpp v6, v6, v6 row_ror:1 row_mask:0xf bank_mask:0xf
    v_mov_b32 v8, v6
    s_nop 1
    v_permlane32_swap_b32 v6, v8
    v_min_i32 v6, v6, v8
    v_mov_b32 v8, v6
    s_nop 1
    v_permlane16_swap_b32 v6, v8
    v_min_i32 v6, v6, v8
    s_nop 0
    v_readfirstlane_b32 s28, v6
    s_cmp_eq_u32 s28, 0
    s_cselect_b32 s28, 1, s28
gate_nou_593:
    s_min_i32 s11, s11, s28
    v_mov_b32 v6, s11
    s_cmp_le_i32 s11, s8
    s_cbranch_scc1 gate_loop_591
    s_mov_b64 exec, 1
    buffer_store_dword v6, v2, s[4:7], s14 offen sc1
    s_cmp_ge_i32 s8, 2
    s_cbranch_scc1 gate_nogo_595
    s_cmp_lt_i32 s11, 2
    s_cbranch_scc1 gate_nogo_595
    buffer_store_dwordx4 v[12:15], v2, s[4:7], s24 offen sc1
gate_nogo_595:
    s_mov_b64 exec, -1
    s_mov_b32 s8, s11
    s_cmp_lt_u32 s8, 63
    s_cbranch_scc1 gate_re_592
    s_branch M_exit
M_Y:
    s_lshl_b32 s34, s11, 2
    s_add_u32 s34, s34, s9
    s_add_u32 s34, s34, 64
    s_cmp_ge_u32 s9, 28
    s_cbranch_scc1 M_H
    s_and_b32 s15, s9, 1
    s_lshr_b32 s9, s9, 1
    s_sub_u32 s11, s11, 1
    s_mul_i32 s11, s11, 14
    s_add_u32 s9, s9, s11
    v_and_b32 v0, 63, v0
    v_lshlrev_b32 v1, 4, v0
    v_and_b32 v4, 2, v0
    v_cmp_eq_u32 s[20:21], 0, v4
    v_mov_b32 v2, 0xeeee
    v_mov_b32 v4, 0x4444
    v_cndmask_b32 v2, v2, v4, s[20:21]
    v_mov_b32 v7, 0
    v_and_b32 v22, 0x38, v0
    v_and_b32 v4, 1, v0
    v_lshl_add_u32 v22, v4, 2, v22
    v_bfe_u32 v4, v0, 1, 2
    v_add_u32 v22, v22, v4
    v_lshlrev_b32 v22, 4, v22
    s_mov_b32 s72, s64
    s_mov_b32 s73, s65
    s_mov_b32 s74, 0x1c0000
    s_mov_b32 s75, 0x00020000
    s_mov_b32 s76, s4
    s_mov_b32 s77, s5
    s_mov_b32 s78, 0x0
    s_mov_b32 s79, 0x00020000
    v_and_b32 v4, 15, v0
    v_mul_u32_u24 v5, 896, v4
    v_lshrrev_b32 v4, 4, v0
    v_lshl_add_u32 v5, v4, 3, v5
    s_and_b32 s11, s10, 1
    s_mul_i32 s11, s11, 14336
    s_lshl_b32 s12, s9, 5
    s_add_u32 s12, s12, s11
    v_add_u32 v5, s12, v5
    s_lshl_b32 s12, s9, 9
    s_add_u32 s11, s11, s12
    v_lshlrev_b32 v6, 3, v4
    v_and_b32 v4, 15, v0
    v_lshl_add_u32 v6, v4, 5, v6
    v_add_u32 v6, s11, v6
    s_mov_b32 s18, 16384
    s_sleep 30
    s_lshl_b32 s11, s10, 8
    s_add_u32 s11, s11, 0x3b02400
    v_min_u32 v8, 15, v0
    v_lshlrev_b32 v8, 4, v8
    s_mov_b32 s22, 0
wt_596:
    buffer_load_dwordx4 v[24:27], v8, s[4:7], s11 offen offset:0 sc1
    s_waitcnt vmcnt(0)
    v_xor_b32 v24, s80, v24
    v_xor_b32 v25, s81, v25
    v_and_b32 v25, -16, v25
    v_xor_b32 v26, s80, v26
    v_xor_b32 v27, s81, v27
    v_and_b32 v27, -16, v27
    v_or3_b32 v24, v24, v25, v26
    v_or_b32 v24, v24, v27
    v_cmp_ne_u32 vcc, 0, v24
    s_cbranch_vccz wtok_597
    s_add_u32 s22, s22, 1
    s_cmp_gt_u32 s22, 65536
    s_cbranch_scc1 M_exit
    s_sleep 16
    s_branch wt_596
wtok_597:
    s_mul_i32 s11, s9, 229376
    s_mul_i32 s12, s10, 57344
    s_add_u32 s11, s11, s12
    s_add_u32 s12, s11, 0x900000
    s_add_u32 s14, s12, 0
    buffer_load_dwordx4 a[0:3], v1, s[4:7], s14 offen offset:0 sc1
    buffer_load_dwordx4 a[4:7], v1, s[4:7], s14 offen offset:1024 sc1
    buffer_load_dwordx4 a[8:11], v1, s[4:7], s14 offen offset:2048 sc1
    buffer_load_dwordx4 a[12:15], v1, s[4:7], s14 offen offset:3072 sc1
    s_add_u32 s14, s12, 4096
    buffer_load_dwordx4 a[16:19], v1, s[4:7], s14 offen offset:0 sc1
    buffer_load_dwordx4 a[20:23], v1, s[4:7], s14 offen offset:1024 sc1
    buffer_load_dwordx4 a[24:27], v1, s[4:7], s14 offen offset:2048 sc1
    buffer_load_dwordx4 a[28:31], v1, s[4:7], s14 offen offset:3072 sc1
    s_add_u32 s14, s12, 8192
    buffer_load_dwordx4 a[32:35], v1, s[4:7], s14 offen offset:0 sc1
    buffer_load_dwordx4 a[36:39], v1, s[4:7], s14 offen offset:1024 sc1
    buffer_load_dwordx4 a[40:43], v1, s[4:7], s14 offen offset:2048 sc1
    buffer_load_dwordx4 a[44:47], v1, s[4:7], s14 offen offset:3072 sc1
    s_add_u32 s14, s12, 12288
    buffer_load_dwordx4 a[48:51], v1, s[4:7], s14 offen offset:0 sc1
    buffer_load_dwordx4 a[52:55], v1, s[4:7], s14 offen offset:1024 sc1
    s_add_u32 s12, s11, 0x903800
    s_add_u32 s14, s12, 0
    buffer_load_dwordx4 a[56:59], v1, s[4:7], s14 offen offset:0 sc1
    buffer_load_dwordx4 a[60:63], v1, s[4:7], s14 offen offset:1024 sc1
    buffer_load_dwordx4 a[64:67], v1, s[4:7], s14 offen offset:2048 sc1
    buffer_load_dwordx4 a[68:71], v1, s[4:7], s14 offen offset:3072 sc1
    s_add_u32 s14, s12, 4096
    buffer_load_dwordx4 a[72:75], v1, s[4:7], s14 offen offset:0 sc1
    buffer_load_dwordx4 a[76:79], v1, s[4:7], s14 offen offset:1024 sc1
    buffer_load_dwordx4 a[80:83], v1, s[4:7], s14 offen offset:2048 sc1
    buffer_load_dwordx4 a[84:87], v1, s[4:7], s14 offen offset:3072 sc1
    s_add_u32 s14, s12, 8192
    buffer_load_dwordx4 a[88:91], v1, s[4:7], s14 offen offset:0 sc1
    buffer_load_dwordx4 a[92:95], v1, s[4:7], s14 offen offset:1024 sc1
    buffer_load_dwordx4 a[96:99], v1, s[4:7], s14 offen offset:2048 sc1
    buffer_load_dwordx4 a[100:103], v1, s[4:7], s14 offen offset:3072 sc1
    s_add_u32 s14, s12, 12288
    buffer_load_dwordx4 a[104:107], v1, s[4:7], s14 offen offset:0 sc1
    buffer_load_dwordx4 a[108:111], v1, s[4:7], s14 offen offset:1024 sc1
    s_add_u32 s12, s11, 0x907000
    s_add_u32 s14, s12, 0
    buffer_load_dwordx4 a[112:115], v1, s[4:7], s14 offen offset:0 sc1
    buffer_load_dwordx4 a[116:119], v1, s[4:7], s14 offen offset:1024 sc1
    buffer_load_dwordx4 a[120:123], v1, s[4:7], s14 offen offset:2048 sc1
    buffer_load_dwordx4 a[124:127], v1, s[4:7], s14 offen offset:3072 sc1
    s_add_u32 s14, s12, 4096
    buffer_load_dwordx4 a[128:131], v1, s[4:7], s14 offen offset:0 sc1
    buffer_load_dwordx4 a[132:135], v1, s[4:7], s14 offen offset:1024 sc1
    buffer_load_dwordx4 a[136:139], v1, s[4:7], s14 offen offset:2048 sc1
    buffer_load_dwordx4 a[140:143], v1, s[4:7], s14 offen offset:3072 sc1
    s_add_u32 s14, s12, 8192
    buffer_load_dwordx4 a[144:147], v1, s[4:7], s14 offen offset:0 sc1
    buffer_load_dwordx4 a[148:151], v1, s[4:7], s14 offen offset:1024 sc1
    buffer_load_dwordx4 a[152:155], v1, s[4:7], s14 offen offset:2048 sc1
    buffer_load_dwordx4 a[156:159], v1, s[4:7], s14 offen offset:3072 sc1
    s_add_u32 s14, s12, 12288
    buffer_load_dwordx4 a[160:163], v1, s[4:7], s14 offen offset:0 sc1
    buffer_load_dwordx4 a[164:167], v1, s[4:7], s14 offen offset:1024 sc1
    s_add_u32 s12, s11, 0x90a800
    s_add_u32 s14, s12, 0
    buffer_load_dwordx4 a[168:171], v1, s[4:7], s14 offen offset:0 sc1
    buffer_load_dwordx4 a[172:175], v1, s[4:7], s14 offen offset:1024 sc1
    buffer_load_dwordx4 a[176:179], v1, s[4:7], s14 offen offset:2048 sc1
    buffer_load_dwordx4 a[180:183], v1, s[4:7], s14 offen offset:3072 sc1
    s_add_u32 s14, s12, 4096
    buffer_load_dwordx4 a[184:187], v1, s[4:7], s14 offen offset:0 sc1
    buffer_load_dwordx4 a[188:191], v1, s[4:7], s14 offen offset:1024 sc1
    buffer_load_dwordx4 a[192:195], v1, s[4:7], s14 offen offset:2048 sc1
    buffer_load_dwordx4 a[196:199], v1, s[4:7], s14 offen offset:3072 sc1
    s_add_u32 s14, s12, 8192
    buffer_load_dwordx4 a[200:203], v1, s[4:7], s14 offen offset:0 sc1
    buffer_load_dwordx4 a[204:207], v1, s[4:7], s14 offen offset:1024 sc1
    buffer_load_dwordx4 a[208:211], v1, s[4:7], s14 offen offset:2048 sc1
    buffer_load_dwordx4 a[212:215], v1, s[4:7], s14 offen offset:3072 sc1
    s_add_u32 s14, s12, 12288
    buffer_load_dwordx4 a[216:219], v1, s[4:7], s14 offen offset:0 sc1
    buffer_load_dwordx4 a[220:223], v1, s[4:7], s14 offen offset:1024 sc1
    s_mov_b32 s11, 0x3b02000
    v_min_u32 v8, 63, v0
    v_lshlrev_b32 v8, 4, v8
    s_mov_b32 s22, 0
wt_598:
    buffer_load_dwordx4 v[24:27], v8, s[4:7], s11 offen offset:0 sc1
    buffer_load_dwordx4 v[28:31], v8, s[4:7], s11 offen offset:1024 sc1
    s_waitcnt vmcnt(0)
    v_xor_b32 v24, s80, v24
    v_xor_b32 v25, s81, v25
    v_and_b32 v25, -16, v25
    v_xor_b32 v26, s80, v26
    v_xor_b32 v27, s81, v27
    v_and_b32 v27, -16, v27
    v_xor_b32 v28, s80, v28
    v_xor_b32 v29, s81, v29
    v_and_b32 v29, -16, v29
    v_xor_b32 v30, s80, v30
    v_xor_b32 v31, s81, v31
    v_and_b32 v31, -16, v31
    v_or3_b32 v24, v24, v25, v26
    v_or_b32 v24, v24, v27
    v_or3_b32 v24, v24, v28, v29
    v_or3_b32 v24, v24, v30, v31
    v_cmp_ne_u32 vcc, 0, v24
    s_cbranch_vccz wtok_599
    s_add_u32 s22, s22, 1
    s_cmp_gt_u32 s22, 65536
    s_cbranch_scc1 M_exit
    s_sleep 16
    s_branch wt_598
wtok_599:
    s_mul_i32 s13, s15, 28672
    s_mul_i32 s14, s10, 7168
    s_add_u32 s13, s13, s14
    s_add_u32 m0, s18, s14
    s_nop 0
    buffer_load_dwordx4 v1, s[4:7], s13 offen offset:0 sc1 lds
    buffer_load_dwordx4 v1, s[4:7], s13 offen offset:1024 sc1 lds
    buffer_load_dwordx4 v1, s[4:7], s13 offen offset:2048 sc1 lds
    buffer_load_dwordx4 v1, s[4:7], s13 offen offset:3072 sc1 lds
    s_add_u32 m0, m0, 4096
    s_add_u32 s13, s13, 4096
    buffer_load_dwordx4 v1, s[4:7], s13 offen offset:0 sc1 lds
    buffer_load_dwordx4 v1, s[4:7], s13 offen offset:1024 sc1 lds
    buffer_load_dwordx4 v1, s[4:7], s13 offen offset:2048 sc1 lds
    s_mov_b32 s16, 0
    s_waitcnt vmcnt(0)
y_loop_600:
    s_cmp_lg_u32 s16, 6
    s_cbranch_scc1 y_two_604
    s_mov_b32 s11, 0x3b02800
    v_min_u32 v8, 51, v0
    v_lshlrev_b32 v8, 4, v8
    s_mov_b32 s22, 0
wt_605:
    buffer_load_dwordx4 v[24:27], v8, s[4:7], s11 offen offset:0 sc1
    s_waitcnt vmcnt(0)
    v_xor_b32 v24, s80, v24
    v_xor_b32 v25, s81, v25
    v_and_b32 v25, -16, v25
    v_xor_b32 v26, s80, v26
    v_xor_b32 v27, s81, v27
    v_and_b32 v27, -16, v27
    v_or3_b32 v24, v24, v25, v26
    v_or_b32 v24, v24, v27
    v_cmp_ne_u32 vcc, 0, v24
    s_cbranch_vccz wtok_606
    s_add_u32 s22, s22, 1
    s_cmp_gt_u32 s22, 65536
    s_cbranch_scc1 M_exit
    s_sleep 16
    s_branch wt_605
wtok_606:
    s_mov_b32 s78, 0x10000000
    s_barrier
    s_cmp_lg_u32 s10, 3
    s_cbranch_scc1 y_nofl_607
    s_lshl_b32 s11, s15, 5
    s_add_u32 s11, s11, s9
    s_lshl_b32 s11, s11, 4
    s_add_u32 s11, s11, 0x3b00000
    s_add_u32 s13, s16, 0
    v_mov_b32 v4, s13
    s_mov_b64 exec, 1
    buffer_store_dword v4, v7, s[4:7], s11 offen sc1
    s_mov_b64 exec, -1
y_nofl_607:
y_two_604:
    s_sub_u32 s19, s16, 6
    s_max_i32 s19, s19, 0
    s_mul_i32 s19, s19, 2
    s_add_u32 s19, s19, s15
    s_lshl_b32 s30, s19, 13
    s_add_u32 s30, s30, 0x3080000
    s_add_u32 s31, s30, 4096
    s_mul_i32 s29, s19, 28672
    s_mul_i32 s24, s19, 40960
    s_mul_i32 s12, s10, 10240
    s_add_u32 s24, s24, s12
    s_add_u32 s24, s24, 0x3120000
    s_add_u32 s25, s24, 4096
    s_add_u32 s26, s24, 8192
    s_cmp_ge_u32 s16, 32
    s_cbranch_scc1 y_nou1_608
    s_mul_i32 s17, s16, 2
    s_add_u32 s17, s17, s15
    s_barrier
    v_add_u32 v3, s18, v22
    s_sub_u32 s18, 61440, s18
    s_add_u32 s11, s17, 2
    s_min_u32 s11, s11, 63
    s_mul_i32 s13, s11, 28672
    s_mul_i32 s14, s10, 7168
    s_add_u32 s13, s13, s14
    s_add_u32 m0, s18, s14
    s_nop 0
    s_cmp_lt_u32 s16, 6
    s_cbranch_scc1 y_fill_609
    ds_read_b128 v[8:11], v3 offset:0
    ds_read_b128 v[12:15], v3 offset:14336
    ds_read_b128 v[16:19], v3 offset:1024
    s_waitcnt lgkmcnt(2)
    v_mfma_f32_16x16x32_bf16 v[24:27], v[8:11], a[0:3], 0
    buffer_load_dwordx4 v1, s[4:7], s13 offen offset:0 sc1 lds
    v_mov_b32 v56, v72
    v_mov_b32 v57, v73
    v_mfma_f32_16x16x32_bf16 v[28:31], v[8:11], a[56:59], 0
    v_mov_b32 v58, v74
    v_mfma_f32_16x16x32_bf16 v[32:35], v[8:11], a[112:115], 0
    v_mov_b32 v59, v75
    v_mfma_f32_16x16x32_bf16 v[36:39], v[8:11], a[168:171], 0
    ds_read_b128 v[8:11], v3 offset:15360
    s_waitcnt lgkmcnt(2)
    v_mfma_f32_16x16x32_bf16 v[40:43], v[12:15], a[0:3], 0
    buffer_load_dwordx4 v1, s[4:7], s13 offen offset:1024 sc1 lds
    v_mov_b32 v60, v76
    v_mov_b32 v61, v77
    v_mfma_f32_16x16x32_bf16 v[44:47], v[12:15], a[56:59], 0
    v_mov_b32 v62, v78
    v_mfma_f32_16x16x32_bf16 v[48:51], v[12:15], a[112:115], 0
    v_mov_b32 v63, v79
    v_mfma_f32_16x16x32_bf16 v[52:55], v[12:15], a[168:171], 0
    ds_read_b128 v[12:15], v3 offset:2048
    s_waitcnt lgkmcnt(2)
    v_mfma_f32_16x16x32_bf16 v[24:27], v[16:19], a[4:7], v[24:27]
    buffer_load_dwordx4 v1, s[4:7], s13 offen offset:2048 sc1 lds
    v_mov_b32 v64, v80
    v_mov_b32 v65, v81
    v_mfma_f32_16x16x32_bf16 v[28:31], v[16:19], a[60:63], v[28:31]
    v_mov_b32 v66, v82
    v_mfma_f32_16x16x32_bf16 v[32:35], v[16:19], a[116:119], v[32:35]
    v_mov_b32 v67, v83
    v_mfma_f32_16x16x32_bf16 v[36:39], v[16:19], a[172:175], v[36:39]
    ds_read_b128 v[16:19], v3 offset:16384
    s_waitcnt lgkmcnt(2)
    v_mfma_f32_16x16x32_bf16 v[40:43], v[8:11], a[4:7], v[40:43]
    buffer_load_dwordx4 v1, s[4:7], s13 offen offset:3072 sc1 lds
    s_add_u32 m0, m0, 4096
    s_add_u32 s13, s13, 4096
    v_mov_b32 v68, v84
    v_mov_b32 v69, v85
    v_mfma_f32_16x16x32_bf16 v[44:47], v[8:11], a[60:63], v[44:47]
    v_mov_b32 v70, v86
    v_mfma_f32_16x16x32_bf16 v[48:51], v[8:11], a[116:119], v[48:51]
    v_mov_b32 v71, v87
    v_mfma_f32_16x16x32_bf16 v[52:55], v[8:11], a[172:175], v[52:55]
    ds_read_b128 v[8:11], v3 offset:3072
    s_waitcnt lgkmcnt(2)
    v_mfma_f32_16x16x32_bf16 v[24:27], v[12:15], a[8:11], v[24:27]
    buffer_load_dwordx4 v1, s[4:7], s13 offen offset:0 sc1 lds
    v_mov_b32 v72, v88
    v_mov_b32 v73, v89
    v_mfma_f32_16x16x32_bf16 v[28:31], v[12:15], a[64:67], v[28:31]
    v_mov_b32 v74, v90
    v_mfma_f32_16x16x32_bf16 v[32:35], v[12:15], a[120:123], v[32:35]
    v_mov_b32 v75, v91
    v_mfma_f32_16x16x32_bf16 v[36:39], v[12:15], a[176:179], v[36:39]
    ds_read_b128 v[12:15], v3 offset:17408
    s_waitcnt lgkmcnt(2)
    v_mfma_f32_16x16x32_bf16 v[40:43], v[16:19], a[8:11], v[40:43]
    buffer_load_dwordx4 v1, s[4:7], s13 offen offset:1024 sc1 lds
    v_mov_b32 v76, v92
    v_mov_b32 v77, v93
    v_mfma_f32_16x16x32_bf16 v[44:47], v[16:19], a[64:67], v[44:47]
    v_mov_b32 v78, v94
    v_mfma_f32_16x16x32_bf16 v[48:51], v[16:19], a[120:123], v[48:51]
    v_mov_b32 v79, v95
    v_mfma_f32_16x16x32_bf16 v[52:55], v[16:19], a[176:179], v[52:55]
    ds_read_b128 v[16:19], v3 offset:4096
    s_waitcnt lgkmcnt(2)
    v_mfma_f32_16x16x32_bf16 v[24:27], v[8:11], a[12:15], v[24:27]
    buffer_load_dwordx4 v1, s[4:7], s13 offen offset:2048 sc1 lds
    v_mov_b32 v80, v96
    v_mov_b32 v81, v97
    v_mfma_f32_16x16x32_bf16 v[28:31], v[8:11], a[68:71], v[28:31]
    v_mov_b32 v82, v98
    v_mfma_f32_16x16x32_bf16 v[32:35], v[8:11], a[124:127], v[32:35]
    v_mov_b32 v83, v99
    v_mfma_f32_16x16x32_bf16 v[36:39], v[8:11], a[180:183], v[36:39]
    ds_read_b128 v[8:11], v3 offset:18432
    s_waitcnt lgkmcnt(2)
    v_mfma_f32_16x16x32_bf16 v[40:43], v[12:15], a[12:15], v[40:43]
    v_mov_b32 v84, v100
    v_mov_b32 v85, v101
    v_mfma_f32_16x16x32_bf16 v[44:47], v[12:15], a[68:71], v[44:47]
    v_mov_b32 v86, v102
    v_mfma_f32_16x16x32_bf16 v[48:51], v[12:15], a[124:127], v[48:51]
    v_mov_b32 v87, v103
    v_mfma_f32_16x16x32_bf16 v[52:55], v[12:15], a[180:183], v[52:55]
    ds_read_b128 v[12:15], v3 offset:5120
    s_waitcnt lgkmcnt(2)
    v_mfma_f32_16x16x32_bf16 v[24:27], v[16:19], a[16:19], v[24:27]
    v_mov_b32 v88, v104
    v_mov_b32 v89, v105
    v_mfma_f32_16x16x32_bf16 v[28:31], v[16:19], a[72:75], v[28:31]
    v_mov_b32 v90, v106
    v_mfma_f32_16x16x32_bf16 v[32:35], v[16:19], a[128:131], v[32:35]
    v_mov_b32 v91, v107
    v_mfma_f32_16x16x32_bf16 v[36:39], v[16:19], a[184:187], v[36:39]
    ds_read_b128 v[16:19], v3 offset:19456
    s_waitcnt lgkmcnt(2)
    v_mfma_f32_16x16x32_bf16 v[40:43], v[8:11], a[16:19], v[40:43]
    v_mov_b32 v92, v108
    v_mov_b32 v93, v109
    v_mfma_f32_16x16x32_bf16 v[44:47], v[8:11], a[72:75], v[44:47]
    v_mov_b32 v94, v110
    v_mfma_f32_16x16x32_bf16 v[48:51], v[8:11], a[128:131], v[48:51]
    v_mov_b32 v95, v111
    v_mfma_f32_16x16x32_bf16 v[52:55], v[8:11], a[184:187], v[52:55]
    ds_read_b128 v[8:11], v3 offset:6144
    s_waitcnt lgkmcnt(2)
    v_mfma_f32_16x16x32_bf16 v[24:27], v[12:15], a[20:23], v[24:27]
    buffer_load_dwordx2 v[20:21], v5, s[72:75], s29 offen
    v_mov_b32 v96, v112
    v_mov_b32 v97, v113
    v_mfma_f32_16x16x32_bf16 v[28:31], v[12:15], a[76:79], v[28:31]
    v_mov_b32 v98, v114
    v_mfma_f32_16x16x32_bf16 v[32:35], v[12:15], a[132:135], v[32:35]
    v_mov_b32 v99, v115
    v_mfma_f32_16x16x32_bf16 v[36:39], v[12:15], a[188:191], v[36:39]
    ds_read_b128 v[12:15], v3 offset:20480
    s_waitcnt lgkmcnt(2)
    v_mfma_f32_16x16x32_bf16 v[40:43], v[16:19], a[20:23], v[40:43]
    buffer_load_dwordx4 v[168:171], v1, s[76:79], s30 offen offset:0 sc1
    v_mov_b32 v100, v116
    v_mov_b32 v101, v117
    v_mfma_f32_16x16x32_bf16 v[44:47], v[16:19], a[76:79], v[44:47]
    v_mov_b32 v102, v118
    v_mfma_f32_16x16x32_bf16 v[48:51], v[16:19], a[132:135], v[48:51]
    v_mov_b32 v103, v119
    v_mfma_f32_16x16x32_bf16 v[52:55], v[16:19], a[188:191], v[52:55]
    ds_read_b128 v[16:19], v3 offset:7168
    s_waitcnt lgkmcnt(2)
    v_mfma_f32_16x16x32_bf16 v[24:27], v[8:11], a[24:27], v[24:27]
    buffer_load_dwordx4 v[172:175], v1, s[76:79], s30 offen offset:1024 sc1
    v_mov_b32 v104, v120
    v_mov_b32 v105, v121
    v_mfma_f32_16x16x32_bf16 v[28:31], v[8:11], a[80:83], v[28:31]
    v_mov_b32 v106, v122
    v_mfma_f32_16x16x32_bf16 v[32:35], v[8:11], a[136:139], v[32:35]
    v_mov_b32 v107, v123
    v_mfma_f32_16x16x32_bf16 v[36:39], v[8:11], a[192:195], v[36:39]
    ds_read_b128 v[8:11], v3 offset:21504
    s_waitcnt lgkmcnt(2)
    v_mfma_f32_16x16x32_bf16 v[40:43], v[12:15], a[24:27], v[40:43]
    buffer_load_dwordx4 v[176:179], v1, s[76:79], s30 offen offset:2048 sc1
    v_mov_b32 v108, v124
    v_mov_b32 v109, v125
    v_mfma_f32_16x16x32_bf16 v[44:47], v[12:15], a[80:83], v[44:47]
    v_mov_b32 v110, v126
    v_mfma_f32_16x16x32_bf16 v[48:51], v[12:15], a[136:139], v[48:51]
    v_mov_b32 v111, v127
    v_mfma_f32_16x16x32_bf16 v[52:55], v[12:15], a[192:195], v[52:55]
    ds_read_b128 v[12:15], v3 offset:8192
    s_waitcnt lgkmcnt(2)
    v_mfma_f32_16x16x32_bf16 v[24:27], v[16:19], a[28:31], v[24:27]
    buffer_load_dwordx4 v[180:183], v1, s[76:79], s30 offen offset:3072 sc1
    v_mov_b32 v112, v128
    v_mov_b32 v113, v129
    v_mfma_f32_16x16x32_bf16 v[28:31], v[16:19], a[84:87], v[28:31]
    v_mov_b32 v114, v130
    v_mfma_f32_16x16x32_bf16 v[32:35], v[16:19], a[140:143], v[32:35]
    v_mov_b32 v115, v131
    v_mfma_f32_16x16x32_bf16 v[36:39], v[16:19], a[196:199], v[36:39]
    ds_read_b128 v[16:19], v3 offset:22528
    s_waitcnt lgkmcnt(2)
    v_mfma_f32_16x16x32_bf16 v[40:43], v[8:11], a[28:31], v[40:43]
    buffer_load_dwordx4 v[184:187], v1, s[76:79], s31 offen offset:0 sc1
    v_mov_b32 v116, v132
    v_mov_b32 v117, v133
    v_mfma_f32_16x16x32_bf16 v[44:47], v[8:11], a[84:87], v[44:47]
    v_mov_b32 v118, v134
    v_mfma_f32_16x16x32_bf16 v[48:51], v[8:11], a[140:143], v[48:51]
    v_mov_b32 v119, v135
    v_mfma_f32_16x16x32_bf16 v[52:55], v[8:11], a[196:199], v[52:55]
    ds_read_b128 v[8:11], v3 offset:9216
    s_waitcnt lgkmcnt(2)
    v_mfma_f32_16x16x32_bf16 v[24:27], v[12:15], a[32:35], v[24:27]
    buffer_load_dwordx4 v[188:191], v1, s[76:79], s31 offen offset:1024 sc1
    v_mov_b32 v120, v136
    v_mov_b32 v121, v137
    v_mfma_f32_16x16x32_bf16 v[28:31], v[12:15], a[88:91], v[28:31]
    v_mov_b32 v122, v138
    v_mfma_f32_16x16x32_bf16 v[32:35], v[12:15], a[144:147], v[32:35]
    v_mov_b32 v123, v139
    v_mfma_f32_16x16x32_bf16 v[36:39], v[12:15], a[200:203], v[36:39]
    ds_read_b128 v[12:15], v3 offset:23552
    s_waitcnt lgkmcnt(2)
    v_mfma_f32_16x16x32_bf16 v[40:43], v[16:19], a[32:35], v[40:43]
    buffer_load_dwordx4 v[192:195], v1, s[76:79], s31 offen offset:2048 sc1
    v_mov_b32 v124, v140
    v_mov_b32 v125, v141
    v_mfma_f32_16x16x32_bf16 v[44:47], v[16:19], a[88:91], v[44:47]
    v_mov_b32 v126, v142
    v_mfma_f32_16x16x32_bf16 v[48:51], v[16:19], a[144:147], v[48:51]
    v_mov_b32 v127, v143
    v_mfma_f32_16x16x32_bf16 v[52:55], v[16:19], a[200:203], v[52:55]
    ds_read_b128 v[16:19], v3 offset:10240
    s_waitcnt lgkmcnt(2)
    v_mfma_f32_16x16x32_bf16 v[24:27], v[8:11], a[36:39], v[24:27]
    buffer_load_dwordx4 v[196:199], v1, s[76:79], s24 offen offset:0 sc1
    v_mov_b32 v128, v144
    v_mov_b32 v129, v145
    v_mfma_f32_16x16x32_bf16 v[28:31], v[8:11], a[92:95], v[28:31]
    v_mov_b32 v130, v146
    v_mfma_f32_16x16x32_bf16 v[32:35], v[8:11], a[148:151], v[32:35]
    v_mov_b32 v131, v147
    v_mfma_f32_16x16x32_bf16 v[36:39], v[8:11], a[204:207], v[36:39]
    ds_read_b128 v[8:11], v3 offset:24576
    s_waitcnt lgkmcnt(2)
    v_mfma_f32_16x16x32_bf16 v[40:43], v[12:15], a[36:39], v[40:43]
    buffer_load_dwordx4 v[200:203], v1, s[76:79], s24 offen offset:1024 sc1
    v_mov_b32 v132, v148
    v_mov_b32 v133, v149
    v_mfma_f32_16x16x32_bf16 v[44:47], v[12:15], a[92:95], v[44:47]
    v_mov_b32 v134, v150
    v_mfma_f32_16x16x32_bf16 v[48:51], v[12:15], a[148:151], v[48:51]
    v_mov_b32 v135, v151
    v_mfma_f32_16x16x32_bf16 v[52:55], v[12:15], a[204:207], v[52:55]
    ds_read_b128 v[12:15], v3 offset:11264
    s_waitcnt lgkmcnt(2)
    v_mfma_f32_16x16x32_bf16 v[24:27], v[16:19], a[40:43], v[24:27]
    buffer_load_dwordx4 v[204:207], v1, s[76:79], s24 offen offset:2048 sc1
    v_mov_b32 v136, v152
    v_mov_b32 v137, v153
    v_mfma_f32_16x16x32_bf16 v[28:31], v[16:19], a[96:99], v[28:31]
    v_mov_b32 v138, v154
    v_mfma_f32_16x16x32_bf16 v[32:35], v[16:19], a[152:155], v[32:35]
    v_mov_b32 v139, v155
    v_mfma_f32_16x16x32_bf16 v[36:39], v[16:19], a[208:211], v[36:39]
    ds_read_b128 v[16:19], v3 offset:25600
    s_waitcnt lgkmcnt(2)
    v_mfma_f32_16x16x32_bf16 v[40:43], v[8:11], a[40:43], v[40:43]
    buffer_load_dwordx4 v[208:211], v1, s[76:79], s24 offen offset:3072 sc1
    v_mov_b32 v140, v156
    v_mov_b32 v141, v157
    v_mfma_f32_16x16x32_bf16 v[44:47], v[8:11], a[96:99], v[44:47]
    v_mov_b32 v142, v158
    v_mfma_f32_16x16x32_bf16 v[48:51], v[8:11], a[152:155], v[48:51]
    v_mov_b32 v143, v159
    v_mfma_f32_16x16x32_bf16 v[52:55], v[8:11], a[208:211], v[52:55]
    ds_read_b128 v[8:11], v3 offset:12288
    s_waitcnt lgkmcnt(2)
    v_mfma_f32_16x16x32_bf16 v[24:27], v[12:15], a[44:47], v[24:27]
    buffer_load_dwordx4 v[212:215], v1, s[76:79], s25 offen offset:0 sc1
    v_mov_b32 v144, v160
    v_mov_b32 v145, v161
    v_mfma_f32_16x16x32_bf16 v[28:31], v[12:15], a[100:103], v[28:31]
    v_mov_b32 v146, v162
    v_mfma_f32_16x16x32_bf16 v[32:35], v[12:15], a[156:159], v[32:35]
    v_mov_b32 v147, v163
    v_mfma_f32_16x16x32_bf16 v[36:39], v[12:15], a[212:215], v[36:39]
    ds_read_b128 v[12:15], v3 offset:26624
    s_waitcnt lgkmcnt(2)
    v_mfma_f32_16x16x32_bf16 v[40:43], v[16:19], a[44:47], v[40:43]
    buffer_load_dwordx4 v[216:219], v1, s[76:79], s25 offen offset:1024 sc1
    v_mov_b32 v148, v164
    v_mov_b32 v149, v165
    v_mfma_f32_16x16x32_bf16 v[44:47], v[16:19], a[100:103], v[44:47]
    v_mov_b32 v150, v166
    v_mfma_f32_16x16x32_bf16 v[48:51], v[16:19], a[156:159], v[48:51]
    v_mov_b32 v151, v167
    v_mfma_f32_16x16x32_bf16 v[52:55], v[16:19], a[212:215], v[52:55]
    ds_read_b128 v[16:19], v3 offset:13312
    s_waitcnt lgkmcnt(2)
    v_mfma_f32_16x16x32_bf16 v[24:27], v[8:11], a[48:51], v[24:27]
    buffer_load_dwordx4 v[220:223], v1, s[76:79], s25 offen offset:2048 sc1
    v_mfma_f32_16x16x32_bf16 v[28:31], v[8:11], a[104:107], v[28:31]
    v_mfma_f32_16x16x32_bf16 v[32:35], v[8:11], a[160:163], v[32:35]
    v_mfma_f32_16x16x32_bf16 v[36:39], v[8:11], a[216:219], v[36:39]
    ds_read_b128 v[8:11], v3 offset:27648
    s_waitcnt lgkmcnt(2)
    v_mfma_f32_16x16x32_bf16 v[40:43], v[12:15], a[48:51], v[40:43]
    buffer_load_dwordx4 v[224:227], v1, s[76:79], s25 offen offset:3072 sc1
    v_mfma_f32_16x16x32_bf16 v[44:47], v[12:15], a[104:107], v[44:47]
    v_mfma_f32_16x16x32_bf16 v[48:51], v[12:15], a[160:163], v[48:51]
    v_mfma_f32_16x16x32_bf16 v[52:55], v[12:15], a[216:219], v[52:55]
    s_waitcnt lgkmcnt(1)
    v_mfma_f32_16x16x32_bf16 v[24:27], v[16:19], a[52:55], v[24:27]
    buffer_load_dwordx4 v[228:231], v1, s[76:79], s26 offen offset:0 sc1
    v_mfma_f32_16x16x32_bf16 v[28:31], v[16:19], a[108:111], v[28:31]
    v_mfma_f32_16x16x32_bf16 v[32:35], v[16:19], a[164:167], v[32:35]
    v_mfma_f32_16x16x32_bf16 v[36:39], v[16:19], a[220:223], v[36:39]
    s_waitcnt lgkmcnt(0)
    v_mfma_f32_16x16x32_bf16 v[40:43], v[8:11], a[52:55], v[40:43]
    buffer_load_dwordx4 v[232:235], v1, s[76:79], s26 offen offset:1024 sc1
    v_mfma_f32_16x16x32_bf16 v[44:47], v[8:11], a[108:111], v[44:47]
    v_mfma_f32_16x16x32_bf16 v[48:51], v[8:11], a[164:167], v[48:51]
    v_mfma_f32_16x16x32_bf16 v[52:55], v[8:11], a[220:223], v[52:55]
    s_branch y_cont_610
y_fill_609:
    ds_read_b128 v[8:11], v3 offset:0
    ds_read_b128 v[12:15], v3 offset:14336
    ds_read_b128 v[16:19], v3 offset:1024
    s_waitcnt lgkmcnt(2)
    v_mfma_f32_16x16x32_bf16 v[24:27], v[8:11], a[0:3], 0
    v_mov_b32 v56, v72
    v_mov_b32 v57, v73
    v_mfma_f32_16x16x32_bf16 v[28:31], v[8:11], a[56:59], 0
    v_mov_b32 v58, v74
    v_mfma_f32_16x16x32_bf16 v[32:35], v[8:11], a[112:115], 0
    v_mov_b32 v59, v75
    v_mfma_f32_16x16x32_bf16 v[36:39], v[8:11], a[168:171], 0
    ds_read_b128 v[8:11], v3 offset:15360
    s_waitcnt lgkmcnt(2)
    v_mfma_f32_16x16x32_bf16 v[40:43], v[12:15], a[0:3], 0
    v_mov_b32 v60, v76
    v_mov_b32 v61, v77
    v_mfma_f32_16x16x32_bf16 v[44:47], v[12:15], a[56:59], 0
    v_mov_b32 v62, v78
    v_mfma_f32_16x16x32_bf16 v[48:51], v[12:15], a[112:115], 0
    v_mov_b32 v63, v79
    v_mfma_f32_16x16x32_bf16 v[52:55], v[12:15], a[168:171], 0
    ds_read_b128 v[12:15], v3 offset:2048
    s_waitcnt lgkmcnt(2)
    v_mfma_f32_16x16x32_bf16 v[24:27], v[16:19], a[4:7], v[24:27]
    v_mov_b32 v64, v80
    v_mov_b32 v65, v81
    v_mfma_f32_16x16x32_bf16 v[28:31], v[16:19], a[60:63], v[28:31]
    v_mov_b32 v66, v82
    v_mfma_f32_16x16x32_bf16 v[32:35], v[16:19], a[116:119], v[32:35]
    v_mov_b32 v67, v83
    v_mfma_f32_16x16x32_bf16 v[36:39], v[16:19], a[172:175], v[36:39]
    ds_read_b128 v[16:19], v3 offset:16384
    s_waitcnt lgkmcnt(2)
    v_mfma_f32_16x16x32_bf16 v[40:43], v[8:11], a[4:7], v[40:43]
    v_mov_b32 v68, v84
    v_mov_b32 v69, v85
    v_mfma_f32_16x16x32_bf16 v[44:47], v[8:11], a[60:63], v[44:47]
    v_mov_b32 v70, v86
    v_mfma_f32_16x16x32_bf16 v[48:51], v[8:11], a[116:119], v[48:51]
    v_mov_b32 v71, v87
    v_mfma_f32_16x16x32_bf16 v[52:55], v[8:11], a[172:175], v[52:55]
    ds_read_b128 v[8:11], v3 offset:3072
    s_waitcnt lgkmcnt(2)
    v_mfma_f32_16x16x32_bf16 v[24:27], v[12:15], a[8:11], v[24:27]
    v_mov_b32 v72, v88
    v_mov_b32 v73, v89
    v_mfma_f32_16x16x32_bf16 v[28:31], v[12:15], a[64:67], v[28:31]
    v_mov_b32 v74, v90
    v_mfma_f32_16x16x32_bf16 v[32:35], v[12:15], a[120:123], v[32:35]
    v_mov_b32 v75, v91
    v_mfma_f32_16x16x32_bf16 v[36:39], v[12:15], a[176:179], v[36:39]
    ds_read_b128 v[12:15], v3 offset:17408
    s_waitcnt lgkmcnt(2)
    v_mfma_f32_16x16x32_bf16 v[40:43], v[16:19], a[8:11], v[40:43]
    v_mov_b32 v76, v92
    v_mov_b32 v77, v93
    v_mfma_f32_16x16x32_bf16 v[44:47], v[16:19], a[64:67], v[44:47]
    v_mov_b32 v78, v94
    v_mfma_f32_16x16x32_bf16 v[48:51], v[16:19], a[120:123], v[48:51]
    v_mov_b32 v79, v95
    v_mfma_f32_16x16x32_bf16 v[52:55], v[16:19], a[176:179], v[52:55]
    ds_read_b128 v[16:19], v3 offset:4096
    s_waitcnt lgkmcnt(2)
    v_mfma_f32_16x16x32_bf16 v[24:27], v[8:11], a[12:15], v[24:27]
    v_mov_b32 v80, v96
    v_mov_b32 v81, v97
    v_mfma_f32_16x16x32_bf16 v[28:31], v[8:11], a[68:71], v[28:31]
    v_mov_b32 v82, v98
    v_mfma_f32_16x16x32_bf16 v[32:35], v[8:11], a[124:127], v[32:35]
    v_mov_b32 v83, v99
    v_mfma_f32_16x16x32_bf16 v[36:39], v[8:11], a[180:183], v[36:39]
    ds_read_b128 v[8:11], v3 offset:18432
    s_waitcnt lgkmcnt(2)
    v_mfma_f32_16x16x32_bf16 v[40:43], v[12:15], a[12:15], v[40:43]
    v_mov_b32 v84, v100
    v_mov_b32 v85, v101
    v_mfma_f32_16x16x32_bf16 v[44:47], v[12:15], a[68:71], v[44:47]
    v_mov_b32 v86, v102
    v_mfma_f32_16x16x32_bf16 v[48:51], v[12:15], a[124:127], v[48:51]
    v_mov_b32 v87, v103
    v_mfma_f32_16x16x32_bf16 v[52:55], v[12:15], a[180:183], v[52:55]
    ds_read_b128 v[12:15], v3 offset:5120
    s_waitcnt lgkmcnt(2)
    v_mfma_f32_16x16x32_bf16 v[24:27], v[16:19], a[16:19], v[24:27]
    v_mov_b32 v88, v104
    v_mov_b32 v89, v105
    v_mfma_f32_16x16x32_bf16 v[28:31], v[16:19], a[72:75], v[28:31]
    v_mov_b32 v90, v106
    v_mfma_f32_16x16x32_bf16 v[32:35], v[16:19], a[128:131], v[32:35]
    v_mov_b32 v91, v107
    v_mfma_f32_16x16x32_bf16 v[36:39], v[16:19], a[184:187], v[36:39]
    ds_read_b128 v[16:19], v3 offset:19456
    s_waitcnt lgkmcnt(2)
    v_mfma_f32_16x16x32_bf16 v[40:43], v[8:11], a[16:19], v[40:43]
    v_mov_b32 v92, v108
    v_mov_b32 v93, v109
    v_mfma_f32_16x16x32_bf16 v[44:47], v[8:11], a[72:75], v[44:47]
    v_mov_b32 v94, v110
    v_mfma_f32_16x16x32_bf16 v[48:51], v[8:11], a[128:131], v[48:51]
    v_mov_b32 v95, v111
    v_mfma_f32_16x16x32_bf16 v[52:55], v[8:11], a[184:187], v[52:55]
    ds_read_b128 v[8:11], v3 offset:6144
    s_waitcnt lgkmcnt(2)
    v_mfma_f32_16x16x32_bf16 v[24:27], v[12:15], a[20:23], v[24:27]
    v_mov_b32 v96, v112
    v_mov_b32 v97, v113
    v_mfma_f32_16x16x32_bf16 v[28:31], v[12:15], a[76:79], v[28:31]
    v_mov_b32 v98, v114
    v_mfma_f32_16x16x32_bf16 v[32:35], v[12:15], a[132:135], v[32:35]
    v_mov_b32 v99, v115
    v_mfma_f32_16x16x32_bf16 v[36:39], v[12:15], a[188:191], v[36:39]
    ds_read_b128 v[12:15], v3 offset:20480
    s_waitcnt lgkmcnt(2)
    v_mfma_f32_16x16x32_bf16 v[40:43], v[16:19], a[20:23], v[40:43]
    v_mov_b32 v100, v116
    v_mov_b32 v101, v117
    v_mfma_f32_16x16x32_bf16 v[44:47], v[16:19], a[76:79], v[44:47]
    v_mov_b32 v102, v118
    v_mfma_f32_16x16x32_bf16 v[48:51], v[16:19], a[132:135], v[48:51]
    v_mov_b32 v103, v119
    v_mfma_f32_16x16x32_bf16 v[52:55], v[16:19], a[188:191], v[52:55]
    ds_read_b128 v[16:19], v3 offset:7168
    s_waitcnt lgkmcnt(2)
    v_mfma_f32_16x16x32_bf16 v[24:27], v[8:11], a[24:27], v[24:27]
    v_mov_b32 v104, v120
    v_mov_b32 v105, v121
    v_mfma_f32_16x16x32_bf16 v[28:31], v[8:11], a[80:83], v[28:31]
    v_mov_b32 v106, v122
    v_mfma_f32_16x16x32_bf16 v[32:35], v[8:11], a[136:139], v[32:35]
    v_mov_b32 v107, v123
    v_mfma_f32_16x16x32_bf16 v[36:39], v[8:11], a[192:195], v[36:39]
    ds_read_b128 v[8:11], v3 offset:21504
    s_waitcnt lgkmcnt(2)
    v_mfma_f32_16x16x32_bf16 v[40:43], v[12:15], a[24:27], v[40:43]
    v_mov_b32 v108, v124
    v_mov_b32 v109, v125
    v_mfma_f32_16x16x32_bf16 v[44:47], v[12:15], a[80:83], v[44:47]
    v_mov_b32 v110, v126
    v_mfma_f32_16x16x32_bf16 v[48:51], v[12:15], a[136:139], v[48:51]
    v_mov_b32 v111, v127
    v_mfma_f32_16x16x32_bf16 v[52:55], v[12:15], a[192:195], v[52:55]
    ds_read_b128 v[12:15], v3 offset:8192
    s_waitcnt lgkmcnt(2)
    v_mfma_f32_16x16x32_bf16 v[24:27], v[16:19], a[28:31], v[24:27]
    v_mov_b32 v112, v128
    v_mov_b32 v113, v129
    v_mfma_f32_16x16x32_bf16 v[28:31], v[16:19], a[84:87], v[28:31]
    v_mov_b32 v114, v130
    v_mfma_f32_16x16x32_bf16 v[32:35], v[16:19], a[140:143], v[32:35]
    v_mov_b32 v115, v131
    v_mfma_f32_16x16x32_bf16 v[36:39], v[16:19], a[196:199], v[36:39]
    ds_read_b128 v[16:19], v3 offset:22528
    s_waitcnt lgkmcnt(2)
    v_mfma_f32_16x16x32_bf16 v[40:43], v[8:11], a[28:31], v[40:43]
    v_mov_b32 v116, v132
    v_mov_b32 v117, v133
    v_mfma_f32_16x16x32_bf16 v[44:47], v[8:11], a[84:87], v[44:47]
    v_mov_b32 v118, v134
    v_mfma_f32_16x16x32_bf16 v[48:51], v[8:11], a[140:143], v[48:51]
    v_mov_b32 v119, v135
    v_mfma_f32_16x16x32_bf16 v[52:55], v[8:11], a[196:199], v[52:55]
    ds_read_b128 v[8:11], v3 offset:9216
    s_waitcnt lgkmcnt(2)
    v_mfma_f32_16x16x32_bf16 v[24:27], v[12:15], a[32:35], v[24:27]
    v_mov_b32 v120, v136
    v_mov_b32 v121, v137
    v_mfma_f32_16x16x32_bf16 v[28:31], v[12:15], a[88:91], v[28:31]
    v_mov_b32 v122, v138
    v_mfma_f32_16x16x32_bf16 v[32:35], v[12:15], a[144:147], v[32:35]
    v_mov_b32 v123, v139
    v_mfma_f32_16x16x32_bf16 v[36:39], v[12:15], a[200:203], v[36:39]
    ds_read_b128 v[12:15], v3 offset:23552
    s_waitcnt lgkmcnt(2)
    v_mfma_f32_16x16x32_bf16 v[40:43], v[16:19], a[32:35], v[40:43]
    buffer_load_dwordx4 v1, s[4:7], s13 offen offset:0 sc1 lds
    v_mov_b32 v124, v140
    v_mov_b32 v125, v141
    v_mfma_f32_16x16x32_bf16 v[44:47], v[16:19], a[88:91], v[44:47]
    v_mov_b32 v126, v142
    v_mfma_f32_16x16x32_bf16 v[48:51], v[16:19], a[144:147], v[48:51]
    v_mov_b32 v127, v143
    v_mfma_f32_16x16x32_bf16 v[52:55], v[16:19], a[200:203], v[52:55]
    ds_read_b128 v[16:19], v3 offset:10240
    s_waitcnt lgkmcnt(2)
    v_mfma_f32_16x16x32_bf16 v[24:27], v[8:11], a[36:39], v[24:27]
    buffer_load_dwordx4 v1, s[4:7], s13 offen offset:1024 sc1 lds
    v_mov_b32 v128, v144
    v_mov_b32 v129, v145
    v_mfma_f32_16x16x32_bf16 v[28:31], v[8:11], a[92:95], v[28:31]
    v_mov_b32 v130, v146
    v_mfma_f32_16x16x32_bf16 v[32:35], v[8:11], a[148:151], v[32:35]
    v_mov_b32 v131, v147
    v_mfma_f32_16x16x32_bf16 v[36:39], v[8:11], a[204:207], v[36:39]
    ds_read_b128 v[8:11], v3 offset:24576
    s_waitcnt lgkmcnt(2)
    v_mfma_f32_16x16x32_bf16 v[40:43], v[12:15], a[36:39], v[40:43]
    buffer_load_dwordx4 v1, s[4:7], s13 offen offset:2048 sc1 lds
    v_mov_b32 v132, v148
    v_mov_b32 v133, v149
    v_mfma_f32_16x16x32_bf16 v[44:47], v[12:15], a[92:95], v[44:47]
    v_mov_b32 v134, v150
    v_mfma_f32_16x16x32_bf16 v[48:51], v[12:15], a[148:151], v[48:51]
    v_mov_b32 v135, v151
    v_mfma_f32_16x16x32_bf16 v[52:55], v[12:15], a[204:207], v[52:55]
    ds_read_b128 v[12:15], v3 offset:11264
    s_waitcnt lgkmcnt(2)
    v_mfma_f32_16x16x32_bf16 v[24:27], v[16:19], a[40:43], v[24:27]
    buffer_load_dwordx4 v1, s[4:7], s13 offen offset:3072 sc1 lds
    s_add_u32 m0, m0, 4096
    s_add_u32 s13, s13, 4096
    v_mov_b32 v136, v152
    v_mov_b32 v137, v153
    v_mfma_f32_16x16x32_bf16 v[28:31], v[16:19], a[96:99], v[28:31]
    v_mov_b32 v138, v154
    v_mfma_f32_16x16x32_bf16 v[32:35], v[16:19], a[152:155], v[32:35]
    v_mov_b32 v139, v155
    v_mfma_f32_16x16x32_bf16 v[36:39], v[16:19], a[208:211], v[36:39]
    ds_read_b128 v[16:19], v3 offset:25600
    s_waitcnt lgkmcnt(2)
    v_mfma_f32_16x16x32_bf16 v[40:43], v[8:11], a[40:43], v[40:43]
    buffer_load_dwordx4 v1, s[4:7], s13 offen offset:0 sc1 lds
    v_mov_b32 v140, v156
    v_mov_b32 v141, v157
    v_mfma_f32_16x16x32_bf16 v[44:47], v[8:11], a[96:99], v[44:47]
    v_mov_b32 v142, v158
    v_mfma_f32_16x16x32_bf16 v[48:51], v[8:11], a[152:155], v[48:51]
    v_mov_b32 v143, v159
    v_mfma_f32_16x16x32_bf16 v[52:55], v[8:11], a[208:211], v[52:55]
    ds_read_b128 v[8:11], v3 offset:12288
    s_waitcnt lgkmcnt(2)
    v_mfma_f32_16x16x32_bf16 v[24:27], v[12:15], a[44:47], v[24:27]
    buffer_load_dwordx4 v1, s[4:7], s13 offen offset:1024 sc1 lds
    v_mov_b32 v144, v160
    v_mov_b32 v145, v161
    v_mfma_f32_16x16x32_bf16 v[28:31], v[12:15], a[100:103], v[28:31]
    v_mov_b32 v146, v162
    v_mfma_f32_16x16x32_bf16 v[32:35], v[12:15], a[156:159], v[32:35]
    v_mov_b32 v147, v163
    v_mfma_f32_16x16x32_bf16 v[36:39], v[12:15], a[212:215], v[36:39]
    ds_read_b128 v[12:15], v3 offset:26624
    s_waitcnt lgkmcnt(2)
    v_mfma_f32_16x16x32_bf16 v[40:43], v[16:19], a[44:47], v[40:43]
    buffer_load_dwordx4 v1, s[4:7], s13 offen offset:2048 sc1 lds
    v_mov_b32 v148, v164
    v_mov_b32 v149, v165
    v_mfma_f32_16x16x32_bf16 v[44:47], v[16:19], a[100:103], v[44:47]
    v_mov_b32 v150, v166
    v_mfma_f32_16x16x32_bf16 v[48:51], v[16:19], a[156:159], v[48:51]
    v_mov_b32 v151, v167
    v_mfma_f32_16x16x32_bf16 v[52:55], v[16:19], a[212:215], v[52:55]
    ds_read_b128 v[16:19], v3 offset:13312
    s_waitcnt lgkmcnt(2)
    v_mfma_f32_16x16x32_bf16 v[24:27], v[8:11], a[48:51], v[24:27]
    v_mfma_f32_16x16x32_bf16 v[28:31], v[8:11], a[104:107], v[28:31]
    v_mfma_f32_16x16x32_bf16 v[32:35], v[8:11], a[160:163], v[32:35]
    v_mfma_f32_16x16x32_bf16 v[36:39], v[8:11], a[216:219], v[36:39]
    ds_read_b128 v[8:11], v3 offset:27648
    s_waitcnt lgkmcnt(2)
    v_mfma_f32_16x16x32_bf16 v[40:43], v[12:15], a[48:51], v[40:43]
    v_mfma_f32_16x16x32_bf16 v[44:47], v[12:15], a[104:107], v[44:47]
    v_mfma_f32_16x16x32_bf16 v[48:51], v[12:15], a[160:163], v[48:51]
    v_mfma_f32_16x16x32_bf16 v[52:55], v[12:15], a[216:219], v[52:55]
    s_waitcnt lgkmcnt(1)
    v_mfma_f32_16x16x32_bf16 v[24:27], v[16:19], a[52:55], v[24:27]
    v_mfma_f32_16x16x32_bf16 v[28:31], v[16:19], a[108:111], v[28:31]
    v_mfma_f32_16x16x32_bf16 v[32:35], v[16:19], a[164:167], v[32:35]
    v_mfma_f32_16x16x32_bf16 v[36:39], v[16:19], a[220:223], v[36:39]
    s_waitcnt lgkmcnt(0)
    v_mfma_f32_16x16x32_bf16 v[40:43], v[8:11], a[52:55], v[40:43]
    v_mfma_f32_16x16x32_bf16 v[44:47], v[8:11], a[108:111], v[44:47]
    v_mfma_f32_16x16x32_bf16 v[48:51], v[8:11], a[164:167], v[48:51]
    v_mfma_f32_16x16x32_bf16 v[52:55], v[8:11], a[220:223], v[52:55]
y_cont_610:
    s_and_b32 s11, s17, 15
    s_mul_i32 s11, s11, 458752
    s_lshl_b32 s12, s9, 14
    s_add_u32 s11, s11, s12
    s_lshl_b32 s12, s10, 12
    s_add_u32 s11, s11, s12
    s_add_u32 s11, s11, 0x1000000
    s_nop 4
    v_cvt_pk_bf16_f32 v152, v24, v40
    v_cvt_pk_bf16_f32 v153, v25, v41
    v_cvt_pk_bf16_f32 v154, v26, v42
    v_cvt_pk_bf16_f32 v155, v27, v43
    buffer_store_dwordx4 v[152:155], v1, s[4:7], s11 offen offset:0 sc1
    v_cvt_pk_bf16_f32 v156, v28, v44
    v_cvt_pk_bf16_f32 v157, v29, v45
    v_cvt_pk_bf16_f32 v158, v30, v46
    v_cvt_pk_bf16_f32 v159, v31, v47
    buffer_store_dwordx4 v[156:159], v1, s[4:7], s11 offen offset:1024 sc1
    v_cvt_pk_bf16_f32 v160, v32, v48
    v_cvt_pk_bf16_f32 v161, v33, v49
    v_cvt_pk_bf16_f32 v162, v34, v50
    v_cvt_pk_bf16_f32 v163, v35, v51
    buffer_store_dwordx4 v[160:163], v1, s[4:7], s11 offen offset:2048 sc1
    v_cvt_pk_bf16_f32 v164, v36, v52
    v_cvt_pk_bf16_f32 v165, v37, v53
    v_cvt_pk_bf16_f32 v166, v38, v54
    v_cvt_pk_bf16_f32 v167, v39, v55
    buffer_store_dwordx4 v[164:167], v1, s[4:7], s11 offen offset:3072 sc1
    s_branch y_nou_601
y_nou1_608:
    buffer_load_dwordx2 v[20:21], v5, s[72:75], s29 offen
    buffer_load_dwordx4 v[168:171], v1, s[76:79], s30 offen offset:0 sc1
    buffer_load_dwordx4 v[172:175], v1, s[76:79], s30 offen offset:1024 sc1
    buffer_load_dwordx4 v[176:179], v1, s[76:79], s30 offen offset:2048 sc1
    buffer_load_dwordx4 v[180:183], v1, s[76:79], s30 offen offset:3072 sc1
    buffer_load_dwordx4 v[184:187], v1, s[76:79], s31 offen offset:0 sc1
    buffer_load_dwordx4 v[188:191], v1, s[76:79], s31 offen offset:1024 sc1
    buffer_load_dwordx4 v[192:195], v1, s[76:79], s31 offen offset:2048 sc1
    v_mov_b32 v56, v72
    v_mov_b32 v57, v73
    v_mov_b32 v58, v74
    v_mov_b32 v59, v75
    v_mov_b32 v60, v76
    v_mov_b32 v61, v77
    v_mov_b32 v62, v78
    v_mov_b32 v63, v79
    v_mov_b32 v64, v80
    v_mov_b32 v65, v81
    v_mov_b32 v66, v82
    v_mov_b32 v67, v83
    v_mov_b32 v68, v84
    v_mov_b32 v69, v85
    v_mov_b32 v70, v86
    v_mov_b32 v71, v87
    v_mov_b32 v72, v88
    v_mov_b32 v73, v89
    v_mov_b32 v74, v90
    v_mov_b32 v75, v91
    v_mov_b32 v76, v92
    v_mov_b32 v77, v93
    v_mov_b32 v78, v94
    v_mov_b32 v79, v95
    v_mov_b32 v80, v96
    v_mov_b32 v81, v97
    v_mov_b32 v82, v98
    v_mov_b32 v83, v99
    v_mov_b32 v84, v100
    v_mov_b32 v85, v101
    v_mov_b32 v86, v102
    v_mov_b32 v87, v103
    v_mov_b32 v88, v104
    v_mov_b32 v89, v105
    v_mov_b32 v90, v106
    v_mov_b32 v91, v107
    v_mov_b32 v92, v108
    v_mov_b32 v93, v109
    v_mov_b32 v94, v110
    v_mov_b32 v95, v111
    v_mov_b32 v96, v112
    v_mov_b32 v97, v113
    v_mov_b32 v98, v114
    v_mov_b32 v99, v115
    v_mov_b32 v100, v116
    v_mov_b32 v101, v117
    v_mov_b32 v102, v118
    v_mov_b32 v103, v119
    v_mov_b32 v104, v120
    v_mov_b32 v105, v121
    v_mov_b32 v106, v122
    v_mov_b32 v107, v123
    v_mov_b32 v108, v124
    v_mov_b32 v109, v125
    v_mov_b32 v110, v126
    v_mov_b32 v111, v127
    v_mov_b32 v112, v128
    v_mov_b32 v113, v129
    v_mov_b32 v114, v130
    v_mov_b32 v115, v131
    v_mov_b32 v116, v132
    v_mov_b32 v117, v133
    v_mov_b32 v118, v134
    v_mov_b32 v119, v135
    v_mov_b32 v120, v136
    v_mov_b32 v121, v137
    v_mov_b32 v122, v138
    v_mov_b32 v123, v139
    v_mov_b32 v124, v140
    v_mov_b32 v125, v141
    v_mov_b32 v126, v142
    v_mov_b32 v127, v143
    v_mov_b32 v128, v144
    v_mov_b32 v129, v145
    v_mov_b32 v130, v146
    v_mov_b32 v131, v147
    v_mov_b32 v132, v148
    v_mov_b32 v133, v149
    v_mov_b32 v134, v150
    v_mov_b32 v135, v151
    v_mov_b32 v136, v152
    v_mov_b32 v137, v153
    v_mov_b32 v138, v154
    v_mov_b32 v139, v155
    v_mov_b32 v140, v156
    v_mov_b32 v141, v157
    v_mov_b32 v142, v158
    v_mov_b32 v143, v159
    v_mov_b32 v144, v160
    v_mov_b32 v145, v161
    v_mov_b32 v146, v162
    v_mov_b32 v147, v163
    v_mov_b32 v148, v164
    v_mov_b32 v149, v165
    v_mov_b32 v150, v166
    v_mov_b32 v151, v167
    v_mov_b32 v196, -1
    s_waitcnt vmcnt(0)
y_nou_601:
    s_cmp_ge_u32 s16, 6
    s_cbranch_scc1 y_px_611
    s_waitcnt vmcnt(4)
    s_barrier
    s_cmp_lg_u32 s10, 3
    s_cbranch_scc1 y_nofl_612
    s_lshl_b32 s11, s15, 5
    s_add_u32 s11, s11, s9
    s_lshl_b32 s11, s11, 4
    s_add_u32 s11, s11, 0x3b00000
    s_add_u32 s13, s16, 0
    v_mov_b32 v4, s13
    s_mov_b64 exec, 1
    buffer_store_dword v4, v7, s[4:7], s11 offen sc1
    s_mov_b64 exec, -1
y_nofl_612:
    s_branch y_nopx_602
y_px_611:
    s_mov_b32 s17, s19
    v_mov_b32 v24, 0
    v_mov_b32 v25, 0
    v_mov_b32 v26, 0
    v_mov_b32 v27, 0
    v_mov_b32 v28, 0
    v_mov_b32 v29, 0
    v_mov_b32 v30, 0
    v_mov_b32 v31, 0
    v_mov_b32 v32, 0
    v_mov_b32 v33, 0
    v_mov_b32 v34, 0
    v_mov_b32 v35, 0
    v_mov_b32 v36, 0
    v_mov_b32 v37, 0
    v_mov_b32 v38, 0
    v_mov_b32 v39, 0
    s_waitcnt vmcnt(10)
    s_mov_b32 s28, 0
y_m1_613:
    v_max3_u32 v4, v168, v169, v170
    v_max3_u32 v4, v4, v171, v172
    v_max3_u32 v4, v4, v173, v174
    v_max3_u32 v4, v4, v175, v176
    v_max3_u32 v4, v4, v177, v178
    v_max3_u32 v4, v4, v179, v180
    v_max3_u32 v4, v4, v181, v182
    v_max3_u32 v4, v4, v183, v184
    v_max3_u32 v4, v4, v185, v186
    v_max3_u32 v4, v4, v187, v188
    v_max3_u32 v4, v4, v189, v190
    v_max3_u32 v4, v4, v191, v192
    v_max3_u32 v4, v4, v193, v194
    v_max_u32 v4, v4, v195
    v_cmp_eq_u32 vcc, -1, v4
    s_cbranch_vccz y_m2_614
    s_add_u32 s28, s28, 1
    s_cmp_gt_u32 s28, 65536
    s_cbranch_scc1 M_exit
    s_mov_b32 s22, 0
spin_615:
    buffer_load_dwordx4 v[192:195], v1, s[76:79], s31 offen offset:2048 sc1
    s_waitcnt vmcnt(0)
spin2_617:
    v_max3_u32 v4, v192, v193, v194
    v_max_u32 v4, v4, v195
    v_cmp_eq_u32 vcc, -1, v4
    s_cbranch_vccz spok_616
    s_add_u32 s22, s22, 1
    s_cmp_gt_u32 s22, 65536
    s_cbranch_scc1 M_exit
    s_sleep 2
    s_branch spin_615
spok_616:
    buffer_load_dwordx4 v[168:171], v1, s[76:79], s30 offen offset:0 sc1
    buffer_load_dwordx4 v[172:175], v1, s[76:79], s30 offen offset:1024 sc1
    buffer_load_dwordx4 v[176:179], v1, s[76:79], s30 offen offset:2048 sc1
    buffer_load_dwordx4 v[180:183], v1, s[76:79], s30 offen offset:3072 sc1
    buffer_load_dwordx4 v[184:187], v1, s[76:79], s31 offen offset:0 sc1
    buffer_load_dwordx4 v[188:191], v1, s[76:79], s31 offen offset:1024 sc1
    s_waitcnt vmcnt(0)
    s_branch y_m1_613
y_m2_614:
    v_smfmac_f32_16x16x64_bf16 v[24:27], v[168:171], a[0:7], v2
    v_smfmac_f32_16x16x64_bf16 v[28:31], v[168:171], a[56:63], v2
    v_smfmac_f32_16x16x64_bf16 v[32:35], v[168:171], a[112:119], v2
    v_smfmac_f32_16x16x64_bf16 v[36:39], v[168:171], a[168:175], v2
    v_smfmac_f32_16x16x64_bf16 v[24:27], v[172:175], a[8:15], v2
    v_smfmac_f32_16x16x64_bf16 v[28:31], v[172:175], a[64:71], v2
    v_smfmac_f32_16x16x64_bf16 v[32:35], v[172:175], a[120:127], v2
    v_smfmac_f32_16x16x64_bf16 v[36:39], v[172:175], a[176:183], v2
    v_smfmac_f32_16x16x64_bf16 v[24:27], v[176:179], a[16:23], v2
    v_smfmac_f32_16x16x64_bf16 v[28:31], v[176:179], a[72:79], v2
    v_smfmac_f32_16x16x64_bf16 v[32:35], v[176:179], a[128:135], v2
    v_smfmac_f32_16x16x64_bf16 v[36:39], v[176:179], a[184:191], v2
    v_smfmac_f32_16x16x64_bf16 v[24:27], v[180:183], a[24:31], v2
    v_smfmac_f32_16x16x64_bf16 v[28:31], v[180:183], a[80:87], v2
    v_smfmac_f32_16x16x64_bf16 v[32:35], v[180:183], a[136:143], v2
    v_smfmac_f32_16x16x64_bf16 v[36:39], v[180:183], a[192:199], v2
    v_smfmac_f32_16x16x64_bf16 v[24:27], v[184:187], a[32:39], v2
    v_smfmac_f32_16x16x64_bf16 v[28:31], v[184:187], a[88:95], v2
    v_smfmac_f32_16x16x64_bf16 v[32:35], v[184:187], a[144:151], v2
    v_smfmac_f32_16x16x64_bf16 v[36:39], v[184:187], a[200:207], v2
    v_smfmac_f32_16x16x64_bf16 v[24:27], v[188:191], a[40:47], v2
    v_smfmac_f32_16x16x64_bf16 v[28:31], v[188:191], a[96:103], v2
    v_smfmac_f32_16x16x64_bf16 v[32:35], v[188:191], a[152:159], v2
    v_smfmac_f32_16x16x64_bf16 v[36:39], v[188:191], a[208:215], v2
    v_smfmac_f32_16x16x64_bf16 v[24:27], v[192:195], a[48:55], v2
    v_smfmac_f32_16x16x64_bf16 v[28:31], v[192:195], a[104:111], v2
    v_smfmac_f32_16x16x64_bf16 v[32:35], v[192:195], a[160:167], v2
    v_smfmac_f32_16x16x64_bf16 v[36:39], v[192:195], a[216:223], v2
    s_nop 7
    v_add_f32 v24, v24, v26
    v_add_f32 v25, v25, v27
    v_cvt_pk_bf16_f32 v236, v24, v25
    v_add_f32 v28, v28, v30
    v_add_f32 v29, v29, v31
    v_cvt_pk_bf16_f32 v237, v28, v29
    v_add_f32 v32, v32, v34
    v_add_f32 v33, v33, v35
    v_cvt_pk_bf16_f32 v238, v32, v33
    v_add_f32 v36, v36, v38
    v_add_f32 v37, v37, v39
    v_cvt_pk_bf16_f32 v239, v36, v37
    s_nop 1
    v_permlane16_swap_b32 v236, v237
    v_permlane16_swap_b32 v238, v239
    s_nop 1
    v_permlane32_swap_b32 v236, v238
    v_permlane32_swap_b32 v237, v239
    s_mov_b32 s22, 0
    s_waitcnt vmcnt(4)
    s_cmp_lt_u32 s16, 32
    s_cbranch_scc1 y_w4_618
    s_waitcnt vmcnt(0)
    y_w4_618:
    s_branch spin2_621
spin_619:
    buffer_load_dwordx4 v[196:199], v1, s[76:79], s24 offen offset:0 sc1
    buffer_load_dwordx4 v[200:203], v1, s[76:79], s24 offen offset:1024 sc1
    buffer_load_dwordx4 v[204:207], v1, s[76:79], s24 offen offset:2048 sc1
    buffer_load_dwordx4 v[208:211], v1, s[76:79], s24 offen offset:3072 sc1
    buffer_load_dwordx4 v[212:215], v1, s[76:79], s25 offen offset:0 sc1
    buffer_load_dwordx4 v[216:219], v1, s[76:79], s25 offen offset:1024 sc1
    buffer_load_dwordx4 v[220:223], v1, s[76:79], s25 offen offset:2048 sc1
    buffer_load_dwordx4 v[224:227], v1, s[76:79], s25 offen offset:3072 sc1
    buffer_load_dwordx4 v[228:231], v1, s[76:79], s26 offen offset:0 sc1
    buffer_load_dwordx4 v[232:235], v1, s[76:79], s26 offen offset:1024 sc1
    s_waitcnt vmcnt(0)
spin2_621:
    v_max3_u32 v4, v196, v197, v198
    v_max3_u32 v4, v4, v199, v200
    v_max3_u32 v4, v4, v201, v202
    v_max3_u32 v4, v4, v203, v204
    v_max3_u32 v4, v4, v205, v206
    v_max3_u32 v4, v4, v207, v208
    v_max3_u32 v4, v4, v209, v210
    v_max3_u32 v4, v4, v211, v212
    v_max3_u32 v4, v4, v213, v214
    v_max3_u32 v4, v4, v215, v216
    v_max3_u32 v4, v4, v217, v218
    v_max3_u32 v4, v4, v219, v220
    v_max3_u32 v4, v4, v221, v222
    v_max3_u32 v4, v4, v223, v224
    v_max3_u32 v4, v4, v225, v226
    v_max3_u32 v4, v4, v227, v228
    v_max3_u32 v4, v4, v229, v230
    v_max3_u32 v4, v4, v231, v232
    v_max3_u32 v4, v4, v233, v234
    v_max_u32 v4, v4, v235
    v_cmp_eq_u32 vcc, -1, v4
    s_cbranch_vccz spok_620
    s_add_u32 s22, s22, 1
    s_cmp_gt_u32 s22, 65536
    s_cbranch_scc1 M_exit
    s_sleep 1
    s_branch spin_619
spok_620:
    v_mfma_f32_16x16x32_bf16 v[240:243], v[236:239], v[228:231], 0
    v_mfma_f32_16x16x32_bf16 v[244:247], v[236:239], v[232:235], 0
    v_mfma_f32_16x16x32_bf16 v[240:243], v[56:59], v[196:199], v[240:243]
    v_mfma_f32_16x16x32_bf16 v[244:247], v[56:59], v[200:203], v[244:247]
    v_mfma_f32_16x16x32_bf16 v[240:243], v[60:63], v[204:207], v[240:243]
    v_mfma_f32_16x16x32_bf16 v[244:247], v[60:63], v[208:211], v[244:247]
    v_mfma_f32_16x16x32_bf16 v[240:243], v[64:67], v[212:215], v[240:243]
    v_mfma_f32_16x16x32_bf16 v[244:247], v[64:67], v[216:219], v[244:247]
    v_mfma_f32_16x16x32_bf16 v[240:243], v[68:71], v[220:223], v[240:243]
    v_mfma_f32_16x16x32_bf16 v[244:247], v[68:71], v[224:227], v[244:247]
    s_and_b32 s12, s16, 1
    s_lshl_b32 s12, s12, 13
    s_lshl_b32 s11, s10, 11
    s_add_u32 s11, s11, s12
    v_add_u32 v4, s11, v1
    s_nop 4
    ds_write_b128 v4, v[240:243] offset:0
    ds_write_b128 v4, v[244:247] offset:1024
    s_waitcnt vmcnt(0) lgkmcnt(0)
    s_barrier
    s_cmp_lg_u32 s10, 3
    s_cbranch_scc1 y_nofl_622
    s_lshl_b32 s11, s15, 5
    s_add_u32 s11, s11, s9
    s_lshl_b32 s11, s11, 4
    s_add_u32 s11, s11, 0x3b00000
    s_add_u32 s13, s16, 1
    v_mov_b32 v4, s13
    s_mov_b64 exec, 1
    buffer_store_dword v4, v7, s[4:7], s11 offen sc1
    s_mov_b64 exec, -1
y_nofl_622:
    s_cmp_ge_u32 s10, 2
    s_cbranch_scc1 y_nopx_602
    s_lshl_b32 s11, s10, 10
    s_add_u32 s11, s11, s12
    v_add_u32 v4, s11, v1
    ds_read_b128 v[196:199], v4 offset:0
    ds_read_b128 v[200:203], v4 offset:2048
    ds_read_b128 v[204:207], v4 offset:4096
    ds_read_b128 v[208:211], v4 offset:6144
    s_mul_i32 s11, s17, 28672
    s_add_u32 s11, s11, 0x33a0000
    s_waitcnt lgkmcnt(0)
    v_add_f32 v196, v196, v200
    v_add_f32 v204, v204, v208
    v_add_f32 v197, v197, v201
    v_add_f32 v205, v205, v209
    v_add_f32 v198, v198, v202
    v_add_f32 v206, v206, v210
    v_add_f32 v199, v199, v203
    v_add_f32 v207, v207, v211
    v_add_f32 v196, v196, v204
    v_add_f32 v197, v197, v205
    v_add_f32 v198, v198, v206
    v_add_f32 v199, v199, v207
    v_cvt_pk_bf16_f32 v200, v196, v197
    v_lshlrev_b32 v201, 16, v200
    v_and_b32 v202, 0xffff0000, v200
    v_lshlrev_b32 v203, 16, v20
    v_and_b32 v204, 0xffff0000, v20
    v_add_f32 v201, v201, v203
    v_add_f32 v202, v202, v204
    v_cvt_pk_bf16_f32 v206, v201, v202
    v_min_u32 v206, -2, v206
    v_cvt_pk_bf16_f32 v200, v198, v199
    v_lshlrev_b32 v201, 16, v200
    v_and_b32 v202, 0xffff0000, v200
    v_lshlrev_b32 v203, 16, v21
    v_and_b32 v204, 0xffff0000, v21
    v_add_f32 v201, v201, v203
    v_add_f32 v202, v202, v204
    v_cvt_pk_bf16_f32 v207, v201, v202
    v_min_u32 v207, -2, v207
    buffer_store_dwordx2 v[206:207], v6, s[4:7], s11 offen sc1
y_nopx_602:
    s_add_u32 s16, s16, 1
    s_cmp_lt_u32 s16, 38
    s_cbranch_scc1 y_loop_600
    s_branch M_exit
M_H:
    s_mov_b32 s35, s11
    s_lshl_b32 s33, s34, 2
    s_add_u32 s33, s33, s10
    v_lshlrev_b32 v5, 4, v0
    v_mov_b32 v7, 0
    s_mov_b32 s11, 0x3b03000
    v_min_u32 v24, 0, v0
    v_lshlrev_b32 v24, 4, v24
    s_mov_b32 s22, 0
wt_623:
    buffer_load_dwordx4 v[16:19], v24, s[4:7], s11 offen offset:0 sc1
    s_waitcnt vmcnt(0)
    v_xor_b32 v16, s80, v16
    v_xor_b32 v17, s81, v17
    v_and_b32 v17, -16, v17
    v_xor_b32 v18, s80, v18
    v_xor_b32 v19, s81, v19
    v_and_b32 v19, -16, v19
    v_or3_b32 v16, v16, v17, v18
    v_or_b32 v16, v16, v19
    v_cmp_ne_u32 vcc, 0, v16
    s_cbranch_vccz wtok_624
    s_add_u32 s22, s22, 1
    s_cmp_gt_u32 s22, 65536
    s_cbranch_scc1 M_exit
    s_sleep 16
    s_branch wt_623
wtok_624:
    v_mov_b32 v240, -1
    v_mov_b32 v241, -1
    v_mov_b32 v242, -1
    v_mov_b32 v243, -1
    s_mov_b32 s28, s33
    s_cmp_ge_u32 s28, 624
    s_cbranch_scc1 H_none
H_loop:
    s_cmp_le_u32 s28, 10
    s_cbranch_scc1 H_skip
    s_sub_u32 s25, s28, 64
    s_cmp_lt_u32 s25, 16
    s_cbranch_scc1 H_skip
    s_lshl_b32 s25, s28, 13
    s_add_u32 s25, s25, 0x3080000
    s_add_u32 s26, s25, 4096
    buffer_store_dwordx4 v[240:243], v5, s[4:7], s25 offen offset:0 sc1
    buffer_store_dwordx4 v[240:243], v5, s[4:7], s25 offen offset:1024 sc1
    buffer_store_dwordx4 v[240:243], v5, s[4:7], s25 offen offset:2048 sc1
    buffer_store_dwordx4 v[240:243], v5, s[4:7], s25 offen offset:3072 sc1
    buffer_store_dwordx4 v[240:243], v5, s[4:7], s26 offen offset:0 sc1
    buffer_store_dwordx4 v[240:243], v5, s[4:7], s26 offen offset:1024 sc1
    buffer_store_dwordx4 v[240:243], v5, s[4:7], s26 offen offset:2048 sc1
    buffer_store_dwordx4 v[240:243], v5, s[4:7], s26 offen offset:3072 sc1
    s_waitcnt vmcnt(40)
H_skip:
    s_add_u32 s28, s28, 416
    s_cmp_lt_u32 s28, 624
    s_cbranch_scc1 H_loop
H_none:
    s_cmp_lt_u32 s35, 5
    s_cbranch_scc1 H_nof
    s_cmp_ge_u32 s9, 28
    s_cbranch_scc1 H_nof
    s_sub_u32 s15, s35, 5
    s_cmp_ge_u32 s9, 14
    s_cselect_b32 s12, 3, 0
    s_add_u32 s15, s15, s12
    s_cmp_ge_u32 s9, 14
    s_cselect_b32 s12, 14, 0
    s_sub_u32 s9, s9, s12
    s_mul_i32 s24, s15, 802816
    s_add_u32 s24, s24, 0x3560000
    s_lshr_b32 s25, s10, 1
    s_mul_i32 s25, s25, 200704
    s_add_u32 s24, s24, s25
    s_lshl_b32 s25, s9, 11
    s_add_u32 s24, s24, s25
    s_and_b32 s25, s10, 1
    s_lshl_b32 s25, s25, 10
    s_add_u32 s24, s24, s25
    s_and_b32 s12, s2, 7
    s_lshl_b32 s12, s12, 5
    s_lshr_b32 s13, s2, 3
    s_add_u32 s12, s12, s13
    s_sub_u32 s12, s12, s9
    s_getreg_b32 s27, hwreg(HW_REG_XCC_ID, 0, 4)
    v_min_u32 v17, 13, v0
    v_lshlrev_b32 v17, 3, v17
    s_lshl_b32 s11, s12, 3
    s_add_u32 s11, s11, 0x3b02000
    buffer_load_dword v16, v17, s[4:7], s11 offen offset:4 sc1
    s_waitcnt vmcnt(0)
    v_and_b32 v16, 15, v16
    v_cmp_ne_u32 vcc, s27, v16
    s_cbranch_vccnz fp_mode_625
    s_add_u32 s25, s24, 0
    buffer_store_dwordx4 v[240:243], v5, s[4:7], s25 offen
    s_add_u32 s25, s24, 28672
    buffer_store_dwordx4 v[240:243], v5, s[4:7], s25 offen
    s_add_u32 s25, s24, 57344
    buffer_store_dwordx4 v[240:243], v5, s[4:7], s25 offen
    s_add_u32 s25, s24, 86016
    buffer_store_dwordx4 v[240:243], v5, s[4:7], s25 offen
    s_add_u32 s25, s24, 114688
    buffer_store_dwordx4 v[240:243], v5, s[4:7], s25 offen
    s_add_u32 s25, s24, 143360
    buffer_store_dwordx4 v[240:243], v5, s[4:7], s25 offen
    s_add_u32 s25, s24, 172032
    buffer_store_dwordx4 v[240:243], v5, s[4:7], s25 offen
    s_add_u32 s25, s24, 401408
    buffer_store_dwordx4 v[240:243], v5, s[4:7], s25 offen
    s_add_u32 s25, s24, 430080
    buffer_store_dwordx4 v[240:243], v5, s[4:7], s25 offen
    s_add_u32 s25, s24, 458752
    buffer_store_dwordx4 v[240:243], v5, s[4:7], s25 offen
    s_add_u32 s25, s24, 487424
    buffer_store_dwordx4 v[240:243], v5, s[4:7], s25 offen
    s_add_u32 s25, s24, 516096
    buffer_store_dwordx4 v[240:243], v5, s[4:7], s25 offen
    s_add_u32 s25, s24, 544768
    buffer_store_dwordx4 v[240:243], v5, s[4:7], s25 offen
    s_add_u32 s25, s24, 573440
    buffer_store_dwordx4 v[240:243], v5, s[4:7], s25 offen
    s_branch fp_end_626
fp_mode_625:
    s_add_u32 s25, s24, 0
    buffer_store_dwordx4 v[240:243], v5, s[4:7], s25 offen sc1
    s_add_u32 s25, s24, 28672
    buffer_store_dwordx4 v[240:243], v5, s[4:7], s25 offen sc1
    s_add_u32 s25, s24, 57344
    buffer_store_dwordx4 v[240:243], v5, s[4:7], s25 offen sc1
    s_add_u32 s25, s24, 86016
    buffer_store_dwordx4 v[240:243], v5, s[4:7], s25 offen sc1
    s_add_u32 s25, s24, 114688
    buffer_store_dwordx4 v[240:243], v5, s[4:7], s25 offen sc1
    s_add_u32 s25, s24, 143360
    buffer_store_dwordx4 v[240:243], v5, s[4:7], s25 offen sc1
    s_add_u32 s25, s24, 172032
    buffer_store_dwordx4 v[240:243], v5, s[4:7], s25 offen sc1
    s_add_u32 s25, s24, 401408
    buffer_store_dwordx4 v[240:243], v5, s[4:7], s25 offen sc1
    s_add_u32 s25, s24, 430080
    buffer_store_dwordx4 v[240:243], v5, s[4:7], s25 offen sc1
    s_add_u32 s25, s24, 458752
    buffer_store_dwordx4 v[240:243], v5, s[4:7], s25 offen sc1
    s_add_u32 s25, s24, 487424
    buffer_store_dwordx4 v[240:243], v5, s[4:7], s25 offen sc1
    s_add_u32 s25, s24, 516096
    buffer_store_dwordx4 v[240:243], v5, s[4:7], s25 offen sc1
    s_add_u32 s25, s24, 544768
    buffer_store_dwordx4 v[240:243], v5, s[4:7], s25 offen sc1
    s_add_u32 s25, s24, 573440
    buffer_store_dwordx4 v[240:243], v5, s[4:7], s25 offen sc1
fp_end_626:
H_nof:
    s_waitcnt vmcnt(0)
    s_barrier
    s_cmp_lg_u32 s10, 0
    s_cbranch_scc1 H_end
    v_mov_b32 v2, s80
    v_mov_b32 v3, s81
    s_lshl_b32 s51, s34, 3
    s_add_u32 s51, s51, 0x3b02800
    s_mov_b64 exec, 1
    buffer_store_dwordx2 v[2:3], v7, s[4:7], s51 offen sc1
    s_mov_b64 exec, -1
H_end:
    s_mov_b32 s11, s35
    s_cmp_ge_u32 s11, 5
    s_cbranch_scc1 M_F
    s_branch M_exit
M_SX:
    s_and_b32 s15, s9, 3
    s_lshr_b32 s9, s9, 2
    s_sub_u32 s11, s11, 3
    s_lshl_b32 s11, s11, 3
    s_add_u32 s9, s9, s11
    s_cmp_eq_u32 s10, 1
    s_cbranch_scc1 sx_w1_628
    s_cmp_eq_u32 s10, 2
    s_cbranch_scc1 sx_w2_629
    s_cmp_eq_u32 s10, 3
    s_cbranch_scc1 sx_w3_630
sx_w0_627:
    v_and_b32 v0, 63, v0
    v_lshlrev_b32 v1, 4, v0
    v_mov_b32 v5, 0
    v_mov_b32 v6, 0xff800000
    v_lshrrev_b32 v3, 4, v0
    v_lshrrev_b32 v104, 5, v0
    v_lshlrev_b32 v4, 8, v104
    v_and_b32 v104, 13, v0
    v_lshl_add_u32 v4, v104, 4, v4
    v_bfe_u32 v104, v0, 4, 1
    v_lshl_add_u32 v4, v104, 3, v4
    v_and_b32 v118, 0x38, v0
    v_and_b32 v104, 1, v0
    v_lshl_add_u32 v118, v104, 2, v118
    v_bfe_u32 v104, v0, 1, 2
    v_add_u32 v118, v118, v104
    v_lshlrev_b32 v118, 4, v118
    v_lshrrev_b32 v104, 5, v0
    v_lshlrev_b32 v3, 3, v104
    v_bfe_u32 v104, v0, 4, 1
    v_lshl_add_u32 v3, v104, 1, v3
    v_and_b32 v104, 15, v0
    v_add_u32 v105, 0, v3
    v_cmp_le_u32 s[40:41], v105, v104
    v_add_u32 v105, 4, v3
    v_cmp_le_u32 s[42:43], v105, v104
    v_add_u32 v105, 1, v3
    v_cmp_le_u32 s[44:45], v105, v104
    v_add_u32 v105, 5, v3
    v_cmp_le_u32 s[46:47], v105, v104
    s_and_b32 s11, s9, 3
    s_lshl_b32 s11, s11, 8
    v_and_b32 v104, 15, v0
    v_lshlrev_b32 v7, 4, v104
    v_lshrrev_b32 v104, 4, v0
    v_lshl_add_u32 v7, v104, 2, v7
    v_add_u32 v7, s11, v7
    s_mov_b32 s18, 20480
    s_mov_b32 s11, 0x3b03000
    v_min_u32 v8, 0, v0
    v_lshlrev_b32 v8, 4, v8
    s_mov_b32 s22, 0
wt_631:
    buffer_load_dwordx4 v[20:23], v8, s[4:7], s11 offen offset:0 sc1
    s_waitcnt vmcnt(0)
    v_xor_b32 v20, s80, v20
    v_xor_b32 v21, s81, v21
    v_and_b32 v21, -16, v21
    v_xor_b32 v22, s80, v22
    v_xor_b32 v23, s81, v23
    v_and_b32 v23, -16, v23
    v_or3_b32 v20, v20, v21, v22
    v_or_b32 v20, v20, v23
    v_cmp_ne_u32 vcc, 0, v20
    s_cbranch_vccz wtok_632
    s_add_u32 s22, s22, 1
    s_cmp_gt_u32 s22, 65536
    s_cbranch_scc1 M_exit
    s_sleep 16
    s_branch wt_631
wtok_632:
    s_mul_i32 s13, s15, 28672
    s_mul_i32 s14, s10, 7168
    s_add_u32 s13, s13, s14
    s_add_u32 m0, s18, s14
    s_nop 0
    buffer_load_dwordx4 v1, s[4:7], s13 offen offset:0 sc1 lds
    buffer_load_dwordx4 v1, s[4:7], s13 offen offset:1024 sc1 lds
    buffer_load_dwordx4 v1, s[4:7], s13 offen offset:2048 sc1 lds
    buffer_load_dwordx4 v1, s[4:7], s13 offen offset:3072 sc1 lds
    s_add_u32 m0, m0, 4096
    s_add_u32 s13, s13, 4096
    buffer_load_dwordx4 v1, s[4:7], s13 offen offset:0 sc1 lds
    buffer_load_dwordx4 v1, s[4:7], s13 offen offset:1024 sc1 lds
    buffer_load_dwordx4 v1, s[4:7], s13 offen offset:2048 sc1 lds
    s_mul_i32 s11, s9, 401408
    s_add_u32 s12, s11, 0x200000
    s_add_u32 s14, s12, 0
    buffer_load_dwordx4 a[0:3], v1, s[4:7], s14 offen offset:0 sc1
    buffer_load_dwordx4 a[4:7], v1, s[4:7], s14 offen offset:1024 sc1
    buffer_load_dwordx4 a[8:11], v1, s[4:7], s14 offen offset:2048 sc1
    buffer_load_dwordx4 a[12:15], v1, s[4:7], s14 offen offset:3072 sc1
    s_add_u32 s14, s12, 4096
    buffer_load_dwordx4 a[16:19], v1, s[4:7], s14 offen offset:0 sc1
    buffer_load_dwordx4 a[20:23], v1, s[4:7], s14 offen offset:1024 sc1
    buffer_load_dwordx4 a[24:27], v1, s[4:7], s14 offen offset:2048 sc1
    buffer_load_dwordx4 a[28:31], v1, s[4:7], s14 offen offset:3072 sc1
    s_add_u32 s14, s12, 8192
    buffer_load_dwordx4 a[32:35], v1, s[4:7], s14 offen offset:0 sc1
    buffer_load_dwordx4 a[36:39], v1, s[4:7], s14 offen offset:1024 sc1
    buffer_load_dwordx4 a[40:43], v1, s[4:7], s14 offen offset:2048 sc1
    buffer_load_dwordx4 a[44:47], v1, s[4:7], s14 offen offset:3072 sc1
    s_add_u32 s14, s12, 12288
    buffer_load_dwordx4 a[48:51], v1, s[4:7], s14 offen offset:0 sc1
    buffer_load_dwordx4 a[52:55], v1, s[4:7], s14 offen offset:1024 sc1
    s_add_u32 s12, s11, 0x203800
    s_add_u32 s14, s12, 0
    buffer_load_dwordx4 a[56:59], v1, s[4:7], s14 offen offset:0 sc1
    buffer_load_dwordx4 a[60:63], v1, s[4:7], s14 offen offset:1024 sc1
    buffer_load_dwordx4 a[64:67], v1, s[4:7], s14 offen offset:2048 sc1
    buffer_load_dwordx4 a[68:71], v1, s[4:7], s14 offen offset:3072 sc1
    s_add_u32 s14, s12, 4096
    buffer_load_dwordx4 a[72:75], v1, s[4:7], s14 offen offset:0 sc1
    buffer_load_dwordx4 a[76:79], v1, s[4:7], s14 offen offset:1024 sc1
    buffer_load_dwordx4 a[80:83], v1, s[4:7], s14 offen offset:2048 sc1
    buffer_load_dwordx4 a[84:87], v1, s[4:7], s14 offen offset:3072 sc1
    s_add_u32 s14, s12, 8192
    buffer_load_dwordx4 a[88:91], v1, s[4:7], s14 offen offset:0 sc1
    buffer_load_dwordx4 a[92:95], v1, s[4:7], s14 offen offset:1024 sc1
    buffer_load_dwordx4 a[96:99], v1, s[4:7], s14 offen offset:2048 sc1
    buffer_load_dwordx4 a[100:103], v1, s[4:7], s14 offen offset:3072 sc1
    s_add_u32 s14, s12, 12288
    buffer_load_dwordx4 a[104:107], v1, s[4:7], s14 offen offset:0 sc1
    buffer_load_dwordx4 a[108:111], v1, s[4:7], s14 offen offset:1024 sc1
    s_add_u32 s12, s11, 0x207000
    s_add_u32 s14, s12, 0
    buffer_load_dwordx4 a[112:115], v1, s[4:7], s14 offen offset:0 sc1
    buffer_load_dwordx4 a[116:119], v1, s[4:7], s14 offen offset:1024 sc1
    buffer_load_dwordx4 a[120:123], v1, s[4:7], s14 offen offset:2048 sc1
    buffer_load_dwordx4 a[124:127], v1, s[4:7], s14 offen offset:3072 sc1
    s_add_u32 s14, s12, 4096
    buffer_load_dwordx4 a[128:131], v1, s[4:7], s14 offen offset:0 sc1
    buffer_load_dwordx4 a[132:135], v1, s[4:7], s14 offen offset:1024 sc1
    buffer_load_dwordx4 a[136:139], v1, s[4:7], s14 offen offset:2048 sc1
    buffer_load_dwordx4 a[140:143], v1, s[4:7], s14 offen offset:3072 sc1
    s_add_u32 s14, s12, 8192
    buffer_load_dwordx4 a[144:147], v1, s[4:7], s14 offen offset:0 sc1
    buffer_load_dwordx4 a[148:151], v1, s[4:7], s14 offen offset:1024 sc1
    buffer_load_dwordx4 a[152:155], v1, s[4:7], s14 offen offset:2048 sc1
    buffer_load_dwordx4 a[156:159], v1, s[4:7], s14 offen offset:3072 sc1
    s_add_u32 s14, s12, 12288
    buffer_load_dwordx4 a[160:163], v1, s[4:7], s14 offen offset:0 sc1
    buffer_load_dwordx4 a[164:167], v1, s[4:7], s14 offen offset:1024 sc1
    s_waitcnt vmcnt(46)
    s_add_u32 s12, s11, 0x20a800
    s_add_u32 s14, s12, 0
    buffer_load_dwordx4 a[168:171], v1, s[4:7], s14 offen offset:0 sc1
    buffer_load_dwordx4 a[172:175], v1, s[4:7], s14 offen offset:1024 sc1
    buffer_load_dwordx4 a[176:179], v1, s[4:7], s14 offen offset:2048 sc1
    buffer_load_dwordx4 a[180:183], v1, s[4:7], s14 offen offset:3072 sc1
    s_add_u32 s14, s12, 4096
    buffer_load_dwordx4 a[184:187], v1, s[4:7], s14 offen offset:0 sc1
    buffer_load_dwordx4 a[188:191], v1, s[4:7], s14 offen offset:1024 sc1
    buffer_load_dwordx4 a[192:195], v1, s[4:7], s14 offen offset:2048 sc1
    buffer_load_dwordx4 a[196:199], v1, s[4:7], s14 offen offset:3072 sc1
    s_add_u32 s14, s12, 8192
    buffer_load_dwordx4 a[200:203], v1, s[4:7], s14 offen offset:0 sc1
    buffer_load_dwordx4 a[204:207], v1, s[4:7], s14 offen offset:1024 sc1
    buffer_load_dwordx4 a[208:211], v1, s[4:7], s14 offen offset:2048 sc1
    buffer_load_dwordx4 a[212:215], v1, s[4:7], s14 offen offset:3072 sc1
    s_add_u32 s14, s12, 12288
    buffer_load_dwordx4 a[216:219], v1, s[4:7], s14 offen offset:0 sc1
    buffer_load_dwordx4 a[220:223], v1, s[4:7], s14 offen offset:1024 sc1
    s_waitcnt vmcnt(46)
    s_add_u32 s12, s11, 0x20e000
    s_add_u32 s14, s12, 0
    buffer_load_dwordx4 a[224:227], v1, s[4:7], s14 offen offset:0 sc1
    buffer_load_dwordx4 a[228:231], v1, s[4:7], s14 offen offset:1024 sc1
    buffer_load_dwordx4 a[232:235], v1, s[4:7], s14 offen offset:2048 sc1
    buffer_load_dwordx4 a[236:239], v1, s[4:7], s14 offen offset:3072 sc1
    s_add_u32 s14, s12, 4096
    buffer_load_dwordx4 a[240:243], v1, s[4:7], s14 offen offset:0 sc1
    buffer_load_dwordx4 a[244:247], v1, s[4:7], s14 offen offset:1024 sc1
    buffer_load_dwordx4 a[248:251], v1, s[4:7], s14 offen offset:2048 sc1
    buffer_load_dwordx4 a[252:255], v1, s[4:7], s14 offen offset:3072 sc1
    s_add_u32 s14, s12, 8192
    buffer_load_dwordx4 v[120:123], v1, s[4:7], s14 offen offset:0 sc1
    buffer_load_dwordx4 v[124:127], v1, s[4:7], s14 offen offset:1024 sc1
    buffer_load_dwordx4 v[128:131], v1, s[4:7], s14 offen offset:2048 sc1
    buffer_load_dwordx4 v[132:135], v1, s[4:7], s14 offen offset:3072 sc1
    s_add_u32 s14, s12, 12288
    buffer_load_dwordx4 v[136:139], v1, s[4:7], s14 offen offset:0 sc1
    buffer_load_dwordx4 v[140:143], v1, s[4:7], s14 offen offset:1024 sc1
    s_waitcnt vmcnt(46)
    s_add_u32 s12, s11, 0x211800
    s_add_u32 s14, s12, 0
    buffer_load_dwordx4 v[144:147], v1, s[4:7], s14 offen offset:0 sc1
    buffer_load_dwordx4 v[148:151], v1, s[4:7], s14 offen offset:1024 sc1
    buffer_load_dwordx4 v[152:155], v1, s[4:7], s14 offen offset:2048 sc1
    buffer_load_dwordx4 v[156:159], v1, s[4:7], s14 offen offset:3072 sc1
    s_add_u32 s14, s12, 4096
    buffer_load_dwordx4 v[160:163], v1, s[4:7], s14 offen offset:0 sc1
    buffer_load_dwordx4 v[164:167], v1, s[4:7], s14 offen offset:1024 sc1
    buffer_load_dwordx4 v[168:171], v1, s[4:7], s14 offen offset:2048 sc1
    buffer_load_dwordx4 v[172:175], v1, s[4:7], s14 offen offset:3072 sc1
    s_add_u32 s14, s12, 8192
    buffer_load_dwordx4 v[176:179], v1, s[4:7], s14 offen offset:0 sc1
    buffer_load_dwordx4 v[180:183], v1, s[4:7], s14 offen offset:1024 sc1
    buffer_load_dwordx4 v[184:187], v1, s[4:7], s14 offen offset:2048 sc1
    buffer_load_dwordx4 v[188:191], v1, s[4:7], s14 offen offset:3072 sc1
    s_add_u32 s14, s12, 12288
    buffer_load_dwordx4 v[192:195], v1, s[4:7], s14 offen offset:0 sc1
    buffer_load_dwordx4 v[196:199], v1, s[4:7], s14 offen offset:1024 sc1
    s_waitcnt vmcnt(46)
    s_add_u32 s12, s11, 0x215000
    s_add_u32 s14, s12, 0
    buffer_load_dwordx4 v[200:203], v1, s[4:7], s14 offen offset:0 sc1
    buffer_load_dwordx4 v[204:207], v1, s[4:7], s14 offen offset:1024 sc1
    buffer_load_dwordx4 v[208:211], v1, s[4:7], s14 offen offset:2048 sc1
    buffer_load_dwordx4 v[212:215], v1, s[4:7], s14 offen offset:3072 sc1
    s_add_u32 s14, s12, 4096
    buffer_load_dwordx4 v[216:219], v1, s[4:7], s14 offen offset:0 sc1
    buffer_load_dwordx4 v[220:223], v1, s[4:7], s14 offen offset:1024 sc1
    buffer_load_dwordx4 v[224:227], v1, s[4:7], s14 offen offset:2048 sc1
    buffer_load_dwordx4 v[228:231], v1, s[4:7], s14 offen offset:3072 sc1
    s_add_u32 s14, s12, 8192
    buffer_load_dwordx4 v[232:235], v1, s[4:7], s14 offen offset:0 sc1
    buffer_load_dwordx4 v[236:239], v1, s[4:7], s14 offen offset:1024 sc1
    buffer_load_dwordx4 v[240:243], v1, s[4:7], s14 offen offset:2048 sc1
    buffer_load_dwordx4 v[244:247], v1, s[4:7], s14 offen offset:3072 sc1
    s_add_u32 s14, s12, 12288
    buffer_load_dwordx4 v[248:251], v1, s[4:7], s14 offen offset:0 sc1
    buffer_load_dwordx4 v[252:255], v1, s[4:7], s14 offen offset:1024 sc1
    s_waitcnt vmcnt(46)
    s_mov_b32 s11, 0x3b02800
    v_min_u32 v8, 51, v0
    v_lshlrev_b32 v8, 4, v8
    s_mov_b32 s22, 0
wt_633:
    buffer_load_dwordx4 v[20:23], v8, s[4:7], s11 offen offset:0 sc1
    s_waitcnt vmcnt(0)
    v_xor_b32 v20, s80, v20
    v_xor_b32 v21, s81, v21
    v_and_b32 v21, -16, v21
    v_xor_b32 v22, s80, v22
    v_xor_b32 v23, s81, v23
    v_and_b32 v23, -16, v23
    v_or3_b32 v20, v20, v21, v22
    v_or_b32 v20, v20, v23
    v_cmp_ne_u32 vcc, 0, v20
    s_cbranch_vccz wtok_634
    s_add_u32 s22, s22, 1
    s_cmp_gt_u32 s22, 65536
    s_cbranch_scc1 M_exit
    s_sleep 16
    s_branch wt_633
wtok_634:
    s_mov_b32 s17, s15
    s_waitcnt vmcnt(0)
sx_loop_635:
    s_barrier
    v_add_u32 v2, s18, v1
    v_add_u32 v119, s18, v118
    s_sub_u32 s18, 69632, s18
    s_add_u32 s11, s17, 4
    s_min_u32 s11, s11, 63
    s_mul_i32 s13, s11, 28672
    s_mul_i32 s14, s10, 7168
    s_add_u32 s13, s13, s14
    s_add_u32 m0, s18, s14
    s_nop 0
    ds_read_b128 v[8:11], v2 offset:0
    ds_read_b128 v[12:15], v2 offset:1024
    ds_read_b128 v[16:19], v2 offset:2048
    s_waitcnt lgkmcnt(2)
    v_mfma_f32_16x16x32_bf16 v[20:23], a[0:3], v[8:11], 0
    buffer_load_dwordx4 v1, s[4:7], s13 offen offset:0 sc1 lds
    v_mfma_f32_16x16x32_bf16 v[24:27], a[56:59], v[8:11], 0
    v_mfma_f32_16x16x32_bf16 v[28:31], a[112:115], v[8:11], 0
    v_mfma_f32_16x16x32_bf16 v[32:35], a[168:171], v[8:11], 0
    v_mfma_f32_16x16x32_bf16 v[36:39], a[224:227], v[8:11], 0
    v_mfma_f32_16x16x32_bf16 v[40:43], v[144:147], v[8:11], 0
    v_mfma_f32_16x16x32_bf16 v[44:47], v[200:203], v[8:11], 0
    ds_read_b128 v[8:11], v2 offset:3072
    s_waitcnt lgkmcnt(2)
    v_mfma_f32_16x16x32_bf16 v[20:23], a[4:7], v[12:15], v[20:23]
    buffer_load_dwordx4 v1, s[4:7], s13 offen offset:1024 sc1 lds
    v_mfma_f32_16x16x32_bf16 v[24:27], a[60:63], v[12:15], v[24:27]
    v_mfma_f32_16x16x32_bf16 v[28:31], a[116:119], v[12:15], v[28:31]
    v_mfma_f32_16x16x32_bf16 v[32:35], a[172:175], v[12:15], v[32:35]
    v_mfma_f32_16x16x32_bf16 v[36:39], a[228:231], v[12:15], v[36:39]
    v_mfma_f32_16x16x32_bf16 v[40:43], v[148:151], v[12:15], v[40:43]
    v_mfma_f32_16x16x32_bf16 v[44:47], v[204:207], v[12:15], v[44:47]
    ds_read_b128 v[12:15], v2 offset:4096
    s_waitcnt lgkmcnt(2)
    v_mfma_f32_16x16x32_bf16 v[20:23], a[8:11], v[16:19], v[20:23]
    buffer_load_dwordx4 v1, s[4:7], s13 offen offset:2048 sc1 lds
    v_mfma_f32_16x16x32_bf16 v[24:27], a[64:67], v[16:19], v[24:27]
    v_mfma_f32_16x16x32_bf16 v[28:31], a[120:123], v[16:19], v[28:31]
    v_mfma_f32_16x16x32_bf16 v[32:35], a[176:179], v[16:19], v[32:35]
    v_mfma_f32_16x16x32_bf16 v[36:39], a[232:235], v[16:19], v[36:39]
    v_mfma_f32_16x16x32_bf16 v[40:43], v[152:155], v[16:19], v[40:43]
    v_mfma_f32_16x16x32_bf16 v[44:47], v[208:211], v[16:19], v[44:47]
    ds_read_b128 v[16:19], v2 offset:5120
    s_waitcnt lgkmcnt(2)
    v_mfma_f32_16x16x32_bf16 v[20:23], a[12:15], v[8:11], v[20:23]
    buffer_load_dwordx4 v1, s[4:7], s13 offen offset:3072 sc1 lds
    s_add_u32 m0, m0, 4096
    s_add_u32 s13, s13, 4096
    v_mfma_f32_16x16x32_bf16 v[24:27], a[68:71], v[8:11], v[24:27]
    v_mfma_f32_16x16x32_bf16 v[28:31], a[124:127], v[8:11], v[28:31]
    v_mfma_f32_16x16x32_bf16 v[32:35], a[180:183], v[8:11], v[32:35]
    v_mfma_f32_16x16x32_bf16 v[36:39], a[236:239], v[8:11], v[36:39]
    v_mfma_f32_16x16x32_bf16 v[40:43], v[156:159], v[8:11], v[40:43]
    v_mfma_f32_16x16x32_bf16 v[44:47], v[212:215], v[8:11], v[44:47]
    ds_read_b128 v[8:11], v2 offset:6144
    s_waitcnt lgkmcnt(2)
    v_mfma_f32_16x16x32_bf16 v[20:23], a[16:19], v[12:15], v[20:23]
    buffer_load_dwordx4 v1, s[4:7], s13 offen offset:0 sc1 lds
    v_mfma_f32_16x16x32_bf16 v[24:27], a[72:75], v[12:15], v[24:27]
    v_mfma_f32_16x16x32_bf16 v[28:31], a[128:131], v[12:15], v[28:31]
    v_mfma_f32_16x16x32_bf16 v[32:35], a[184:187], v[12:15], v[32:35]
    v_mfma_f32_16x16x32_bf16 v[36:39], a[240:243], v[12:15], v[36:39]
    v_mfma_f32_16x16x32_bf16 v[40:43], v[160:163], v[12:15], v[40:43]
    v_mfma_f32_16x16x32_bf16 v[44:47], v[216:219], v[12:15], v[44:47]
    ds_read_b128 v[12:15], v2 offset:7168
    s_waitcnt lgkmcnt(2)
    v_mfma_f32_16x16x32_bf16 v[20:23], a[20:23], v[16:19], v[20:23]
    buffer_load_dwordx4 v1, s[4:7], s13 offen offset:1024 sc1 lds
    v_mfma_f32_16x16x32_bf16 v[24:27], a[76:79], v[16:19], v[24:27]
    v_mfma_f32_16x16x32_bf16 v[28:31], a[132:135], v[16:19], v[28:31]
    v_mfma_f32_16x16x32_bf16 v[32:35], a[188:191], v[16:19], v[32:35]
    v_mfma_f32_16x16x32_bf16 v[36:39], a[244:247], v[16:19], v[36:39]
    v_mfma_f32_16x16x32_bf16 v[40:43], v[164:167], v[16:19], v[40:43]
    v_mfma_f32_16x16x32_bf16 v[44:47], v[220:223], v[16:19], v[44:47]
    ds_read_b128 v[16:19], v2 offset:8192
    s_waitcnt lgkmcnt(2)
    v_mfma_f32_16x16x32_bf16 v[20:23], a[24:27], v[8:11], v[20:23]
    buffer_load_dwordx4 v1, s[4:7], s13 offen offset:2048 sc1 lds
    v_mfma_f32_16x16x32_bf16 v[24:27], a[80:83], v[8:11], v[24:27]
    v_mfma_f32_16x16x32_bf16 v[28:31], a[136:139], v[8:11], v[28:31]
    v_mfma_f32_16x16x32_bf16 v[32:35], a[192:195], v[8:11], v[32:35]
    v_mfma_f32_16x16x32_bf16 v[36:39], a[248:251], v[8:11], v[36:39]
    v_mfma_f32_16x16x32_bf16 v[40:43], v[168:171], v[8:11], v[40:43]
    v_mfma_f32_16x16x32_bf16 v[44:47], v[224:227], v[8:11], v[44:47]
    ds_read_b128 v[8:11], v2 offset:9216
    s_waitcnt lgkmcnt(2)
    v_mfma_f32_16x16x32_bf16 v[20:23], a[28:31], v[12:15], v[20:23]
    v_mfma_f32_16x16x32_bf16 v[24:27], a[84:87], v[12:15], v[24:27]
    v_mfma_f32_16x16x32_bf16 v[28:31], a[140:143], v[12:15], v[28:31]
    v_mfma_f32_16x16x32_bf16 v[32:35], a[196:199], v[12:15], v[32:35]
    v_mfma_f32_16x16x32_bf16 v[36:39], a[252:255], v[12:15], v[36:39]
    v_mfma_f32_16x16x32_bf16 v[40:43], v[172:175], v[12:15], v[40:43]
    v_mfma_f32_16x16x32_bf16 v[44:47], v[228:231], v[12:15], v[44:47]
    ds_read_b128 v[12:15], v2 offset:10240
    s_waitcnt lgkmcnt(2)
    v_mfma_f32_16x16x32_bf16 v[20:23], a[32:35], v[16:19], v[20:23]
    v_mfma_f32_16x16x32_bf16 v[24:27], a[88:91], v[16:19], v[24:27]
    v_mfma_f32_16x16x32_bf16 v[28:31], a[144:147], v[16:19], v[28:31]
    v_mfma_f32_16x16x32_bf16 v[32:35], a[200:203], v[16:19], v[32:35]
    v_mfma_f32_16x16x32_bf16 v[36:39], v[120:123], v[16:19], v[36:39]
    v_mfma_f32_16x16x32_bf16 v[40:43], v[176:179], v[16:19], v[40:43]
    v_mfma_f32_16x16x32_bf16 v[44:47], v[232:235], v[16:19], v[44:47]
    ds_read_b128 v[16:19], v2 offset:11264
    s_waitcnt lgkmcnt(2)
    v_mfma_f32_16x16x32_bf16 v[20:23], a[36:39], v[8:11], v[20:23]
    v_mfma_f32_16x16x32_bf16 v[24:27], a[92:95], v[8:11], v[24:27]
    v_mfma_f32_16x16x32_bf16 v[28:31], a[148:151], v[8:11], v[28:31]
    v_mfma_f32_16x16x32_bf16 v[32:35], a[204:207], v[8:11], v[32:35]
    v_mfma_f32_16x16x32_bf16 v[36:39], v[124:127], v[8:11], v[36:39]
    v_mfma_f32_16x16x32_bf16 v[40:43], v[180:183], v[8:11], v[40:43]
    v_mfma_f32_16x16x32_bf16 v[44:47], v[236:239], v[8:11], v[44:47]
    ds_read_b128 v[8:11], v2 offset:12288
    s_waitcnt lgkmcnt(2)
    v_mfma_f32_16x16x32_bf16 v[20:23], a[40:43], v[12:15], v[20:23]
    v_mfma_f32_16x16x32_bf16 v[24:27], a[96:99], v[12:15], v[24:27]
    v_mfma_f32_16x16x32_bf16 v[28:31], a[152:155], v[12:15], v[28:31]
    v_mfma_f32_16x16x32_bf16 v[32:35], a[208:211], v[12:15], v[32:35]
    v_mfma_f32_16x16x32_bf16 v[36:39], v[128:131], v[12:15], v[36:39]
    v_mfma_f32_16x16x32_bf16 v[40:43], v[184:187], v[12:15], v[40:43]
    v_mfma_f32_16x16x32_bf16 v[44:47], v[240:243], v[12:15], v[44:47]
    ds_read_b128 v[12:15], v2 offset:13312
    s_waitcnt lgkmcnt(2)
    v_mfma_f32_16x16x32_bf16 v[20:23], a[44:47], v[16:19], v[20:23]
    v_mfma_f32_16x16x32_bf16 v[24:27], a[100:103], v[16:19], v[24:27]
    v_mfma_f32_16x16x32_bf16 v[28:31], a[156:159], v[16:19], v[28:31]
    v_mfma_f32_16x16x32_bf16 v[32:35], a[212:215], v[16:19], v[32:35]
    v_mfma_f32_16x16x32_bf16 v[36:39], v[132:135], v[16:19], v[36:39]
    v_mfma_f32_16x16x32_bf16 v[40:43], v[188:191], v[16:19], v[40:43]
    v_mfma_f32_16x16x32_bf16 v[44:47], v[244:247], v[16:19], v[44:47]
    s_waitcnt lgkmcnt(1)
    v_mfma_f32_16x16x32_bf16 v[20:23], a[48:51], v[8:11], v[20:23]
    v_mfma_f32_16x16x32_bf16 v[24:27], a[104:107], v[8:11], v[24:27]
    v_mfma_f32_16x16x32_bf16 v[28:31], a[160:163], v[8:11], v[28:31]
    v_mfma_f32_16x16x32_bf16 v[32:35], a[216:219], v[8:11], v[32:35]
    v_mfma_f32_16x16x32_bf16 v[36:39], v[136:139], v[8:11], v[36:39]
    v_mfma_f32_16x16x32_bf16 v[40:43], v[192:195], v[8:11], v[40:43]
    v_mfma_f32_16x16x32_bf16 v[44:47], v[248:251], v[8:11], v[44:47]
    s_waitcnt lgkmcnt(0)
    v_mfma_f32_16x16x32_bf16 v[20:23], a[52:55], v[12:15], v[20:23]
    v_mfma_f32_16x16x32_bf16 v[24:27], a[108:111], v[12:15], v[24:27]
    v_mfma_f32_16x16x32_bf16 v[28:31], a[164:167], v[12:15], v[28:31]
    v_mfma_f32_16x16x32_bf16 v[32:35], a[220:223], v[12:15], v[32:35]
    v_mfma_f32_16x16x32_bf16 v[36:39], v[140:143], v[12:15], v[36:39]
    v_mfma_f32_16x16x32_bf16 v[40:43], v[196:199], v[12:15], v[40:43]
    v_mfma_f32_16x16x32_bf16 v[44:47], v[252:255], v[12:15], v[44:47]
    s_nop 7
    v_cvt_pk_bf16_f32 v48, v20, v24
    v_cvt_pk_bf16_f32 v49, v21, v25
    v_cvt_pk_bf16_f32 v50, v22, v26
    v_cvt_pk_bf16_f32 v51, v23, v27
    v_cvt_pk_bf16_f32 v52, v28, v32
    v_cvt_pk_bf16_f32 v53, v29, v33
    v_cvt_pk_bf16_f32 v54, v30, v34
    v_cvt_pk_bf16_f32 v55, v31, v35
    v_cvt_pk_bf16_f32 v56, v36, v40
    v_cvt_pk_bf16_f32 v57, v37, v41
    v_cvt_pk_bf16_f32 v58, v38, v42
    v_cvt_pk_bf16_f32 v59, v39, v43
    v_cvt_pk_bf16_f32 v60, v44, v5
    v_cvt_pk_bf16_f32 v61, v45, v5
    v_cvt_pk_bf16_f32 v62, v46, v5
    v_cvt_pk_bf16_f32 v63, v47, v5
    ds_read_b128 v[8:11], v2 offset:14336
    ds_read_b128 v[12:15], v2 offset:15360
    ds_read_b128 v[16:19], v2 offset:16384
    s_waitcnt lgkmcnt(2)
    v_mfma_f32_16x16x32_bf16 v[20:23], a[0:3], v[8:11], 0
    v_mfma_f32_16x16x32_bf16 v[24:27], a[56:59], v[8:11], 0
    v_mfma_f32_16x16x32_bf16 v[28:31], a[112:115], v[8:11], 0
    v_mfma_f32_16x16x32_bf16 v[32:35], a[168:171], v[8:11], 0
    v_mfma_f32_16x16x32_bf16 v[36:39], a[224:227], v[8:11], 0
    v_mfma_f32_16x16x32_bf16 v[40:43], v[144:147], v[8:11], 0
    v_mfma_f32_16x16x32_bf16 v[44:47], v[200:203], v[8:11], 0
    ds_read_b128 v[8:11], v2 offset:17408
    s_waitcnt lgkmcnt(2)
    v_mfma_f32_16x16x32_bf16 v[20:23], a[4:7], v[12:15], v[20:23]
    v_mfma_f32_16x16x32_bf16 v[24:27], a[60:63], v[12:15], v[24:27]
    v_mfma_f32_16x16x32_bf16 v[28:31], a[116:119], v[12:15], v[28:31]
    v_mfma_f32_16x16x32_bf16 v[32:35], a[172:175], v[12:15], v[32:35]
    v_mfma_f32_16x16x32_bf16 v[36:39], a[228:231], v[12:15], v[36:39]
    v_mfma_f32_16x16x32_bf16 v[40:43], v[148:151], v[12:15], v[40:43]
    v_mfma_f32_16x16x32_bf16 v[44:47], v[204:207], v[12:15], v[44:47]
    ds_read_b128 v[12:15], v2 offset:18432
    s_waitcnt lgkmcnt(2)
    v_mfma_f32_16x16x32_bf16 v[20:23], a[8:11], v[16:19], v[20:23]
    v_mfma_f32_16x16x32_bf16 v[24:27], a[64:67], v[16:19], v[24:27]
    v_mfma_f32_16x16x32_bf16 v[28:31], a[120:123], v[16:19], v[28:31]
    v_mfma_f32_16x16x32_bf16 v[32:35], a[176:179], v[16:19], v[32:35]
    v_mfma_f32_16x16x32_bf16 v[36:39], a[232:235], v[16:19], v[36:39]
    v_mfma_f32_16x16x32_bf16 v[40:43], v[152:155], v[16:19], v[40:43]
    v_mfma_f32_16x16x32_bf16 v[44:47], v[208:211], v[16:19], v[44:47]
    ds_read_b128 v[16:19], v2 offset:19456
    s_waitcnt lgkmcnt(2)
    v_mfma_f32_16x16x32_bf16 v[20:23], a[12:15], v[8:11], v[20:23]
    v_mfma_f32_16x16x32_bf16 v[24:27], a[68:71], v[8:11], v[24:27]
    v_mfma_f32_16x16x32_bf16 v[28:31], a[124:127], v[8:11], v[28:31]
    v_mfma_f32_16x16x32_bf16 v[32:35], a[180:183], v[8:11], v[32:35]
    v_mfma_f32_16x16x32_bf16 v[36:39], a[236:239], v[8:11], v[36:39]
    v_mfma_f32_16x16x32_bf16 v[40:43], v[156:159], v[8:11], v[40:43]
    v_mfma_f32_16x16x32_bf16 v[44:47], v[212:215], v[8:11], v[44:47]
    ds_read_b128 v[8:11], v2 offset:20480
    s_waitcnt lgkmcnt(2)
    v_mfma_f32_16x16x32_bf16 v[20:23], a[16:19], v[12:15], v[20:23]
    v_mfma_f32_16x16x32_bf16 v[24:27], a[72:75], v[12:15], v[24:27]
    v_mfma_f32_16x16x32_bf16 v[28:31], a[128:131], v[12:15], v[28:31]
    v_mfma_f32_16x16x32_bf16 v[32:35], a[184:187], v[12:15], v[32:35]
    v_mfma_f32_16x16x32_bf16 v[36:39], a[240:243], v[12:15], v[36:39]
    v_mfma_f32_16x16x32_bf16 v[40:43], v[160:163], v[12:15], v[40:43]
    v_mfma_f32_16x16x32_bf16 v[44:47], v[216:219], v[12:15], v[44:47]
    ds_read_b128 v[12:15], v2 offset:21504
    s_waitcnt lgkmcnt(2)
    v_mfma_f32_16x16x32_bf16 v[20:23], a[20:23], v[16:19], v[20:23]
    v_mfma_f32_16x16x32_bf16 v[24:27], a[76:79], v[16:19], v[24:27]
    v_mfma_f32_16x16x32_bf16 v[28:31], a[132:135], v[16:19], v[28:31]
    v_mfma_f32_16x16x32_bf16 v[32:35], a[188:191], v[16:19], v[32:35]
    v_mfma_f32_16x16x32_bf16 v[36:39], a[244:247], v[16:19], v[36:39]
    v_mfma_f32_16x16x32_bf16 v[40:43], v[164:167], v[16:19], v[40:43]
    v_mfma_f32_16x16x32_bf16 v[44:47], v[220:223], v[16:19], v[44:47]
    ds_read_b128 v[16:19], v2 offset:22528
    s_waitcnt lgkmcnt(2)
    v_mfma_f32_16x16x32_bf16 v[20:23], a[24:27], v[8:11], v[20:23]
    v_mfma_f32_16x16x32_bf16 v[24:27], a[80:83], v[8:11], v[24:27]
    v_mfma_f32_16x16x32_bf16 v[28:31], a[136:139], v[8:11], v[28:31]
    v_mfma_f32_16x16x32_bf16 v[32:35], a[192:195], v[8:11], v[32:35]
    v_mfma_f32_16x16x32_bf16 v[36:39], a[248:251], v[8:11], v[36:39]
    v_mfma_f32_16x16x32_bf16 v[40:43], v[168:171], v[8:11], v[40:43]
    v_mfma_f32_16x16x32_bf16 v[44:47], v[224:227], v[8:11], v[44:47]
    ds_read_b128 v[8:11], v2 offset:23552
    s_waitcnt lgkmcnt(2)
    v_mfma_f32_16x16x32_bf16 v[20:23], a[28:31], v[12:15], v[20:23]
    v_mfma_f32_16x16x32_bf16 v[24:27], a[84:87], v[12:15], v[24:27]
    v_mfma_f32_16x16x32_bf16 v[28:31], a[140:143], v[12:15], v[28:31]
    v_mfma_f32_16x16x32_bf16 v[32:35], a[196:199], v[12:15], v[32:35]
    v_mfma_f32_16x16x32_bf16 v[36:39], a[252:255], v[12:15], v[36:39]
    v_mfma_f32_16x16x32_bf16 v[40:43], v[172:175], v[12:15], v[40:43]
    v_mfma_f32_16x16x32_bf16 v[44:47], v[228:231], v[12:15], v[44:47]
    ds_read_b128 v[12:15], v2 offset:24576
    s_waitcnt lgkmcnt(2)
    v_mfma_f32_16x16x32_bf16 v[20:23], a[32:35], v[16:19], v[20:23]
    v_mfma_f32_16x16x32_bf16 v[24:27], a[88:91], v[16:19], v[24:27]
    v_mfma_f32_16x16x32_bf16 v[28:31], a[144:147], v[16:19], v[28:31]
    v_mfma_f32_16x16x32_bf16 v[32:35], a[200:203], v[16:19], v[32:35]
    v_mfma_f32_16x16x32_bf16 v[36:39], v[120:123], v[16:19], v[36:39]
    v_mfma_f32_16x16x32_bf16 v[40:43], v[176:179], v[16:19], v[40:43]
    v_mfma_f32_16x16x32_bf16 v[44:47], v[232:235], v[16:19], v[44:47]
    ds_read_b128 v[16:19], v2 offset:25600
    s_waitcnt lgkmcnt(2)
    v_mfma_f32_16x16x32_bf16 v[20:23], a[36:39], v[8:11], v[20:23]
    v_mfma_f32_16x16x32_bf16 v[24:27], a[92:95], v[8:11], v[24:27]
    v_mfma_f32_16x16x32_bf16 v[28:31], a[148:151], v[8:11], v[28:31]
    v_mfma_f32_16x16x32_bf16 v[32:35], a[204:207], v[8:11], v[32:35]
    v_mfma_f32_16x16x32_bf16 v[36:39], v[124:127], v[8:11], v[36:39]
    v_mfma_f32_16x16x32_bf16 v[40:43], v[180:183], v[8:11], v[40:43]
    v_mfma_f32_16x16x32_bf16 v[44:47], v[236:239], v[8:11], v[44:47]
    ds_read_b128 v[8:11], v2 offset:26624
    s_waitcnt lgkmcnt(2)
    v_mfma_f32_16x16x32_bf16 v[20:23], a[40:43], v[12:15], v[20:23]
    v_mfma_f32_16x16x32_bf16 v[24:27], a[96:99], v[12:15], v[24:27]
    v_mfma_f32_16x16x32_bf16 v[28:31], a[152:155], v[12:15], v[28:31]
    v_mfma_f32_16x16x32_bf16 v[32:35], a[208:211], v[12:15], v[32:35]
    v_mfma_f32_16x16x32_bf16 v[36:39], v[128:131], v[12:15], v[36:39]
    v_mfma_f32_16x16x32_bf16 v[40:43], v[184:187], v[12:15], v[40:43]
    v_mfma_f32_16x16x32_bf16 v[44:47], v[240:243], v[12:15], v[44:47]
    ds_read_b128 v[12:15], v2 offset:27648
    s_waitcnt lgkmcnt(2)
    v_mfma_f32_16x16x32_bf16 v[20:23], a[44:47], v[16:19], v[20:23]
    v_mfma_f32_16x16x32_bf16 v[24:27], a[100:103], v[16:19], v[24:27]
    v_mfma_f32_16x16x32_bf16 v[28:31], a[156:159], v[16:19], v[28:31]
    v_mfma_f32_16x16x32_bf16 v[32:35], a[212:215], v[16:19], v[32:35]
    v_mfma_f32_16x16x32_bf16 v[36:39], v[132:135], v[16:19], v[36:39]
    v_mfma_f32_16x16x32_bf16 v[40:43], v[188:191], v[16:19], v[40:43]
    v_mfma_f32_16x16x32_bf16 v[44:47], v[244:247], v[16:19], v[44:47]
    s_waitcnt lgkmcnt(1)
    v_mfma_f32_16x16x32_bf16 v[20:23], a[48:51], v[8:11], v[20:23]
    v_mfma_f32_16x16x32_bf16 v[24:27], a[104:107], v[8:11], v[24:27]
    v_mfma_f32_16x16x32_bf16 v[28:31], a[160:163], v[8:11], v[28:31]
    v_mfma_f32_16x16x32_bf16 v[32:35], a[216:219], v[8:11], v[32:35]
    v_mfma_f32_16x16x32_bf16 v[36:39], v[136:139], v[8:11], v[36:39]
    v_mfma_f32_16x16x32_bf16 v[40:43], v[192:195], v[8:11], v[40:43]
    v_mfma_f32_16x16x32_bf16 v[44:47], v[248:251], v[8:11], v[44:47]
    s_waitcnt lgkmcnt(0)
    v_mfma_f32_16x16x32_bf16 v[20:23], a[52:55], v[12:15], v[20:23]
    v_mfma_f32_16x16x32_bf16 v[24:27], a[108:111], v[12:15], v[24:27]
    v_mfma_f32_16x16x32_bf16 v[28:31], a[164:167], v[12:15], v[28:31]
    v_mfma_f32_16x16x32_bf16 v[32:35], a[220:223], v[12:15], v[32:35]
    v_mfma_f32_16x16x32_bf16 v[36:39], v[140:143], v[12:15], v[36:39]
    v_mfma_f32_16x16x32_bf16 v[40:43], v[196:199], v[12:15], v[40:43]
    v_mfma_f32_16x16x32_bf16 v[44:47], v[252:255], v[12:15], v[44:47]
    s_nop 7
    v_cvt_pk_bf16_f32 v64, v20, v24
    v_cvt_pk_bf16_f32 v65, v21, v25
    v_cvt_pk_bf16_f32 v66, v22, v26
    v_cvt_pk_bf16_f32 v67, v23, v27
    v_cvt_pk_bf16_f32 v68, v28, v32
    v_cvt_pk_bf16_f32 v69, v29, v33
    v_cvt_pk_bf16_f32 v70, v30, v34
    v_cvt_pk_bf16_f32 v71, v31, v35
    v_cvt_pk_bf16_f32 v72, v36, v40
    v_cvt_pk_bf16_f32 v73, v37, v41
    v_cvt_pk_bf16_f32 v74, v38, v42
    v_cvt_pk_bf16_f32 v75, v39, v43
    v_cvt_pk_bf16_f32 v76, v44, v5
    v_cvt_pk_bf16_f32 v77, v45, v5
    v_cvt_pk_bf16_f32 v78, v46, v5
    v_cvt_pk_bf16_f32 v79, v47, v5
    ds_read_b128 v[80:83], v119 offset:0
    ds_read_b128 v[84:87], v119 offset:1024
    ds_read_b128 v[88:91], v119 offset:2048
    ds_read_b128 v[92:95], v119 offset:3072
    s_waitcnt lgkmcnt(3)
    v_mfma_f32_16x16x32_bf16 v[20:23], v[80:83], v[48:51], 0
    v_mfma_f32_16x16x32_bf16 v[24:27], v[80:83], v[64:67], 0
    s_waitcnt lgkmcnt(2)
    v_mfma_f32_16x16x32_bf16 v[20:23], v[84:87], v[52:55], v[20:23]
    v_mfma_f32_16x16x32_bf16 v[24:27], v[84:87], v[68:71], v[24:27]
    s_waitcnt lgkmcnt(1)
    v_mfma_f32_16x16x32_bf16 v[20:23], v[88:91], v[56:59], v[20:23]
    v_mfma_f32_16x16x32_bf16 v[24:27], v[88:91], v[72:75], v[24:27]
    s_waitcnt lgkmcnt(0)
    v_mfma_f32_16x16x32_bf16 v[20:23], v[92:95], v[60:63], v[20:23]
    v_mfma_f32_16x16x32_bf16 v[24:27], v[92:95], v[76:79], v[24:27]
    ds_read_b128 v[80:83], v119 offset:14336
    ds_read_b128 v[84:87], v119 offset:15360
    ds_read_b128 v[88:91], v119 offset:16384
    ds_read_b128 v[92:95], v119 offset:17408
    s_waitcnt lgkmcnt(3)
    v_mfma_f32_16x16x32_bf16 v[28:31], v[80:83], v[64:67], 0
    s_waitcnt lgkmcnt(2)
    v_mfma_f32_16x16x32_bf16 v[28:31], v[84:87], v[68:71], v[28:31]
    s_waitcnt lgkmcnt(1)
    v_mfma_f32_16x16x32_bf16 v[28:31], v[88:91], v[72:75], v[28:31]
    s_waitcnt lgkmcnt(0)
    v_mfma_f32_16x16x32_bf16 v[28:31], v[92:95], v[76:79], v[28:31]
    s_nop 7
    ds_write_b128 v1, v[20:23] offset:0
    ds_write_b128 v1, v[24:27] offset:1024
    ds_write_b128 v1, v[28:31] offset:2048
    s_waitcnt lgkmcnt(0)
    s_barrier
    ds_read_b128 v[20:23], v1 offset:0
    ds_read_b128 v[24:27], v1 offset:3072
    ds_read_b128 v[28:31], v1 offset:6144
    ds_read_b128 v[32:35], v1 offset:9216
    s_waitcnt lgkmcnt(0)
    v_add_f32 v20, v20, v24
    v_add_f32 v28, v28, v32
    v_add_f32 v21, v21, v25
    v_add_f32 v29, v29, v33
    v_add_f32 v22, v22, v26
    v_add_f32 v30, v30, v34
    v_add_f32 v23, v23, v27
    v_add_f32 v31, v31, v35
    v_add_f32 v96, v20, v28
    v_add_f32 v97, v21, v29
    v_add_f32 v98, v22, v30
    v_add_f32 v99, v23, v31
    v_cndmask_b32 v96, v6, v96, s[40:41]
    v_cndmask_b32 v97, v6, v97, s[42:43]
    v_cndmask_b32 v98, v6, v98, s[44:45]
    v_cndmask_b32 v99, v6, v99, s[46:47]
    s_lshl_b32 s11, s17, 13
    s_add_u32 s11, s11, 0x3080000
    s_mov_b32 s22, 0
spin_638:
    buffer_load_dwordx2 v[80:81], v4, s[4:7], s11 offen offset:0 sc1
    buffer_load_dwordx2 v[82:83], v4, s[4:7], s11 offen offset:32 sc1
    buffer_load_dwordx2 v[84:85], v4, s[4:7], s11 offen offset:512 sc1
    buffer_load_dwordx2 v[86:87], v4, s[4:7], s11 offen offset:544 sc1
    buffer_load_dwordx2 v[88:89], v4, s[4:7], s11 offen offset:1024 sc1
    buffer_load_dwordx2 v[90:91], v4, s[4:7], s11 offen offset:1056 sc1
    buffer_load_dwordx2 v[92:93], v4, s[4:7], s11 offen offset:1536 sc1
    buffer_load_dwordx2 v[94:95], v4, s[4:7], s11 offen offset:1568 sc1
    s_waitcnt vmcnt(0)
spin2_640:
    v_max3_u32 v3, v80, v81, v82
    v_max3_u32 v3, v3, v83, v84
    v_max3_u32 v3, v3, v85, v86
    v_max3_u32 v3, v3, v87, v88
    v_max3_u32 v3, v3, v89, v90
    v_max3_u32 v3, v3, v91, v92
    v_max3_u32 v3, v3, v93, v94
    v_max_u32 v3, v3, v95
    v_cmp_eq_u32 vcc, -1, v3
    s_cbranch_vccz spok_639
    s_add_u32 s22, s22, 1
    s_cmp_gt_u32 s22, 65536
    s_cbranch_scc1 M_exit
    s_sleep 1
    s_branch spin_638
spok_639:
    v_swap_b32 v81, v82
    v_swap_b32 v85, v86
    v_swap_b32 v89, v90
    v_swap_b32 v93, v94
    s_nop 1
    v_mfma_f32_16x16x32_bf16 v[20:23], v[80:83], v[48:51], 0
    v_mfma_f32_16x16x32_bf16 v[24:27], v[80:83], v[64:67], 0
    v_mfma_f32_16x16x32_bf16 v[20:23], v[84:87], v[52:55], v[20:23]
    v_mfma_f32_16x16x32_bf16 v[24:27], v[84:87], v[68:71], v[24:27]
    v_mfma_f32_16x16x32_bf16 v[20:23], v[88:91], v[56:59], v[20:23]
    v_mfma_f32_16x16x32_bf16 v[24:27], v[88:91], v[72:75], v[24:27]
    v_mfma_f32_16x16x32_bf16 v[20:23], v[92:95], v[60:63], v[20:23]
    v_mfma_f32_16x16x32_bf16 v[24:27], v[92:95], v[76:79], v[24:27]
    s_nop 7
    ds_write_b64 v1, v[20:21] offset:12288
    ds_write_b64 v1, v[24:25] offset:12296
    s_waitcnt lgkmcnt(0)
    s_barrier
    ds_read_b64 v[20:21], v1 offset:12288
    ds_read_b64 v[22:23], v1 offset:13312
    ds_read_b64 v[24:25], v1 offset:14336
    ds_read_b64 v[26:27], v1 offset:15360
    s_mul_i32 s11, s17, 40960
    s_lshr_b32 s12, s9, 2
    s_mul_i32 s12, s12, 10240
    s_add_u32 s11, s11, s12
    s_add_u32 s11, s11, 0x3120000
    s_add_u32 s13, s11, 8192
    s_and_b32 s12, s9, 3
    s_lshl_b32 s12, s12, 11
    s_add_u32 s11, s11, s12
    v_max3_f32 v104, v96, v97, v98
    v_max_f32 v104, v104, v99
    s_waitcnt lgkmcnt(0)
    v_add_f32 v20, v20, v22
    v_add_f32 v24, v24, v26
    v_add_f32 v21, v21, v23
    v_add_f32 v25, v25, v27
    v_add_f32 v20, v20, v24
    v_add_f32 v21, v21, v25
    v_max3_f32 v104, v104, v20, v21
    v_mov_b32 v106, v104
    s_nop 1
    v_permlane32_swap_b32 v104, v106
    v_max_f32 v104, v104, v106
    v_mov_b32 v106, v104
    s_nop 1
    v_permlane16_swap_b32 v104, v106
    v_max_f32 v104, v104, v106
    v_sub_f32 v96, v96, v104
    v_sub_f32 v97, v97, v104
    v_sub_f32 v98, v98, v104
    v_sub_f32 v99, v99, v104
    v_sub_f32 v20, v20, v104
    v_sub_f32 v21, v21, v104
    v_exp_f32 v96, v96
    v_exp_f32 v97, v97
    v_exp_f32 v98, v98
    v_exp_f32 v99, v99
    v_exp_f32 v20, v20
    v_exp_f32 v21, v21
    v_add_f32 v105, v96, v97
    v_add_f32 v105, v105, v98
    v_add_f32 v105, v105, v99
    v_add_f32 v105, v105, v20
    v_add_f32 v105, v105, v21
    v_mov_b32 v106, v105
    s_nop 1
    v_permlane32_swap_b32 v105, v106
    v_add_f32 v105, v105, v106
    v_mov_b32 v106, v105
    s_nop 1
    v_permlane16_swap_b32 v105, v106
    v_add_f32 v105, v105, v106
    v_rcp_f32 v105, v105
    s_nop 0
    v_mul_f32 v96, v96, v105
    v_mul_f32 v97, v97, v105
    v_mul_f32 v98, v98, v105
    v_mul_f32 v99, v99, v105
    v_mul_f32 v20, v20, v105
    v_mul_f32 v21, v21, v105
    v_cvt_pk_bf16_f32 v108, v96, v5
    v_min_u32 v108, -2, v108
    v_cvt_pk_bf16_f32 v109, v97, v5
    v_min_u32 v109, -2, v109
    v_cvt_pk_bf16_f32 v110, v98, v5
    v_min_u32 v110, -2, v110
    v_cvt_pk_bf16_f32 v111, v99, v5
    v_min_u32 v111, -2, v111
    v_cvt_pk_bf16_f32 v112, v20, v21
    v_min_u32 v112, -2, v112
    buffer_store_dwordx4 v[108:111], v1, s[4:7], s11 offen sc1
    buffer_store_dword v112, v7, s[4:7], s13 offen sc1
    s_add_u32 s17, s17, 4
    s_cmp_lt_u32 s17, 64
    s_cbranch_scc1 sx_loop_635
    s_branch M_exit
sx_w1_628:
    v_and_b32 v0, 63, v0
    v_lshlrev_b32 v1, 4, v0
    v_mov_b32 v5, 0
    v_mov_b32 v6, 0xff800000
    v_lshrrev_b32 v3, 4, v0
    v_lshrrev_b32 v104, 5, v0
    v_lshlrev_b32 v4, 8, v104
    v_and_b32 v104, 13, v0
    v_lshl_add_u32 v4, v104, 4, v4
    v_bfe_u32 v104, v0, 4, 1
    v_lshl_add_u32 v4, v104, 3, v4
    v_and_b32 v118, 0x38, v0
    v_and_b32 v104, 1, v0
    v_lshl_add_u32 v118, v104, 2, v118
    v_bfe_u32 v104, v0, 1, 2
    v_add_u32 v118, v118, v104
    v_lshlrev_b32 v118, 4, v118
    v_lshrrev_b32 v104, 5, v0
    v_lshlrev_b32 v3, 3, v104
    v_bfe_u32 v104, v0, 4, 1
    v_lshl_add_u32 v3, v104, 1, v3
    v_and_b32 v104, 15, v0
    v_add_u32 v105, 0, v3
    v_cmp_le_u32 s[40:41], v105, v104
    v_add_u32 v105, 4, v3
    v_cmp_le_u32 s[42:43], v105, v104
    v_add_u32 v105, 1, v3
    v_cmp_le_u32 s[44:45], v105, v104
    v_add_u32 v105, 5, v3
    v_cmp_le_u32 s[46:47], v105, v104
    s_and_b32 s11, s9, 3
    s_lshl_b32 s11, s11, 8
    v_and_b32 v104, 15, v0
    v_lshlrev_b32 v7, 4, v104
    v_lshrrev_b32 v104, 4, v0
    v_lshl_add_u32 v7, v104, 2, v7
    v_add_u32 v7, s11, v7
    s_mov_b32 s18, 20480
    s_mov_b32 s11, 0x3b03000
    v_min_u32 v8, 0, v0
    v_lshlrev_b32 v8, 4, v8
    s_mov_b32 s22, 0
wt_641:
    buffer_load_dwordx4 v[20:23], v8, s[4:7], s11 offen offset:0 sc1
    s_waitcnt vmcnt(0)
    v_xor_b32 v20, s80, v20
    v_xor_b32 v21, s81, v21
    v_and_b32 v21, -16, v21
    v_xor_b32 v22, s80, v22
    v_xor_b32 v23, s81, v23
    v_and_b32 v23, -16, v23
    v_or3_b32 v20, v20, v21, v22
    v_or_b32 v20, v20, v23
    v_cmp_ne_u32 vcc, 0, v20
    s_cbranch_vccz wtok_642
    s_add_u32 s22, s22, 1
    s_cmp_gt_u32 s22, 65536
    s_cbranch_scc1 M_exit
    s_sleep 16
    s_branch wt_641
wtok_642:
    s_mul_i32 s13, s15, 28672
    s_mul_i32 s14, s10, 7168
    s_add_u32 s13, s13, s14
    s_add_u32 m0, s18, s14
    s_nop 0
    buffer_load_dwordx4 v1, s[4:7], s13 offen offset:0 sc1 lds
    buffer_load_dwordx4 v1, s[4:7], s13 offen offset:1024 sc1 lds
    buffer_load_dwordx4 v1, s[4:7], s13 offen offset:2048 sc1 lds
    buffer_load_dwordx4 v1, s[4:7], s13 offen offset:3072 sc1 lds
    s_add_u32 m0, m0, 4096
    s_add_u32 s13, s13, 4096
    buffer_load_dwordx4 v1, s[4:7], s13 offen offset:0 sc1 lds
    buffer_load_dwordx4 v1, s[4:7], s13 offen offset:1024 sc1 lds
    buffer_load_dwordx4 v1, s[4:7], s13 offen offset:2048 sc1 lds
    s_mul_i32 s11, s9, 401408
    s_add_u32 s12, s11, 0x218800
    s_add_u32 s14, s12, 0
    buffer_load_dwordx4 a[0:3], v1, s[4:7], s14 offen offset:0 sc1
    buffer_load_dwordx4 a[4:7], v1, s[4:7], s14 offen offset:1024 sc1
    buffer_load_dwordx4 a[8:11], v1, s[4:7], s14 offen offset:2048 sc1
    buffer_load_dwordx4 a[12:15], v1, s[4:7], s14 offen offset:3072 sc1
    s_add_u32 s14, s12, 4096
    buffer_load_dwordx4 a[16:19], v1, s[4:7], s14 offen offset:0 sc1
    buffer_load_dwordx4 a[20:23], v1, s[4:7], s14 offen offset:1024 sc1
    buffer_load_dwordx4 a[24:27], v1, s[4:7], s14 offen offset:2048 sc1
    buffer_load_dwordx4 a[28:31], v1, s[4:7], s14 offen offset:3072 sc1
    s_add_u32 s14, s12, 8192
    buffer_load_dwordx4 a[32:35], v1, s[4:7], s14 offen offset:0 sc1
    buffer_load_dwordx4 a[36:39], v1, s[4:7], s14 offen offset:1024 sc1
    buffer_load_dwordx4 a[40:43], v1, s[4:7], s14 offen offset:2048 sc1
    buffer_load_dwordx4 a[44:47], v1, s[4:7], s14 offen offset:3072 sc1
    s_add_u32 s14, s12, 12288
    buffer_load_dwordx4 a[48:51], v1, s[4:7], s14 offen offset:0 sc1
    buffer_load_dwordx4 a[52:55], v1, s[4:7], s14 offen offset:1024 sc1
    s_add_u32 s12, s11, 0x21c000
    s_add_u32 s14, s12, 0
    buffer_load_dwordx4 a[56:59], v1, s[4:7], s14 offen offset:0 sc1
    buffer_load_dwordx4 a[60:63], v1, s[4:7], s14 offen offset:1024 sc1
    buffer_load_dwordx4 a[64:67], v1, s[4:7], s14 offen offset:2048 sc1
    buffer_load_dwordx4 a[68:71], v1, s[4:7], s14 offen offset:3072 sc1
    s_add_u32 s14, s12, 4096
    buffer_load_dwordx4 a[72:75], v1, s[4:7], s14 offen offset:0 sc1
    buffer_load_dwordx4 a[76:79], v1, s[4:7], s14 offen offset:1024 sc1
    buffer_load_dwordx4 a[80:83], v1, s[4:7], s14 offen offset:2048 sc1
    buffer_load_dwordx4 a[84:87], v1, s[4:7], s14 offen offset:3072 sc1
    s_add_u32 s14, s12, 8192
    buffer_load_dwordx4 a[88:91], v1, s[4:7], s14 offen offset:0 sc1
    buffer_load_dwordx4 a[92:95], v1, s[4:7], s14 offen offset:1024 sc1
    buffer_load_dwordx4 a[96:99], v1, s[4:7], s14 offen offset:2048 sc1
    buffer_load_dwordx4 a[100:103], v1, s[4:7], s14 offen offset:3072 sc1
    s_add_u32 s14, s12, 12288
    buffer_load_dwordx4 a[104:107], v1, s[4:7], s14 offen offset:0 sc1
    buffer_load_dwordx4 a[108:111], v1, s[4:7], s14 offen offset:1024 sc1
    s_add_u32 s12, s11, 0x21f800
    s_add_u32 s14, s12, 0
    buffer_load_dwordx4 a[112:115], v1, s[4:7], s14 offen offset:0 sc1
    buffer_load_dwordx4 a[116:119], v1, s[4:7], s14 offen offset:1024 sc1
    buffer_load_dwordx4 a[120:123], v1, s[4:7], s14 offen offset:2048 sc1
    buffer_load_dwordx4 a[124:127], v1, s[4:7], s14 offen offset:3072 sc1
    s_add_u32 s14, s12, 4096
    buffer_load_dwordx4 a[128:131], v1, s[4:7], s14 offen offset:0 sc1
    buffer_load_dwordx4 a[132:135], v1, s[4:7], s14 offen offset:1024 sc1
    buffer_load_dwordx4 a[136:139], v1, s[4:7], s14 offen offset:2048 sc1
    buffer_load_dwordx4 a[140:143], v1, s[4:7], s14 offen offset:3072 sc1
    s_add_u32 s14, s12, 8192
    buffer_load_dwordx4 a[144:147], v1, s[4:7], s14 offen offset:0 sc1
    buffer_load_dwordx4 a[148:151], v1, s[4:7], s14 offen offset:1024 sc1
    buffer_load_dwordx4 a[152:155], v1, s[4:7], s14 offen offset:2048 sc1
    buffer_load_dwordx4 a[156:159], v1, s[4:7], s14 offen offset:3072 sc1
    s_add_u32 s14, s12, 12288
    buffer_load_dwordx4 a[160:163], v1, s[4:7], s14 offen offset:0 sc1
    buffer_load_dwordx4 a[164:167], v1, s[4:7], s14 offen offset:1024 sc1
    s_waitcnt vmcnt(46)
    s_add_u32 s12, s11, 0x223000
    s_add_u32 s14, s12, 0
    buffer_load_dwordx4 a[168:171], v1, s[4:7], s14 offen offset:0 sc1
    buffer_load_dwordx4 a[172:175], v1, s[4:7], s14 offen offset:1024 sc1
    buffer_load_dwordx4 a[176:179], v1, s[4:7], s14 offen offset:2048 sc1
    buffer_load_dwordx4 a[180:183], v1, s[4:7], s14 offen offset:3072 sc1
    s_add_u32 s14, s12, 4096
    buffer_load_dwordx4 a[184:187], v1, s[4:7], s14 offen offset:0 sc1
    buffer_load_dwordx4 a[188:191], v1, s[4:7], s14 offen offset:1024 sc1
    buffer_load_dwordx4 a[192:195], v1, s[4:7], s14 offen offset:2048 sc1
    buffer_load_dwordx4 a[196:199], v1, s[4:7], s14 offen offset:3072 sc1
    s_add_u32 s14, s12, 8192
    buffer_load_dwordx4 a[200:203], v1, s[4:7], s14 offen offset:0 sc1
    buffer_load_dwordx4 a[204:207], v1, s[4:7], s14 offen offset:1024 sc1
    buffer_load_dwordx4 a[208:211], v1, s[4:7], s14 offen offset:2048 sc1
    buffer_load_dwordx4 a[212:215], v1, s[4:7], s14 offen offset:3072 sc1
    s_add_u32 s14, s12, 12288
    buffer_load_dwordx4 a[216:219], v1, s[4:7], s14 offen offset:0 sc1
    buffer_load_dwordx4 a[220:223], v1, s[4:7], s14 offen offset:1024 sc1
    s_waitcnt vmcnt(46)
    s_add_u32 s12, s11, 0x226800
    s_add_u32 s14, s12, 0
    buffer_load_dwordx4 a[224:227], v1, s[4:7], s14 offen offset:0 sc1
    buffer_load_dwordx4 a[228:231], v1, s[4:7], s14 offen offset:1024 sc1
    buffer_load_dwordx4 a[232:235], v1, s[4:7], s14 offen offset:2048 sc1
    buffer_load_dwordx4 a[236:239], v1, s[4:7], s14 offen offset:3072 sc1
    s_add_u32 s14, s12, 4096
    buffer_load_dwordx4 a[240:243], v1, s[4:7], s14 offen offset:0 sc1
    buffer_load_dwordx4 a[244:247], v1, s[4:7], s14 offen offset:1024 sc1
    buffer_load_dwordx4 a[248:251], v1, s[4:7], s14 offen offset:2048 sc1
    buffer_load_dwordx4 a[252:255], v1, s[4:7], s14 offen offset:3072 sc1
    s_add_u32 s14, s12, 8192
    buffer_load_dwordx4 v[120:123], v1, s[4:7], s14 offen offset:0 sc1
    buffer_load_dwordx4 v[124:127], v1, s[4:7], s14 offen offset:1024 sc1
    buffer_load_dwordx4 v[128:131], v1, s[4:7], s14 offen offset:2048 sc1
    buffer_load_dwordx4 v[132:135], v1, s[4:7], s14 offen offset:3072 sc1
    s_add_u32 s14, s12, 12288
    buffer_load_dwordx4 v[136:139], v1, s[4:7], s14 offen offset:0 sc1
    buffer_load_dwordx4 v[140:143], v1, s[4:7], s14 offen offset:1024 sc1
    s_waitcnt vmcnt(46)
    s_add_u32 s12, s11, 0x22a000
    s_add_u32 s14, s12, 0
    buffer_load_dwordx4 v[144:147], v1, s[4:7], s14 offen offset:0 sc1
    buffer_load_dwordx4 v[148:151], v1, s[4:7], s14 offen offset:1024 sc1
    buffer_load_dwordx4 v[152:155], v1, s[4:7], s14 offen offset:2048 sc1
    buffer_load_dwordx4 v[156:159], v1, s[4:7], s14 offen offset:3072 sc1
    s_add_u32 s14, s12, 4096
    buffer_load_dwordx4 v[160:163], v1, s[4:7], s14 offen offset:0 sc1
    buffer_load_dwordx4 v[164:167], v1, s[4:7], s14 offen offset:1024 sc1
    buffer_load_dwordx4 v[168:171], v1, s[4:7], s14 offen offset:2048 sc1
    buffer_load_dwordx4 v[172:175], v1, s[4:7], s14 offen offset:3072 sc1
    s_add_u32 s14, s12, 8192
    buffer_load_dwordx4 v[176:179], v1, s[4:7], s14 offen offset:0 sc1
    buffer_load_dwordx4 v[180:183], v1, s[4:7], s14 offen offset:1024 sc1
    buffer_load_dwordx4 v[184:187], v1, s[4:7], s14 offen offset:2048 sc1
    buffer_load_dwordx4 v[188:191], v1, s[4:7], s14 offen offset:3072 sc1
    s_add_u32 s14, s12, 12288
    buffer_load_dwordx4 v[192:195], v1, s[4:7], s14 offen offset:0 sc1
    buffer_load_dwordx4 v[196:199], v1, s[4:7], s14 offen offset:1024 sc1
    s_waitcnt vmcnt(46)
    s_add_u32 s12, s11, 0x22d800
    s_add_u32 s14, s12, 0
    buffer_load_dwordx4 v[200:203], v1, s[4:7], s14 offen offset:0 sc1
    buffer_load_dwordx4 v[204:207], v1, s[4:7], s14 offen offset:1024 sc1
    buffer_load_dwordx4 v[208:211], v1, s[4:7], s14 offen offset:2048 sc1
    buffer_load_dwordx4 v[212:215], v1, s[4:7], s14 offen offset:3072 sc1
    s_add_u32 s14, s12, 4096
    buffer_load_dwordx4 v[216:219], v1, s[4:7], s14 offen offset:0 sc1
    buffer_load_dwordx4 v[220:223], v1, s[4:7], s14 offen offset:1024 sc1
    buffer_load_dwordx4 v[224:227], v1, s[4:7], s14 offen offset:2048 sc1
    buffer_load_dwordx4 v[228:231], v1, s[4:7], s14 offen offset:3072 sc1
    s_add_u32 s14, s12, 8192
    buffer_load_dwordx4 v[232:235], v1, s[4:7], s14 offen offset:0 sc1
    buffer_load_dwordx4 v[236:239], v1, s[4:7], s14 offen offset:1024 sc1
    buffer_load_dwordx4 v[240:243], v1, s[4:7], s14 offen offset:2048 sc1
    buffer_load_dwordx4 v[244:247], v1, s[4:7], s14 offen offset:3072 sc1
    s_add_u32 s14, s12, 12288
    buffer_load_dwordx4 v[248:251], v1, s[4:7], s14 offen offset:0 sc1
    buffer_load_dwordx4 v[252:255], v1, s[4:7], s14 offen offset:1024 sc1
    s_waitcnt vmcnt(46)
    s_mov_b32 s11, 0x3b02800
    v_min_u32 v8, 51, v0
    v_lshlrev_b32 v8, 4, v8
    s_mov_b32 s22, 0
wt_643:
    buffer_load_dwordx4 v[20:23], v8, s[4:7], s11 offen offset:0 sc1
    s_waitcnt vmcnt(0)
    v_xor_b32 v20, s80, v20
    v_xor_b32 v21, s81, v21
    v_and_b32 v21, -16, v21
    v_xor_b32 v22, s80, v22
    v_xor_b32 v23, s81, v23
    v_and_b32 v23, -16, v23
    v_or3_b32 v20, v20, v21, v22
    v_or_b32 v20, v20, v23
    v_cmp_ne_u32 vcc, 0, v20
    s_cbranch_vccz wtok_644
    s_add_u32 s22, s22, 1
    s_cmp_gt_u32 s22, 65536
    s_cbranch_scc1 M_exit
    s_sleep 16
    s_branch wt_643
wtok_644:
    s_mov_b32 s17, s15
    s_waitcnt vmcnt(0)
sx_loop_645:
    s_barrier
    v_add_u32 v2, s18, v1
    v_add_u32 v119, s18, v118
    s_sub_u32 s18, 69632, s18
    s_add_u32 s11, s17, 4
    s_min_u32 s11, s11, 63
    s_mul_i32 s13, s11, 28672
    s_mul_i32 s14, s10, 7168
    s_add_u32 s13, s13, s14
    s_add_u32 m0, s18, s14
    s_nop 0
    ds_read_b128 v[8:11], v2 offset:0
    ds_read_b128 v[12:15], v2 offset:1024
    ds_read_b128 v[16:19], v2 offset:2048
    s_waitcnt lgkmcnt(2)
    v_mfma_f32_16x16x32_bf16 v[20:23], a[0:3], v[8:11], 0
    buffer_load_dwordx4 v1, s[4:7], s13 offen offset:0 sc1 lds
    v_mfma_f32_16x16x32_bf16 v[24:27], a[56:59], v[8:11], 0
    v_mfma_f32_16x16x32_bf16 v[28:31], a[112:115], v[8:11], 0
    v_mfma_f32_16x16x32_bf16 v[32:35], a[168:171], v[8:11], 0
    v_mfma_f32_16x16x32_bf16 v[36:39], a[224:227], v[8:11], 0
    v_mfma_f32_16x16x32_bf16 v[40:43], v[144:147], v[8:11], 0
    v_mfma_f32_16x16x32_bf16 v[44:47], v[200:203], v[8:11], 0
    ds_read_b128 v[8:11], v2 offset:3072
    s_waitcnt lgkmcnt(2)
    v_mfma_f32_16x16x32_bf16 v[20:23], a[4:7], v[12:15], v[20:23]
    buffer_load_dwordx4 v1, s[4:7], s13 offen offset:1024 sc1 lds
    v_mfma_f32_16x16x32_bf16 v[24:27], a[60:63], v[12:15], v[24:27]
    v_mfma_f32_16x16x32_bf16 v[28:31], a[116:119], v[12:15], v[28:31]
    v_mfma_f32_16x16x32_bf16 v[32:35], a[172:175], v[12:15], v[32:35]
    v_mfma_f32_16x16x32_bf16 v[36:39], a[228:231], v[12:15], v[36:39]
    v_mfma_f32_16x16x32_bf16 v[40:43], v[148:151], v[12:15], v[40:43]
    v_mfma_f32_16x16x32_bf16 v[44:47], v[204:207], v[12:15], v[44:47]
    ds_read_b128 v[12:15], v2 offset:4096
    s_waitcnt lgkmcnt(2)
    v_mfma_f32_16x16x32_bf16 v[20:23], a[8:11], v[16:19], v[20:23]
    buffer_load_dwordx4 v1, s[4:7], s13 offen offset:2048 sc1 lds
    v_mfma_f32_16x16x32_bf16 v[24:27], a[64:67], v[16:19], v[24:27]
    v_mfma_f32_16x16x32_bf16 v[28:31], a[120:123], v[16:19], v[28:31]
    v_mfma_f32_16x16x32_bf16 v[32:35], a[176:179], v[16:19], v[32:35]
    v_mfma_f32_16x16x32_bf16 v[36:39], a[232:235], v[16:19], v[36:39]
    v_mfma_f32_16x16x32_bf16 v[40:43], v[152:155], v[16:19], v[40:43]
    v_mfma_f32_16x16x32_bf16 v[44:47], v[208:211], v[16:19], v[44:47]
    ds_read_b128 v[16:19], v2 offset:5120
    s_waitcnt lgkmcnt(2)
    v_mfma_f32_16x16x32_bf16 v[20:23], a[12:15], v[8:11], v[20:23]
    buffer_load_dwordx4 v1, s[4:7], s13 offen offset:3072 sc1 lds
    s_add_u32 m0, m0, 4096
    s_add_u32 s13, s13, 4096
    v_mfma_f32_16x16x32_bf16 v[24:27], a[68:71], v[8:11], v[24:27]
    v_mfma_f32_16x16x32_bf16 v[28:31], a[124:127], v[8:11], v[28:31]
    v_mfma_f32_16x16x32_bf16 v[32:35], a[180:183], v[8:11], v[32:35]
    v_mfma_f32_16x16x32_bf16 v[36:39], a[236:239], v[8:11], v[36:39]
    v_mfma_f32_16x16x32_bf16 v[40:43], v[156:159], v[8:11], v[40:43]
    v_mfma_f32_16x16x32_bf16 v[44:47], v[212:215], v[8:11], v[44:47]
    ds_read_b128 v[8:11], v2 offset:6144
    s_waitcnt lgkmcnt(2)
    v_mfma_f32_16x16x32_bf16 v[20:23], a[16:19], v[12:15], v[20:23]
    buffer_load_dwordx4 v1, s[4:7], s13 offen offset:0 sc1 lds
    v_mfma_f32_16x16x32_bf16 v[24:27], a[72:75], v[12:15], v[24:27]
    v_mfma_f32_16x16x32_bf16 v[28:31], a[128:131], v[12:15], v[28:31]
    v_mfma_f32_16x16x32_bf16 v[32:35], a[184:187], v[12:15], v[32:35]
    v_mfma_f32_16x16x32_bf16 v[36:39], a[240:243], v[12:15], v[36:39]
    v_mfma_f32_16x16x32_bf16 v[40:43], v[160:163], v[12:15], v[40:43]
    v_mfma_f32_16x16x32_bf16 v[44:47], v[216:219], v[12:15], v[44:47]
    ds_read_b128 v[12:15], v2 offset:7168
    s_waitcnt lgkmcnt(2)
    v_mfma_f32_16x16x32_bf16 v[20:23], a[20:23], v[16:19], v[20:23]
    buffer_load_dwordx4 v1, s[4:7], s13 offen offset:1024 sc1 lds
    v_mfma_f32_16x16x32_bf16 v[24:27], a[76:79], v[16:19], v[24:27]
    v_mfma_f32_16x16x32_bf16 v[28:31], a[132:135], v[16:19], v[28:31]
    v_mfma_f32_16x16x32_bf16 v[32:35], a[188:191], v[16:19], v[32:35]
    v_mfma_f32_16x16x32_bf16 v[36:39], a[244:247], v[16:19], v[36:39]
    v_mfma_f32_16x16x32_bf16 v[40:43], v[164:167], v[16:19], v[40:43]
    v_mfma_f32_16x16x32_bf16 v[44:47], v[220:223], v[16:19], v[44:47]
    ds_read_b128 v[16:19], v2 offset:8192
    s_waitcnt lgkmcnt(2)
    v_mfma_f32_16x16x32_bf16 v[20:23], a[24:27], v[8:11], v[20:23]
    buffer_load_dwordx4 v1, s[4:7], s13 offen offset:2048 sc1 lds
    v_mfma_f32_16x16x32_bf16 v[24:27], a[80:83], v[8:11], v[24:27]
    v_mfma_f32_16x16x32_bf16 v[28:31], a[136:139], v[8:11], v[28:31]
    v_mfma_f32_16x16x32_bf16 v[32:35], a[192:195], v[8:11], v[32:35]
    v_mfma_f32_16x16x32_bf16 v[36:39], a[248:251], v[8:11], v[36:39]
    v_mfma_f32_16x16x32_bf16 v[40:43], v[168:171], v[8:11], v[40:43]
    v_mfma_f32_16x16x32_bf16 v[44:47], v[224:227], v[8:11], v[44:47]
    ds_read_b128 v[8:11], v2 offset:9216
    s_waitcnt lgkmcnt(2)
    v_mfma_f32_16x16x32_bf16 v[20:23], a[28:31], v[12:15], v[20:23]
    v_mfma_f32_16x16x32_bf16 v[24:27], a[84:87], v[12:15], v[24:27]
    v_mfma_f32_16x16x32_bf16 v[28:31], a[140:143], v[12:15], v[28:31]
    v_mfma_f32_16x16x32_bf16 v[32:35], a[196:199], v[12:15], v[32:35]
    v_mfma_f32_16x16x32_bf16 v[36:39], a[252:255], v[12:15], v[36:39]
    v_mfma_f32_16x16x32_bf16 v[40:43], v[172:175], v[12:15], v[40:43]
    v_mfma_f32_16x16x32_bf16 v[44:47], v[228:231], v[12:15], v[44:47]
    ds_read_b128 v[12:15], v2 offset:10240
    s_waitcnt lgkmcnt(2)
    v_mfma_f32_16x16x32_bf16 v[20:23], a[32:35], v[16:19], v[20:23]
    v_mfma_f32_16x16x32_bf16 v[24:27], a[88:91], v[16:19], v[24:27]
    v_mfma_f32_16x16x32_bf16 v[28:31], a[144:147], v[16:19], v[28:31]
    v_mfma_f32_16x16x32_bf16 v[32:35], a[200:203], v[16:19], v[32:35]
    v_mfma_f32_16x16x32_bf16 v[36:39], v[120:123], v[16:19], v[36:39]
    v_mfma_f32_16x16x32_bf16 v[40:43], v[176:179], v[16:19], v[40:43]
    v_mfma_f32_16x16x32_bf16 v[44:47], v[232:235], v[16:19], v[44:47]
    ds_read_b128 v[16:19], v2 offset:11264
    s_waitcnt lgkmcnt(2)
    v_mfma_f32_16x16x32_bf16 v[20:23], a[36:39], v[8:11], v[20:23]
    v_mfma_f32_16x16x32_bf16 v[24:27], a[92:95], v[8:11], v[24:27]
    v_mfma_f32_16x16x32_bf16 v[28:31], a[148:151], v[8:11], v[28:31]
    v_mfma_f32_16x16x32_bf16 v[32:35], a[204:207], v[8:11], v[32:35]
    v_mfma_f32_16x16x32_bf16 v[36:39], v[124:127], v[8:11], v[36:39]
    v_mfma_f32_16x16x32_bf16 v[40:43], v[180:183], v[8:11], v[40:43]
    v_mfma_f32_16x16x32_bf16 v[44:47], v[236:239], v[8:11], v[44:47]
    ds_read_b128 v[8:11], v2 offset:12288
    s_waitcnt lgkmcnt(2)
    v_mfma_f32_16x16x32_bf16 v[20:23], a[40:43], v[12:15], v[20:23]
    v_mfma_f32_16x16x32_bf16 v[24:27], a[96:99], v[12:15], v[24:27]
    v_mfma_f32_16x16x32_bf16 v[28:31], a[152:155], v[12:15], v[28:31]
    v_mfma_f32_16x16x32_bf16 v[32:35], a[208:211], v[12:15], v[32:35]
    v_mfma_f32_16x16x32_bf16 v[36:39], v[128:131], v[12:15], v[36:39]
    v_mfma_f32_16x16x32_bf16 v[40:43], v[184:187], v[12:15], v[40:43]
    v_mfma_f32_16x16x32_bf16 v[44:47], v[240:243], v[12:15], v[44:47]
    ds_read_b128 v[12:15], v2 offset:13312
    s_waitcnt lgkmcnt(2)
    v_mfma_f32_16x16x32_bf16 v[20:23], a[44:47], v[16:19], v[20:23]
    v_mfma_f32_16x16x32_bf16 v[24:27], a[100:103], v[16:19], v[24:27]
    v_mfma_f32_16x16x32_bf16 v[28:31], a[156:159], v[16:19], v[28:31]
    v_mfma_f32_16x16x32_bf16 v[32:35], a[212:215], v[16:19], v[32:35]
    v_mfma_f32_16x16x32_bf16 v[36:39], v[132:135], v[16:19], v[36:39]
    v_mfma_f32_16x16x32_bf16 v[40:43], v[188:191], v[16:19], v[40:43]
    v_mfma_f32_16x16x32_bf16 v[44:47], v[244:247], v[16:19], v[44:47]
    s_waitcnt lgkmcnt(1)
    v_mfma_f32_16x16x32_bf16 v[20:23], a[48:51], v[8:11], v[20:23]
    v_mfma_f32_16x16x32_bf16 v[24:27], a[104:107], v[8:11], v[24:27]
    v_mfma_f32_16x16x32_bf16 v[28:31], a[160:163], v[8:11], v[28:31]
    v_mfma_f32_16x16x32_bf16 v[32:35], a[216:219], v[8:11], v[32:35]
    v_mfma_f32_16x16x32_bf16 v[36:39], v[136:139], v[8:11], v[36:39]
    v_mfma_f32_16x16x32_bf16 v[40:43], v[192:195], v[8:11], v[40:43]
    v_mfma_f32_16x16x32_bf16 v[44:47], v[248:251], v[8:11], v[44:47]
    s_waitcnt lgkmcnt(0)
    v_mfma_f32_16x16x32_bf16 v[20:23], a[52:55], v[12:15], v[20:23]
    v_mfma_f32_16x16x32_bf16 v[24:27], a[108:111], v[12:15], v[24:27]
    v_mfma_f32_16x16x32_bf16 v[28:31], a[164:167], v[12:15], v[28:31]
    v_mfma_f32_16x16x32_bf16 v[32:35], a[220:223], v[12:15], v[32:35]
    v_mfma_f32_16x16x32_bf16 v[36:39], v[140:143], v[12:15], v[36:39]
    v_mfma_f32_16x16x32_bf16 v[40:43], v[196:199], v[12:15], v[40:43]
    v_mfma_f32_16x16x32_bf16 v[44:47], v[252:255], v[12:15], v[44:47]
    s_nop 7
    v_cvt_pk_bf16_f32 v48, v5, v20
    v_cvt_pk_bf16_f32 v49, v5, v21
    v_cvt_pk_bf16_f32 v50, v5, v22
    v_cvt_pk_bf16_f32 v51, v5, v23
    v_cvt_pk_bf16_f32 v52, v24, v28
    v_cvt_pk_bf16_f32 v53, v25, v29
    v_cvt_pk_bf16_f32 v54, v26, v30
    v_cvt_pk_bf16_f32 v55, v27, v31
    v_cvt_pk_bf16_f32 v56, v32, v36
    v_cvt_pk_bf16_f32 v57, v33, v37
    v_cvt_pk_bf16_f32 v58, v34, v38
    v_cvt_pk_bf16_f32 v59, v35, v39
    v_cvt_pk_bf16_f32 v60, v40, v44
    v_cvt_pk_bf16_f32 v61, v41, v45
    v_cvt_pk_bf16_f32 v62, v42, v46
    v_cvt_pk_bf16_f32 v63, v43, v47
    ds_read_b128 v[8:11], v2 offset:14336
    ds_read_b128 v[12:15], v2 offset:15360
    ds_read_b128 v[16:19], v2 offset:16384
    s_waitcnt lgkmcnt(2)
    v_mfma_f32_16x16x32_bf16 v[20:23], a[0:3], v[8:11], 0
    v_mfma_f32_16x16x32_bf16 v[24:27], a[56:59], v[8:11], 0
    v_mfma_f32_16x16x32_bf16 v[28:31], a[112:115], v[8:11], 0
    v_mfma_f32_16x16x32_bf16 v[32:35], a[168:171], v[8:11], 0
    v_mfma_f32_16x16x32_bf16 v[36:39], a[224:227], v[8:11], 0
    v_mfma_f32_16x16x32_bf16 v[40:43], v[144:147], v[8:11], 0
    v_mfma_f32_16x16x32_bf16 v[44:47], v[200:203], v[8:11], 0
    ds_read_b128 v[8:11], v2 offset:17408
    s_waitcnt lgkmcnt(2)
    v_mfma_f32_16x16x32_bf16 v[20:23], a[4:7], v[12:15], v[20:23]
    v_mfma_f32_16x16x32_bf16 v[24:27], a[60:63], v[12:15], v[24:27]
    v_mfma_f32_16x16x32_bf16 v[28:31], a[116:119], v[12:15], v[28:31]
    v_mfma_f32_16x16x32_bf16 v[32:35], a[172:175], v[12:15], v[32:35]
    v_mfma_f32_16x16x32_bf16 v[36:39], a[228:231], v[12:15], v[36:39]
    v_mfma_f32_16x16x32_bf16 v[40:43], v[148:151], v[12:15], v[40:43]
    v_mfma_f32_16x16x32_bf16 v[44:47], v[204:207], v[12:15], v[44:47]
    ds_read_b128 v[12:15], v2 offset:18432
    s_waitcnt lgkmcnt(2)
    v_mfma_f32_16x16x32_bf16 v[20:23], a[8:11], v[16:19], v[20:23]
    v_mfma_f32_16x16x32_bf16 v[24:27], a[64:67], v[16:19], v[24:27]
    v_mfma_f32_16x16x32_bf16 v[28:31], a[120:123], v[16:19], v[28:31]
    v_mfma_f32_16x16x32_bf16 v[32:35], a[176:179], v[16:19], v[32:35]
    v_mfma_f32_16x16x32_bf16 v[36:39], a[232:235], v[16:19], v[36:39]
    v_mfma_f32_16x16x32_bf16 v[40:43], v[152:155], v[16:19], v[40:43]
    v_mfma_f32_16x16x32_bf16 v[44:47], v[208:211], v[16:19], v[44:47]
    ds_read_b128 v[16:19], v2 offset:19456
    s_waitcnt lgkmcnt(2)
    v_mfma_f32_16x16x32_bf16 v[20:23], a[12:15], v[8:11], v[20:23]
    v_mfma_f32_16x16x32_bf16 v[24:27], a[68:71], v[8:11], v[24:27]
    v_mfma_f32_16x16x32_bf16 v[28:31], a[124:127], v[8:11], v[28:31]
    v_mfma_f32_16x16x32_bf16 v[32:35], a[180:183], v[8:11], v[32:35]
    v_mfma_f32_16x16x32_bf16 v[36:39], a[236:239], v[8:11], v[36:39]
    v_mfma_f32_16x16x32_bf16 v[40:43], v[156:159], v[8:11], v[40:43]
    v_mfma_f32_16x16x32_bf16 v[44:47], v[212:215], v[8:11], v[44:47]
    ds_read_b128 v[8:11], v2 offset:20480
    s_waitcnt lgkmcnt(2)
    v_mfma_f32_16x16x32_bf16 v[20:23], a[16:19], v[12:15], v[20:23]
    v_mfma_f32_16x16x32_bf16 v[24:27], a[72:75], v[12:15], v[24:27]
    v_mfma_f32_16x16x32_bf16 v[28:31], a[128:131], v[12:15], v[28:31]
    v_mfma_f32_16x16x32_bf16 v[32:35], a[184:187], v[12:15], v[32:35]
    v_mfma_f32_16x16x32_bf16 v[36:39], a[240:243], v[12:15], v[36:39]
    v_mfma_f32_16x16x32_bf16 v[40:43], v[160:163], v[12:15], v[40:43]
    v_mfma_f32_16x16x32_bf16 v[44:47], v[216:219], v[12:15], v[44:47]
    ds_read_b128 v[12:15], v2 offset:21504
    s_waitcnt lgkmcnt(2)
    v_mfma_f32_16x16x32_bf16 v[20:23], a[20:23], v[16:19], v[20:23]
    v_mfma_f32_16x16x32_bf16 v[24:27], a[76:79], v[16:19], v[24:27]
    v_mfma_f32_16x16x32_bf16 v[28:31], a[132:135], v[16:19], v[28:31]
    v_mfma_f32_16x16x32_bf16 v[32:35], a[188:191], v[16:19], v[32:35]
    v_mfma_f32_16x16x32_bf16 v[36:39], a[244:247], v[16:19], v[36:39]
    v_mfma_f32_16x16x32_bf16 v[40:43], v[164:167], v[16:19], v[40:43]
    v_mfma_f32_16x16x32_bf16 v[44:47], v[220:223], v[16:19], v[44:47]
    ds_read_b128 v[16:19], v2 offset:22528
    s_waitcnt lgkmcnt(2)
    v_mfma_f32_16x16x32_bf16 v[20:23], a[24:27], v[8:11], v[20:23]
    v_mfma_f32_16x16x32_bf16 v[24:27], a[80:83], v[8:11], v[24:27]
    v_mfma_f32_16x16x32_bf16 v[28:31], a[136:139], v[8:11], v[28:31]
    v_mfma_f32_16x16x32_bf16 v[32:35], a[192:195], v[8:11], v[32:35]
    v_mfma_f32_16x16x32_bf16 v[36:39], a[248:251], v[8:11], v[36:39]
    v_mfma_f32_16x16x32_bf16 v[40:43], v[168:171], v[8:11], v[40:43]
    v_mfma_f32_16x16x32_bf16 v[44:47], v[224:227], v[8:11], v[44:47]
    ds_read_b128 v[8:11], v2 offset:23552
    s_waitcnt lgkmcnt(2)
    v_mfma_f32_16x16x32_bf16 v[20:23], a[28:31], v[12:15], v[20:23]
    v_mfma_f32_16x16x32_bf16 v[24:27], a[84:87], v[12:15], v[24:27]
    v_mfma_f32_16x16x32_bf16 v[28:31], a[140:143], v[12:15], v[28:31]
    v_mfma_f32_16x16x32_bf16 v[32:35], a[196:199], v[12:15], v[32:35]
    v_mfma_f32_16x16x32_bf16 v[36:39], a[252:255], v[12:15], v[36:39]
    v_mfma_f32_16x16x32_bf16 v[40:43], v[172:175], v[12:15], v[40:43]
    v_mfma_f32_16x16x32_bf16 v[44:47], v[228:231], v[12:15], v[44:47]
    ds_read_b128 v[12:15], v2 offset:24576
    s_waitcnt lgkmcnt(2)
    v_mfma_f32_16x16x32_bf16 v[20:23], a[32:35], v[16:19], v[20:23]
    v_mfma_f32_16x16x32_bf16 v[24:27], a[88:91], v[16:19], v[24:27]
    v_mfma_f32_16x16x32_bf16 v[28:31], a[144:147], v[16:19], v[28:31]
    v_mfma_f32_16x16x32_bf16 v[32:35], a[200:203], v[16:19], v[32:35]
    v_mfma_f32_16x16x32_bf16 v[36:39], v[120:123], v[16:19], v[36:39]
    v_mfma_f32_16x16x32_bf16 v[40:43], v[176:179], v[16:19], v[40:43]
    v_mfma_f32_16x16x32_bf16 v[44:47], v[232:235], v[16:19], v[44:47]
    ds_read_b128 v[16:19], v2 offset:25600
    s_waitcnt lgkmcnt(2)
    v_mfma_f32_16x16x32_bf16 v[20:23], a[36:39], v[8:11], v[20:23]
    v_mfma_f32_16x16x32_bf16 v[24:27], a[92:95], v[8:11], v[24:27]
    v_mfma_f32_16x16x32_bf16 v[28:31], a[148:151], v[8:11], v[28:31]
    v_mfma_f32_16x16x32_bf16 v[32:35], a[204:207], v[8:11], v[32:35]
    v_mfma_f32_16x16x32_bf16 v[36:39], v[124:127], v[8:11], v[36:39]
    v_mfma_f32_16x16x32_bf16 v[40:43], v[180:183], v[8:11], v[40:43]
    v_mfma_f32_16x16x32_bf16 v[44:47], v[236:239], v[8:11], v[44:47]
    ds_read_b128 v[8:11], v2 offset:26624
    s_waitcnt lgkmcnt(2)
    v_mfma_f32_16x16x32_bf16 v[20:23], a[40:43], v[12:15], v[20:23]
    v_mfma_f32_16x16x32_bf16 v[24:27], a[96:99], v[12:15], v[24:27]
    v_mfma_f32_16x16x32_bf16 v[28:31], a[152:155], v[12:15], v[28:31]
    v_mfma_f32_16x16x32_bf16 v[32:35], a[208:211], v[12:15], v[32:35]
    v_mfma_f32_16x16x32_bf16 v[36:39], v[128:131], v[12:15], v[36:39]
    v_mfma_f32_16x16x32_bf16 v[40:43], v[184:187], v[12:15], v[40:43]
    v_mfma_f32_16x16x32_bf16 v[44:47], v[240:243], v[12:15], v[44:47]
    ds_read_b128 v[12:15], v2 offset:27648
    s_waitcnt lgkmcnt(2)
    v_mfma_f32_16x16x32_bf16 v[20:23], a[44:47], v[16:19], v[20:23]
    v_mfma_f32_16x16x32_bf16 v[24:27], a[100:103], v[16:19], v[24:27]
    v_mfma_f32_16x16x32_bf16 v[28:31], a[156:159], v[16:19], v[28:31]
    v_mfma_f32_16x16x32_bf16 v[32:35], a[212:215], v[16:19], v[32:35]
    v_mfma_f32_16x16x32_bf16 v[36:39], v[132:135], v[16:19], v[36:39]
    v_mfma_f32_16x16x32_bf16 v[40:43], v[188:191], v[16:19], v[40:43]
    v_mfma_f32_16x16x32_bf16 v[44:47], v[244:247], v[16:19], v[44:47]
    s_waitcnt lgkmcnt(1)
    v_mfma_f32_16x16x32_bf16 v[20:23], a[48:51], v[8:11], v[20:23]
    v_mfma_f32_16x16x32_bf16 v[24:27], a[104:107], v[8:11], v[24:27]
    v_mfma_f32_16x16x32_bf16 v[28:31], a[160:163], v[8:11], v[28:31]
    v_mfma_f32_16x16x32_bf16 v[32:35], a[216:219], v[8:11], v[32:35]
    v_mfma_f32_16x16x32_bf16 v[36:39], v[136:139], v[8:11], v[36:39]
    v_mfma_f32_16x16x32_bf16 v[40:43], v[192:195], v[8:11], v[40:43]
    v_mfma_f32_16x16x32_bf16 v[44:47], v[248:251], v[8:11], v[44:47]
    s_waitcnt lgkmcnt(0)
    v_mfma_f32_16x16x32_bf16 v[20:23], a[52:55], v[12:15], v[20:23]
    v_mfma_f32_16x16x32_bf16 v[24:27], a[108:111], v[12:15], v[24:27]
    v_mfma_f32_16x16x32_bf16 v[28:31], a[164:167], v[12:15], v[28:31]
    v_mfma_f32_16x16x32_bf16 v[32:35], a[220:223], v[12:15], v[32:35]
    v_mfma_f32_16x16x32_bf16 v[36:39], v[140:143], v[12:15], v[36:39]
    v_mfma_f32_16x16x32_bf16 v[40:43], v[196:199], v[12:15], v[40:43]
    v_mfma_f32_16x16x32_bf16 v[44:47], v[252:255], v[12:15], v[44:47]
    s_nop 7
    v_cvt_pk_bf16_f32 v64, v5, v20
    v_cvt_pk_bf16_f32 v65, v5, v21
    v_cvt_pk_bf16_f32 v66, v5, v22
    v_cvt_pk_bf16_f32 v67, v5, v23
    v_cvt_pk_bf16_f32 v68, v24, v28
    v_cvt_pk_bf16_f32 v69, v25, v29
    v_cvt_pk_bf16_f32 v70, v26, v30
    v_cvt_pk_bf16_f32 v71, v27, v31
    v_cvt_pk_bf16_f32 v72, v32, v36
    v_cvt_pk_bf16_f32 v73, v33, v37
    v_cvt_pk_bf16_f32 v74, v34, v38
    v_cvt_pk_bf16_f32 v75, v35, v39
    v_cvt_pk_bf16_f32 v76, v40, v44
    v_cvt_pk_bf16_f32 v77, v41, v45
    v_cvt_pk_bf16_f32 v78, v42, v46
    v_cvt_pk_bf16_f32 v79, v43, v47
    ds_read_b128 v[80:83], v119 offset:3072
    ds_read_b128 v[84:87], v119 offset:4096
    ds_read_b128 v[88:91], v119 offset:5120
    ds_read_b128 v[92:95], v119 offset:6144
    s_waitcnt lgkmcnt(3)
    v_mfma_f32_16x16x32_bf16 v[20:23], v[80:83], v[48:51], 0
    v_mfma_f32_16x16x32_bf16 v[24:27], v[80:83], v[64:67], 0
    s_waitcnt lgkmcnt(2)
    v_mfma_f32_16x16x32_bf16 v[20:23], v[84:87], v[52:55], v[20:23]
    v_mfma_f32_16x16x32_bf16 v[24:27], v[84:87], v[68:71], v[24:27]
    s_waitcnt lgkmcnt(1)
    v_mfma_f32_16x16x32_bf16 v[20:23], v[88:91], v[56:59], v[20:23]
    v_mfma_f32_16x16x32_bf16 v[24:27], v[88:91], v[72:75], v[24:27]
    s_waitcnt lgkmcnt(0)
    v_mfma_f32_16x16x32_bf16 v[20:23], v[92:95], v[60:63], v[20:23]
    v_mfma_f32_16x16x32_bf16 v[24:27], v[92:95], v[76:79], v[24:27]
    ds_read_b128 v[80:83], v119 offset:17408
    ds_read_b128 v[84:87], v119 offset:18432
    ds_read_b128 v[88:91], v119 offset:19456
    ds_read_b128 v[92:95], v119 offset:20480
    s_waitcnt lgkmcnt(3)
    v_mfma_f32_16x16x32_bf16 v[28:31], v[80:83], v[64:67], 0
    s_waitcnt lgkmcnt(2)
    v_mfma_f32_16x16x32_bf16 v[28:31], v[84:87], v[68:71], v[28:31]
    s_waitcnt lgkmcnt(1)
    v_mfma_f32_16x16x32_bf16 v[28:31], v[88:91], v[72:75], v[28:31]
    s_waitcnt lgkmcnt(0)
    v_mfma_f32_16x16x32_bf16 v[28:31], v[92:95], v[76:79], v[28:31]
    s_nop 7
    ds_write_b128 v1, v[20:23] offset:3072
    ds_write_b128 v1, v[24:27] offset:4096
    ds_write_b128 v1, v[28:31] offset:5120
    s_waitcnt lgkmcnt(0)
    s_barrier
    ds_read_b128 v[20:23], v1 offset:1024
    ds_read_b128 v[24:27], v1 offset:4096
    ds_read_b128 v[28:31], v1 offset:7168
    ds_read_b128 v[32:35], v1 offset:10240
    s_waitcnt lgkmcnt(0)
    v_add_f32 v20, v20, v24
    v_add_f32 v28, v28, v32
    v_add_f32 v21, v21, v25
    v_add_f32 v29, v29, v33
    v_add_f32 v22, v22, v26
    v_add_f32 v30, v30, v34
    v_add_f32 v23, v23, v27
    v_add_f32 v31, v31, v35
    v_add_f32 v96, v20, v28
    v_add_f32 v97, v21, v29
    v_add_f32 v98, v22, v30
    v_add_f32 v99, v23, v31
    ds_read_b128 v[20:23], v1 offset:2048
    ds_read_b128 v[24:27], v1 offset:5120
    ds_read_b128 v[28:31], v1 offset:8192
    ds_read_b128 v[32:35], v1 offset:11264
    s_waitcnt lgkmcnt(0)
    v_add_f32 v20, v20, v24
    v_add_f32 v28, v28, v32
    v_add_f32 v21, v21, v25
    v_add_f32 v29, v29, v33
    v_add_f32 v22, v22, v26
    v_add_f32 v30, v30, v34
    v_add_f32 v23, v23, v27
    v_add_f32 v31, v31, v35
    v_add_f32 v100, v20, v28
    v_add_f32 v101, v21, v29
    v_add_f32 v102, v22, v30
    v_add_f32 v103, v23, v31
    v_cndmask_b32 v100, v6, v100, s[40:41]
    v_cndmask_b32 v101, v6, v101, s[42:43]
    v_cndmask_b32 v102, v6, v102, s[44:45]
    v_cndmask_b32 v103, v6, v103, s[46:47]
    s_lshl_b32 s11, s17, 13
    s_add_u32 s11, s11, 0x3080600
    s_mov_b32 s22, 0
spin_648:
    buffer_load_dwordx2 v[80:81], v4, s[4:7], s11 offen offset:0 sc1
    buffer_load_dwordx2 v[82:83], v4, s[4:7], s11 offen offset:32 sc1
    buffer_load_dwordx2 v[84:85], v4, s[4:7], s11 offen offset:512 sc1
    buffer_load_dwordx2 v[86:87], v4, s[4:7], s11 offen offset:544 sc1
    buffer_load_dwordx2 v[88:89], v4, s[4:7], s11 offen offset:1024 sc1
    buffer_load_dwordx2 v[90:91], v4, s[4:7], s11 offen offset:1056 sc1
    buffer_load_dwordx2 v[92:93], v4, s[4:7], s11 offen offset:1536 sc1
    buffer_load_dwordx2 v[94:95], v4, s[4:7], s11 offen offset:1568 sc1
    s_waitcnt vmcnt(0)
spin2_650:
    v_max3_u32 v3, v80, v81, v82
    v_max3_u32 v3, v3, v83, v84
    v_max3_u32 v3, v3, v85, v86
    v_max3_u32 v3, v3, v87, v88
    v_max3_u32 v3, v3, v89, v90
    v_max3_u32 v3, v3, v91, v92
    v_max3_u32 v3, v3, v93, v94
    v_max_u32 v3, v3, v95
    v_cmp_eq_u32 vcc, -1, v3
    s_cbranch_vccz spok_649
    s_add_u32 s22, s22, 1
    s_cmp_gt_u32 s22, 65536
    s_cbranch_scc1 M_exit
    s_sleep 1
    s_branch spin_648
spok_649:
    v_swap_b32 v81, v82
    v_swap_b32 v85, v86
    v_swap_b32 v89, v90
    v_swap_b32 v93, v94
    s_nop 1
    v_mfma_f32_16x16x32_bf16 v[20:23], v[80:83], v[48:51], 0
    v_mfma_f32_16x16x32_bf16 v[24:27], v[80:83], v[64:67], 0
    v_mfma_f32_16x16x32_bf16 v[20:23], v[84:87], v[52:55], v[20:23]
    v_mfma_f32_16x16x32_bf16 v[24:27], v[84:87], v[68:71], v[24:27]
    v_mfma_f32_16x16x32_bf16 v[20:23], v[88:91], v[56:59], v[20:23]
    v_mfma_f32_16x16x32_bf16 v[24:27], v[88:91], v[72:75], v[24:27]
    v_mfma_f32_16x16x32_bf16 v[20:23], v[92:95], v[60:63], v[20:23]
    v_mfma_f32_16x16x32_bf16 v[24:27], v[92:95], v[76:79], v[24:27]
    s_nop 7
    ds_write_b64 v1, v[20:21] offset:13312
    ds_write_b64 v1, v[24:25] offset:13320
    s_waitcnt lgkmcnt(0)
    s_barrier
    ds_read_b64 v[20:21], v1 offset:12296
    ds_read_b64 v[22:23], v1 offset:13320
    ds_read_b64 v[24:25], v1 offset:14344
    ds_read_b64 v[26:27], v1 offset:15368
    s_mul_i32 s11, s17, 40960
    s_lshr_b32 s12, s9, 2
    s_mul_i32 s12, s12, 10240
    s_add_u32 s11, s11, s12
    s_add_u32 s11, s11, 0x3120400
    s_add_u32 s13, s11, 8192
    s_and_b32 s12, s9, 3
    s_lshl_b32 s12, s12, 11
    s_add_u32 s11, s11, s12
    v_max3_f32 v104, v96, v97, v98
    v_max3_f32 v104, v104, v99, v100
    v_max3_f32 v104, v104, v101, v102
    v_max_f32 v104, v104, v103
    s_waitcnt lgkmcnt(0)
    v_add_f32 v20, v20, v22
    v_add_f32 v24, v24, v26
    v_add_f32 v21, v21, v23
    v_add_f32 v25, v25, v27
    v_add_f32 v20, v20, v24
    v_add_f32 v21, v21, v25
    v_max3_f32 v104, v104, v20, v21
    v_mov_b32 v106, v104
    s_nop 1
    v_permlane32_swap_b32 v104, v106
    v_max_f32 v104, v104, v106
    v_mov_b32 v106, v104
    s_nop 1
    v_permlane16_swap_b32 v104, v106
    v_max_f32 v104, v104, v106
    v_sub_f32 v96, v96, v104
    v_sub_f32 v97, v97, v104
    v_sub_f32 v98, v98, v104
    v_sub_f32 v99, v99, v104
    v_sub_f32 v100, v100, v104
    v_sub_f32 v101, v101, v104
    v_sub_f32 v102, v102, v104
    v_sub_f32 v103, v103, v104
    v_sub_f32 v20, v20, v104
    v_sub_f32 v21, v21, v104
    v_exp_f32 v96, v96
    v_exp_f32 v97, v97
    v_exp_f32 v98, v98
    v_exp_f32 v99, v99
    v_exp_f32 v100, v100
    v_exp_f32 v101, v101
    v_exp_f32 v102, v102
    v_exp_f32 v103, v103
    v_exp_f32 v20, v20
    v_exp_f32 v21, v21
    v_add_f32 v105, v96, v97
    v_add_f32 v105, v105, v98
    v_add_f32 v105, v105, v99
    v_add_f32 v105, v105, v100
    v_add_f32 v105, v105, v101
    v_add_f32 v105, v105, v102
    v_add_f32 v105, v105, v103
    v_add_f32 v105, v105, v20
    v_add_f32 v105, v105, v21
    v_mov_b32 v106, v105
    s_nop 1
    v_permlane32_swap_b32 v105, v106
    v_add_f32 v105, v105, v106
    v_mov_b32 v106, v105
    s_nop 1
    v_permlane16_swap_b32 v105, v106
    v_add_f32 v105, v105, v106
    v_rcp_f32 v105, v105
    s_nop 0
    v_mul_f32 v96, v96, v105
    v_mul_f32 v97, v97, v105
    v_mul_f32 v98, v98, v105
    v_mul_f32 v99, v99, v105
    v_mul_f32 v100, v100, v105
    v_mul_f32 v101, v101, v105
    v_mul_f32 v102, v102, v105
    v_mul_f32 v103, v103, v105
    v_mul_f32 v20, v20, v105
    v_mul_f32 v21, v21, v105
    v_cvt_pk_bf16_f32 v108, v96, v100
    v_min_u32 v108, -2, v108
    v_cvt_pk_bf16_f32 v109, v97, v101
    v_min_u32 v109, -2, v109
    v_cvt_pk_bf16_f32 v110, v98, v102
    v_min_u32 v110, -2, v110
    v_cvt_pk_bf16_f32 v111, v99, v103
    v_min_u32 v111, -2, v111
    v_cvt_pk_bf16_f32 v112, v20, v21
    v_min_u32 v112, -2, v112
    buffer_store_dwordx4 v[108:111], v1, s[4:7], s11 offen sc1
    buffer_store_dword v112, v7, s[4:7], s13 offen sc1
    s_add_u32 s17, s17, 4
    s_cmp_lt_u32 s17, 64
    s_cbranch_scc1 sx_loop_645
    s_branch M_exit
sx_w2_629:
    v_and_b32 v0, 63, v0
    v_lshlrev_b32 v1, 4, v0
    v_mov_b32 v5, 0
    v_mov_b32 v6, 0xff800000
    v_lshrrev_b32 v3, 4, v0
    v_lshrrev_b32 v104, 5, v0
    v_lshlrev_b32 v4, 8, v104
    v_and_b32 v104, 13, v0
    v_lshl_add_u32 v4, v104, 4, v4
    v_bfe_u32 v104, v0, 4, 1
    v_lshl_add_u32 v4, v104, 3, v4
    v_and_b32 v118, 0x38, v0
    v_and_b32 v104, 1, v0
    v_lshl_add_u32 v118, v104, 2, v118
    v_bfe_u32 v104, v0, 1, 2
    v_add_u32 v118, v118, v104
    v_lshlrev_b32 v118, 4, v118
    v_lshrrev_b32 v104, 5, v0
    v_lshlrev_b32 v3, 3, v104
    v_bfe_u32 v104, v0, 4, 1
    v_lshl_add_u32 v3, v104, 1, v3
    v_and_b32 v104, 15, v0
    v_add_u32 v105, 0, v3
    v_cmp_le_u32 s[40:41], v105, v104
    v_add_u32 v105, 4, v3
    v_cmp_le_u32 s[42:43], v105, v104
    v_add_u32 v105, 1, v3
    v_cmp_le_u32 s[44:45], v105, v104
    v_add_u32 v105, 5, v3
    v_cmp_le_u32 s[46:47], v105, v104
    s_and_b32 s11, s9, 3
    s_lshl_b32 s11, s11, 8
    v_and_b32 v104, 15, v0
    v_lshlrev_b32 v7, 4, v104
    v_lshrrev_b32 v104, 4, v0
    v_lshl_add_u32 v7, v104, 2, v7
    v_add_u32 v7, s11, v7
    s_mov_b32 s18, 20480
    s_mov_b32 s11, 0x3b03000
    v_min_u32 v8, 0, v0
    v_lshlrev_b32 v8, 4, v8
    s_mov_b32 s22, 0
wt_651:
    buffer_load_dwordx4 v[20:23], v8, s[4:7], s11 offen offset:0 sc1
    s_waitcnt vmcnt(0)
    v_xor_b32 v20, s80, v20
    v_xor_b32 v21, s81, v21
    v_and_b32 v21, -16, v21
    v_xor_b32 v22, s80, v22
    v_xor_b32 v23, s81, v23
    v_and_b32 v23, -16, v23
    v_or3_b32 v20, v20, v21, v22
    v_or_b32 v20, v20, v23
    v_cmp_ne_u32 vcc, 0, v20
    s_cbranch_vccz wtok_652
    s_add_u32 s22, s22, 1
    s_cmp_gt_u32 s22, 65536
    s_cbranch_scc1 M_exit
    s_sleep 16
    s_branch wt_651
wtok_652:
    s_mul_i32 s13, s15, 28672
    s_mul_i32 s14, s10, 7168
    s_add_u32 s13, s13, s14
    s_add_u32 m0, s18, s14
    s_nop 0
    buffer_load_dwordx4 v1, s[4:7], s13 offen offset:0 sc1 lds
    buffer_load_dwordx4 v1, s[4:7], s13 offen offset:1024 sc1 lds
    buffer_load_dwordx4 v1, s[4:7], s13 offen offset:2048 sc1 lds
    buffer_load_dwordx4 v1, s[4:7], s13 offen offset:3072 sc1 lds
    s_add_u32 m0, m0, 4096
    s_add_u32 s13, s13, 4096
    buffer_load_dwordx4 v1, s[4:7], s13 offen offset:0 sc1 lds
    buffer_load_dwordx4 v1, s[4:7], s13 offen offset:1024 sc1 lds
    buffer_load_dwordx4 v1, s[4:7], s13 offen offset:2048 sc1 lds
    s_mul_i32 s11, s9, 401408
    s_add_u32 s12, s11, 0x231000
    s_add_u32 s14, s12, 0
    buffer_load_dwordx4 a[0:3], v1, s[4:7], s14 offen offset:0 sc1
    buffer_load_dwordx4 a[4:7], v1, s[4:7], s14 offen offset:1024 sc1
    buffer_load_dwordx4 a[8:11], v1, s[4:7], s14 offen offset:2048 sc1
    buffer_load_dwordx4 a[12:15], v1, s[4:7], s14 offen offset:3072 sc1
    s_add_u32 s14, s12, 4096
    buffer_load_dwordx4 a[16:19], v1, s[4:7], s14 offen offset:0 sc1
    buffer_load_dwordx4 a[20:23], v1, s[4:7], s14 offen offset:1024 sc1
    buffer_load_dwordx4 a[24:27], v1, s[4:7], s14 offen offset:2048 sc1
    buffer_load_dwordx4 a[28:31], v1, s[4:7], s14 offen offset:3072 sc1
    s_add_u32 s14, s12, 8192
    buffer_load_dwordx4 a[32:35], v1, s[4:7], s14 offen offset:0 sc1
    buffer_load_dwordx4 a[36:39], v1, s[4:7], s14 offen offset:1024 sc1
    buffer_load_dwordx4 a[40:43], v1, s[4:7], s14 offen offset:2048 sc1
    buffer_load_dwordx4 a[44:47], v1, s[4:7], s14 offen offset:3072 sc1
    s_add_u32 s14, s12, 12288
    buffer_load_dwordx4 a[48:51], v1, s[4:7], s14 offen offset:0 sc1
    buffer_load_dwordx4 a[52:55], v1, s[4:7], s14 offen offset:1024 sc1
    s_add_u32 s12, s11, 0x234800
    s_add_u32 s14, s12, 0
    buffer_load_dwordx4 a[56:59], v1, s[4:7], s14 offen offset:0 sc1
    buffer_load_dwordx4 a[60:63], v1, s[4:7], s14 offen offset:1024 sc1
    buffer_load_dwordx4 a[64:67], v1, s[4:7], s14 offen offset:2048 sc1
    buffer_load_dwordx4 a[68:71], v1, s[4:7], s14 offen offset:3072 sc1
    s_add_u32 s14, s12, 4096
    buffer_load_dwordx4 a[72:75], v1, s[4:7], s14 offen offset:0 sc1
    buffer_load_dwordx4 a[76:79], v1, s[4:7], s14 offen offset:1024 sc1
    buffer_load_dwordx4 a[80:83], v1, s[4:7], s14 offen offset:2048 sc1
    buffer_load_dwordx4 a[84:87], v1, s[4:7], s14 offen offset:3072 sc1
    s_add_u32 s14, s12, 8192
    buffer_load_dwordx4 a[88:91], v1, s[4:7], s14 offen offset:0 sc1
    buffer_load_dwordx4 a[92:95], v1, s[4:7], s14 offen offset:1024 sc1
    buffer_load_dwordx4 a[96:99], v1, s[4:7], s14 offen offset:2048 sc1
    buffer_load_dwordx4 a[100:103], v1, s[4:7], s14 offen offset:3072 sc1
    s_add_u32 s14, s12, 12288
    buffer_load_dwordx4 a[104:107], v1, s[4:7], s14 offen offset:0 sc1
    buffer_load_dwordx4 a[108:111], v1, s[4:7], s14 offen offset:1024 sc1
    s_add_u32 s12, s11, 0x238000
    s_add_u32 s14, s12, 0
    buffer_load_dwordx4 a[112:115], v1, s[4:7], s14 offen offset:0 sc1
    buffer_load_dwordx4 a[116:119], v1, s[4:7], s14 offen offset:1024 sc1
    buffer_load_dwordx4 a[120:123], v1, s[4:7], s14 offen offset:2048 sc1
    buffer_load_dwordx4 a[124:127], v1, s[4:7], s14 offen offset:3072 sc1
    s_add_u32 s14, s12, 4096
    buffer_load_dwordx4 a[128:131], v1, s[4:7], s14 offen offset:0 sc1
    buffer_load_dwordx4 a[132:135], v1, s[4:7], s14 offen offset:1024 sc1
    buffer_load_dwordx4 a[136:139], v1, s[4:7], s14 offen offset:2048 sc1
    buffer_load_dwordx4 a[140:143], v1, s[4:7], s14 offen offset:3072 sc1
    s_add_u32 s14, s12, 8192
    buffer_load_dwordx4 a[144:147], v1, s[4:7], s14 offen offset:0 sc1
    buffer_load_dwordx4 a[148:151], v1, s[4:7], s14 offen offset:1024 sc1
    buffer_load_dwordx4 a[152:155], v1, s[4:7], s14 offen offset:2048 sc1
    buffer_load_dwordx4 a[156:159], v1, s[4:7], s14 offen offset:3072 sc1
    s_add_u32 s14, s12, 12288
    buffer_load_dwordx4 a[160:163], v1, s[4:7], s14 offen offset:0 sc1
    buffer_load_dwordx4 a[164:167], v1, s[4:7], s14 offen offset:1024 sc1
    s_waitcnt vmcnt(46)
    s_add_u32 s12, s11, 0x23b800
    s_add_u32 s14, s12, 0
    buffer_load_dwordx4 a[168:171], v1, s[4:7], s14 offen offset:0 sc1
    buffer_load_dwordx4 a[172:175], v1, s[4:7], s14 offen offset:1024 sc1
    buffer_load_dwordx4 a[176:179], v1, s[4:7], s14 offen offset:2048 sc1
    buffer_load_dwordx4 a[180:183], v1, s[4:7], s14 offen offset:3072 sc1
    s_add_u32 s14, s12, 4096
    buffer_load_dwordx4 a[184:187], v1, s[4:7], s14 offen offset:0 sc1
    buffer_load_dwordx4 a[188:191], v1, s[4:7], s14 offen offset:1024 sc1
    buffer_load_dwordx4 a[192:195], v1, s[4:7], s14 offen offset:2048 sc1
    buffer_load_dwordx4 a[196:199], v1, s[4:7], s14 offen offset:3072 sc1
    s_add_u32 s14, s12, 8192
    buffer_load_dwordx4 a[200:203], v1, s[4:7], s14 offen offset:0 sc1
    buffer_load_dwordx4 a[204:207], v1, s[4:7], s14 offen offset:1024 sc1
    buffer_load_dwordx4 a[208:211], v1, s[4:7], s14 offen offset:2048 sc1
    buffer_load_dwordx4 a[212:215], v1, s[4:7], s14 offen offset:3072 sc1
    s_add_u32 s14, s12, 12288
    buffer_load_dwordx4 a[216:219], v1, s[4:7], s14 offen offset:0 sc1
    buffer_load_dwordx4 a[220:223], v1, s[4:7], s14 offen offset:1024 sc1
    s_waitcnt vmcnt(46)
    s_add_u32 s12, s11, 0x23f000
    s_add_u32 s14, s12, 0
    buffer_load_dwordx4 a[224:227], v1, s[4:7], s14 offen offset:0 sc1
    buffer_load_dwordx4 a[228:231], v1, s[4:7], s14 offen offset:1024 sc1
    buffer_load_dwordx4 a[232:235], v1, s[4:7], s14 offen offset:2048 sc1
    buffer_load_dwordx4 a[236:239], v1, s[4:7], s14 offen offset:3072 sc1
    s_add_u32 s14, s12, 4096
    buffer_load_dwordx4 a[240:243], v1, s[4:7], s14 offen offset:0 sc1
    buffer_load_dwordx4 a[244:247], v1, s[4:7], s14 offen offset:1024 sc1
    buffer_load_dwordx4 a[248:251], v1, s[4:7], s14 offen offset:2048 sc1
    buffer_load_dwordx4 a[252:255], v1, s[4:7], s14 offen offset:3072 sc1
    s_add_u32 s14, s12, 8192
    buffer_load_dwordx4 v[120:123], v1, s[4:7], s14 offen offset:0 sc1
    buffer_load_dwordx4 v[124:127], v1, s[4:7], s14 offen offset:1024 sc1
    buffer_load_dwordx4 v[128:131], v1, s[4:7], s14 offen offset:2048 sc1
    buffer_load_dwordx4 v[132:135], v1, s[4:7], s14 offen offset:3072 sc1
    s_add_u32 s14, s12, 12288
    buffer_load_dwordx4 v[136:139], v1, s[4:7], s14 offen offset:0 sc1
    buffer_load_dwordx4 v[140:143], v1, s[4:7], s14 offen offset:1024 sc1
    s_waitcnt vmcnt(46)
    s_add_u32 s12, s11, 0x242800
    s_add_u32 s14, s12, 0
    buffer_load_dwordx4 v[144:147], v1, s[4:7], s14 offen offset:0 sc1
    buffer_load_dwordx4 v[148:151], v1, s[4:7], s14 offen offset:1024 sc1
    buffer_load_dwordx4 v[152:155], v1, s[4:7], s14 offen offset:2048 sc1
    buffer_load_dwordx4 v[156:159], v1, s[4:7], s14 offen offset:3072 sc1
    s_add_u32 s14, s12, 4096
    buffer_load_dwordx4 v[160:163], v1, s[4:7], s14 offen offset:0 sc1
    buffer_load_dwordx4 v[164:167], v1, s[4:7], s14 offen offset:1024 sc1
    buffer_load_dwordx4 v[168:171], v1, s[4:7], s14 offen offset:2048 sc1
    buffer_load_dwordx4 v[172:175], v1, s[4:7], s14 offen offset:3072 sc1
    s_add_u32 s14, s12, 8192
    buffer_load_dwordx4 v[176:179], v1, s[4:7], s14 offen offset:0 sc1
    buffer_load_dwordx4 v[180:183], v1, s[4:7], s14 offen offset:1024 sc1
    buffer_load_dwordx4 v[184:187], v1, s[4:7], s14 offen offset:2048 sc1
    buffer_load_dwordx4 v[188:191], v1, s[4:7], s14 offen offset:3072 sc1
    s_add_u32 s14, s12, 12288
    buffer_load_dwordx4 v[192:195], v1, s[4:7], s14 offen offset:0 sc1
    buffer_load_dwordx4 v[196:199], v1, s[4:7], s14 offen offset:1024 sc1
    s_waitcnt vmcnt(46)
    s_add_u32 s12, s11, 0x246000
    s_add_u32 s14, s12, 0
    buffer_load_dwordx4 v[200:203], v1, s[4:7], s14 offen offset:0 sc1
    buffer_load_dwordx4 v[204:207], v1, s[4:7], s14 offen offset:1024 sc1
    buffer_load_dwordx4 v[208:211], v1, s[4:7], s14 offen offset:2048 sc1
    buffer_load_dwordx4 v[212:215], v1, s[4:7], s14 offen offset:3072 sc1
    s_add_u32 s14, s12, 4096
    buffer_load_dwordx4 v[216:219], v1, s[4:7], s14 offen offset:0 sc1
    buffer_load_dwordx4 v[220:223], v1, s[4:7], s14 offen offset:1024 sc1
    buffer_load_dwordx4 v[224:227], v1, s[4:7], s14 offen offset:2048 sc1
    buffer_load_dwordx4 v[228:231], v1, s[4:7], s14 offen offset:3072 sc1
    s_add_u32 s14, s12, 8192
    buffer_load_dwordx4 v[232:235], v1, s[4:7], s14 offen offset:0 sc1
    buffer_load_dwordx4 v[236:239], v1, s[4:7], s14 offen offset:1024 sc1
    buffer_load_dwordx4 v[240:243], v1, s[4:7], s14 offen offset:2048 sc1
    buffer_load_dwordx4 v[244:247], v1, s[4:7], s14 offen offset:3072 sc1
    s_add_u32 s14, s12, 12288
    buffer_load_dwordx4 v[248:251], v1, s[4:7], s14 offen offset:0 sc1
    buffer_load_dwordx4 v[252:255], v1, s[4:7], s14 offen offset:1024 sc1
    s_waitcnt vmcnt(46)
    s_mov_b32 s11, 0x3b02800
    v_min_u32 v8, 51, v0
    v_lshlrev_b32 v8, 4, v8
    s_mov_b32 s22, 0
wt_653:
    buffer_load_dwordx4 v[20:23], v8, s[4:7], s11 offen offset:0 sc1
    s_waitcnt vmcnt(0)
    v_xor_b32 v20, s80, v20
    v_xor_b32 v21, s81, v21
    v_and_b32 v21, -16, v21
    v_xor_b32 v22, s80, v22
    v_xor_b32 v23, s81, v23
    v_and_b32 v23, -16, v23
    v_or3_b32 v20, v20, v21, v22
    v_or_b32 v20, v20, v23
    v_cmp_ne_u32 vcc, 0, v20
    s_cbranch_vccz wtok_654
    s_add_u32 s22, s22, 1
    s_cmp_gt_u32 s22, 65536
    s_cbranch_scc1 M_exit
    s_sleep 16
    s_branch wt_653
wtok_654:
    s_mov_b32 s17, s15
    s_waitcnt vmcnt(0)
sx_loop_655:
    s_barrier
    v_add_u32 v2, s18, v1
    v_add_u32 v119, s18, v118
    s_sub_u32 s18, 69632, s18
    s_add_u32 s11, s17, 4
    s_min_u32 s11, s11, 63
    s_mul_i32 s13, s11, 28672
    s_mul_i32 s14, s10, 7168
    s_add_u32 s13, s13, s14
    s_add_u32 m0, s18, s14
    s_nop 0
    ds_read_b128 v[8:11], v2 offset:0
    ds_read_b128 v[12:15], v2 offset:1024
    ds_read_b128 v[16:19], v2 offset:2048
    s_waitcnt lgkmcnt(2)
    v_mfma_f32_16x16x32_bf16 v[20:23], a[0:3], v[8:11], 0
    buffer_load_dwordx4 v1, s[4:7], s13 offen offset:0 sc1 lds
    v_mfma_f32_16x16x32_bf16 v[24:27], a[56:59], v[8:11], 0
    v_mfma_f32_16x16x32_bf16 v[28:31], a[112:115], v[8:11], 0
    v_mfma_f32_16x16x32_bf16 v[32:35], a[168:171], v[8:11], 0
    v_mfma_f32_16x16x32_bf16 v[36:39], a[224:227], v[8:11], 0
    v_mfma_f32_16x16x32_bf16 v[40:43], v[144:147], v[8:11], 0
    v_mfma_f32_16x16x32_bf16 v[44:47], v[200:203], v[8:11], 0
    ds_read_b128 v[8:11], v2 offset:3072
    s_waitcnt lgkmcnt(2)
    v_mfma_f32_16x16x32_bf16 v[20:23], a[4:7], v[12:15], v[20:23]
    buffer_load_dwordx4 v1, s[4:7], s13 offen offset:1024 sc1 lds
    v_mfma_f32_16x16x32_bf16 v[24:27], a[60:63], v[12:15], v[24:27]
    v_mfma_f32_16x16x32_bf16 v[28:31], a[116:119], v[12:15], v[28:31]
    v_mfma_f32_16x16x32_bf16 v[32:35], a[172:175], v[12:15], v[32:35]
    v_mfma_f32_16x16x32_bf16 v[36:39], a[228:231], v[12:15], v[36:39]
    v_mfma_f32_16x16x32_bf16 v[40:43], v[148:151], v[12:15], v[40:43]
    v_mfma_f32_16x16x32_bf16 v[44:47], v[204:207], v[12:15], v[44:47]
    ds_read_b128 v[12:15], v2 offset:4096
    s_waitcnt lgkmcnt(2)
    v_mfma_f32_16x16x32_bf16 v[20:23], a[8:11], v[16:19], v[20:23]
    buffer_load_dwordx4 v1, s[4:7], s13 offen offset:2048 sc1 lds
    v_mfma_f32_16x16x32_bf16 v[24:27], a[64:67], v[16:19], v[24:27]
    v_mfma_f32_16x16x32_bf16 v[28:31], a[120:123], v[16:19], v[28:31]
    v_mfma_f32_16x16x32_bf16 v[32:35], a[176:179], v[16:19], v[32:35]
    v_mfma_f32_16x16x32_bf16 v[36:39], a[232:235], v[16:19], v[36:39]
    v_mfma_f32_16x16x32_bf16 v[40:43], v[152:155], v[16:19], v[40:43]
    v_mfma_f32_16x16x32_bf16 v[44:47], v[208:211], v[16:19], v[44:47]
    ds_read_b128 v[16:19], v2 offset:5120
    s_waitcnt lgkmcnt(2)
    v_mfma_f32_16x16x32_bf16 v[20:23], a[12:15], v[8:11], v[20:23]
    buffer_load_dwordx4 v1, s[4:7], s13 offen offset:3072 sc1 lds
    s_add_u32 m0, m0, 4096
    s_add_u32 s13, s13, 4096
    v_mfma_f32_16x16x32_bf16 v[24:27], a[68:71], v[8:11], v[24:27]
    v_mfma_f32_16x16x32_bf16 v[28:31], a[124:127], v[8:11], v[28:31]
    v_mfma_f32_16x16x32_bf16 v[32:35], a[180:183], v[8:11], v[32:35]
    v_mfma_f32_16x16x32_bf16 v[36:39], a[236:239], v[8:11], v[36:39]
    v_mfma_f32_16x16x32_bf16 v[40:43], v[156:159], v[8:11], v[40:43]
    v_mfma_f32_16x16x32_bf16 v[44:47], v[212:215], v[8:11], v[44:47]
    ds_read_b128 v[8:11], v2 offset:6144
    s_waitcnt lgkmcnt(2)
    v_mfma_f32_16x16x32_bf16 v[20:23], a[16:19], v[12:15], v[20:23]
    buffer_load_dwordx4 v1, s[4:7], s13 offen offset:0 sc1 lds
    v_mfma_f32_16x16x32_bf16 v[24:27], a[72:75], v[12:15], v[24:27]
    v_mfma_f32_16x16x32_bf16 v[28:31], a[128:131], v[12:15], v[28:31]
    v_mfma_f32_16x16x32_bf16 v[32:35], a[184:187], v[12:15], v[32:35]
    v_mfma_f32_16x16x32_bf16 v[36:39], a[240:243], v[12:15], v[36:39]
    v_mfma_f32_16x16x32_bf16 v[40:43], v[160:163], v[12:15], v[40:43]
    v_mfma_f32_16x16x32_bf16 v[44:47], v[216:219], v[12:15], v[44:47]
    ds_read_b128 v[12:15], v2 offset:7168
    s_waitcnt lgkmcnt(2)
    v_mfma_f32_16x16x32_bf16 v[20:23], a[20:23], v[16:19], v[20:23]
    buffer_load_dwordx4 v1, s[4:7], s13 offen offset:1024 sc1 lds
    v_mfma_f32_16x16x32_bf16 v[24:27], a[76:79], v[16:19], v[24:27]
    v_mfma_f32_16x16x32_bf16 v[28:31], a[132:135], v[16:19], v[28:31]
    v_mfma_f32_16x16x32_bf16 v[32:35], a[188:191], v[16:19], v[32:35]
    v_mfma_f32_16x16x32_bf16 v[36:39], a[244:247], v[16:19], v[36:39]
    v_mfma_f32_16x16x32_bf16 v[40:43], v[164:167], v[16:19], v[40:43]
    v_mfma_f32_16x16x32_bf16 v[44:47], v[220:223], v[16:19], v[44:47]
    ds_read_b128 v[16:19], v2 offset:8192
    s_waitcnt lgkmcnt(2)
    v_mfma_f32_16x16x32_bf16 v[20:23], a[24:27], v[8:11], v[20:23]
    buffer_load_dwordx4 v1, s[4:7], s13 offen offset:2048 sc1 lds
    v_mfma_f32_16x16x32_bf16 v[24:27], a[80:83], v[8:11], v[24:27]
    v_mfma_f32_16x16x32_bf16 v[28:31], a[136:139], v[8:11], v[28:31]
    v_mfma_f32_16x16x32_bf16 v[32:35], a[192:195], v[8:11], v[32:35]
    v_mfma_f32_16x16x32_bf16 v[36:39], a[248:251], v[8:11], v[36:39]
    v_mfma_f32_16x16x32_bf16 v[40:43], v[168:171], v[8:11], v[40:43]
    v_mfma_f32_16x16x32_bf16 v[44:47], v[224:227], v[8:11], v[44:47]
    ds_read_b128 v[8:11], v2 offset:9216
    s_waitcnt lgkmcnt(2)
    v_mfma_f32_16x16x32_bf16 v[20:23], a[28:31], v[12:15], v[20:23]
    v_mfma_f32_16x16x32_bf16 v[24:27], a[84:87], v[12:15], v[24:27]
    v_mfma_f32_16x16x32_bf16 v[28:31], a[140:143], v[12:15], v[28:31]
    v_mfma_f32_16x16x32_bf16 v[32:35], a[196:199], v[12:15], v[32:35]
    v_mfma_f32_16x16x32_bf16 v[36:39], a[252:255], v[12:15], v[36:39]
    v_mfma_f32_16x16x32_bf16 v[40:43], v[172:175], v[12:15], v[40:43]
    v_mfma_f32_16x16x32_bf16 v[44:47], v[228:231], v[12:15], v[44:47]
    ds_read_b128 v[12:15], v2 offset:10240
    s_waitcnt lgkmcnt(2)
    v_mfma_f32_16x16x32_bf16 v[20:23], a[32:35], v[16:19], v[20:23]
    v_mfma_f32_16x16x32_bf16 v[24:27], a[88:91], v[16:19], v[24:27]
    v_mfma_f32_16x16x32_bf16 v[28:31], a[144:147], v[16:19], v[28:31]
    v_mfma_f32_16x16x32_bf16 v[32:35], a[200:203], v[16:19], v[32:35]
    v_mfma_f32_16x16x32_bf16 v[36:39], v[120:123], v[16:19], v[36:39]
    v_mfma_f32_16x16x32_bf16 v[40:43], v[176:179], v[16:19], v[40:43]
    v_mfma_f32_16x16x32_bf16 v[44:47], v[232:235], v[16:19], v[44:47]
    ds_read_b128 v[16:19], v2 offset:11264
    s_waitcnt lgkmcnt(2)
    v_mfma_f32_16x16x32_bf16 v[20:23], a[36:39], v[8:11], v[20:23]
    v_mfma_f32_16x16x32_bf16 v[24:27], a[92:95], v[8:11], v[24:27]
    v_mfma_f32_16x16x32_bf16 v[28:31], a[148:151], v[8:11], v[28:31]
    v_mfma_f32_16x16x32_bf16 v[32:35], a[204:207], v[8:11], v[32:35]
    v_mfma_f32_16x16x32_bf16 v[36:39], v[124:127], v[8:11], v[36:39]
    v_mfma_f32_16x16x32_bf16 v[40:43], v[180:183], v[8:11], v[40:43]
    v_mfma_f32_16x16x32_bf16 v[44:47], v[236:239], v[8:11], v[44:47]
    ds_read_b128 v[8:11], v2 offset:12288
    s_waitcnt lgkmcnt(2)
    v_mfma_f32_16x16x32_bf16 v[20:23], a[40:43], v[12:15], v[20:23]
    v_mfma_f32_16x16x32_bf16 v[24:27], a[96:99], v[12:15], v[24:27]
    v_mfma_f32_16x16x32_bf16 v[28:31], a[152:155], v[12:15], v[28:31]
    v_mfma_f32_16x16x32_bf16 v[32:35], a[208:211], v[12:15], v[32:35]
    v_mfma_f32_16x16x32_bf16 v[36:39], v[128:131], v[12:15], v[36:39]
    v_mfma_f32_16x16x32_bf16 v[40:43], v[184:187], v[12:15], v[40:43]
    v_mfma_f32_16x16x32_bf16 v[44:47], v[240:243], v[12:15], v[44:47]
    ds_read_b128 v[12:15], v2 offset:13312
    s_waitcnt lgkmcnt(2)
    v_mfma_f32_16x16x32_bf16 v[20:23], a[44:47], v[16:19], v[20:23]
    v_mfma_f32_16x16x32_bf16 v[24:27], a[100:103], v[16:19], v[24:27]
    v_mfma_f32_16x16x32_bf16 v[28:31], a[156:159], v[16:19], v[28:31]
    v_mfma_f32_16x16x32_bf16 v[32:35], a[212:215], v[16:19], v[32:35]
    v_mfma_f32_16x16x32_bf16 v[36:39], v[132:135], v[16:19], v[36:39]
    v_mfma_f32_16x16x32_bf16 v[40:43], v[188:191], v[16:19], v[40:43]
    v_mfma_f32_16x16x32_bf16 v[44:47], v[244:247], v[16:19], v[44:47]
    s_waitcnt lgkmcnt(1)
    v_mfma_f32_16x16x32_bf16 v[20:23], a[48:51], v[8:11], v[20:23]
    v_mfma_f32_16x16x32_bf16 v[24:27], a[104:107], v[8:11], v[24:27]
    v_mfma_f32_16x16x32_bf16 v[28:31], a[160:163], v[8:11], v[28:31]
    v_mfma_f32_16x16x32_bf16 v[32:35], a[216:219], v[8:11], v[32:35]
    v_mfma_f32_16x16x32_bf16 v[36:39], v[136:139], v[8:11], v[36:39]
    v_mfma_f32_16x16x32_bf16 v[40:43], v[192:195], v[8:11], v[40:43]
    v_mfma_f32_16x16x32_bf16 v[44:47], v[248:251], v[8:11], v[44:47]
    s_waitcnt lgkmcnt(0)
    v_mfma_f32_16x16x32_bf16 v[20:23], a[52:55], v[12:15], v[20:23]
    v_mfma_f32_16x16x32_bf16 v[24:27], a[108:111], v[12:15], v[24:27]
    v_mfma_f32_16x16x32_bf16 v[28:31], a[164:167], v[12:15], v[28:31]
    v_mfma_f32_16x16x32_bf16 v[32:35], a[220:223], v[12:15], v[32:35]
    v_mfma_f32_16x16x32_bf16 v[36:39], v[140:143], v[12:15], v[36:39]
    v_mfma_f32_16x16x32_bf16 v[40:43], v[196:199], v[12:15], v[40:43]
    v_mfma_f32_16x16x32_bf16 v[44:47], v[252:255], v[12:15], v[44:47]
    s_nop 7
    v_cvt_pk_bf16_f32 v48, v20, v24
    v_cvt_pk_bf16_f32 v49, v21, v25
    v_cvt_pk_bf16_f32 v50, v22, v26
    v_cvt_pk_bf16_f32 v51, v23, v27
    v_cvt_pk_bf16_f32 v52, v28, v32
    v_cvt_pk_bf16_f32 v53, v29, v33
    v_cvt_pk_bf16_f32 v54, v30, v34
    v_cvt_pk_bf16_f32 v55, v31, v35
    v_cvt_pk_bf16_f32 v56, v36, v40
    v_cvt_pk_bf16_f32 v57, v37, v41
    v_cvt_pk_bf16_f32 v58, v38, v42
    v_cvt_pk_bf16_f32 v59, v39, v43
    v_cvt_pk_bf16_f32 v60, v44, v5
    v_cvt_pk_bf16_f32 v61, v45, v5
    v_cvt_pk_bf16_f32 v62, v46, v5
    v_cvt_pk_bf16_f32 v63, v47, v5
    ds_read_b128 v[8:11], v2 offset:14336
    ds_read_b128 v[12:15], v2 offset:15360
    ds_read_b128 v[16:19], v2 offset:16384
    s_waitcnt lgkmcnt(2)
    v_mfma_f32_16x16x32_bf16 v[20:23], a[0:3], v[8:11], 0
    v_mfma_f32_16x16x32_bf16 v[24:27], a[56:59], v[8:11], 0
    v_mfma_f32_16x16x32_bf16 v[28:31], a[112:115], v[8:11], 0
    v_mfma_f32_16x16x32_bf16 v[32:35], a[168:171], v[8:11], 0
    v_mfma_f32_16x16x32_bf16 v[36:39], a[224:227], v[8:11], 0
    v_mfma_f32_16x16x32_bf16 v[40:43], v[144:147], v[8:11], 0
    v_mfma_f32_16x16x32_bf16 v[44:47], v[200:203], v[8:11], 0
    ds_read_b128 v[8:11], v2 offset:17408
    s_waitcnt lgkmcnt(2)
    v_mfma_f32_16x16x32_bf16 v[20:23], a[4:7], v[12:15], v[20:23]
    v_mfma_f32_16x16x32_bf16 v[24:27], a[60:63], v[12:15], v[24:27]
    v_mfma_f32_16x16x32_bf16 v[28:31], a[116:119], v[12:15], v[28:31]
    v_mfma_f32_16x16x32_bf16 v[32:35], a[172:175], v[12:15], v[32:35]
    v_mfma_f32_16x16x32_bf16 v[36:39], a[228:231], v[12:15], v[36:39]
    v_mfma_f32_16x16x32_bf16 v[40:43], v[148:151], v[12:15], v[40:43]
    v_mfma_f32_16x16x32_bf16 v[44:47], v[204:207], v[12:15], v[44:47]
    ds_read_b128 v[12:15], v2 offset:18432
    s_waitcnt lgkmcnt(2)
    v_mfma_f32_16x16x32_bf16 v[20:23], a[8:11], v[16:19], v[20:23]
    v_mfma_f32_16x16x32_bf16 v[24:27], a[64:67], v[16:19], v[24:27]
    v_mfma_f32_16x16x32_bf16 v[28:31], a[120:123], v[16:19], v[28:31]
    v_mfma_f32_16x16x32_bf16 v[32:35], a[176:179], v[16:19], v[32:35]
    v_mfma_f32_16x16x32_bf16 v[36:39], a[232:235], v[16:19], v[36:39]
    v_mfma_f32_16x16x32_bf16 v[40:43], v[152:155], v[16:19], v[40:43]
    v_mfma_f32_16x16x32_bf16 v[44:47], v[208:211], v[16:19], v[44:47]
    ds_read_b128 v[16:19], v2 offset:19456
    s_waitcnt lgkmcnt(2)
    v_mfma_f32_16x16x32_bf16 v[20:23], a[12:15], v[8:11], v[20:23]
    v_mfma_f32_16x16x32_bf16 v[24:27], a[68:71], v[8:11], v[24:27]
    v_mfma_f32_16x16x32_bf16 v[28:31], a[124:127], v[8:11], v[28:31]
    v_mfma_f32_16x16x32_bf16 v[32:35], a[180:183], v[8:11], v[32:35]
    v_mfma_f32_16x16x32_bf16 v[36:39], a[236:239], v[8:11], v[36:39]
    v_mfma_f32_16x16x32_bf16 v[40:43], v[156:159], v[8:11], v[40:43]
    v_mfma_f32_16x16x32_bf16 v[44:47], v[212:215], v[8:11], v[44:47]
    ds_read_b128 v[8:11], v2 offset:20480
    s_waitcnt lgkmcnt(2)
    v_mfma_f32_16x16x32_bf16 v[20:23], a[16:19], v[12:15], v[20:23]
    v_mfma_f32_16x16x32_bf16 v[24:27], a[72:75], v[12:15], v[24:27]
    v_mfma_f32_16x16x32_bf16 v[28:31], a[128:131], v[12:15], v[28:31]
    v_mfma_f32_16x16x32_bf16 v[32:35], a[184:187], v[12:15], v[32:35]
    v_mfma_f32_16x16x32_bf16 v[36:39], a[240:243], v[12:15], v[36:39]
    v_mfma_f32_16x16x32_bf16 v[40:43], v[160:163], v[12:15], v[40:43]
    v_mfma_f32_16x16x32_bf16 v[44:47], v[216:219], v[12:15], v[44:47]
    ds_read_b128 v[12:15], v2 offset:21504
    s_waitcnt lgkmcnt(2)
    v_mfma_f32_16x16x32_bf16 v[20:23], a[20:23], v[16:19], v[20:23]
    v_mfma_f32_16x16x32_bf16 v[24:27], a[76:79], v[16:19], v[24:27]
    v_mfma_f32_16x16x32_bf16 v[28:31], a[132:135], v[16:19], v[28:31]
    v_mfma_f32_16x16x32_bf16 v[32:35], a[188:191], v[16:19], v[32:35]
    v_mfma_f32_16x16x32_bf16 v[36:39], a[244:247], v[16:19], v[36:39]
    v_mfma_f32_16x16x32_bf16 v[40:43], v[164:167], v[16:19], v[40:43]
    v_mfma_f32_16x16x32_bf16 v[44:47], v[220:223], v[16:19], v[44:47]
    ds_read_b128 v[16:19], v2 offset:22528
    s_waitcnt lgkmcnt(2)
    v_mfma_f32_16x16x32_bf16 v[20:23], a[24:27], v[8:11], v[20:23]
    v_mfma_f32_16x16x32_bf16 v[24:27], a[80:83], v[8:11], v[24:27]
    v_mfma_f32_16x16x32_bf16 v[28:31], a[136:139], v[8:11], v[28:31]
    v_mfma_f32_16x16x32_bf16 v[32:35], a[192:195], v[8:11], v[32:35]
    v_mfma_f32_16x16x32_bf16 v[36:39], a[248:251], v[8:11], v[36:39]
    v_mfma_f32_16x16x32_bf16 v[40:43], v[168:171], v[8:11], v[40:43]
    v_mfma_f32_16x16x32_bf16 v[44:47], v[224:227], v[8:11], v[44:47]
    ds_read_b128 v[8:11], v2 offset:23552
    s_waitcnt lgkmcnt(2)
    v_mfma_f32_16x16x32_bf16 v[20:23], a[28:31], v[12:15], v[20:23]
    v_mfma_f32_16x16x32_bf16 v[24:27], a[84:87], v[12:15], v[24:27]
    v_mfma_f32_16x16x32_bf16 v[28:31], a[140:143], v[12:15], v[28:31]
    v_mfma_f32_16x16x32_bf16 v[32:35], a[196:199], v[12:15], v[32:35]
    v_mfma_f32_16x16x32_bf16 v[36:39], a[252:255], v[12:15], v[36:39]
    v_mfma_f32_16x16x32_bf16 v[40:43], v[172:175], v[12:15], v[40:43]
    v_mfma_f32_16x16x32_bf16 v[44:47], v[228:231], v[12:15], v[44:47]
    ds_read_b128 v[12:15], v2 offset:24576
    s_waitcnt lgkmcnt(2)
    v_mfma_f32_16x16x32_bf16 v[20:23], a[32:35], v[16:19], v[20:23]
    v_mfma_f32_16x16x32_bf16 v[24:27], a[88:91], v[16:19], v[24:27]
    v_mfma_f32_16x16x32_bf16 v[28:31], a[144:147], v[16:19], v[28:31]
    v_mfma_f32_16x16x32_bf16 v[32:35], a[200:203], v[16:19], v[32:35]
    v_mfma_f32_16x16x32_bf16 v[36:39], v[120:123], v[16:19], v[36:39]
    v_mfma_f32_16x16x32_bf16 v[40:43], v[176:179], v[16:19], v[40:43]
    v_mfma_f32_16x16x32_bf16 v[44:47], v[232:235], v[16:19], v[44:47]
    ds_read_b128 v[16:19], v2 offset:25600
    s_waitcnt lgkmcnt(2)
    v_mfma_f32_16x16x32_bf16 v[20:23], a[36:39], v[8:11], v[20:23]
    v_mfma_f32_16x16x32_bf16 v[24:27], a[92:95], v[8:11], v[24:27]
    v_mfma_f32_16x16x32_bf16 v[28:31], a[148:151], v[8:11], v[28:31]
    v_mfma_f32_16x16x32_bf16 v[32:35], a[204:207], v[8:11], v[32:35]
    v_mfma_f32_16x16x32_bf16 v[36:39], v[124:127], v[8:11], v[36:39]
    v_mfma_f32_16x16x32_bf16 v[40:43], v[180:183], v[8:11], v[40:43]
    v_mfma_f32_16x16x32_bf16 v[44:47], v[236:239], v[8:11], v[44:47]
    ds_read_b128 v[8:11], v2 offset:26624
    s_waitcnt lgkmcnt(2)
    v_mfma_f32_16x16x32_bf16 v[20:23], a[40:43], v[12:15], v[20:23]
    v_mfma_f32_16x16x32_bf16 v[24:27], a[96:99], v[12:15], v[24:27]
    v_mfma_f32_16x16x32_bf16 v[28:31], a[152:155], v[12:15], v[28:31]
    v_mfma_f32_16x16x32_bf16 v[32:35], a[208:211], v[12:15], v[32:35]
    v_mfma_f32_16x16x32_bf16 v[36:39], v[128:131], v[12:15], v[36:39]
    v_mfma_f32_16x16x32_bf16 v[40:43], v[184:187], v[12:15], v[40:43]
    v_mfma_f32_16x16x32_bf16 v[44:47], v[240:243], v[12:15], v[44:47]
    ds_read_b128 v[12:15], v2 offset:27648
    s_waitcnt lgkmcnt(2)
    v_mfma_f32_16x16x32_bf16 v[20:23], a[44:47], v[16:19], v[20:23]
    v_mfma_f32_16x16x32_bf16 v[24:27], a[100:103], v[16:19], v[24:27]
    v_mfma_f32_16x16x32_bf16 v[28:31], a[156:159], v[16:19], v[28:31]
    v_mfma_f32_16x16x32_bf16 v[32:35], a[212:215], v[16:19], v[32:35]
    v_mfma_f32_16x16x32_bf16 v[36:39], v[132:135], v[16:19], v[36:39]
    v_mfma_f32_16x16x32_bf16 v[40:43], v[188:191], v[16:19], v[40:43]
    v_mfma_f32_16x16x32_bf16 v[44:47], v[244:247], v[16:19], v[44:47]
    s_waitcnt lgkmcnt(1)
    v_mfma_f32_16x16x32_bf16 v[20:23], a[48:51], v[8:11], v[20:23]
    v_mfma_f32_16x16x32_bf16 v[24:27], a[104:107], v[8:11], v[24:27]
    v_mfma_f32_16x16x32_bf16 v[28:31], a[160:163], v[8:11], v[28:31]
    v_mfma_f32_16x16x32_bf16 v[32:35], a[216:219], v[8:11], v[32:35]
    v_mfma_f32_16x16x32_bf16 v[36:39], v[136:139], v[8:11], v[36:39]
    v_mfma_f32_16x16x32_bf16 v[40:43], v[192:195], v[8:11], v[40:43]
    v_mfma_f32_16x16x32_bf16 v[44:47], v[248:251], v[8:11], v[44:47]
    s_waitcnt lgkmcnt(0)
    v_mfma_f32_16x16x32_bf16 v[20:23], a[52:55], v[12:15], v[20:23]
    v_mfma_f32_16x16x32_bf16 v[24:27], a[108:111], v[12:15], v[24:27]
    v_mfma_f32_16x16x32_bf16 v[28:31], a[164:167], v[12:15], v[28:31]
    v_mfma_f32_16x16x32_bf16 v[32:35], a[220:223], v[12:15], v[32:35]
    v_mfma_f32_16x16x32_bf16 v[36:39], v[140:143], v[12:15], v[36:39]
    v_mfma_f32_16x16x32_bf16 v[40:43], v[196:199], v[12:15], v[40:43]
    v_mfma_f32_16x16x32_bf16 v[44:47], v[252:255], v[12:15], v[44:47]
    s_nop 7
    v_cvt_pk_bf16_f32 v64, v20, v24
    v_cvt_pk_bf16_f32 v65, v21, v25
    v_cvt_pk_bf16_f32 v66, v22, v26
    v_cvt_pk_bf16_f32 v67, v23, v27
    v_cvt_pk_bf16_f32 v68, v28, v32
    v_cvt_pk_bf16_f32 v69, v29, v33
    v_cvt_pk_bf16_f32 v70, v30, v34
    v_cvt_pk_bf16_f32 v71, v31, v35
    v_cvt_pk_bf16_f32 v72, v36, v40
    v_cvt_pk_bf16_f32 v73, v37, v41
    v_cvt_pk_bf16_f32 v74, v38, v42
    v_cvt_pk_bf16_f32 v75, v39, v43
    v_cvt_pk_bf16_f32 v76, v44, v5
    v_cvt_pk_bf16_f32 v77, v45, v5
    v_cvt_pk_bf16_f32 v78, v46, v5
    v_cvt_pk_bf16_f32 v79, v47, v5
    ds_read_b128 v[80:83], v119 offset:7168
    ds_read_b128 v[84:87], v119 offset:8192
    ds_read_b128 v[88:91], v119 offset:9216
    ds_read_b128 v[92:95], v119 offset:10240
    s_waitcnt lgkmcnt(3)
    v_mfma_f32_16x16x32_bf16 v[20:23], v[80:83], v[48:51], 0
    v_mfma_f32_16x16x32_bf16 v[24:27], v[80:83], v[64:67], 0
    s_waitcnt lgkmcnt(2)
    v_mfma_f32_16x16x32_bf16 v[20:23], v[84:87], v[52:55], v[20:23]
    v_mfma_f32_16x16x32_bf16 v[24:27], v[84:87], v[68:71], v[24:27]
    s_waitcnt lgkmcnt(1)
    v_mfma_f32_16x16x32_bf16 v[20:23], v[88:91], v[56:59], v[20:23]
    v_mfma_f32_16x16x32_bf16 v[24:27], v[88:91], v[72:75], v[24:27]
    s_waitcnt lgkmcnt(0)
    v_mfma_f32_16x16x32_bf16 v[20:23], v[92:95], v[60:63], v[20:23]
    v_mfma_f32_16x16x32_bf16 v[24:27], v[92:95], v[76:79], v[24:27]
    ds_read_b128 v[80:83], v119 offset:21504
    ds_read_b128 v[84:87], v119 offset:22528
    ds_read_b128 v[88:91], v119 offset:23552
    ds_read_b128 v[92:95], v119 offset:24576
    s_waitcnt lgkmcnt(3)
    v_mfma_f32_16x16x32_bf16 v[28:31], v[80:83], v[64:67], 0
    s_waitcnt lgkmcnt(2)
    v_mfma_f32_16x16x32_bf16 v[28:31], v[84:87], v[68:71], v[28:31]
    s_waitcnt lgkmcnt(1)
    v_mfma_f32_16x16x32_bf16 v[28:31], v[88:91], v[72:75], v[28:31]
    s_waitcnt lgkmcnt(0)
    v_mfma_f32_16x16x32_bf16 v[28:31], v[92:95], v[76:79], v[28:31]
    s_nop 7
    ds_write_b128 v1, v[20:23] offset:6144
    ds_write_b128 v1, v[24:27] offset:7168
    ds_write_b128 v1, v[28:31] offset:8192
    s_waitcnt lgkmcnt(0)
    s_barrier
    s_lshl_b32 s11, s17, 13
    s_add_u32 s11, s11, 0x3080e00
    s_mov_b32 s22, 0
spin_658:
    buffer_load_dwordx2 v[80:81], v4, s[4:7], s11 offen offset:0 sc1
    buffer_load_dwordx2 v[82:83], v4, s[4:7], s11 offen offset:32 sc1
    buffer_load_dwordx2 v[84:85], v4, s[4:7], s11 offen offset:512 sc1
    buffer_load_dwordx2 v[86:87], v4, s[4:7], s11 offen offset:544 sc1
    buffer_load_dwordx2 v[88:89], v4, s[4:7], s11 offen offset:1024 sc1
    buffer_load_dwordx2 v[90:91], v4, s[4:7], s11 offen offset:1056 sc1
    buffer_load_dwordx2 v[92:93], v4, s[4:7], s11 offen offset:1536 sc1
    buffer_load_dwordx2 v[94:95], v4, s[4:7], s11 offen offset:1568 sc1
    s_waitcnt vmcnt(0)
spin2_660:
    v_max3_u32 v3, v80, v81, v82
    v_max3_u32 v3, v3, v83, v84
    v_max3_u32 v3, v3, v85, v86
    v_max3_u32 v3, v3, v87, v88
    v_max3_u32 v3, v3, v89, v90
    v_max3_u32 v3, v3, v91, v92
    v_max3_u32 v3, v3, v93, v94
    v_max_u32 v3, v3, v95
    v_cmp_eq_u32 vcc, -1, v3
    s_cbranch_vccz spok_659
    s_add_u32 s22, s22, 1
    s_cmp_gt_u32 s22, 65536
    s_cbranch_scc1 M_exit
    s_sleep 1
    s_branch spin_658
spok_659:
    v_swap_b32 v81, v82
    v_swap_b32 v85, v86
    v_swap_b32 v89, v90
    v_swap_b32 v93, v94
    s_nop 1
    v_mfma_f32_16x16x32_bf16 v[20:23], v[80:83], v[48:51], 0
    v_mfma_f32_16x16x32_bf16 v[24:27], v[80:83], v[64:67], 0
    v_mfma_f32_16x16x32_bf16 v[20:23], v[84:87], v[52:55], v[20:23]
    v_mfma_f32_16x16x32_bf16 v[24:27], v[84:87], v[68:71], v[24:27]
    v_mfma_f32_16x16x32_bf16 v[20:23], v[88:91], v[56:59], v[20:23]
    v_mfma_f32_16x16x32_bf16 v[24:27], v[88:91], v[72:75], v[24:27]
    v_mfma_f32_16x16x32_bf16 v[20:23], v[92:95], v[60:63], v[20:23]
    v_mfma_f32_16x16x32_bf16 v[24:27], v[92:95], v[76:79], v[24:27]
    s_nop 7
    ds_write_b64 v1, v[20:21] offset:14336
    ds_write_b64 v1, v[24:25] offset:14344
    s_waitcnt lgkmcnt(0)
    s_barrier
    s_add_u32 s17, s17, 4
    s_cmp_lt_u32 s17, 64
    s_cbranch_scc1 sx_loop_655
    s_branch M_exit
sx_w3_630:
    v_and_b32 v0, 63, v0
    v_lshlrev_b32 v1, 4, v0
    v_mov_b32 v5, 0
    v_mov_b32 v6, 0xff800000
    v_lshrrev_b32 v3, 4, v0
    v_lshrrev_b32 v104, 5, v0
    v_lshlrev_b32 v4, 8, v104
    v_and_b32 v104, 13, v0
    v_lshl_add_u32 v4, v104, 4, v4
    v_bfe_u32 v104, v0, 4, 1
    v_lshl_add_u32 v4, v104, 3, v4
    v_and_b32 v118, 0x38, v0
    v_and_b32 v104, 1, v0
    v_lshl_add_u32 v118, v104, 2, v118
    v_bfe_u32 v104, v0, 1, 2
    v_add_u32 v118, v118, v104
    v_lshlrev_b32 v118, 4, v118
    v_lshrrev_b32 v104, 5, v0
    v_lshlrev_b32 v3, 3, v104
    v_bfe_u32 v104, v0, 4, 1
    v_lshl_add_u32 v3, v104, 1, v3
    v_and_b32 v104, 15, v0
    v_add_u32 v105, 0, v3
    v_cmp_le_u32 s[40:41], v105, v104
    v_add_u32 v105, 4, v3
    v_cmp_le_u32 s[42:43], v105, v104
    v_add_u32 v105, 1, v3
    v_cmp_le_u32 s[44:45], v105, v104
    v_add_u32 v105, 5, v3
    v_cmp_le_u32 s[46:47], v105, v104
    s_and_b32 s11, s9, 3
    s_lshl_b32 s11, s11, 8
    v_and_b32 v104, 15, v0
    v_lshlrev_b32 v7, 4, v104
    v_lshrrev_b32 v104, 4, v0
    v_lshl_add_u32 v7, v104, 2, v7
    v_add_u32 v7, s11, v7
    s_mov_b32 s18, 20480
    s_mov_b32 s11, 0x3b03000
    v_min_u32 v8, 0, v0
    v_lshlrev_b32 v8, 4, v8
    s_mov_b32 s22, 0
wt_661:
    buffer_load_dwordx4 v[20:23], v8, s[4:7], s11 offen offset:0 sc1
    s_waitcnt vmcnt(0)
    v_xor_b32 v20, s80, v20
    v_xor_b32 v21, s81, v21
    v_and_b32 v21, -16, v21
    v_xor_b32 v22, s80, v22
    v_xor_b32 v23, s81, v23
    v_and_b32 v23, -16, v23
    v_or3_b32 v20, v20, v21, v22
    v_or_b32 v20, v20, v23
    v_cmp_ne_u32 vcc, 0, v20
    s_cbranch_vccz wtok_662
    s_add_u32 s22, s22, 1
    s_cmp_gt_u32 s22, 65536
    s_cbranch_scc1 M_exit
    s_sleep 16
    s_branch wt_661
wtok_662:
    s_mul_i32 s13, s15, 28672
    s_mul_i32 s14, s10, 7168
    s_add_u32 s13, s13, s14
    s_add_u32 m0, s18, s14
    s_nop 0
    buffer_load_dwordx4 v1, s[4:7], s13 offen offset:0 sc1 lds
    buffer_load_dwordx4 v1, s[4:7], s13 offen offset:1024 sc1 lds
    buffer_load_dwordx4 v1, s[4:7], s13 offen offset:2048 sc1 lds
    buffer_load_dwordx4 v1, s[4:7], s13 offen offset:3072 sc1 lds
    s_add_u32 m0, m0, 4096
    s_add_u32 s13, s13, 4096
    buffer_load_dwordx4 v1, s[4:7], s13 offen offset:0 sc1 lds
    buffer_load_dwordx4 v1, s[4:7], s13 offen offset:1024 sc1 lds
    buffer_load_dwordx4 v1, s[4:7], s13 offen offset:2048 sc1 lds
    s_mul_i32 s11, s9, 401408
    s_add_u32 s12, s11, 0x249800
    s_add_u32 s14, s12, 0
    buffer_load_dwordx4 a[0:3], v1, s[4:7], s14 offen offset:0 sc1
    buffer_load_dwordx4 a[4:7], v1, s[4:7], s14 offen offset:1024 sc1
    buffer_load_dwordx4 a[8:11], v1, s[4:7], s14 offen offset:2048 sc1
    buffer_load_dwordx4 a[12:15], v1, s[4:7], s14 offen offset:3072 sc1
    s_add_u32 s14, s12, 4096
    buffer_load_dwordx4 a[16:19], v1, s[4:7], s14 offen offset:0 sc1
    buffer_load_dwordx4 a[20:23], v1, s[4:7], s14 offen offset:1024 sc1
    buffer_load_dwordx4 a[24:27], v1, s[4:7], s14 offen offset:2048 sc1
    buffer_load_dwordx4 a[28:31], v1, s[4:7], s14 offen offset:3072 sc1
    s_add_u32 s14, s12, 8192
    buffer_load_dwordx4 a[32:35], v1, s[4:7], s14 offen offset:0 sc1
    buffer_load_dwordx4 a[36:39], v1, s[4:7], s14 offen offset:1024 sc1
    buffer_load_dwordx4 a[40:43], v1, s[4:7], s14 offen offset:2048 sc1
    buffer_load_dwordx4 a[44:47], v1, s[4:7], s14 offen offset:3072 sc1
    s_add_u32 s14, s12, 12288
    buffer_load_dwordx4 a[48:51], v1, s[4:7], s14 offen offset:0 sc1
    buffer_load_dwordx4 a[52:55], v1, s[4:7], s14 offen offset:1024 sc1
    s_add_u32 s12, s11, 0x24d000
    s_add_u32 s14, s12, 0
    buffer_load_dwordx4 a[56:59], v1, s[4:7], s14 offen offset:0 sc1
    buffer_load_dwordx4 a[60:63], v1, s[4:7], s14 offen offset:1024 sc1
    buffer_load_dwordx4 a[64:67], v1, s[4:7], s14 offen offset:2048 sc1
    buffer_load_dwordx4 a[68:71], v1, s[4:7], s14 offen offset:3072 sc1
    s_add_u32 s14, s12, 4096
    buffer_load_dwordx4 a[72:75], v1, s[4:7], s14 offen offset:0 sc1
    buffer_load_dwordx4 a[76:79], v1, s[4:7], s14 offen offset:1024 sc1
    buffer_load_dwordx4 a[80:83], v1, s[4:7], s14 offen offset:2048 sc1
    buffer_load_dwordx4 a[84:87], v1, s[4:7], s14 offen offset:3072 sc1
    s_add_u32 s14, s12, 8192
    buffer_load_dwordx4 a[88:91], v1, s[4:7], s14 offen offset:0 sc1
    buffer_load_dwordx4 a[92:95], v1, s[4:7], s14 offen offset:1024 sc1
    buffer_load_dwordx4 a[96:99], v1, s[4:7], s14 offen offset:2048 sc1
    buffer_load_dwordx4 a[100:103], v1, s[4:7], s14 offen offset:3072 sc1
    s_add_u32 s14, s12, 12288
    buffer_load_dwordx4 a[104:107], v1, s[4:7], s14 offen offset:0 sc1
    buffer_load_dwordx4 a[108:111], v1, s[4:7], s14 offen offset:1024 sc1
    s_add_u32 s12, s11, 0x250800
    s_add_u32 s14, s12, 0
    buffer_load_dwordx4 a[112:115], v1, s[4:7], s14 offen offset:0 sc1
    buffer_load_dwordx4 a[116:119], v1, s[4:7], s14 offen offset:1024 sc1
    buffer_load_dwordx4 a[120:123], v1, s[4:7], s14 offen offset:2048 sc1
    buffer_load_dwordx4 a[124:127], v1, s[4:7], s14 offen offset:3072 sc1
    s_add_u32 s14, s12, 4096
    buffer_load_dwordx4 a[128:131], v1, s[4:7], s14 offen offset:0 sc1
    buffer_load_dwordx4 a[132:135], v1, s[4:7], s14 offen offset:1024 sc1
    buffer_load_dwordx4 a[136:139], v1, s[4:7], s14 offen offset:2048 sc1
    buffer_load_dwordx4 a[140:143], v1, s[4:7], s14 offen offset:3072 sc1
    s_add_u32 s14, s12, 8192
    buffer_load_dwordx4 a[144:147], v1, s[4:7], s14 offen offset:0 sc1
    buffer_load_dwordx4 a[148:151], v1, s[4:7], s14 offen offset:1024 sc1
    buffer_load_dwordx4 a[152:155], v1, s[4:7], s14 offen offset:2048 sc1
    buffer_load_dwordx4 a[156:159], v1, s[4:7], s14 offen offset:3072 sc1
    s_add_u32 s14, s12, 12288
    buffer_load_dwordx4 a[160:163], v1, s[4:7], s14 offen offset:0 sc1
    buffer_load_dwordx4 a[164:167], v1, s[4:7], s14 offen offset:1024 sc1
    s_waitcnt vmcnt(46)
    s_add_u32 s12, s11, 0x254000
    s_add_u32 s14, s12, 0
    buffer_load_dwordx4 a[168:171], v1, s[4:7], s14 offen offset:0 sc1
    buffer_load_dwordx4 a[172:175], v1, s[4:7], s14 offen offset:1024 sc1
    buffer_load_dwordx4 a[176:179], v1, s[4:7], s14 offen offset:2048 sc1
    buffer_load_dwordx4 a[180:183], v1, s[4:7], s14 offen offset:3072 sc1
    s_add_u32 s14, s12, 4096
    buffer_load_dwordx4 a[184:187], v1, s[4:7], s14 offen offset:0 sc1
    buffer_load_dwordx4 a[188:191], v1, s[4:7], s14 offen offset:1024 sc1
    buffer_load_dwordx4 a[192:195], v1, s[4:7], s14 offen offset:2048 sc1
    buffer_load_dwordx4 a[196:199], v1, s[4:7], s14 offen offset:3072 sc1
    s_add_u32 s14, s12, 8192
    buffer_load_dwordx4 a[200:203], v1, s[4:7], s14 offen offset:0 sc1
    buffer_load_dwordx4 a[204:207], v1, s[4:7], s14 offen offset:1024 sc1
    buffer_load_dwordx4 a[208:211], v1, s[4:7], s14 offen offset:2048 sc1
    buffer_load_dwordx4 a[212:215], v1, s[4:7], s14 offen offset:3072 sc1
    s_add_u32 s14, s12, 12288
    buffer_load_dwordx4 a[216:219], v1, s[4:7], s14 offen offset:0 sc1
    buffer_load_dwordx4 a[220:223], v1, s[4:7], s14 offen offset:1024 sc1
    s_waitcnt vmcnt(46)
    s_add_u32 s12, s11, 0x257800
    s_add_u32 s14, s12, 0
    buffer_load_dwordx4 a[224:227], v1, s[4:7], s14 offen offset:0 sc1
    buffer_load_dwordx4 a[228:231], v1, s[4:7], s14 offen offset:1024 sc1
    buffer_load_dwordx4 a[232:235], v1, s[4:7], s14 offen offset:2048 sc1
    buffer_load_dwordx4 a[236:239], v1, s[4:7], s14 offen offset:3072 sc1
    s_add_u32 s14, s12, 4096
    buffer_load_dwordx4 a[240:243], v1, s[4:7], s14 offen offset:0 sc1
    buffer_load_dwordx4 a[244:247], v1, s[4:7], s14 offen offset:1024 sc1
    buffer_load_dwordx4 a[248:251], v1, s[4:7], s14 offen offset:2048 sc1
    buffer_load_dwordx4 a[252:255], v1, s[4:7], s14 offen offset:3072 sc1
    s_add_u32 s14, s12, 8192
    buffer_load_dwordx4 v[120:123], v1, s[4:7], s14 offen offset:0 sc1
    buffer_load_dwordx4 v[124:127], v1, s[4:7], s14 offen offset:1024 sc1
    buffer_load_dwordx4 v[128:131], v1, s[4:7], s14 offen offset:2048 sc1
    buffer_load_dwordx4 v[132:135], v1, s[4:7], s14 offen offset:3072 sc1
    s_add_u32 s14, s12, 12288
    buffer_load_dwordx4 v[136:139], v1, s[4:7], s14 offen offset:0 sc1
    buffer_load_dwordx4 v[140:143], v1, s[4:7], s14 offen offset:1024 sc1
    s_waitcnt vmcnt(46)
    s_add_u32 s12, s11, 0x25b000
    s_add_u32 s14, s12, 0
    buffer_load_dwordx4 v[144:147], v1, s[4:7], s14 offen offset:0 sc1
    buffer_load_dwordx4 v[148:151], v1, s[4:7], s14 offen offset:1024 sc1
    buffer_load_dwordx4 v[152:155], v1, s[4:7], s14 offen offset:2048 sc1
    buffer_load_dwordx4 v[156:159], v1, s[4:7], s14 offen offset:3072 sc1
    s_add_u32 s14, s12, 4096
    buffer_load_dwordx4 v[160:163], v1, s[4:7], s14 offen offset:0 sc1
    buffer_load_dwordx4 v[164:167], v1, s[4:7], s14 offen offset:1024 sc1
    buffer_load_dwordx4 v[168:171], v1, s[4:7], s14 offen offset:2048 sc1
    buffer_load_dwordx4 v[172:175], v1, s[4:7], s14 offen offset:3072 sc1
    s_add_u32 s14, s12, 8192
    buffer_load_dwordx4 v[176:179], v1, s[4:7], s14 offen offset:0 sc1
    buffer_load_dwordx4 v[180:183], v1, s[4:7], s14 offen offset:1024 sc1
    buffer_load_dwordx4 v[184:187], v1, s[4:7], s14 offen offset:2048 sc1
    buffer_load_dwordx4 v[188:191], v1, s[4:7], s14 offen offset:3072 sc1
    s_add_u32 s14, s12, 12288
    buffer_load_dwordx4 v[192:195], v1, s[4:7], s14 offen offset:0 sc1
    buffer_load_dwordx4 v[196:199], v1, s[4:7], s14 offen offset:1024 sc1
    s_waitcnt vmcnt(46)
    s_add_u32 s12, s11, 0x25e800
    s_add_u32 s14, s12, 0
    buffer_load_dwordx4 v[200:203], v1, s[4:7], s14 offen offset:0 sc1
    buffer_load_dwordx4 v[204:207], v1, s[4:7], s14 offen offset:1024 sc1
    buffer_load_dwordx4 v[208:211], v1, s[4:7], s14 offen offset:2048 sc1
    buffer_load_dwordx4 v[212:215], v1, s[4:7], s14 offen offset:3072 sc1
    s_add_u32 s14, s12, 4096
    buffer_load_dwordx4 v[216:219], v1, s[4:7], s14 offen offset:0 sc1
    buffer_load_dwordx4 v[220:223], v1, s[4:7], s14 offen offset:1024 sc1
    buffer_load_dwordx4 v[224:227], v1, s[4:7], s14 offen offset:2048 sc1
    buffer_load_dwordx4 v[228:231], v1, s[4:7], s14 offen offset:3072 sc1
    s_add_u32 s14, s12, 8192
    buffer_load_dwordx4 v[232:235], v1, s[4:7], s14 offen offset:0 sc1
    buffer_load_dwordx4 v[236:239], v1, s[4:7], s14 offen offset:1024 sc1
    buffer_load_dwordx4 v[240:243], v1, s[4:7], s14 offen offset:2048 sc1
    buffer_load_dwordx4 v[244:247], v1, s[4:7], s14 offen offset:3072 sc1
    s_add_u32 s14, s12, 12288
    buffer_load_dwordx4 v[248:251], v1, s[4:7], s14 offen offset:0 sc1
    buffer_load_dwordx4 v[252:255], v1, s[4:7], s14 offen offset:1024 sc1
    s_waitcnt vmcnt(46)
    s_mov_b32 s11, 0x3b02800
    v_min_u32 v8, 51, v0
    v_lshlrev_b32 v8, 4, v8
    s_mov_b32 s22, 0
wt_663:
    buffer_load_dwordx4 v[20:23], v8, s[4:7], s11 offen offset:0 sc1
    s_waitcnt vmcnt(0)
    v_xor_b32 v20, s80, v20
    v_xor_b32 v21, s81, v21
    v_and_b32 v21, -16, v21
    v_xor_b32 v22, s80, v22
    v_xor_b32 v23, s81, v23
    v_and_b32 v23, -16, v23
    v_or3_b32 v20, v20, v21, v22
    v_or_b32 v20, v20, v23
    v_cmp_ne_u32 vcc, 0, v20
    s_cbranch_vccz wtok_664
    s_add_u32 s22, s22, 1
    s_cmp_gt_u32 s22, 65536
    s_cbranch_scc1 M_exit
    s_sleep 16
    s_branch wt_663
wtok_664:
    s_mov_b32 s17, s15
    s_waitcnt vmcnt(0)
sx_loop_665:
    s_barrier
    v_add_u32 v2, s18, v1
    v_add_u32 v119, s18, v118
    s_sub_u32 s18, 69632, s18
    s_add_u32 s11, s17, 4
    s_min_u32 s11, s11, 63
    s_mul_i32 s13, s11, 28672
    s_mul_i32 s14, s10, 7168
    s_add_u32 s13, s13, s14
    s_add_u32 m0, s18, s14
    s_nop 0
    ds_read_b128 v[8:11], v2 offset:0
    ds_read_b128 v[12:15], v2 offset:1024
    ds_read_b128 v[16:19], v2 offset:2048
    s_waitcnt lgkmcnt(2)
    v_mfma_f32_16x16x32_bf16 v[20:23], a[0:3], v[8:11], 0
    buffer_load_dwordx4 v1, s[4:7], s13 offen offset:0 sc1 lds
    v_mfma_f32_16x16x32_bf16 v[24:27], a[56:59], v[8:11], 0
    v_mfma_f32_16x16x32_bf16 v[28:31], a[112:115], v[8:11], 0
    v_mfma_f32_16x16x32_bf16 v[32:35], a[168:171], v[8:11], 0
    v_mfma_f32_16x16x32_bf16 v[36:39], a[224:227], v[8:11], 0
    v_mfma_f32_16x16x32_bf16 v[40:43], v[144:147], v[8:11], 0
    v_mfma_f32_16x16x32_bf16 v[44:47], v[200:203], v[8:11], 0
    ds_read_b128 v[8:11], v2 offset:3072
    s_waitcnt lgkmcnt(2)
    v_mfma_f32_16x16x32_bf16 v[20:23], a[4:7], v[12:15], v[20:23]
    buffer_load_dwordx4 v1, s[4:7], s13 offen offset:1024 sc1 lds
    v_mfma_f32_16x16x32_bf16 v[24:27], a[60:63], v[12:15], v[24:27]
    v_mfma_f32_16x16x32_bf16 v[28:31], a[116:119], v[12:15], v[28:31]
    v_mfma_f32_16x16x32_bf16 v[32:35], a[172:175], v[12:15], v[32:35]
    v_mfma_f32_16x16x32_bf16 v[36:39], a[228:231], v[12:15], v[36:39]
    v_mfma_f32_16x16x32_bf16 v[40:43], v[148:151], v[12:15], v[40:43]
    v_mfma_f32_16x16x32_bf16 v[44:47], v[204:207], v[12:15], v[44:47]
    ds_read_b128 v[12:15], v2 offset:4096
    s_waitcnt lgkmcnt(2)
    v_mfma_f32_16x16x32_bf16 v[20:23], a[8:11], v[16:19], v[20:23]
    buffer_load_dwordx4 v1, s[4:7], s13 offen offset:2048 sc1 lds
    v_mfma_f32_16x16x32_bf16 v[24:27], a[64:67], v[16:19], v[24:27]
    v_mfma_f32_16x16x32_bf16 v[28:31], a[120:123], v[16:19], v[28:31]
    v_mfma_f32_16x16x32_bf16 v[32:35], a[176:179], v[16:19], v[32:35]
    v_mfma_f32_16x16x32_bf16 v[36:39], a[232:235], v[16:19], v[36:39]
    v_mfma_f32_16x16x32_bf16 v[40:43], v[152:155], v[16:19], v[40:43]
    v_mfma_f32_16x16x32_bf16 v[44:47], v[208:211], v[16:19], v[44:47]
    ds_read_b128 v[16:19], v2 offset:5120
    s_waitcnt lgkmcnt(2)
    v_mfma_f32_16x16x32_bf16 v[20:23], a[12:15], v[8:11], v[20:23]
    buffer_load_dwordx4 v1, s[4:7], s13 offen offset:3072 sc1 lds
    s_add_u32 m0, m0, 4096
    s_add_u32 s13, s13, 4096
    v_mfma_f32_16x16x32_bf16 v[24:27], a[68:71], v[8:11], v[24:27]
    v_mfma_f32_16x16x32_bf16 v[28:31], a[124:127], v[8:11], v[28:31]
    v_mfma_f32_16x16x32_bf16 v[32:35], a[180:183], v[8:11], v[32:35]
    v_mfma_f32_16x16x32_bf16 v[36:39], a[236:239], v[8:11], v[36:39]
    v_mfma_f32_16x16x32_bf16 v[40:43], v[156:159], v[8:11], v[40:43]
    v_mfma_f32_16x16x32_bf16 v[44:47], v[212:215], v[8:11], v[44:47]
    ds_read_b128 v[8:11], v2 offset:6144
    s_waitcnt lgkmcnt(2)
    v_mfma_f32_16x16x32_bf16 v[20:23], a[16:19], v[12:15], v[20:23]
    buffer_load_dwordx4 v1, s[4:7], s13 offen offset:0 sc1 lds
    v_mfma_f32_16x16x32_bf16 v[24:27], a[72:75], v[12:15], v[24:27]
    v_mfma_f32_16x16x32_bf16 v[28:31], a[128:131], v[12:15], v[28:31]
    v_mfma_f32_16x16x32_bf16 v[32:35], a[184:187], v[12:15], v[32:35]
    v_mfma_f32_16x16x32_bf16 v[36:39], a[240:243], v[12:15], v[36:39]
    v_mfma_f32_16x16x32_bf16 v[40:43], v[160:163], v[12:15], v[40:43]
    v_mfma_f32_16x16x32_bf16 v[44:47], v[216:219], v[12:15], v[44:47]
    ds_read_b128 v[12:15], v2 offset:7168
    s_waitcnt lgkmcnt(2)
    v_mfma_f32_16x16x32_bf16 v[20:23], a[20:23], v[16:19], v[20:23]
    buffer_load_dwordx4 v1, s[4:7], s13 offen offset:1024 sc1 lds
    v_mfma_f32_16x16x32_bf16 v[24:27], a[76:79], v[16:19], v[24:27]
    v_mfma_f32_16x16x32_bf16 v[28:31], a[132:135], v[16:19], v[28:31]
    v_mfma_f32_16x16x32_bf16 v[32:35], a[188:191], v[16:19], v[32:35]
    v_mfma_f32_16x16x32_bf16 v[36:39], a[244:247], v[16:19], v[36:39]
    v_mfma_f32_16x16x32_bf16 v[40:43], v[164:167], v[16:19], v[40:43]
    v_mfma_f32_16x16x32_bf16 v[44:47], v[220:223], v[16:19], v[44:47]
    ds_read_b128 v[16:19], v2 offset:8192
    s_waitcnt lgkmcnt(2)
    v_mfma_f32_16x16x32_bf16 v[20:23], a[24:27], v[8:11], v[20:23]
    buffer_load_dwordx4 v1, s[4:7], s13 offen offset:2048 sc1 lds
    v_mfma_f32_16x16x32_bf16 v[24:27], a[80:83], v[8:11], v[24:27]
    v_mfma_f32_16x16x32_bf16 v[28:31], a[136:139], v[8:11], v[28:31]
    v_mfma_f32_16x16x32_bf16 v[32:35], a[192:195], v[8:11], v[32:35]
    v_mfma_f32_16x16x32_bf16 v[36:39], a[248:251], v[8:11], v[36:39]
    v_mfma_f32_16x16x32_bf16 v[40:43], v[168:171], v[8:11], v[40:43]
    v_mfma_f32_16x16x32_bf16 v[44:47], v[224:227], v[8:11], v[44:47]
    ds_read_b128 v[8:11], v2 offset:9216
    s_waitcnt lgkmcnt(2)
    v_mfma_f32_16x16x32_bf16 v[20:23], a[28:31], v[12:15], v[20:23]
    v_mfma_f32_16x16x32_bf16 v[24:27], a[84:87], v[12:15], v[24:27]
    v_mfma_f32_16x16x32_bf16 v[28:31], a[140:143], v[12:15], v[28:31]
    v_mfma_f32_16x16x32_bf16 v[32:35], a[196:199], v[12:15], v[32:35]
    v_mfma_f32_16x16x32_bf16 v[36:39], a[252:255], v[12:15], v[36:39]
    v_mfma_f32_16x16x32_bf16 v[40:43], v[172:175], v[12:15], v[40:43]
    v_mfma_f32_16x16x32_bf16 v[44:47], v[228:231], v[12:15], v[44:47]
    ds_read_b128 v[12:15], v2 offset:10240
    s_waitcnt lgkmcnt(2)
    v_mfma_f32_16x16x32_bf16 v[20:23], a[32:35], v[16:19], v[20:23]
    v_mfma_f32_16x16x32_bf16 v[24:27], a[88:91], v[16:19], v[24:27]
    v_mfma_f32_16x16x32_bf16 v[28:31], a[144:147], v[16:19], v[28:31]
    v_mfma_f32_16x16x32_bf16 v[32:35], a[200:203], v[16:19], v[32:35]
    v_mfma_f32_16x16x32_bf16 v[36:39], v[120:123], v[16:19], v[36:39]
    v_mfma_f32_16x16x32_bf16 v[40:43], v[176:179], v[16:19], v[40:43]
    v_mfma_f32_16x16x32_bf16 v[44:47], v[232:235], v[16:19], v[44:47]
    ds_read_b128 v[16:19], v2 offset:11264
    s_waitcnt lgkmcnt(2)
    v_mfma_f32_16x16x32_bf16 v[20:23], a[36:39], v[8:11], v[20:23]
    v_mfma_f32_16x16x32_bf16 v[24:27], a[92:95], v[8:11], v[24:27]
    v_mfma_f32_16x16x32_bf16 v[28:31], a[148:151], v[8:11], v[28:31]
    v_mfma_f32_16x16x32_bf16 v[32:35], a[204:207], v[8:11], v[32:35]
    v_mfma_f32_16x16x32_bf16 v[36:39], v[124:127], v[8:11], v[36:39]
    v_mfma_f32_16x16x32_bf16 v[40:43], v[180:183], v[8:11], v[40:43]
    v_mfma_f32_16x16x32_bf16 v[44:47], v[236:239], v[8:11], v[44:47]
    ds_read_b128 v[8:11], v2 offset:12288
    s_waitcnt lgkmcnt(2)
    v_mfma_f32_16x16x32_bf16 v[20:23], a[40:43], v[12:15], v[20:23]
    v_mfma_f32_16x16x32_bf16 v[24:27], a[96:99], v[12:15], v[24:27]
    v_mfma_f32_16x16x32_bf16 v[28:31], a[152:155], v[12:15], v[28:31]
    v_mfma_f32_16x16x32_bf16 v[32:35], a[208:211], v[12:15], v[32:35]
    v_mfma_f32_16x16x32_bf16 v[36:39], v[128:131], v[12:15], v[36:39]
    v_mfma_f32_16x16x32_bf16 v[40:43], v[184:187], v[12:15], v[40:43]
    v_mfma_f32_16x16x32_bf16 v[44:47], v[240:243], v[12:15], v[44:47]
    ds_read_b128 v[12:15], v2 offset:13312
    s_waitcnt lgkmcnt(2)
    v_mfma_f32_16x16x32_bf16 v[20:23], a[44:47], v[16:19], v[20:23]
    v_mfma_f32_16x16x32_bf16 v[24:27], a[100:103], v[16:19], v[24:27]
    v_mfma_f32_16x16x32_bf16 v[28:31], a[156:159], v[16:19], v[28:31]
    v_mfma_f32_16x16x32_bf16 v[32:35], a[212:215], v[16:19], v[32:35]
    v_mfma_f32_16x16x32_bf16 v[36:39], v[132:135], v[16:19], v[36:39]
    v_mfma_f32_16x16x32_bf16 v[40:43], v[188:191], v[16:19], v[40:43]
    v_mfma_f32_16x16x32_bf16 v[44:47], v[244:247], v[16:19], v[44:47]
    s_waitcnt lgkmcnt(1)
    v_mfma_f32_16x16x32_bf16 v[20:23], a[48:51], v[8:11], v[20:23]
    v_mfma_f32_16x16x32_bf16 v[24:27], a[104:107], v[8:11], v[24:27]
    v_mfma_f32_16x16x32_bf16 v[28:31], a[160:163], v[8:11], v[28:31]
    v_mfma_f32_16x16x32_bf16 v[32:35], a[216:219], v[8:11], v[32:35]
    v_mfma_f32_16x16x32_bf16 v[36:39], v[136:139], v[8:11], v[36:39]
    v_mfma_f32_16x16x32_bf16 v[40:43], v[192:195], v[8:11], v[40:43]
    v_mfma_f32_16x16x32_bf16 v[44:47], v[248:251], v[8:11], v[44:47]
    s_waitcnt lgkmcnt(0)
    v_mfma_f32_16x16x32_bf16 v[20:23], a[52:55], v[12:15], v[20:23]
    v_mfma_f32_16x16x32_bf16 v[24:27], a[108:111], v[12:15], v[24:27]
    v_mfma_f32_16x16x32_bf16 v[28:31], a[164:167], v[12:15], v[28:31]
    v_mfma_f32_16x16x32_bf16 v[32:35], a[220:223], v[12:15], v[32:35]
    v_mfma_f32_16x16x32_bf16 v[36:39], v[140:143], v[12:15], v[36:39]
    v_mfma_f32_16x16x32_bf16 v[40:43], v[196:199], v[12:15], v[40:43]
    v_mfma_f32_16x16x32_bf16 v[44:47], v[252:255], v[12:15], v[44:47]
    s_nop 7
    v_cvt_pk_bf16_f32 v48, v5, v20
    v_cvt_pk_bf16_f32 v49, v5, v21
    v_cvt_pk_bf16_f32 v50, v5, v22
    v_cvt_pk_bf16_f32 v51, v5, v23
    v_cvt_pk_bf16_f32 v52, v24, v28
    v_cvt_pk_bf16_f32 v53, v25, v29
    v_cvt_pk_bf16_f32 v54, v26, v30
    v_cvt_pk_bf16_f32 v55, v27, v31
    v_cvt_pk_bf16_f32 v56, v32, v36
    v_cvt_pk_bf16_f32 v57, v33, v37
    v_cvt_pk_bf16_f32 v58, v34, v38
    v_cvt_pk_bf16_f32 v59, v35, v39
    v_cvt_pk_bf16_f32 v60, v40, v44
    v_cvt_pk_bf16_f32 v61, v41, v45
    v_cvt_pk_bf16_f32 v62, v42, v46
    v_cvt_pk_bf16_f32 v63, v43, v47
    ds_read_b128 v[8:11], v2 offset:14336
    ds_read_b128 v[12:15], v2 offset:15360
    ds_read_b128 v[16:19], v2 offset:16384
    s_waitcnt lgkmcnt(2)
    v_mfma_f32_16x16x32_bf16 v[20:23], a[0:3], v[8:11], 0
    v_mfma_f32_16x16x32_bf16 v[24:27], a[56:59], v[8:11], 0
    v_mfma_f32_16x16x32_bf16 v[28:31], a[112:115], v[8:11], 0
    v_mfma_f32_16x16x32_bf16 v[32:35], a[168:171], v[8:11], 0
    v_mfma_f32_16x16x32_bf16 v[36:39], a[224:227], v[8:11], 0
    v_mfma_f32_16x16x32_bf16 v[40:43], v[144:147], v[8:11], 0
    v_mfma_f32_16x16x32_bf16 v[44:47], v[200:203], v[8:11], 0
    ds_read_b128 v[8:11], v2 offset:17408
    s_waitcnt lgkmcnt(2)
    v_mfma_f32_16x16x32_bf16 v[20:23], a[4:7], v[12:15], v[20:23]
    v_mfma_f32_16x16x32_bf16 v[24:27], a[60:63], v[12:15], v[24:27]
    v_mfma_f32_16x16x32_bf16 v[28:31], a[116:119], v[12:15], v[28:31]
    v_mfma_f32_16x16x32_bf16 v[32:35], a[172:175], v[12:15], v[32:35]
    v_mfma_f32_16x16x32_bf16 v[36:39], a[228:231], v[12:15], v[36:39]
    v_mfma_f32_16x16x32_bf16 v[40:43], v[148:151], v[12:15], v[40:43]
    v_mfma_f32_16x16x32_bf16 v[44:47], v[204:207], v[12:15], v[44:47]
    ds_read_b128 v[12:15], v2 offset:18432
    s_waitcnt lgkmcnt(2)
    v_mfma_f32_16x16x32_bf16 v[20:23], a[8:11], v[16:19], v[20:23]
    v_mfma_f32_16x16x32_bf16 v[24:27], a[64:67], v[16:19], v[24:27]
    v_mfma_f32_16x16x32_bf16 v[28:31], a[120:123], v[16:19], v[28:31]
    v_mfma_f32_16x16x32_bf16 v[32:35], a[176:179], v[16:19], v[32:35]
    v_mfma_f32_16x16x32_bf16 v[36:39], a[232:235], v[16:19], v[36:39]
    v_mfma_f32_16x16x32_bf16 v[40:43], v[152:155], v[16:19], v[40:43]
    v_mfma_f32_16x16x32_bf16 v[44:47], v[208:211], v[16:19], v[44:47]
    ds_read_b128 v[16:19], v2 offset:19456
    s_waitcnt lgkmcnt(2)
    v_mfma_f32_16x16x32_bf16 v[20:23], a[12:15], v[8:11], v[20:23]
    v_mfma_f32_16x16x32_bf16 v[24:27], a[68:71], v[8:11], v[24:27]
    v_mfma_f32_16x16x32_bf16 v[28:31], a[124:127], v[8:11], v[28:31]
    v_mfma_f32_16x16x32_bf16 v[32:35], a[180:183], v[8:11], v[32:35]
    v_mfma_f32_16x16x32_bf16 v[36:39], a[236:239], v[8:11], v[36:39]
    v_mfma_f32_16x16x32_bf16 v[40:43], v[156:159], v[8:11], v[40:43]
    v_mfma_f32_16x16x32_bf16 v[44:47], v[212:215], v[8:11], v[44:47]
    ds_read_b128 v[8:11], v2 offset:20480
    s_waitcnt lgkmcnt(2)
    v_mfma_f32_16x16x32_bf16 v[20:23], a[16:19], v[12:15], v[20:23]
    v_mfma_f32_16x16x32_bf16 v[24:27], a[72:75], v[12:15], v[24:27]
    v_mfma_f32_16x16x32_bf16 v[28:31], a[128:131], v[12:15], v[28:31]
    v_mfma_f32_16x16x32_bf16 v[32:35], a[184:187], v[12:15], v[32:35]
    v_mfma_f32_16x16x32_bf16 v[36:39], a[240:243], v[12:15], v[36:39]
    v_mfma_f32_16x16x32_bf16 v[40:43], v[160:163], v[12:15], v[40:43]
    v_mfma_f32_16x16x32_bf16 v[44:47], v[216:219], v[12:15], v[44:47]
    ds_read_b128 v[12:15], v2 offset:21504
    s_waitcnt lgkmcnt(2)
    v_mfma_f32_16x16x32_bf16 v[20:23], a[20:23], v[16:19], v[20:23]
    v_mfma_f32_16x16x32_bf16 v[24:27], a[76:79], v[16:19], v[24:27]
    v_mfma_f32_16x16x32_bf16 v[28:31], a[132:135], v[16:19], v[28:31]
    v_mfma_f32_16x16x32_bf16 v[32:35], a[188:191], v[16:19], v[32:35]
    v_mfma_f32_16x16x32_bf16 v[36:39], a[244:247], v[16:19], v[36:39]
    v_mfma_f32_16x16x32_bf16 v[40:43], v[164:167], v[16:19], v[40:43]
    v_mfma_f32_16x16x32_bf16 v[44:47], v[220:223], v[16:19], v[44:47]
    ds_read_b128 v[16:19], v2 offset:22528
    s_waitcnt lgkmcnt(2)
    v_mfma_f32_16x16x32_bf16 v[20:23], a[24:27], v[8:11], v[20:23]
    v_mfma_f32_16x16x32_bf16 v[24:27], a[80:83], v[8:11], v[24:27]
    v_mfma_f32_16x16x32_bf16 v[28:31], a[136:139], v[8:11], v[28:31]
    v_mfma_f32_16x16x32_bf16 v[32:35], a[192:195], v[8:11], v[32:35]
    v_mfma_f32_16x16x32_bf16 v[36:39], a[248:251], v[8:11], v[36:39]
    v_mfma_f32_16x16x32_bf16 v[40:43], v[168:171], v[8:11], v[40:43]
    v_mfma_f32_16x16x32_bf16 v[44:47], v[224:227], v[8:11], v[44:47]
    ds_read_b128 v[8:11], v2 offset:23552
    s_waitcnt lgkmcnt(2)
    v_mfma_f32_16x16x32_bf16 v[20:23], a[28:31], v[12:15], v[20:23]
    v_mfma_f32_16x16x32_bf16 v[24:27], a[84:87], v[12:15], v[24:27]
    v_mfma_f32_16x16x32_bf16 v[28:31], a[140:143], v[12:15], v[28:31]
    v_mfma_f32_16x16x32_bf16 v[32:35], a[196:199], v[12:15], v[32:35]
    v_mfma_f32_16x16x32_bf16 v[36:39], a[252:255], v[12:15], v[36:39]
    v_mfma_f32_16x16x32_bf16 v[40:43], v[172:175], v[12:15], v[40:43]
    v_mfma_f32_16x16x32_bf16 v[44:47], v[228:231], v[12:15], v[44:47]
    ds_read_b128 v[12:15], v2 offset:24576
    s_waitcnt lgkmcnt(2)
    v_mfma_f32_16x16x32_bf16 v[20:23], a[32:35], v[16:19], v[20:23]
    v_mfma_f32_16x16x32_bf16 v[24:27], a[88:91], v[16:19], v[24:27]
    v_mfma_f32_16x16x32_bf16 v[28:31], a[144:147], v[16:19], v[28:31]
    v_mfma_f32_16x16x32_bf16 v[32:35], a[200:203], v[16:19], v[32:35]
    v_mfma_f32_16x16x32_bf16 v[36:39], v[120:123], v[16:19], v[36:39]
    v_mfma_f32_16x16x32_bf16 v[40:43], v[176:179], v[16:19], v[40:43]
    v_mfma_f32_16x16x32_bf16 v[44:47], v[232:235], v[16:19], v[44:47]
    ds_read_b128 v[16:19], v2 offset:25600
    s_waitcnt lgkmcnt(2)
    v_mfma_f32_16x16x32_bf16 v[20:23], a[36:39], v[8:11], v[20:23]
    v_mfma_f32_16x16x32_bf16 v[24:27], a[92:95], v[8:11], v[24:27]
    v_mfma_f32_16x16x32_bf16 v[28:31], a[148:151], v[8:11], v[28:31]
    v_mfma_f32_16x16x32_bf16 v[32:35], a[204:207], v[8:11], v[32:35]
    v_mfma_f32_16x16x32_bf16 v[36:39], v[124:127], v[8:11], v[36:39]
    v_mfma_f32_16x16x32_bf16 v[40:43], v[180:183], v[8:11], v[40:43]
    v_mfma_f32_16x16x32_bf16 v[44:47], v[236:239], v[8:11], v[44:47]
    ds_read_b128 v[8:11], v2 offset:26624
    s_waitcnt lgkmcnt(2)
    v_mfma_f32_16x16x32_bf16 v[20:23], a[40:43], v[12:15], v[20:23]
    v_mfma_f32_16x16x32_bf16 v[24:27], a[96:99], v[12:15], v[24:27]
    v_mfma_f32_16x16x32_bf16 v[28:31], a[152:155], v[12:15], v[28:31]
    v_mfma_f32_16x16x32_bf16 v[32:35], a[208:211], v[12:15], v[32:35]
    v_mfma_f32_16x16x32_bf16 v[36:39], v[128:131], v[12:15], v[36:39]
    v_mfma_f32_16x16x32_bf16 v[40:43], v[184:187], v[12:15], v[40:43]
    v_mfma_f32_16x16x32_bf16 v[44:47], v[240:243], v[12:15], v[44:47]
    ds_read_b128 v[12:15], v2 offset:27648
    s_waitcnt lgkmcnt(2)
    v_mfma_f32_16x16x32_bf16 v[20:23], a[44:47], v[16:19], v[20:23]
    v_mfma_f32_16x16x32_bf16 v[24:27], a[100:103], v[16:19], v[24:27]
    v_mfma_f32_16x16x32_bf16 v[28:31], a[156:159], v[16:19], v[28:31]
    v_mfma_f32_16x16x32_bf16 v[32:35], a[212:215], v[16:19], v[32:35]
    v_mfma_f32_16x16x32_bf16 v[36:39], v[132:135], v[16:19], v[36:39]
    v_mfma_f32_16x16x32_bf16 v[40:43], v[188:191], v[16:19], v[40:43]
    v_mfma_f32_16x16x32_bf16 v[44:47], v[244:247], v[16:19], v[44:47]
    s_waitcnt lgkmcnt(1)
    v_mfma_f32_16x16x32_bf16 v[20:23], a[48:51], v[8:11], v[20:23]
    v_mfma_f32_16x16x32_bf16 v[24:27], a[104:107], v[8:11], v[24:27]
    v_mfma_f32_16x16x32_bf16 v[28:31], a[160:163], v[8:11], v[28:31]
    v_mfma_f32_16x16x32_bf16 v[32:35], a[216:219], v[8:11], v[32:35]
    v_mfma_f32_16x16x32_bf16 v[36:39], v[136:139], v[8:11], v[36:39]
    v_mfma_f32_16x16x32_bf16 v[40:43], v[192:195], v[8:11], v[40:43]
    v_mfma_f32_16x16x32_bf16 v[44:47], v[248:251], v[8:11], v[44:47]
    s_waitcnt lgkmcnt(0)
    v_mfma_f32_16x16x32_bf16 v[20:23], a[52:55], v[12:15], v[20:23]
    v_mfma_f32_16x16x32_bf16 v[24:27], a[108:111], v[12:15], v[24:27]
    v_mfma_f32_16x16x32_bf16 v[28:31], a[164:167], v[12:15], v[28:31]
    v_mfma_f32_16x16x32_bf16 v[32:35], a[220:223], v[12:15], v[32:35]
    v_mfma_f32_16x16x32_bf16 v[36:39], v[140:143], v[12:15], v[36:39]
    v_mfma_f32_16x16x32_bf16 v[40:43], v[196:199], v[12:15], v[40:43]
    v_mfma_f32_16x16x32_bf16 v[44:47], v[252:255], v[12:15], v[44:47]
    s_nop 7
    v_cvt_pk_bf16_f32 v64, v5, v20
    v_cvt_pk_bf16_f32 v65, v5, v21
    v_cvt_pk_bf16_f32 v66, v5, v22
    v_cvt_pk_bf16_f32 v67, v5, v23
    v_cvt_pk_bf16_f32 v68, v24, v28
    v_cvt_pk_bf16_f32 v69, v25, v29
    v_cvt_pk_bf16_f32 v70, v26, v30
    v_cvt_pk_bf16_f32 v71, v27, v31
    v_cvt_pk_bf16_f32 v72, v32, v36
    v_cvt_pk_bf16_f32 v73, v33, v37
    v_cvt_pk_bf16_f32 v74, v34, v38
    v_cvt_pk_bf16_f32 v75, v35, v39
    v_cvt_pk_bf16_f32 v76, v40, v44
    v_cvt_pk_bf16_f32 v77, v41, v45
    v_cvt_pk_bf16_f32 v78, v42, v46
    v_cvt_pk_bf16_f32 v79, v43, v47
    ds_read_b128 v[80:83], v119 offset:10240
    ds_read_b128 v[84:87], v119 offset:11264
    ds_read_b128 v[88:91], v119 offset:12288
    ds_read_b128 v[92:95], v119 offset:13312
    s_waitcnt lgkmcnt(3)
    v_mfma_f32_16x16x32_bf16 v[20:23], v[80:83], v[48:51], 0
    v_mfma_f32_16x16x32_bf16 v[24:27], v[80:83], v[64:67], 0
    s_waitcnt lgkmcnt(2)
    v_mfma_f32_16x16x32_bf16 v[20:23], v[84:87], v[52:55], v[20:23]
    v_mfma_f32_16x16x32_bf16 v[24:27], v[84:87], v[68:71], v[24:27]
    s_waitcnt lgkmcnt(1)
    v_mfma_f32_16x16x32_bf16 v[20:23], v[88:91], v[56:59], v[20:23]
    v_mfma_f32_16x16x32_bf16 v[24:27], v[88:91], v[72:75], v[24:27]
    s_waitcnt lgkmcnt(0)
    v_mfma_f32_16x16x32_bf16 v[20:23], v[92:95], v[60:63], v[20:23]
    v_mfma_f32_16x16x32_bf16 v[24:27], v[92:95], v[76:79], v[24:27]
    ds_read_b128 v[80:83], v119 offset:24576
    ds_read_b128 v[84:87], v119 offset:25600
    ds_read_b128 v[88:91], v119 offset:26624
    ds_read_b128 v[92:95], v119 offset:27648
    s_waitcnt lgkmcnt(3)
    v_mfma_f32_16x16x32_bf16 v[28:31], v[80:83], v[64:67], 0
    s_waitcnt lgkmcnt(2)
    v_mfma_f32_16x16x32_bf16 v[28:31], v[84:87], v[68:71], v[28:31]
    s_waitcnt lgkmcnt(1)
    v_mfma_f32_16x16x32_bf16 v[28:31], v[88:91], v[72:75], v[28:31]
    s_waitcnt lgkmcnt(0)
    v_mfma_f32_16x16x32_bf16 v[28:31], v[92:95], v[76:79], v[28:31]
    s_nop 7
    ds_write_b128 v1, v[20:23] offset:9216
    ds_write_b128 v1, v[24:27] offset:10240
    ds_write_b128 v1, v[28:31] offset:11264
    s_waitcnt lgkmcnt(0)
    s_barrier
    s_lshl_b32 s11, s17, 13
    s_add_u32 s11, s11, 0x3081400
    s_mov_b32 s22, 0
spin_668:
    buffer_load_dwordx2 v[80:81], v4, s[4:7], s11 offen offset:0 sc1
    buffer_load_dwordx2 v[82:83], v4, s[4:7], s11 offen offset:32 sc1
    buffer_load_dwordx2 v[84:85], v4, s[4:7], s11 offen offset:512 sc1
    buffer_load_dwordx2 v[86:87], v4, s[4:7], s11 offen offset:544 sc1
    buffer_load_dwordx2 v[88:89], v4, s[4:7], s11 offen offset:1024 sc1
    buffer_load_dwordx2 v[90:91], v4, s[4:7], s11 offen offset:1056 sc1
    buffer_load_dwordx2 v[92:93], v4, s[4:7], s11 offen offset:1536 sc1
    buffer_load_dwordx2 v[94:95], v4, s[4:7], s11 offen offset:1568 sc1
    s_waitcnt vmcnt(0)
spin2_670:
    v_max3_u32 v3, v80, v81, v82
    v_max3_u32 v3, v3, v83, v84
    v_max3_u32 v3, v3, v85, v86
    v_max3_u32 v3, v3, v87, v88
    v_max3_u32 v3, v3, v89, v90
    v_max3_u32 v3, v3, v91, v92
    v_max3_u32 v3, v3, v93, v94
    v_max_u32 v3, v3, v95
    v_cmp_eq_u32 vcc, -1, v3
    s_cbranch_vccz spok_669
    s_add_u32 s22, s22, 1
    s_cmp_gt_u32 s22, 65536
    s_cbranch_scc1 M_exit
    s_sleep 1
    s_branch spin_668
spok_669:
    v_swap_b32 v81, v82
    v_swap_b32 v85, v86
    v_swap_b32 v89, v90
    v_swap_b32 v93, v94
    s_nop 1
    v_mfma_f32_16x16x32_bf16 v[20:23], v[80:83], v[48:51], 0
    v_mfma_f32_16x16x32_bf16 v[24:27], v[80:83], v[64:67], 0
    v_mfma_f32_16x16x32_bf16 v[20:23], v[84:87], v[52:55], v[20:23]
    v_mfma_f32_16x16x32_bf16 v[24:27], v[84:87], v[68:71], v[24:27]
    v_mfma_f32_16x16x32_bf16 v[20:23], v[88:91], v[56:59], v[20:23]
    v_mfma_f32_16x16x32_bf16 v[24:27], v[88:91], v[72:75], v[24:27]
    v_mfma_f32_16x16x32_bf16 v[20:23], v[92:95], v[60:63], v[20:23]
    v_mfma_f32_16x16x32_bf16 v[24:27], v[92:95], v[76:79], v[24:27]
    s_nop 7
    ds_write_b64 v1, v[20:21] offset:15360
    ds_write_b64 v1, v[24:25] offset:15368
    s_waitcnt lgkmcnt(0)
    s_barrier
    s_add_u32 s17, s17, 4
    s_cmp_lt_u32 s17, 64
    s_cbranch_scc1 sx_loop_665
    s_branch M_exit
M_F:
    s_cmp_ge_u32 s9, 28
    s_cbranch_scc1 M_exit
    v_and_b32 v0, 63, v0
    v_lshlrev_b32 v1, 4, v0
    v_lshlrev_b32 v2, 3, v0
    v_mov_b32 v7, 0
    s_mov_b32 s40, -1
    s_mov_b32 s41, 0
    v_mov_b32 v156, -1
    v_mov_b32 v157, -1
    v_mov_b32 v158, -1
    v_mov_b32 v159, -1
    s_mul_i32 s11, s10, 28672
    v_add_u32 v5, s11, v2
    s_mov_b32 s72, s66
    s_mov_b32 s73, s67
    s_mov_b32 s74, 0x188000
    s_mov_b32 s75, 0x00020000
    s_lshl_b32 s12, s9, 8
    s_lshl_b32 s13, s10, 6
    s_add_u32 s12, s12, s13
    v_bfe_u32 v3, v0, 3, 2
    v_lshlrev_b32 v3, 3, v3
    v_lshrrev_b32 v4, 5, v0
    v_lshl_add_u32 v3, v4, 2, v3
    v_bfe_u32 v4, v0, 1, 2
    v_add_u32 v3, v3, v4
    v_mul_u32_u24 v3, 3584, v3
    v_and_b32 v4, 1, v0
    v_lshl_add_u32 v3, v4, 4, v3
    s_add_u32 m0, s11, 0
    s_add_u32 s13, s12, 0
    buffer_load_dwordx4 v3, s[72:75], s13 offen lds
    s_add_u32 m0, s11, 1024
    s_add_u32 s13, s12, 114688
    buffer_load_dwordx4 v3, s[72:75], s13 offen lds
    s_add_u32 m0, s11, 2048
    s_add_u32 s13, s12, 229376
    buffer_load_dwordx4 v3, s[72:75], s13 offen lds
    s_add_u32 m0, s11, 3072
    s_add_u32 s13, s12, 344064
    buffer_load_dwordx4 v3, s[72:75], s13 offen lds
    s_add_u32 m0, s11, 4096
    s_add_u32 s13, s12, 458752
    buffer_load_dwordx4 v3, s[72:75], s13 offen lds
    s_add_u32 m0, s11, 5120
    s_add_u32 s13, s12, 573440
    buffer_load_dwordx4 v3, s[72:75], s13 offen lds
    s_add_u32 m0, s11, 6144
    s_add_u32 s13, s12, 688128
    buffer_load_dwordx4 v3, s[72:75], s13 offen lds
    s_add_u32 m0, s11, 7168
    s_add_u32 s13, s12, 802816
    buffer_load_dwordx4 v3, s[72:75], s13 offen lds
    s_add_u32 m0, s11, 8192
    s_add_u32 s13, s12, 917504
    buffer_load_dwordx4 v3, s[72:75], s13 offen lds
    s_add_u32 m0, s11, 9216
    s_add_u32 s13, s12, 1032192
    buffer_load_dwordx4 v3, s[72:75], s13 offen lds
    s_add_u32 m0, s11, 10240
    s_add_u32 s13, s12, 1146880
    buffer_load_dwordx4 v3, s[72:75], s13 offen lds
    s_add_u32 m0, s11, 11264
    s_add_u32 s13, s12, 1261568
    buffer_load_dwordx4 v3, s[72:75], s13 offen lds
    s_add_u32 m0, s11, 12288
    s_add_u32 s13, s12, 1376256
    buffer_load_dwordx4 v3, s[72:75], s13 offen lds
    s_add_u32 m0, s11, 13312
    s_add_u32 s13, s12, 1490944
    buffer_load_dwordx4 v3, s[72:75], s13 offen lds
    s_add_u32 m0, s11, 14336
    s_add_u32 s13, s12, 32
    buffer_load_dwordx4 v3, s[72:75], s13 offen lds
    s_add_u32 m0, s11, 15360
    s_add_u32 s13, s12, 114720
    buffer_load_dwordx4 v3, s[72:75], s13 offen lds
    s_add_u32 m0, s11, 16384
    s_add_u32 s13, s12, 229408
    buffer_load_dwordx4 v3, s[72:75], s13 offen lds
    s_add_u32 m0, s11, 17408
    s_add_u32 s13, s12, 344096
    buffer_load_dwordx4 v3, s[72:75], s13 offen lds
    s_add_u32 m0, s11, 18432
    s_add_u32 s13, s12, 458784
    buffer_load_dwordx4 v3, s[72:75], s13 offen lds
    s_add_u32 m0, s11, 19456
    s_add_u32 s13, s12, 573472
    buffer_load_dwordx4 v3, s[72:75], s13 offen lds
    s_add_u32 m0, s11, 20480
    s_add_u32 s13, s12, 688160
    buffer_load_dwordx4 v3, s[72:75], s13 offen lds
    s_add_u32 m0, s11, 21504
    s_add_u32 s13, s12, 802848
    buffer_load_dwordx4 v3, s[72:75], s13 offen lds
    s_add_u32 m0, s11, 22528
    s_add_u32 s13, s12, 917536
    buffer_load_dwordx4 v3, s[72:75], s13 offen lds
    s_add_u32 m0, s11, 23552
    s_add_u32 s13, s12, 1032224
    buffer_load_dwordx4 v3, s[72:75], s13 offen lds
    s_add_u32 m0, s11, 24576
    s_add_u32 s13, s12, 1146912
    buffer_load_dwordx4 v3, s[72:75], s13 offen lds
    s_add_u32 m0, s11, 25600
    s_add_u32 s13, s12, 1261600
    buffer_load_dwordx4 v3, s[72:75], s13 offen lds
    s_add_u32 m0, s11, 26624
    s_add_u32 s13, s12, 1376288
    buffer_load_dwordx4 v3, s[72:75], s13 offen lds
    s_add_u32 m0, s11, 27648
    s_add_u32 s13, s12, 1490976
    buffer_load_dwordx4 v3, s[72:75], s13 offen lds
    s_waitcnt vmcnt(0)
    ds_read_b64_tr_b16 a[0:1], v5 offset:0
    ds_read_b64_tr_b16 a[2:3], v5 offset:512
    ds_read_b64_tr_b16 a[4:5], v5 offset:1024
    ds_read_b64_tr_b16 a[6:7], v5 offset:1536
    ds_read_b64_tr_b16 a[8:9], v5 offset:2048
    ds_read_b64_tr_b16 a[10:11], v5 offset:2560
    ds_read_b64_tr_b16 a[12:13], v5 offset:3072
    ds_read_b64_tr_b16 a[14:15], v5 offset:3584
    s_waitcnt lgkmcnt(0)
    ds_read_b64_tr_b16 a[16:17], v5 offset:4096
    ds_read_b64_tr_b16 a[18:19], v5 offset:4608
    ds_read_b64_tr_b16 a[20:21], v5 offset:5120
    ds_read_b64_tr_b16 a[22:23], v5 offset:5632
    ds_read_b64_tr_b16 a[24:25], v5 offset:6144
    ds_read_b64_tr_b16 a[26:27], v5 offset:6656
    ds_read_b64_tr_b16 a[28:29], v5 offset:7168
    ds_read_b64_tr_b16 a[30:31], v5 offset:7680
    s_waitcnt lgkmcnt(0)
    ds_read_b64_tr_b16 a[32:33], v5 offset:8192
    ds_read_b64_tr_b16 a[34:35], v5 offset:8704
    ds_read_b64_tr_b16 a[36:37], v5 offset:9216
    ds_read_b64_tr_b16 a[38:39], v5 offset:9728
    ds_read_b64_tr_b16 a[40:41], v5 offset:10240
    ds_read_b64_tr_b16 a[42:43], v5 offset:10752
    ds_read_b64_tr_b16 a[44:45], v5 offset:11264
    ds_read_b64_tr_b16 a[46:47], v5 offset:11776
    s_waitcnt lgkmcnt(0)
    ds_read_b64_tr_b16 a[48:49], v5 offset:12288
    ds_read_b64_tr_b16 a[50:51], v5 offset:12800
    ds_read_b64_tr_b16 a[52:53], v5 offset:13312
    ds_read_b64_tr_b16 a[54:55], v5 offset:13824
    ds_read_b64_tr_b16 a[56:57], v5 offset:14336
    ds_read_b64_tr_b16 a[58:59], v5 offset:14848
    ds_read_b64_tr_b16 a[60:61], v5 offset:15360
    ds_read_b64_tr_b16 a[62:63], v5 offset:15872
    s_waitcnt lgkmcnt(0)
    ds_read_b64_tr_b16 a[64:65], v5 offset:16384
    ds_read_b64_tr_b16 a[66:67], v5 offset:16896
    ds_read_b64_tr_b16 a[68:69], v5 offset:17408
    ds_read_b64_tr_b16 a[70:71], v5 offset:17920
    ds_read_b64_tr_b16 a[72:73], v5 offset:18432
    ds_read_b64_tr_b16 a[74:75], v5 offset:18944
    ds_read_b64_tr_b16 a[76:77], v5 offset:19456
    ds_read_b64_tr_b16 a[78:79], v5 offset:19968
    s_waitcnt lgkmcnt(0)
    ds_read_b64_tr_b16 a[80:81], v5 offset:20480
    ds_read_b64_tr_b16 a[82:83], v5 offset:20992
    ds_read_b64_tr_b16 a[84:85], v5 offset:21504
    ds_read_b64_tr_b16 a[86:87], v5 offset:22016
    ds_read_b64_tr_b16 a[88:89], v5 offset:22528
    ds_read_b64_tr_b16 a[90:91], v5 offset:23040
    ds_read_b64_tr_b16 a[92:93], v5 offset:23552
    ds_read_b64_tr_b16 a[94:95], v5 offset:24064
    s_waitcnt lgkmcnt(0)
    ds_read_b64_tr_b16 a[96:97], v5 offset:24576
    ds_read_b64_tr_b16 a[98:99], v5 offset:25088
    ds_read_b64_tr_b16 a[100:101], v5 offset:25600
    ds_read_b64_tr_b16 a[102:103], v5 offset:26112
    ds_read_b64_tr_b16 a[104:105], v5 offset:26624
    ds_read_b64_tr_b16 a[106:107], v5 offset:27136
    ds_read_b64_tr_b16 a[108:109], v5 offset:27648
    ds_read_b64_tr_b16 a[110:111], v5 offset:28160
    s_waitcnt lgkmcnt(0)
    s_mov_b32 s72, s68
    s_mov_b32 s73, s69
    s_mov_b32 s74, 0x188000
    s_mov_b32 s75, 0x00020000
    s_mul_i32 s12, s9, 114688
    s_mul_i32 s13, s10, 224
    s_add_u32 s12, s12, s13
    v_lshrrev_b32 v3, 1, v0
    v_mul_u32_u24 v3, 896, v3
    v_and_b32 v4, 1, v0
    v_lshl_add_u32 v3, v4, 4, v3
    s_add_u32 m0, s11, 0
    s_add_u32 s13, s12, 0
    buffer_load_dwordx4 v3, s[72:75], s13 offen lds
    s_add_u32 m0, s11, 1024
    s_add_u32 s13, s12, 28672
    buffer_load_dwordx4 v3, s[72:75], s13 offen lds
    s_add_u32 m0, s11, 2048
    s_add_u32 s13, s12, 57344
    buffer_load_dwordx4 v3, s[72:75], s13 offen lds
    s_add_u32 m0, s11, 3072
    s_add_u32 s13, s12, 86016
    buffer_load_dwordx4 v3, s[72:75], s13 offen lds
    s_add_u32 m0, s11, 4096
    s_add_u32 s13, s12, 32
    buffer_load_dwordx4 v3, s[72:75], s13 offen lds
    s_add_u32 m0, s11, 5120
    s_add_u32 s13, s12, 28704
    buffer_load_dwordx4 v3, s[72:75], s13 offen lds
    s_add_u32 m0, s11, 6144
    s_add_u32 s13, s12, 57376
    buffer_load_dwordx4 v3, s[72:75], s13 offen lds
    s_add_u32 m0, s11, 7168
    s_add_u32 s13, s12, 86048
    buffer_load_dwordx4 v3, s[72:75], s13 offen lds
    s_add_u32 m0, s11, 8192
    s_add_u32 s13, s12, 64
    buffer_load_dwordx4 v3, s[72:75], s13 offen lds
    s_add_u32 m0, s11, 9216
    s_add_u32 s13, s12, 28736
    buffer_load_dwordx4 v3, s[72:75], s13 offen lds
    s_add_u32 m0, s11, 10240
    s_add_u32 s13, s12, 57408
    buffer_load_dwordx4 v3, s[72:75], s13 offen lds
    s_add_u32 m0, s11, 11264
    s_add_u32 s13, s12, 86080
    buffer_load_dwordx4 v3, s[72:75], s13 offen lds
    s_add_u32 m0, s11, 12288
    s_add_u32 s13, s12, 96
    buffer_load_dwordx4 v3, s[72:75], s13 offen lds
    s_add_u32 m0, s11, 13312
    s_add_u32 s13, s12, 28768
    buffer_load_dwordx4 v3, s[72:75], s13 offen lds
    s_add_u32 m0, s11, 14336
    s_add_u32 s13, s12, 57440
    buffer_load_dwordx4 v3, s[72:75], s13 offen lds
    s_add_u32 m0, s11, 15360
    s_add_u32 s13, s12, 86112
    buffer_load_dwordx4 v3, s[72:75], s13 offen lds
    s_add_u32 m0, s11, 16384
    s_add_u32 s13, s12, 128
    buffer_load_dwordx4 v3, s[72:75], s13 offen lds
    s_add_u32 m0, s11, 17408
    s_add_u32 s13, s12, 28800
    buffer_load_dwordx4 v3, s[72:75], s13 offen lds
    s_add_u32 m0, s11, 18432
    s_add_u32 s13, s12, 57472
    buffer_load_dwordx4 v3, s[72:75], s13 offen lds
    s_add_u32 m0, s11, 19456
    s_add_u32 s13, s12, 86144
    buffer_load_dwordx4 v3, s[72:75], s13 offen lds
    s_add_u32 m0, s11, 20480
    s_add_u32 s13, s12, 160
    buffer_load_dwordx4 v3, s[72:75], s13 offen lds
    s_add_u32 m0, s11, 21504
    s_add_u32 s13, s12, 28832
    buffer_load_dwordx4 v3, s[72:75], s13 offen lds
    s_add_u32 m0, s11, 22528
    s_add_u32 s13, s12, 57504
    buffer_load_dwordx4 v3, s[72:75], s13 offen lds
    s_add_u32 m0, s11, 23552
    s_add_u32 s13, s12, 86176
    buffer_load_dwordx4 v3, s[72:75], s13 offen lds
    s_add_u32 m0, s11, 24576
    s_add_u32 s13, s12, 192
    buffer_load_dwordx4 v3, s[72:75], s13 offen lds
    s_add_u32 m0, s11, 25600
    s_add_u32 s13, s12, 28864
    buffer_load_dwordx4 v3, s[72:75], s13 offen lds
    s_add_u32 m0, s11, 26624
    s_add_u32 s13, s12, 57536
    buffer_load_dwordx4 v3, s[72:75], s13 offen lds
    s_add_u32 m0, s11, 27648
    s_add_u32 s13, s12, 86208
    buffer_load_dwordx4 v3, s[72:75], s13 offen lds
    s_waitcnt vmcnt(0)
    ds_read_b64_tr_b16 a[112:113], v5 offset:0
    ds_read_b64_tr_b16 a[114:115], v5 offset:512
    ds_read_b64_tr_b16 a[116:117], v5 offset:1024
    ds_read_b64_tr_b16 a[118:119], v5 offset:1536
    ds_read_b64_tr_b16 a[120:121], v5 offset:2048
    ds_read_b64_tr_b16 a[122:123], v5 offset:2560
    ds_read_b64_tr_b16 a[124:125], v5 offset:3072
    ds_read_b64_tr_b16 a[126:127], v5 offset:3584
    s_waitcnt lgkmcnt(0)
    ds_read_b64_tr_b16 a[128:129], v5 offset:4096
    ds_read_b64_tr_b16 a[130:131], v5 offset:4608
    ds_read_b64_tr_b16 a[132:133], v5 offset:5120
    ds_read_b64_tr_b16 a[134:135], v5 offset:5632
    ds_read_b64_tr_b16 a[136:137], v5 offset:6144
    ds_read_b64_tr_b16 a[138:139], v5 offset:6656
    ds_read_b64_tr_b16 a[140:141], v5 offset:7168
    ds_read_b64_tr_b16 a[142:143], v5 offset:7680
    s_waitcnt lgkmcnt(0)
    ds_read_b64_tr_b16 a[144:145], v5 offset:8192
    ds_read_b64_tr_b16 a[146:147], v5 offset:8704
    ds_read_b64_tr_b16 a[148:149], v5 offset:9216
    ds_read_b64_tr_b16 a[150:151], v5 offset:9728
    ds_read_b64_tr_b16 a[152:153], v5 offset:10240
    ds_read_b64_tr_b16 a[154:155], v5 offset:10752
    ds_read_b64_tr_b16 a[156:157], v5 offset:11264
    ds_read_b64_tr_b16 a[158:159], v5 offset:11776
    s_waitcnt lgkmcnt(0)
    ds_read_b64_tr_b16 a[160:161], v5 offset:12288
    ds_read_b64_tr_b16 a[162:163], v5 offset:12800
    ds_read_b64_tr_b16 a[164:165], v5 offset:13312
    ds_read_b64_tr_b16 a[166:167], v5 offset:13824
    ds_read_b64_tr_b16 a[168:169], v5 offset:14336
    ds_read_b64_tr_b16 a[170:171], v5 offset:14848
    ds_read_b64_tr_b16 a[172:173], v5 offset:15360
    ds_read_b64_tr_b16 a[174:175], v5 offset:15872
    s_waitcnt lgkmcnt(0)
    ds_read_b64_tr_b16 a[176:177], v5 offset:16384
    ds_read_b64_tr_b16 a[178:179], v5 offset:16896
    ds_read_b64_tr_b16 a[180:181], v5 offset:17408
    ds_read_b64_tr_b16 a[182:183], v5 offset:17920
    ds_read_b64_tr_b16 a[184:185], v5 offset:18432
    ds_read_b64_tr_b16 a[186:187], v5 offset:18944
    ds_read_b64_tr_b16 a[188:189], v5 offset:19456
    ds_read_b64_tr_b16 a[190:191], v5 offset:19968
    s_waitcnt lgkmcnt(0)
    ds_read_b64_tr_b16 a[192:193], v5 offset:20480
    ds_read_b64_tr_b16 a[194:195], v5 offset:20992
    ds_read_b64_tr_b16 a[196:197], v5 offset:21504
    ds_read_b64_tr_b16 a[198:199], v5 offset:22016
    ds_read_b64_tr_b16 a[200:201], v5 offset:22528
    ds_read_b64_tr_b16 a[202:203], v5 offset:23040
    ds_read_b64_tr_b16 a[204:205], v5 offset:23552
    ds_read_b64_tr_b16 a[206:207], v5 offset:24064
    s_waitcnt lgkmcnt(0)
    ds_read_b64_tr_b16 a[208:209], v5 offset:24576
    ds_read_b64_tr_b16 a[210:211], v5 offset:25088
    ds_read_b64_tr_b16 a[212:213], v5 offset:25600
    ds_read_b64_tr_b16 a[214:215], v5 offset:26112
    ds_read_b64_tr_b16 a[216:217], v5 offset:26624
    ds_read_b64_tr_b16 a[218:219], v5 offset:27136
    ds_read_b64_tr_b16 a[220:221], v5 offset:27648
    ds_read_b64_tr_b16 a[222:223], v5 offset:28160
    s_waitcnt lgkmcnt(0)
    s_mov_b32 s76, s70
    s_mov_b32 s77, s71
    s_mov_b32 s78, 0x1c0000
    s_mov_b32 s79, 0x00020000
    v_lshrrev_b32 v5, 3, v0
    v_lshlrev_b32 v3, 9, v5
    v_mov_b32 v10, v3
    v_and_b32 v5, 7, v0
    v_lshl_add_u32 v3, v5, 4, v3
    s_lshl_b32 s11, s10, 7
    v_add_u32 v3, s11, v3
    v_and_b32 v5, 1, v0
    v_lshl_add_u32 v10, v5, 8, v10
    v_bfe_u32 v5, v0, 1, 2
    v_lshl_add_u32 v10, v5, 4, v10
    s_lshl_b32 s11, s10, 6
    v_add_u32 v10, s11, v10
    v_and_b32 v5, 15, v0
    v_lshlrev_b32 v11, 5, v5
    v_lshrrev_b32 v5, 4, v0
    v_lshl_add_u32 v11, v5, 3, v11
    v_mov_b32 v5, 0x7ffffff0
    v_cndmask_b32 v4, v5, v3, s[40:41]
    v_and_b32 v5, 15, v0
    v_mul_u32_u24 v6, 896, v5
    v_lshrrev_b32 v5, 4, v0
    v_lshl_add_u32 v6, v5, 3, v6
    s_and_b32 s12, s10, 1
    s_lshl_b32 s11, s9, 1
    s_add_u32 s11, s11, s12
    s_lshl_b32 s11, s11, 5
    v_add_u32 v6, s11, v6
    v_min_u32 v8, 13, v0
    v_lshlrev_b32 v8, 2, v8
    s_mov_b32 s11, 0x3b02800
    v_min_u32 v9, 51, v0
    v_lshlrev_b32 v9, 4, v9
    s_mov_b32 s22, 0
wt_671:
    buffer_load_dwordx4 v[16:19], v9, s[4:7], s11 offen offset:0 sc1
    s_waitcnt vmcnt(0)
    v_xor_b32 v16, s80, v16
    v_xor_b32 v17, s81, v17
    v_and_b32 v17, -16, v17
    v_xor_b32 v18, s80, v18
    v_xor_b32 v19, s81, v19
    v_and_b32 v19, -16, v19
    v_or3_b32 v16, v16, v17, v18
    v_or_b32 v16, v16, v19
    v_cmp_ne_u32 vcc, 0, v16
    s_cbranch_vccz wtok_672
    s_add_u32 s22, s22, 1
    s_cmp_gt_u32 s22, 65536
    s_cbranch_scc1 M_exit
    s_sleep 16
    s_branch wt_671
wtok_672:
    s_barrier
    s_mov_b32 s17, s15
    s_mov_b32 s16, 1
    s_and_b32 s12, s2, 7
    s_lshl_b32 s12, s12, 5
    s_lshr_b32 s13, s2, 3
    s_add_u32 s12, s12, s13
    s_sub_u32 s12, s12, s9
    s_getreg_b32 s27, hwreg(HW_REG_XCC_ID, 0, 4)
    v_min_u32 v8, 13, v0
    v_lshlrev_b32 v8, 3, v8
    s_lshl_b32 s11, s12, 3
    s_add_u32 s11, s11, 0x3b02000
    buffer_load_dword v5, v8, s[4:7], s11 offen offset:4 sc1
    s_waitcnt vmcnt(0)
    v_and_b32 v5, 15, v5
    v_cmp_ne_u32 vcc, s27, v5
    s_cbranch_vccnz f_mode_673
f_loop_674:
    s_mul_i32 s11, s17, 14336
    s_add_u32 s11, s11, 0x33a0000
    s_add_u32 s12, s11, 4096
    s_add_u32 s13, s11, 8192
    s_add_u32 s14, s11, 12288
    s_mov_b32 s22, 0
spin_675:
    buffer_load_dwordx4 v[16:19], v3, s[4:7], s11 offen sc1
    buffer_load_dwordx4 v[20:23], v3, s[4:7], s12 offen sc1
    buffer_load_dwordx4 v[24:27], v3, s[4:7], s13 offen sc1
    buffer_load_dwordx4 v[28:31], v4, s[4:7], s14 offen sc1
    s_waitcnt vmcnt(0)
spin2_677:
    v_max3_u32 v5, v16, v17, v18
    v_max3_u32 v5, v5, v19, v20
    v_max3_u32 v5, v5, v21, v22
    v_max3_u32 v5, v5, v23, v24
    v_max3_u32 v5, v5, v25, v26
    v_max3_u32 v5, v5, v27, v28
    v_max3_u32 v5, v5, v29, v30
    v_max_u32 v5, v5, v31
    v_cmp_eq_u32 vcc, -1, v5
    s_cbranch_vccz spok_676
    s_add_u32 s22, s22, 1
    s_cmp_gt_u32 s22, 65536
    s_cbranch_scc1 M_exit
    s_sleep 1
    s_branch spin_675
spok_676:
    v_lshlrev_b32 v32, 16, v16
    v_and_b32 v33, 0xffff0000, v16
    v_lshlrev_b32 v34, 16, v17
    v_and_b32 v35, 0xffff0000, v17
    v_lshlrev_b32 v36, 16, v18
    v_and_b32 v37, 0xffff0000, v18
    v_lshlrev_b32 v38, 16, v19
    v_and_b32 v39, 0xffff0000, v19
    v_lshlrev_b32 v40, 16, v20
    v_and_b32 v41, 0xffff0000, v20
    v_lshlrev_b32 v42, 16, v21
    v_and_b32 v43, 0xffff0000, v21
    v_lshlrev_b32 v44, 16, v22
    v_and_b32 v45, 0xffff0000, v22
    v_lshlrev_b32 v46, 16, v23
    v_and_b32 v47, 0xffff0000, v23
    v_lshlrev_b32 v48, 16, v24
    v_and_b32 v49, 0xffff0000, v24
    v_lshlrev_b32 v50, 16, v25
    v_and_b32 v51, 0xffff0000, v25
    v_lshlrev_b32 v52, 16, v26
    v_and_b32 v53, 0xffff0000, v26
    v_lshlrev_b32 v54, 16, v27
    v_and_b32 v55, 0xffff0000, v27
    v_lshlrev_b32 v56, 16, v28
    v_and_b32 v57, 0xffff0000, v28
    v_lshlrev_b32 v58, 16, v29
    v_and_b32 v59, 0xffff0000, v29
    v_lshlrev_b32 v60, 16, v30
    v_and_b32 v61, 0xffff0000, v30
    v_lshlrev_b32 v62, 16, v31
    v_and_b32 v63, 0xffff0000, v31
    v_pk_add_f32 v[160:161], v[32:33], v[34:35]
    v_pk_add_f32 v[162:163], v[36:37], v[38:39]
    v_pk_add_f32 v[160:161], v[160:161], v[40:41]
    v_pk_add_f32 v[162:163], v[162:163], v[42:43]
    v_pk_add_f32 v[160:161], v[160:161], v[44:45]
    v_pk_add_f32 v[162:163], v[162:163], v[46:47]
    v_pk_add_f32 v[160:161], v[160:161], v[48:49]
    v_pk_add_f32 v[162:163], v[162:163], v[50:51]
    v_pk_add_f32 v[160:161], v[160:161], v[52:53]
    v_pk_add_f32 v[162:163], v[162:163], v[54:55]
    v_pk_add_f32 v[160:161], v[160:161], v[56:57]
    v_pk_add_f32 v[162:163], v[162:163], v[58:59]
    v_pk_add_f32 v[160:161], v[160:161], v[60:61]
    v_pk_add_f32 v[162:163], v[162:163], v[62:63]
    v_pk_add_f32 v[160:161], v[160:161], v[162:163]
    v_add_f32 v160, v160, v161
    s_nop 1
    v_add_f32_dpp v160, v160, v160 quad_perm:[1,0,3,2] row_mask:0xf bank_mask:0xf
    s_nop 1
    v_add_f32_dpp v160, v160, v160 row_ror:8 row_mask:0xf bank_mask:0xf
    v_mov_b32 v166, v160
    s_nop 1
    v_permlane32_swap_b32 v160, v166
    v_add_f32 v160, v160, v166
    v_mov_b32 v166, v160
    s_nop 1
    v_permlane16_swap_b32 v160, v166
    v_add_f32 v160, v160, v166
    v_mul_f32 v160, 0x3b124925, v160
    v_mov_b32 v164, v160
    v_cvt_pk_bf16_f32 v164, v164, v164
    v_and_b32 v164, 0xffff0000, v164
    v_pk_add_f32 v[32:33], v[32:33], v[164:165] op_sel_hi:[1,0] neg_lo:[0,1] neg_hi:[0,1]
    v_pk_add_f32 v[34:35], v[34:35], v[164:165] op_sel_hi:[1,0] neg_lo:[0,1] neg_hi:[0,1]
    v_pk_add_f32 v[36:37], v[36:37], v[164:165] op_sel_hi:[1,0] neg_lo:[0,1] neg_hi:[0,1]
    v_pk_add_f32 v[38:39], v[38:39], v[164:165] op_sel_hi:[1,0] neg_lo:[0,1] neg_hi:[0,1]
    v_pk_add_f32 v[40:41], v[40:41], v[164:165] op_sel_hi:[1,0] neg_lo:[0,1] neg_hi:[0,1]
    v_pk_add_f32 v[42:43], v[42:43], v[164:165] op_sel_hi:[1,0] neg_lo:[0,1] neg_hi:[0,1]
    v_pk_add_f32 v[44:45], v[44:45], v[164:165] op_sel_hi:[1,0] neg_lo:[0,1] neg_hi:[0,1]
    v_pk_add_f32 v[46:47], v[46:47], v[164:165] op_sel_hi:[1,0] neg_lo:[0,1] neg_hi:[0,1]
    v_pk_add_f32 v[48:49], v[48:49], v[164:165] op_sel_hi:[1,0] neg_lo:[0,1] neg_hi:[0,1]
    v_pk_add_f32 v[50:51], v[50:51], v[164:165] op_sel_hi:[1,0] neg_lo:[0,1] neg_hi:[0,1]
    v_pk_add_f32 v[52:53], v[52:53], v[164:165] op_sel_hi:[1,0] neg_lo:[0,1] neg_hi:[0,1]
    v_pk_add_f32 v[54:55], v[54:55], v[164:165] op_sel_hi:[1,0] neg_lo:[0,1] neg_hi:[0,1]
    v_pk_add_f32 v[56:57], v[56:57], v[164:165] op_sel_hi:[1,0] neg_lo:[0,1] neg_hi:[0,1]
    v_pk_add_f32 v[58:59], v[58:59], v[164:165] op_sel_hi:[1,0] neg_lo:[0,1] neg_hi:[0,1]
    v_pk_add_f32 v[60:61], v[60:61], v[164:165] op_sel_hi:[1,0] neg_lo:[0,1] neg_hi:[0,1]
    v_pk_add_f32 v[62:63], v[62:63], v[164:165] op_sel_hi:[1,0] neg_lo:[0,1] neg_hi:[0,1]
    v_pk_mul_f32 v[162:163], v[32:33], v[32:33]
    v_pk_fma_f32 v[162:163], v[34:35], v[34:35], v[162:163]
    v_pk_fma_f32 v[162:163], v[36:37], v[36:37], v[162:163]
    v_pk_fma_f32 v[162:163], v[38:39], v[38:39], v[162:163]
    v_pk_fma_f32 v[162:163], v[40:41], v[40:41], v[162:163]
    v_pk_fma_f32 v[162:163], v[42:43], v[42:43], v[162:163]
    v_pk_fma_f32 v[162:163], v[44:45], v[44:45], v[162:163]
    v_pk_fma_f32 v[162:163], v[46:47], v[46:47], v[162:163]
    v_pk_fma_f32 v[162:163], v[48:49], v[48:49], v[162:163]
    v_pk_fma_f32 v[162:163], v[50:51], v[50:51], v[162:163]
    v_pk_fma_f32 v[162:163], v[52:53], v[52:53], v[162:163]
    v_pk_fma_f32 v[162:163], v[54:55], v[54:55], v[162:163]
    s_mov_b64 exec, s[40:41]
    v_pk_fma_f32 v[162:163], v[56:57], v[56:57], v[162:163]
    v_pk_fma_f32 v[162:163], v[58:59], v[58:59], v[162:163]
    v_pk_fma_f32 v[162:163], v[60:61], v[60:61], v[162:163]
    v_pk_fma_f32 v[162:163], v[62:63], v[62:63], v[162:163]
    s_mov_b64 exec, -1
    v_add_f32 v162, v162, v163
    v_sub_f32 v160, v160, v164
    s_nop 1
    v_add_f32_dpp v162, v162, v162 quad_perm:[1,0,3,2] row_mask:0xf bank_mask:0xf
    s_nop 1
    v_add_f32_dpp v162, v162, v162 row_ror:8 row_mask:0xf bank_mask:0xf
    v_mov_b32 v166, v162
    s_nop 1
    v_permlane32_swap_b32 v162, v166
    v_add_f32 v162, v162, v166
    v_mov_b32 v166, v162
    s_nop 1
    v_permlane16_swap_b32 v162, v166
    v_add_f32 v162, v162, v166
    v_mul_f32 v162, 0x3b124925, v162
    v_fma_f32 v162, -v160, v160, v162
    v_max_f32 v162, 0, v162
    v_cvt_pk_bf16_f32 v162, v162, v162
    v_and_b32 v162, 0xffff0000, v162
    v_add_f32 v162, 0x3727c5ac, v162
    v_cvt_pk_bf16_f32 v162, v162, v162
    v_and_b32 v162, 0xffff0000, v162
    v_sqrt_f32 v162, v162
    s_nop 0
    v_cvt_pk_bf16_f32 v162, v162, v162
    v_and_b32 v162, 0xffff0000, v162
    v_rcp_f32 v162, v162
    v_cvt_pk_bf16_f32 v33, v32, v33
    v_cvt_pk_bf16_f32 v35, v34, v35
    v_cvt_pk_bf16_f32 v37, v36, v37
    v_cvt_pk_bf16_f32 v39, v38, v39
    v_cvt_pk_bf16_f32 v41, v40, v41
    v_cvt_pk_bf16_f32 v43, v42, v43
    v_cvt_pk_bf16_f32 v45, v44, v45
    v_cvt_pk_bf16_f32 v47, v46, v47
    v_cvt_pk_bf16_f32 v49, v48, v49
    v_cvt_pk_bf16_f32 v51, v50, v51
    v_cvt_pk_bf16_f32 v53, v52, v53
    v_cvt_pk_bf16_f32 v55, v54, v55
    v_cvt_pk_bf16_f32 v57, v56, v57
    v_cvt_pk_bf16_f32 v59, v58, v59
    v_cvt_pk_bf16_f32 v61, v60, v61
    v_cvt_pk_bf16_f32 v63, v62, v63
    v_lshlrev_b32 v32, 16, v33
    v_and_b32 v33, 0xffff0000, v33
    v_lshlrev_b32 v34, 16, v35
    v_and_b32 v35, 0xffff0000, v35
    v_lshlrev_b32 v36, 16, v37
    v_and_b32 v37, 0xffff0000, v37
    v_lshlrev_b32 v38, 16, v39
    v_and_b32 v39, 0xffff0000, v39
    v_lshlrev_b32 v40, 16, v41
    v_and_b32 v41, 0xffff0000, v41
    v_lshlrev_b32 v42, 16, v43
    v_and_b32 v43, 0xffff0000, v43
    v_lshlrev_b32 v44, 16, v45
    v_and_b32 v45, 0xffff0000, v45
    v_lshlrev_b32 v46, 16, v47
    v_and_b32 v47, 0xffff0000, v47
    v_lshlrev_b32 v48, 16, v49
    v_and_b32 v49, 0xffff0000, v49
    v_lshlrev_b32 v50, 16, v51
    v_and_b32 v51, 0xffff0000, v51
    v_lshlrev_b32 v52, 16, v53
    v_and_b32 v53, 0xffff0000, v53
    v_lshlrev_b32 v54, 16, v55
    v_and_b32 v55, 0xffff0000, v55
    v_lshlrev_b32 v56, 16, v57
    v_and_b32 v57, 0xffff0000, v57
    v_lshlrev_b32 v58, 16, v59
    v_and_b32 v59, 0xffff0000, v59
    v_lshlrev_b32 v60, 16, v61
    v_and_b32 v61, 0xffff0000, v61
    v_lshlrev_b32 v62, 16, v63
    v_and_b32 v63, 0xffff0000, v63
    v_pk_mul_f32 v[32:33], v[32:33], v[162:163] op_sel_hi:[1,0]
    v_pk_mul_f32 v[34:35], v[34:35], v[162:163] op_sel_hi:[1,0]
    v_pk_mul_f32 v[36:37], v[36:37], v[162:163] op_sel_hi:[1,0]
    v_pk_mul_f32 v[38:39], v[38:39], v[162:163] op_sel_hi:[1,0]
    v_pk_mul_f32 v[40:41], v[40:41], v[162:163] op_sel_hi:[1,0]
    v_pk_mul_f32 v[42:43], v[42:43], v[162:163] op_sel_hi:[1,0]
    v_pk_mul_f32 v[44:45], v[44:45], v[162:163] op_sel_hi:[1,0]
    v_pk_mul_f32 v[46:47], v[46:47], v[162:163] op_sel_hi:[1,0]
    v_pk_mul_f32 v[48:49], v[48:49], v[162:163] op_sel_hi:[1,0]
    v_pk_mul_f32 v[50:51], v[50:51], v[162:163] op_sel_hi:[1,0]
    v_pk_mul_f32 v[52:53], v[52:53], v[162:163] op_sel_hi:[1,0]
    v_pk_mul_f32 v[54:55], v[54:55], v[162:163] op_sel_hi:[1,0]
    v_pk_mul_f32 v[56:57], v[56:57], v[162:163] op_sel_hi:[1,0]
    v_pk_mul_f32 v[58:59], v[58:59], v[162:163] op_sel_hi:[1,0]
    v_pk_mul_f32 v[60:61], v[60:61], v[162:163] op_sel_hi:[1,0]
    v_pk_mul_f32 v[62:63], v[62:63], v[162:163] op_sel_hi:[1,0]
    v_cvt_pk_bf16_f32 v16, v32, v33
    v_cvt_pk_bf16_f32 v17, v34, v35
    v_cvt_pk_bf16_f32 v18, v36, v37
    v_cvt_pk_bf16_f32 v19, v38, v39
    v_cvt_pk_bf16_f32 v20, v40, v41
    v_cvt_pk_bf16_f32 v21, v42, v43
    v_cvt_pk_bf16_f32 v22, v44, v45
    v_cvt_pk_bf16_f32 v23, v46, v47
    v_cvt_pk_bf16_f32 v24, v48, v49
    v_cvt_pk_bf16_f32 v25, v50, v51
    v_cvt_pk_bf16_f32 v26, v52, v53
    v_cvt_pk_bf16_f32 v27, v54, v55
    v_cvt_pk_bf16_f32 v28, v56, v57
    v_cvt_pk_bf16_f32 v29, v58, v59
    v_cvt_pk_bf16_f32 v30, v60, v61
    v_cvt_pk_bf16_f32 v31, v62, v63
    ds_write_b128 v10, v[16:19] offset:0
    ds_write_b128 v10, v[20:23] offset:4096
    ds_write_b128 v10, v[24:27] offset:8192
    ds_write_b128 v10, v[28:31] offset:12288
    s_waitcnt lgkmcnt(0)
    s_barrier
    s_lshl_b32 s12, s9, 10
    s_add_u32 s11, s11, s12
    s_and_b32 s12, s10, 1
    s_lshl_b32 s12, s12, 9
    s_add_u32 s11, s11, s12
    buffer_load_dwordx2 v[14:15], v11, s[4:7], s11 offen sc1
    ds_read_b128 v[32:35], v1 offset:0
    ds_read_b128 v[36:39], v1 offset:1024
    ds_read_b128 v[40:43], v1 offset:2048
    ds_read_b128 v[44:47], v1 offset:3072
    ds_read_b128 v[48:51], v1 offset:4096
    ds_read_b128 v[52:55], v1 offset:5120
    s_waitcnt lgkmcnt(5)
    v_mfma_f32_16x16x32_bf16 v[76:79], a[0:3], v[32:35], 0
    v_mfma_f32_16x16x32_bf16 v[80:83], a[56:59], v[32:35], 0
    ds_read_b128 v[32:35], v1 offset:6144
    s_waitcnt lgkmcnt(5)
    v_mfma_f32_16x16x32_bf16 v[76:79], a[4:7], v[36:39], v[76:79]
    v_mfma_f32_16x16x32_bf16 v[80:83], a[60:63], v[36:39], v[80:83]
    ds_read_b128 v[36:39], v1 offset:7168
    s_waitcnt lgkmcnt(5)
    v_mfma_f32_16x16x32_bf16 v[76:79], a[8:11], v[40:43], v[76:79]
    v_mfma_f32_16x16x32_bf16 v[80:83], a[64:67], v[40:43], v[80:83]
    ds_read_b128 v[40:43], v1 offset:8192
    s_waitcnt lgkmcnt(5)
    v_mfma_f32_16x16x32_bf16 v[76:79], a[12:15], v[44:47], v[76:79]
    v_mfma_f32_16x16x32_bf16 v[80:83], a[68:71], v[44:47], v[80:83]
    ds_read_b128 v[44:47], v1 offset:9216
    s_waitcnt lgkmcnt(5)
    v_mfma_f32_16x16x32_bf16 v[76:79], a[16:19], v[48:51], v[76:79]
    v_mfma_f32_16x16x32_bf16 v[80:83], a[72:75], v[48:51], v[80:83]
    ds_read_b128 v[48:51], v1 offset:10240
    s_waitcnt lgkmcnt(5)
    v_mfma_f32_16x16x32_bf16 v[76:79], a[20:23], v[52:55], v[76:79]
    v_mfma_f32_16x16x32_bf16 v[80:83], a[76:79], v[52:55], v[80:83]
    ds_read_b128 v[52:55], v1 offset:11264
    s_waitcnt lgkmcnt(5)
    v_mfma_f32_16x16x32_bf16 v[76:79], a[24:27], v[32:35], v[76:79]
    v_mfma_f32_16x16x32_bf16 v[80:83], a[80:83], v[32:35], v[80:83]
    ds_read_b128 v[32:35], v1 offset:12288
    s_waitcnt lgkmcnt(5)
    v_mfma_f32_16x16x32_bf16 v[76:79], a[28:31], v[36:39], v[76:79]
    v_mfma_f32_16x16x32_bf16 v[80:83], a[84:87], v[36:39], v[80:83]
    ds_read_b128 v[36:39], v1 offset:13312
    s_waitcnt lgkmcnt(5)
    v_mfma_f32_16x16x32_bf16 v[76:79], a[32:35], v[40:43], v[76:79]
    v_mfma_f32_16x16x32_bf16 v[80:83], a[88:91], v[40:43], v[80:83]
    s_waitcnt lgkmcnt(4)
    v_mfma_f32_16x16x32_bf16 v[76:79], a[36:39], v[44:47], v[76:79]
    v_mfma_f32_16x16x32_bf16 v[80:83], a[92:95], v[44:47], v[80:83]
    s_waitcnt lgkmcnt(3)
    v_mfma_f32_16x16x32_bf16 v[76:79], a[40:43], v[48:51], v[76:79]
    v_mfma_f32_16x16x32_bf16 v[80:83], a[96:99], v[48:51], v[80:83]
    s_waitcnt lgkmcnt(2)
    v_mfma_f32_16x16x32_bf16 v[76:79], a[44:47], v[52:55], v[76:79]
    v_mfma_f32_16x16x32_bf16 v[80:83], a[100:103], v[52:55], v[80:83]
    s_waitcnt lgkmcnt(1)
    v_mfma_f32_16x16x32_bf16 v[76:79], a[48:51], v[32:35], v[76:79]
    v_mfma_f32_16x16x32_bf16 v[80:83], a[104:107], v[32:35], v[80:83]
    s_waitcnt lgkmcnt(0)
    v_mfma_f32_16x16x32_bf16 v[76:79], a[52:55], v[36:39], v[76:79]
    v_mfma_f32_16x16x32_bf16 v[80:83], a[108:111], v[36:39], v[80:83]
    s_lshl_b32 s11, s10, 10
    v_add_u32 v5, s11, v1
    s_nop 6
    v_max_f32 v76, 0, v76
    v_max_f32 v77, 0, v77
    v_max_f32 v78, 0, v78
    v_max_f32 v79, 0, v79
    v_max_f32 v80, 0, v80
    v_max_f32 v81, 0, v81
    v_max_f32 v82, 0, v82
    v_max_f32 v83, 0, v83
    v_cvt_pk_bf16_f32 v64, v76, v77
    v_cvt_pk_bf16_f32 v65, v78, v79
    v_cvt_pk_bf16_f32 v66, v80, v81
    v_cvt_pk_bf16_f32 v67, v82, v83
    ds_write_b128 v5, v[64:67] offset:16384
    s_waitcnt lgkmcnt(0)
    s_barrier
    ds_read_b128 v[84:87], v1 offset:16384
    ds_read_b128 v[88:91], v1 offset:17408
    ds_read_b128 v[92:95], v1 offset:18432
    ds_read_b128 v[96:99], v1 offset:19456
    s_and_b32 s14, s16, 1
    s_lshl_b32 s11, s15, 1
    s_add_u32 s14, s14, s11
    s_mul_i32 s14, s14, 401408
    s_add_u32 s14, s14, 0x3560000
    s_mul_i32 s11, s9, 28672
    s_add_u32 s11, s11, s14
    s_mul_i32 s12, s10, 7168
    s_add_u32 s11, s11, s12
    s_add_u32 s12, s11, 4096
    s_lshr_b32 s24, s10, 1
    s_mul_i32 s24, s24, 200704
    s_add_u32 s24, s24, s14
    s_lshl_b32 s25, s9, 11
    s_add_u32 s24, s24, s25
    s_and_b32 s13, s10, 1
    s_lshl_b32 s13, s13, 10
    s_add_u32 s24, s24, s13
    s_add_u32 s25, s24, 28672
    s_add_u32 s26, s24, 57344
    s_add_u32 s27, s24, 86016
    s_add_u32 s28, s24, 114688
    s_add_u32 s29, s24, 143360
    s_add_u32 s30, s24, 172032
    s_waitcnt lgkmcnt(0)
    v_mfma_f32_16x16x32_bf16 v[100:103], a[112:115], v[84:87], 0
    v_mfma_f32_16x16x32_bf16 v[100:103], a[116:119], v[88:91], v[100:103]
    v_mfma_f32_16x16x32_bf16 v[100:103], a[120:123], v[92:95], v[100:103]
    v_mfma_f32_16x16x32_bf16 v[100:103], a[124:127], v[96:99], v[100:103]
    v_mfma_f32_16x16x32_bf16 v[104:107], a[128:131], v[84:87], 0
    v_mfma_f32_16x16x32_bf16 v[104:107], a[132:135], v[88:91], v[104:107]
    v_mfma_f32_16x16x32_bf16 v[104:107], a[136:139], v[92:95], v[104:107]
    v_min_u32 v100, -2, v100
    v_min_u32 v101, -2, v101
    v_mfma_f32_16x16x32_bf16 v[104:107], a[140:143], v[96:99], v[104:107]
    v_min_u32 v102, -2, v102
    v_min_u32 v103, -2, v103
    v_mfma_f32_16x16x32_bf16 v[108:111], a[144:147], v[84:87], 0
    buffer_store_dwordx4 v[100:103], v1, s[4:7], s11 offen offset:0
    v_mfma_f32_16x16x32_bf16 v[108:111], a[148:151], v[88:91], v[108:111]
    v_mfma_f32_16x16x32_bf16 v[108:111], a[152:155], v[92:95], v[108:111]
    v_min_u32 v104, -2, v104
    v_min_u32 v105, -2, v105
    v_mfma_f32_16x16x32_bf16 v[108:111], a[156:159], v[96:99], v[108:111]
    v_min_u32 v106, -2, v106
    v_min_u32 v107, -2, v107
    v_mfma_f32_16x16x32_bf16 v[112:115], a[160:163], v[84:87], 0
    buffer_store_dwordx4 v[104:107], v1, s[4:7], s11 offen offset:1024
    v_mfma_f32_16x16x32_bf16 v[112:115], a[164:167], v[88:91], v[112:115]
    v_mfma_f32_16x16x32_bf16 v[112:115], a[168:171], v[92:95], v[112:115]
    v_min_u32 v108, -2, v108
    v_min_u32 v109, -2, v109
    v_mfma_f32_16x16x32_bf16 v[112:115], a[172:175], v[96:99], v[112:115]
    v_min_u32 v110, -2, v110
    v_min_u32 v111, -2, v111
    v_mfma_f32_16x16x32_bf16 v[116:119], a[176:179], v[84:87], 0
    buffer_store_dwordx4 v[108:111], v1, s[4:7], s11 offen offset:2048
    v_mfma_f32_16x16x32_bf16 v[116:119], a[180:183], v[88:91], v[116:119]
    v_mfma_f32_16x16x32_bf16 v[116:119], a[184:187], v[92:95], v[116:119]
    v_min_u32 v112, -2, v112
    v_min_u32 v113, -2, v113
    v_mfma_f32_16x16x32_bf16 v[116:119], a[188:191], v[96:99], v[116:119]
    v_min_u32 v114, -2, v114
    v_min_u32 v115, -2, v115
    v_mfma_f32_16x16x32_bf16 v[120:123], a[192:195], v[84:87], 0
    buffer_store_dwordx4 v[112:115], v1, s[4:7], s11 offen offset:3072
    v_mfma_f32_16x16x32_bf16 v[120:123], a[196:199], v[88:91], v[120:123]
    v_mfma_f32_16x16x32_bf16 v[120:123], a[200:203], v[92:95], v[120:123]
    v_min_u32 v116, -2, v116
    v_min_u32 v117, -2, v117
    v_mfma_f32_16x16x32_bf16 v[120:123], a[204:207], v[96:99], v[120:123]
    v_min_u32 v118, -2, v118
    v_min_u32 v119, -2, v119
    v_mfma_f32_16x16x32_bf16 v[124:127], a[208:211], v[84:87], 0
    buffer_store_dwordx4 v[116:119], v1, s[4:7], s12 offen offset:0
    v_mfma_f32_16x16x32_bf16 v[124:127], a[212:215], v[88:91], v[124:127]
    v_mfma_f32_16x16x32_bf16 v[124:127], a[216:219], v[92:95], v[124:127]
    v_min_u32 v120, -2, v120
    v_min_u32 v121, -2, v121
    v_mfma_f32_16x16x32_bf16 v[124:127], a[220:223], v[96:99], v[124:127]
    v_min_u32 v122, -2, v122
    v_min_u32 v123, -2, v123
    s_nop 4
    buffer_store_dwordx4 v[120:123], v1, s[4:7], s12 offen offset:1024
    v_min_u32 v124, -2, v124
    v_min_u32 v125, -2, v125
    v_min_u32 v126, -2, v126
    v_min_u32 v127, -2, v127
    buffer_store_dwordx4 v[124:127], v1, s[4:7], s12 offen offset:2048
    s_mov_b32 s12, s13
    s_mov_b32 s22, 0
spin_678:
    buffer_load_dwordx4 v[128:131], v1, s[4:7], s24 offen sc1
    buffer_load_dwordx4 v[132:135], v1, s[4:7], s25 offen sc1
    buffer_load_dwordx4 v[136:139], v1, s[4:7], s26 offen sc1
    buffer_load_dwordx4 v[140:143], v1, s[4:7], s27 offen sc1
    buffer_load_dwordx4 v[144:147], v1, s[4:7], s28 offen sc1
    buffer_load_dwordx4 v[148:151], v1, s[4:7], s29 offen sc1
    buffer_load_dwordx4 v[152:155], v1, s[4:7], s30 offen sc1
    s_waitcnt vmcnt(0)
spin2_680:
    v_max3_u32 v5, v128, v129, v130
    v_max3_u32 v5, v5, v131, v132
    v_max3_u32 v5, v5, v133, v134
    v_max3_u32 v5, v5, v135, v136
    v_max3_u32 v5, v5, v137, v138
    v_max3_u32 v5, v5, v139, v140
    v_max3_u32 v5, v5, v141, v142
    v_max3_u32 v5, v5, v143, v144
    v_max3_u32 v5, v5, v145, v146
    v_max3_u32 v5, v5, v147, v148
    v_max3_u32 v5, v5, v149, v150
    v_max3_u32 v5, v5, v151, v152
    v_max3_u32 v5, v5, v153, v154
    v_max_u32 v5, v5, v155
    v_cmp_eq_u32 vcc, -1, v5
    s_cbranch_vccz spok_679
    s_add_u32 s22, s22, 1
    s_cmp_gt_u32 s22, 65536
    s_cbranch_scc1 M_exit
    s_sleep 1
    s_branch spin_678
spok_679:
    v_add_u32 v5, s12, v1
    v_pk_add_f32 v[100:101], v[128:129], v[132:133]
    v_pk_add_f32 v[102:103], v[130:131], v[134:135]
    v_pk_add_f32 v[100:101], v[100:101], v[136:137]
    v_pk_add_f32 v[102:103], v[102:103], v[138:139]
    v_pk_add_f32 v[100:101], v[100:101], v[140:141]
    v_pk_add_f32 v[102:103], v[102:103], v[142:143]
    v_pk_add_f32 v[100:101], v[100:101], v[144:145]
    v_pk_add_f32 v[102:103], v[102:103], v[146:147]
    v_pk_add_f32 v[100:101], v[100:101], v[148:149]
    v_pk_add_f32 v[102:103], v[102:103], v[150:151]
    v_pk_add_f32 v[100:101], v[100:101], v[152:153]
    v_pk_add_f32 v[102:103], v[102:103], v[154:155]
    s_cmp_lt_u32 s10, 2
    s_cbranch_scc1 f_lo_681
    ds_write_b128 v5, v[100:103] offset:20480
    s_waitcnt lgkmcnt(0)
    s_barrier
    s_branch f_fin_682
f_lo_681:
    s_barrier
    ds_read_b128 v[104:107], v5 offset:20480
    s_mul_i32 s11, s17, 14336
    s_waitcnt lgkmcnt(0)
    v_add_f32 v100, v100, v104
    v_add_f32 v101, v101, v105
    v_add_f32 v102, v102, v106
    v_add_f32 v103, v103, v107
    v_cvt_pk_bf16_f32 v104, v100, v101
    v_lshlrev_b32 v105, 16, v104
    v_and_b32 v106, 0xffff0000, v104
    v_lshlrev_b32 v107, 16, v14
    v_and_b32 v108, 0xffff0000, v14
    v_add_f32 v105, v105, v107
    v_add_f32 v106, v106, v108
    v_cvt_pk_bf16_f32 v110, v105, v106
    v_cvt_pk_bf16_f32 v104, v102, v103
    v_lshlrev_b32 v105, 16, v104
    v_and_b32 v106, 0xffff0000, v104
    v_lshlrev_b32 v107, 16, v15
    v_and_b32 v108, 0xffff0000, v15
    v_add_f32 v105, v105, v107
    v_add_f32 v106, v106, v108
    v_cvt_pk_bf16_f32 v111, v105, v106
    buffer_store_dwordx2 v[110:111], v6, s[76:79], s11 offen
f_fin_682:
    s_cmp_ge_u32 s17, 116
    s_cbranch_scc1 f_nopoi_683
    buffer_store_dwordx4 v[156:159], v1, s[4:7], s24 offen
    buffer_store_dwordx4 v[156:159], v1, s[4:7], s25 offen
    buffer_store_dwordx4 v[156:159], v1, s[4:7], s26 offen
    buffer_store_dwordx4 v[156:159], v1, s[4:7], s27 offen
    buffer_store_dwordx4 v[156:159], v1, s[4:7], s28 offen
    buffer_store_dwordx4 v[156:159], v1, s[4:7], s29 offen
    buffer_store_dwordx4 v[156:159], v1, s[4:7], s30 offen
f_nopoi_683:
    s_add_u32 s16, s16, 1
    s_add_u32 s17, s17, 6
    s_cmp_lt_u32 s17, 128
    s_cbranch_scc1 f_loop_674
    s_branch M_exit
f_mode_673:
f_loop_684:
    s_mul_i32 s11, s17, 14336
    s_add_u32 s11, s11, 0x33a0000
    s_add_u32 s12, s11, 4096
    s_add_u32 s13, s11, 8192
    s_add_u32 s14, s11, 12288
    s_mov_b32 s22, 0
spin_685:
    buffer_load_dwordx4 v[16:19], v3, s[4:7], s11 offen sc1
    buffer_load_dwordx4 v[20:23], v3, s[4:7], s12 offen sc1
    buffer_load_dwordx4 v[24:27], v3, s[4:7], s13 offen sc1
    buffer_load_dwordx4 v[28:31], v4, s[4:7], s14 offen sc1
    s_waitcnt vmcnt(0)
spin2_687:
    v_max3_u32 v5, v16, v17, v18
    v_max3_u32 v5, v5, v19, v20
    v_max3_u32 v5, v5, v21, v22
    v_max3_u32 v5, v5, v23, v24
    v_max3_u32 v5, v5, v25, v26
    v_max3_u32 v5, v5, v27, v28
    v_max3_u32 v5, v5, v29, v30
    v_max_u32 v5, v5, v31
    v_cmp_eq_u32 vcc, -1, v5
    s_cbranch_vccz spok_686
    s_add_u32 s22, s22, 1
    s_cmp_gt_u32 s22, 65536
    s_cbranch_scc1 M_exit
    s_sleep 1
    s_branch spin_685
spok_686:
    v_lshlrev_b32 v32, 16, v16
    v_and_b32 v33, 0xffff0000, v16
    v_lshlrev_b32 v34, 16, v17
    v_and_b32 v35, 0xffff0000, v17
    v_lshlrev_b32 v36, 16, v18
    v_and_b32 v37, 0xffff0000, v18
    v_lshlrev_b32 v38, 16, v19
    v_and_b32 v39, 0xffff0000, v19
    v_lshlrev_b32 v40, 16, v20
    v_and_b32 v41, 0xffff0000, v20
    v_lshlrev_b32 v42, 16, v21
    v_and_b32 v43, 0xffff0000, v21
    v_lshlrev_b32 v44, 16, v22
    v_and_b32 v45, 0xffff0000, v22
    v_lshlrev_b32 v46, 16, v23
    v_and_b32 v47, 0xffff0000, v23
    v_lshlrev_b32 v48, 16, v24
    v_and_b32 v49, 0xffff0000, v24
    v_lshlrev_b32 v50, 16, v25
    v_and_b32 v51, 0xffff0000, v25
    v_lshlrev_b32 v52, 16, v26
    v_and_b32 v53, 0xffff0000, v26
    v_lshlrev_b32 v54, 16, v27
    v_and_b32 v55, 0xffff0000, v27
    v_lshlrev_b32 v56, 16, v28
    v_and_b32 v57, 0xffff0000, v28
    v_lshlrev_b32 v58, 16, v29
    v_and_b32 v59, 0xffff0000, v29
    v_lshlrev_b32 v60, 16, v30
    v_and_b32 v61, 0xffff0000, v30
    v_lshlrev_b32 v62, 16, v31
    v_and_b32 v63, 0xffff0000, v31
    v_pk_add_f32 v[160:161], v[32:33], v[34:35]
    v_pk_add_f32 v[162:163], v[36:37], v[38:39]
    v_pk_add_f32 v[160:161], v[160:161], v[40:41]
    v_pk_add_f32 v[162:163], v[162:163], v[42:43]
    v_pk_add_f32 v[160:161], v[160:161], v[44:45]
    v_pk_add_f32 v[162:163], v[162:163], v[46:47]
    v_pk_add_f32 v[160:161], v[160:161], v[48:49]
    v_pk_add_f32 v[162:163], v[162:163], v[50:51]
    v_pk_add_f32 v[160:161], v[160:161], v[52:53]
    v_pk_add_f32 v[162:163], v[162:163], v[54:55]
    v_pk_add_f32 v[160:161], v[160:161], v[56:57]
    v_pk_add_f32 v[162:163], v[162:163], v[58:59]
    v_pk_add_f32 v[160:161], v[160:161], v[60:61]
    v_pk_add_f32 v[162:163], v[162:163], v[62:63]
    v_pk_add_f32 v[160:161], v[160:161], v[162:163]
    v_add_f32 v160, v160, v161
    s_nop 1
    v_add_f32_dpp v160, v160, v160 quad_perm:[1,0,3,2] row_mask:0xf bank_mask:0xf
    s_nop 1
    v_add_f32_dpp v160, v160, v160 row_ror:8 row_mask:0xf bank_mask:0xf
    v_mov_b32 v166, v160
    s_nop 1
    v_permlane32_swap_b32 v160, v166
    v_add_f32 v160, v160, v166
    v_mov_b32 v166, v160
    s_nop 1
    v_permlane16_swap_b32 v160, v166
    v_add_f32 v160, v160, v166
    v_mul_f32 v160, 0x3b124925, v160
    v_mov_b32 v164, v160
    v_cvt_pk_bf16_f32 v164, v164, v164
    v_and_b32 v164, 0xffff0000, v164
    v_pk_add_f32 v[32:33], v[32:33], v[164:165] op_sel_hi:[1,0] neg_lo:[0,1] neg_hi:[0,1]
    v_pk_add_f32 v[34:35], v[34:35], v[164:165] op_sel_hi:[1,0] neg_lo:[0,1] neg_hi:[0,1]
    v_pk_add_f32 v[36:37], v[36:37], v[164:165] op_sel_hi:[1,0] neg_lo:[0,1] neg_hi:[0,1]
    v_pk_add_f32 v[38:39], v[38:39], v[164:165] op_sel_hi:[1,0] neg_lo:[0,1] neg_hi:[0,1]
    v_pk_add_f32 v[40:41], v[40:41], v[164:165] op_sel_hi:[1,0] neg_lo:[0,1] neg_hi:[0,1]
    v_pk_add_f32 v[42:43], v[42:43], v[164:165] op_sel_hi:[1,0] neg_lo:[0,1] neg_hi:[0,1]
    v_pk_add_f32 v[44:45], v[44:45], v[164:165] op_sel_hi:[1,0] neg_lo:[0,1] neg_hi:[0,1]
    v_pk_add_f32 v[46:47], v[46:47], v[164:165] op_sel_hi:[1,0] neg_lo:[0,1] neg_hi:[0,1]
    v_pk_add_f32 v[48:49], v[48:49], v[164:165] op_sel_hi:[1,0] neg_lo:[0,1] neg_hi:[0,1]
    v_pk_add_f32 v[50:51], v[50:51], v[164:165] op_sel_hi:[1,0] neg_lo:[0,1] neg_hi:[0,1]
    v_pk_add_f32 v[52:53], v[52:53], v[164:165] op_sel_hi:[1,0] neg_lo:[0,1] neg_hi:[0,1]
    v_pk_add_f32 v[54:55], v[54:55], v[164:165] op_sel_hi:[1,0] neg_lo:[0,1] neg_hi:[0,1]
    v_pk_add_f32 v[56:57], v[56:57], v[164:165] op_sel_hi:[1,0] neg_lo:[0,1] neg_hi:[0,1]
    v_pk_add_f32 v[58:59], v[58:59], v[164:165] op_sel_hi:[1,0] neg_lo:[0,1] neg_hi:[0,1]
    v_pk_add_f32 v[60:61], v[60:61], v[164:165] op_sel_hi:[1,0] neg_lo:[0,1] neg_hi:[0,1]
    v_pk_add_f32 v[62:63], v[62:63], v[164:165] op_sel_hi:[1,0] neg_lo:[0,1] neg_hi:[0,1]
    v_pk_mul_f32 v[162:163], v[32:33], v[32:33]
    v_pk_fma_f32 v[162:163], v[34:35], v[34:35], v[162:163]
    v_pk_fma_f32 v[162:163], v[36:37], v[36:37], v[162:163]
    v_pk_fma_f32 v[162:163], v[38:39], v[38:39], v[162:163]
    v_pk_fma_f32 v[162:163], v[40:41], v[40:41], v[162:163]
    v_pk_fma_f32 v[162:163], v[42:43], v[42:43], v[162:163]
    v_pk_fma_f32 v[162:163], v[44:45], v[44:45], v[162:163]
    v_pk_fma_f32 v[162:163], v[46:47], v[46:47], v[162:163]
    v_pk_fma_f32 v[162:163], v[48:49], v[48:49], v[162:163]
    v_pk_fma_f32 v[162:163], v[50:51], v[50:51], v[162:163]
    v_pk_fma_f32 v[162:163], v[52:53], v[52:53], v[162:163]
    v_pk_fma_f32 v[162:163], v[54:55], v[54:55], v[162:163]
    s_mov_b64 exec, s[40:41]
    v_pk_fma_f32 v[162:163], v[56:57], v[56:57], v[162:163]
    v_pk_fma_f32 v[162:163], v[58:59], v[58:59], v[162:163]
    v_pk_fma_f32 v[162:163], v[60:61], v[60:61], v[162:163]
    v_pk_fma_f32 v[162:163], v[62:63], v[62:63], v[162:163]
    s_mov_b64 exec, -1
    v_add_f32 v162, v162, v163
    v_sub_f32 v160, v160, v164
    s_nop 1
    v_add_f32_dpp v162, v162, v162 quad_perm:[1,0,3,2] row_mask:0xf bank_mask:0xf
    s_nop 1
    v_add_f32_dpp v162, v162, v162 row_ror:8 row_mask:0xf bank_mask:0xf
    v_mov_b32 v166, v162
    s_nop 1
    v_permlane32_swap_b32 v162, v166
    v_add_f32 v162, v162, v166
    v_mov_b32 v166, v162
    s_nop 1
    v_permlane16_swap_b32 v162, v166
    v_add_f32 v162, v162, v166
    v_mul_f32 v162, 0x3b124925, v162
    v_fma_f32 v162, -v160, v160, v162
    v_max_f32 v162, 0, v162
    v_cvt_pk_bf16_f32 v162, v162, v162
    v_and_b32 v162, 0xffff0000, v162
    v_add_f32 v162, 0x3727c5ac, v162
    v_cvt_pk_bf16_f32 v162, v162, v162
    v_and_b32 v162, 0xffff0000, v162
    v_sqrt_f32 v162, v162
    s_nop 0
    v_cvt_pk_bf16_f32 v162, v162, v162
    v_and_b32 v162, 0xffff0000, v162
    v_rcp_f32 v162, v162
    v_cvt_pk_bf16_f32 v33, v32, v33
    v_cvt_pk_bf16_f32 v35, v34, v35
    v_cvt_pk_bf16_f32 v37, v36, v37
    v_cvt_pk_bf16_f32 v39, v38, v39
    v_cvt_pk_bf16_f32 v41, v40, v41
    v_cvt_pk_bf16_f32 v43, v42, v43
    v_cvt_pk_bf16_f32 v45, v44, v45
    v_cvt_pk_bf16_f32 v47, v46, v47
    v_cvt_pk_bf16_f32 v49, v48, v49
    v_cvt_pk_bf16_f32 v51, v50, v51
    v_cvt_pk_bf16_f32 v53, v52, v53
    v_cvt_pk_bf16_f32 v55, v54, v55
    v_cvt_pk_bf16_f32 v57, v56, v57
    v_cvt_pk_bf16_f32 v59, v58, v59
    v_cvt_pk_bf16_f32 v61, v60, v61
    v_cvt_pk_bf16_f32 v63, v62, v63
    v_lshlrev_b32 v32, 16, v33
    v_and_b32 v33, 0xffff0000, v33
    v_lshlrev_b32 v34, 16, v35
    v_and_b32 v35, 0xffff0000, v35
    v_lshlrev_b32 v36, 16, v37
    v_and_b32 v37, 0xffff0000, v37
    v_lshlrev_b32 v38, 16, v39
    v_and_b32 v39, 0xffff0000, v39
    v_lshlrev_b32 v40, 16, v41
    v_and_b32 v41, 0xffff0000, v41
    v_lshlrev_b32 v42, 16, v43
    v_and_b32 v43, 0xffff0000, v43
    v_lshlrev_b32 v44, 16, v45
    v_and_b32 v45, 0xffff0000, v45
    v_lshlrev_b32 v46, 16, v47
    v_and_b32 v47, 0xffff0000, v47
    v_lshlrev_b32 v48, 16, v49
    v_and_b32 v49, 0xffff0000, v49
    v_lshlrev_b32 v50, 16, v51
    v_and_b32 v51, 0xffff0000, v51
    v_lshlrev_b32 v52, 16, v53
    v_and_b32 v53, 0xffff0000, v53
    v_lshlrev_b32 v54, 16, v55
    v_and_b32 v55, 0xffff0000, v55
    v_lshlrev_b32 v56, 16, v57
    v_and_b32 v57, 0xffff0000, v57
    v_lshlrev_b32 v58, 16, v59
    v_and_b32 v59, 0xffff0000, v59
    v_lshlrev_b32 v60, 16, v61
    v_and_b32 v61, 0xffff0000, v61
    v_lshlrev_b32 v62, 16, v63
    v_and_b32 v63, 0xffff0000, v63
    v_pk_mul_f32 v[32:33], v[32:33], v[162:163] op_sel_hi:[1,0]
    v_pk_mul_f32 v[34:35], v[34:35], v[162:163] op_sel_hi:[1,0]
    v_pk_mul_f32 v[36:37], v[36:37], v[162:163] op_sel_hi:[1,0]
    v_pk_mul_f32 v[38:39], v[38:39], v[162:163] op_sel_hi:[1,0]
    v_pk_mul_f32 v[40:41], v[40:41], v[162:163] op_sel_hi:[1,0]
    v_pk_mul_f32 v[42:43], v[42:43], v[162:163] op_sel_hi:[1,0]
    v_pk_mul_f32 v[44:45], v[44:45], v[162:163] op_sel_hi:[1,0]
    v_pk_mul_f32 v[46:47], v[46:47], v[162:163] op_sel_hi:[1,0]
    v_pk_mul_f32 v[48:49], v[48:49], v[162:163] op_sel_hi:[1,0]
    v_pk_mul_f32 v[50:51], v[50:51], v[162:163] op_sel_hi:[1,0]
    v_pk_mul_f32 v[52:53], v[52:53], v[162:163] op_sel_hi:[1,0]
    v_pk_mul_f32 v[54:55], v[54:55], v[162:163] op_sel_hi:[1,0]
    v_pk_mul_f32 v[56:57], v[56:57], v[162:163] op_sel_hi:[1,0]
    v_pk_mul_f32 v[58:59], v[58:59], v[162:163] op_sel_hi:[1,0]
    v_pk_mul_f32 v[60:61], v[60:61], v[162:163] op_sel_hi:[1,0]
    v_pk_mul_f32 v[62:63], v[62:63], v[162:163] op_sel_hi:[1,0]
    v_cvt_pk_bf16_f32 v16, v32, v33
    v_cvt_pk_bf16_f32 v17, v34, v35
    v_cvt_pk_bf16_f32 v18, v36, v37
    v_cvt_pk_bf16_f32 v19, v38, v39
    v_cvt_pk_bf16_f32 v20, v40, v41
    v_cvt_pk_bf16_f32 v21, v42, v43
    v_cvt_pk_bf16_f32 v22, v44, v45
    v_cvt_pk_bf16_f32 v23, v46, v47
    v_cvt_pk_bf16_f32 v24, v48, v49
    v_cvt_pk_bf16_f32 v25, v50, v51
    v_cvt_pk_bf16_f32 v26, v52, v53
    v_cvt_pk_bf16_f32 v27, v54, v55
    v_cvt_pk_bf16_f32 v28, v56, v57
    v_cvt_pk_bf16_f32 v29, v58, v59
    v_cvt_pk_bf16_f32 v30, v60, v61
    v_cvt_pk_bf16_f32 v31, v62, v63
    ds_write_b128 v10, v[16:19] offset:0
    ds_write_b128 v10, v[20:23] offset:4096
    ds_write_b128 v10, v[24:27] offset:8192
    ds_write_b128 v10, v[28:31] offset:12288
    s_waitcnt lgkmcnt(0)
    s_barrier
    s_lshl_b32 s12, s9, 10
    s_add_u32 s11, s11, s12
    s_and_b32 s12, s10, 1
    s_lshl_b32 s12, s12, 9
    s_add_u32 s11, s11, s12
    buffer_load_dwordx2 v[14:15], v11, s[4:7], s11 offen sc1
    ds_read_b128 v[32:35], v1 offset:0
    ds_read_b128 v[36:39], v1 offset:1024
    ds_read_b128 v[40:43], v1 offset:2048
    ds_read_b128 v[44:47], v1 offset:3072
    ds_read_b128 v[48:51], v1 offset:4096
    ds_read_b128 v[52:55], v1 offset:5120
    s_waitcnt lgkmcnt(5)
    v_mfma_f32_16x16x32_bf16 v[76:79], a[0:3], v[32:35], 0
    v_mfma_f32_16x16x32_bf16 v[80:83], a[56:59], v[32:35], 0
    ds_read_b128 v[32:35], v1 offset:6144
    s_waitcnt lgkmcnt(5)
    v_mfma_f32_16x16x32_bf16 v[76:79], a[4:7], v[36:39], v[76:79]
    v_mfma_f32_16x16x32_bf16 v[80:83], a[60:63], v[36:39], v[80:83]
    ds_read_b128 v[36:39], v1 offset:7168
    s_waitcnt lgkmcnt(5)
    v_mfma_f32_16x16x32_bf16 v[76:79], a[8:11], v[40:43], v[76:79]
    v_mfma_f32_16x16x32_bf16 v[80:83], a[64:67], v[40:43], v[80:83]
    ds_read_b128 v[40:43], v1 offset:8192
    s_waitcnt lgkmcnt(5)
    v_mfma_f32_16x16x32_bf16 v[76:79], a[12:15], v[44:47], v[76:79]
    v_mfma_f32_16x16x32_bf16 v[80:83], a[68:71], v[44:47], v[80:83]
    ds_read_b128 v[44:47], v1 offset:9216
    s_waitcnt lgkmcnt(5)
    v_mfma_f32_16x16x32_bf16 v[76:79], a[16:19], v[48:51], v[76:79]
    v_mfma_f32_16x16x32_bf16 v[80:83], a[72:75], v[48:51], v[80:83]
    ds_read_b128 v[48:51], v1 offset:10240
    s_waitcnt lgkmcnt(5)
    v_mfma_f32_16x16x32_bf16 v[76:79], a[20:23], v[52:55], v[76:79]
    v_mfma_f32_16x16x32_bf16 v[80:83], a[76:79], v[52:55], v[80:83]
    ds_read_b128 v[52:55], v1 offset:11264
    s_waitcnt lgkmcnt(5)
    v_mfma_f32_16x16x32_bf16 v[76:79], a[24:27], v[32:35], v[76:79]
    v_mfma_f32_16x16x32_bf16 v[80:83], a[80:83], v[32:35], v[80:83]
    ds_read_b128 v[32:35], v1 offset:12288
    s_waitcnt lgkmcnt(5)
    v_mfma_f32_16x16x32_bf16 v[76:79], a[28:31], v[36:39], v[76:79]
    v_mfma_f32_16x16x32_bf16 v[80:83], a[84:87], v[36:39], v[80:83]
    ds_read_b128 v[36:39], v1 offset:13312
    s_waitcnt lgkmcnt(5)
    v_mfma_f32_16x16x32_bf16 v[76:79], a[32:35], v[40:43], v[76:79]
    v_mfma_f32_16x16x32_bf16 v[80:83], a[88:91], v[40:43], v[80:83]
    s_waitcnt lgkmcnt(4)
    v_mfma_f32_16x16x32_bf16 v[76:79], a[36:39], v[44:47], v[76:79]
    v_mfma_f32_16x16x32_bf16 v[80:83], a[92:95], v[44:47], v[80:83]
    s_waitcnt lgkmcnt(3)
    v_mfma_f32_16x16x32_bf16 v[76:79], a[40:43], v[48:51], v[76:79]
    v_mfma_f32_16x16x32_bf16 v[80:83], a[96:99], v[48:51], v[80:83]
    s_waitcnt lgkmcnt(2)
    v_mfma_f32_16x16x32_bf16 v[76:79], a[44:47], v[52:55], v[76:79]
    v_mfma_f32_16x16x32_bf16 v[80:83], a[100:103], v[52:55], v[80:83]
    s_waitcnt lgkmcnt(1)
    v_mfma_f32_16x16x32_bf16 v[76:79], a[48:51], v[32:35], v[76:79]
    v_mfma_f32_16x16x32_bf16 v[80:83], a[104:107], v[32:35], v[80:83]
    s_waitcnt lgkmcnt(0)
    v_mfma_f32_16x16x32_bf16 v[76:79], a[52:55], v[36:39], v[76:79]
    v_mfma_f32_16x16x32_bf16 v[80:83], a[108:111], v[36:39], v[80:83]
    s_lshl_b32 s11, s10, 10
    v_add_u32 v5, s11, v1
    s_nop 6
    v_max_f32 v76, 0, v76
    v_max_f32 v77, 0, v77
    v_max_f32 v78, 0, v78
    v_max_f32 v79, 0, v79
    v_max_f32 v80, 0, v80
    v_max_f32 v81, 0, v81
    v_max_f32 v82, 0, v82
    v_max_f32 v83, 0, v83
    v_cvt_pk_bf16_f32 v64, v76, v77
    v_cvt_pk_bf16_f32 v65, v78, v79
    v_cvt_pk_bf16_f32 v66, v80, v81
    v_cvt_pk_bf16_f32 v67, v82, v83
    ds_write_b128 v5, v[64:67] offset:16384
    s_waitcnt lgkmcnt(0)
    s_barrier
    ds_read_b128 v[84:87], v1 offset:16384
    ds_read_b128 v[88:91], v1 offset:17408
    ds_read_b128 v[92:95], v1 offset:18432
    ds_read_b128 v[96:99], v1 offset:19456
    s_and_b32 s14, s16, 1
    s_lshl_b32 s11, s15, 1
    s_add_u32 s14, s14, s11
    s_mul_i32 s14, s14, 401408
    s_add_u32 s14, s14, 0x3560000
    s_mul_i32 s11, s9, 28672
    s_add_u32 s11, s11, s14
    s_mul_i32 s12, s10, 7168
    s_add_u32 s11, s11, s12
    s_add_u32 s12, s11, 4096
    s_lshr_b32 s24, s10, 1
    s_mul_i32 s24, s24, 200704
    s_add_u32 s24, s24, s14
    s_lshl_b32 s25, s9, 11
    s_add_u32 s24, s24, s25
    s_and_b32 s13, s10, 1
    s_lshl_b32 s13, s13, 10
    s_add_u32 s24, s24, s13
    s_add_u32 s25, s24, 28672
    s_add_u32 s26, s24, 57344
    s_add_u32 s27, s24, 86016
    s_add_u32 s28, s24, 114688
    s_add_u32 s29, s24, 143360
    s_add_u32 s30, s24, 172032
    s_waitcnt lgkmcnt(0)
    v_mfma_f32_16x16x32_bf16 v[100:103], a[112:115], v[84:87], 0
    v_mfma_f32_16x16x32_bf16 v[100:103], a[116:119], v[88:91], v[100:103]
    v_mfma_f32_16x16x32_bf16 v[100:103], a[120:123], v[92:95], v[100:103]
    v_mfma_f32_16x16x32_bf16 v[100:103], a[124:127], v[96:99], v[100:103]
    v_mfma_f32_16x16x32_bf16 v[104:107], a[128:131], v[84:87], 0
    v_mfma_f32_16x16x32_bf16 v[104:107], a[132:135], v[88:91], v[104:107]
    v_mfma_f32_16x16x32_bf16 v[104:107], a[136:139], v[92:95], v[104:107]
    v_min_u32 v100, -2, v100
    v_min_u32 v101, -2, v101
    v_mfma_f32_16x16x32_bf16 v[104:107], a[140:143], v[96:99], v[104:107]
    v_min_u32 v102, -2, v102
    v_min_u32 v103, -2, v103
    v_mfma_f32_16x16x32_bf16 v[108:111], a[144:147], v[84:87], 0
    buffer_store_dwordx4 v[100:103], v1, s[4:7], s11 offen offset:0 sc1
    v_mfma_f32_16x16x32_bf16 v[108:111], a[148:151], v[88:91], v[108:111]
    v_mfma_f32_16x16x32_bf16 v[108:111], a[152:155], v[92:95], v[108:111]
    v_min_u32 v104, -2, v104
    v_min_u32 v105, -2, v105
    v_mfma_f32_16x16x32_bf16 v[108:111], a[156:159], v[96:99], v[108:111]
    v_min_u32 v106, -2, v106
    v_min_u32 v107, -2, v107
    v_mfma_f32_16x16x32_bf16 v[112:115], a[160:163], v[84:87], 0
    buffer_store_dwordx4 v[104:107], v1, s[4:7], s11 offen offset:1024 sc1
    v_mfma_f32_16x16x32_bf16 v[112:115], a[164:167], v[88:91], v[112:115]
    v_mfma_f32_16x16x32_bf16 v[112:115], a[168:171], v[92:95], v[112:115]
    v_min_u32 v108, -2, v108
    v_min_u32 v109, -2, v109
    v_mfma_f32_16x16x32_bf16 v[112:115], a[172:175], v[96:99], v[112:115]
    v_min_u32 v110, -2, v110
    v_min_u32 v111, -2, v111
    v_mfma_f32_16x16x32_bf16 v[116:119], a[176:179], v[84:87], 0
    buffer_store_dwordx4 v[108:111], v1, s[4:7], s11 offen offset:2048 sc1
    v_mfma_f32_16x16x32_bf16 v[116:119], a[180:183], v[88:91], v[116:119]
    v_mfma_f32_16x16x32_bf16 v[116:119], a[184:187], v[92:95], v[116:119]
    v_min_u32 v112, -2, v112
    v_min_u32 v113, -2, v113
    v_mfma_f32_16x16x32_bf16 v[116:119], a[188:191], v[96:99], v[116:119]
    v_min_u32 v114, -2, v114
    v_min_u32 v115, -2, v115
    v_mfma_f32_16x16x32_bf16 v[120:123], a[192:195], v[84:87], 0
    buffer_store_dwordx4 v[112:115], v1, s[4:7], s11 offen offset:3072 sc1
    v_mfma_f32_16x16x32_bf16 v[120:123], a[196:199], v[88:91], v[120:123]
    v_mfma_f32_16x16x32_bf16 v[120:123], a[200:203], v[92:95], v[120:123]
    v_min_u32 v116, -2, v116
    v_min_u32 v117, -2, v117
    v_mfma_f32_16x16x32_bf16 v[120:123], a[204:207], v[96:99], v[120:123]
    v_min_u32 v118, -2, v118
    v_min_u32 v119, -2, v119
    v_mfma_f32_16x16x32_bf16 v[124:127], a[208:211], v[84:87], 0
    buffer_store_dwordx4 v[116:119], v1, s[4:7], s12 offen offset:0 sc1
    v_mfma_f32_16x16x32_bf16 v[124:127], a[212:215], v[88:91], v[124:127]
    v_mfma_f32_16x16x32_bf16 v[124:127], a[216:219], v[92:95], v[124:127]
    v_min_u32 v120, -2, v120
    v_min_u32 v121, -2, v121
    v_mfma_f32_16x16x32_bf16 v[124:127], a[220:223], v[96:99], v[124:127]
    v_min_u32 v122, -2, v122
    v_min_u32 v123, -2, v123
    s_nop 4
    buffer_store_dwordx4 v[120:123], v1, s[4:7], s12 offen offset:1024 sc1
    v_min_u32 v124, -2, v124
    v_min_u32 v125, -2, v125
    v_min_u32 v126, -2, v126
    v_min_u32 v127, -2, v127
    buffer_store_dwordx4 v[124:127], v1, s[4:7], s12 offen offset:2048 sc1
    s_mov_b32 s12, s13
    s_mov_b32 s22, 0
spin_688:
    buffer_load_dwordx4 v[128:131], v1, s[4:7], s24 offen sc1
    buffer_load_dwordx4 v[132:135], v1, s[4:7], s25 offen sc1
    buffer_load_dwordx4 v[136:139], v1, s[4:7], s26 offen sc1
    buffer_load_dwordx4 v[140:143], v1, s[4:7], s27 offen sc1
    buffer_load_dwordx4 v[144:147], v1, s[4:7], s28 offen sc1
    buffer_load_dwordx4 v[148:151], v1, s[4:7], s29 offen sc1
    buffer_load_dwordx4 v[152:155], v1, s[4:7], s30 offen sc1
    s_waitcnt vmcnt(0)
spin2_690:
    v_max3_u32 v5, v128, v129, v130
    v_max3_u32 v5, v5, v131, v132
    v_max3_u32 v5, v5, v133, v134
    v_max3_u32 v5, v5, v135, v136
    v_max3_u32 v5, v5, v137, v138
    v_max3_u32 v5, v5, v139, v140
    v_max3_u32 v5, v5, v141, v142
    v_max3_u32 v5, v5, v143, v144
    v_max3_u32 v5, v5, v145, v146
    v_max3_u32 v5, v5, v147, v148
    v_max3_u32 v5, v5, v149, v150
    v_max3_u32 v5, v5, v151, v152
    v_max3_u32 v5, v5, v153, v154
    v_max_u32 v5, v5, v155
    v_cmp_eq_u32 vcc, -1, v5
    s_cbranch_vccz spok_689
    s_add_u32 s22, s22, 1
    s_cmp_gt_u32 s22, 65536
    s_cbranch_scc1 M_exit
    s_sleep 1
    s_branch spin_688
spok_689:
    v_add_u32 v5, s12, v1
    v_pk_add_f32 v[100:101], v[128:129], v[132:133]
    v_pk_add_f32 v[102:103], v[130:131], v[134:135]
    v_pk_add_f32 v[100:101], v[100:101], v[136:137]
    v_pk_add_f32 v[102:103], v[102:103], v[138:139]
    v_pk_add_f32 v[100:101], v[100:101], v[140:141]
    v_pk_add_f32 v[102:103], v[102:103], v[142:143]
    v_pk_add_f32 v[100:101], v[100:101], v[144:145]
    v_pk_add_f32 v[102:103], v[102:103], v[146:147]
    v_pk_add_f32 v[100:101], v[100:101], v[148:149]
    v_pk_add_f32 v[102:103], v[102:103], v[150:151]
    v_pk_add_f32 v[100:101], v[100:101], v[152:153]
    v_pk_add_f32 v[102:103], v[102:103], v[154:155]
    s_cmp_lt_u32 s10, 2
    s_cbranch_scc1 f_lo_691
    ds_write_b128 v5, v[100:103] offset:20480
    s_waitcnt lgkmcnt(0)
    s_barrier
    s_branch f_fin_692
f_lo_691:
    s_barrier
    ds_read_b128 v[104:107], v5 offset:20480
    s_mul_i32 s11, s17, 14336
    s_waitcnt lgkmcnt(0)
    v_add_f32 v100, v100, v104
    v_add_f32 v101, v101, v105
    v_add_f32 v102, v102, v106
    v_add_f32 v103, v103, v107
    v_cvt_pk_bf16_f32 v104, v100, v101
    v_lshlrev_b32 v105, 16, v104
    v_and_b32 v106, 0xffff0000, v104
    v_lshlrev_b32 v107, 16, v14
    v_and_b32 v108, 0xffff0000, v14
    v_add_f32 v105, v105, v107
    v_add_f32 v106, v106, v108
    v_cvt_pk_bf16_f32 v110, v105, v106
    v_cvt_pk_bf16_f32 v104, v102, v103
    v_lshlrev_b32 v105, 16, v104
    v_and_b32 v106, 0xffff0000, v104
    v_lshlrev_b32 v107, 16, v15
    v_and_b32 v108, 0xffff0000, v15
    v_add_f32 v105, v105, v107
    v_add_f32 v106, v106, v108
    v_cvt_pk_bf16_f32 v111, v105, v106
    buffer_store_dwordx2 v[110:111], v6, s[76:79], s11 offen
f_fin_692:
    s_cmp_ge_u32 s17, 116
    s_cbranch_scc1 f_nopoi_693
    buffer_store_dwordx4 v[156:159], v1, s[4:7], s24 offen sc1
    buffer_store_dwordx4 v[156:159], v1, s[4:7], s25 offen sc1
    buffer_store_dwordx4 v[156:159], v1, s[4:7], s26 offen sc1
    buffer_store_dwordx4 v[156:159], v1, s[4:7], s27 offen sc1
    buffer_store_dwordx4 v[156:159], v1, s[4:7], s28 offen sc1
    buffer_store_dwordx4 v[156:159], v1, s[4:7], s29 offen sc1
    buffer_store_dwordx4 v[156:159], v1, s[4:7], s30 offen sc1
f_nopoi_693:
    s_add_u32 s16, s16, 1
    s_add_u32 s17, s17, 6
    s_cmp_lt_u32 s17, 128
    s_cbranch_scc1 f_loop_684
    s_branch M_exit
M_exit:
M_exit2:
M_end:
    s_endpgm
.section .rodata,"a"
.p2align 6
.amdhsa_kernel sequential_preLN__memory_aug_recurrent_mem_tr__dense_activation_relu__prompt_kernel
  .amdhsa_next_free_vgpr 512
  .amdhsa_next_free_sgpr 102
  .amdhsa_accum_offset 256
  .amdhsa_group_segment_fixed_size 0
  .amdhsa_kernarg_size 104
  .amdhsa_user_sgpr_count 2
  .amdhsa_user_sgpr_kernarg_segment_ptr 1
  .amdhsa_system_sgpr_workgroup_id_x 1
.end_amdhsa_kernel
```
